```python
import torch

def _softmax(x, axis=-1):
    return torch.softmax(x, dim=axis)
def _gelu(x):
    return torch.nn.functional.gelu(x, approximate="tanh")
def _silu(x):
    return torch.nn.functional.silu(x)
def _sigmoid(x):
    return torch.sigmoid(x)
def _layernorm(x, axis=-1, eps=1e-5):
    m = x.mean(dim=axis, keepdim=True)
    v = x.var(dim=axis, keepdim=True, unbiased=False)
    return (x - m) / torch.sqrt(v + eps)
def _scatter_add(tgt, idx, src, axis=0):
    return tgt.clone().index_add_(axis, idx, src)
def _segment_sum(src, seg, n):
    out = torch.zeros((n,) + src.shape[1:], dtype=src.dtype)
    return out.index_add_(0, seg, src)
def _pad(x, pw):
    flat = tuple(v for pair in reversed(pw) for v in pair)
    return torch.nn.functional.pad(x, flat)

kernel_name = 'recurrent_scan__spectral_gfnet__dense_activation_gelu__prompt'

def setup_inputs():

    _w = (lambda a: (lambda t: t.to(torch.bfloat16) if t.is_floating_point() else t)(torch.as_tensor(a)))
    def _A_setup():
        B, S, D = 1, 2048, 576
        Df = D // 2 + 1
        return {
            "x": _w((lambda *s: torch.randn(*s, dtype=torch.bfloat16) * 0.05)(B, S, D)),
            "w_r": _w((lambda *s: torch.randn(*s, dtype=torch.bfloat16) * 3.2)(S, Df) * 0.02),
            "w_i": _w((lambda *s: torch.randn(*s, dtype=torch.bfloat16) * 3.2)(S, Df) * 0.02),
        }
    _A_in = _A_setup()

    def _B_setup():
        B, S, D, F = 1, 2048, 576, 4608
        return {
            "x": _w((lambda *s: torch.randn(*s, dtype=torch.bfloat16) * 0.05)(B, S, D)),
            "w1": _w((lambda *s: torch.randn(*s, dtype=torch.bfloat16) * 3.2)(D, F) * (D ** -0.5)),
            "b1": _w((lambda *s: torch.randn(*s, dtype=torch.bfloat16) * 3.2)(F) * 0.01),
            "w2": _w((lambda *s: torch.randn(*s, dtype=torch.bfloat16) * 0.4)(F, D) * (F ** -0.5)),
            "b2": _w((lambda *s: torch.randn(*s, dtype=torch.bfloat16) * 0.4)(D) * 0.01),
        }
    _B_in = _B_setup()

    return {
        "A_x": _A_in["x"],
        "A_w_r": _A_in["w_r"],
        "A_w_i": _A_in["w_i"],
        "B_x": _B_in["x"],
        "B_w1": _B_in["w1"],
        "B_b1": _B_in["b1"],
        "B_w2": _B_in["w2"],
        "B_b2": _B_in["b2"],
    }

def reference(A_x, A_w_r, A_w_i, B_x, B_w1, B_b1, B_w2, B_b2):
    def _A_ref(x, w_r, w_i):
        B, S, D = x.shape
        X = (lambda x, axes=(-2,-1): torch.fft.rfft2(x.float(), dim=axes))(x, axes=(-2, -1))
        W = w_r + 1j * w_i
        X = X * W
        y = (lambda x, s, axes=(-2,-1): torch.fft.irfft2(x, s=s, dim=axes).to(torch.bfloat16))(X, (S, D), axes=(-2, -1))
        return y

    def _B_ref(x, w1, b1, w2, b2):
        h = torch.einsum("bsd,df->bsf", x, w1) + b1
        h = _gelu(h)
        return torch.einsum("bsf,fd->bsd", h, w2) + b2

    x = A_x
    xn = _layernorm(x, axis=-1)
    s = _A_ref(xn, A_w_r, A_w_i)
    g = _silu(_B_ref(xn, B_w1, B_b1, B_w2, B_b2))
    return x + s * g
```

```asm
; @launch grid=(256,1,1) block=(256,1,1) lds=163840
.amdgcn_target "amdgcn-amd-amdhsa--gfx950"
.text
.set CODE_LINES, 26
.globl recurrent_scan__spectral_gfnet__dense_activation_gelu__prompt_kernel
.p2align 8
.type recurrent_scan__spectral_gfnet__dense_activation_gelu__prompt_kernel,@function
recurrent_scan__spectral_gfnet__dense_activation_gelu__prompt_kernel:
 s_cmpk_ge_u32 s2, 256
 s_cbranch_scc1 L_end
 s_load_dwordx16 s[44:59], s[0:1], 0
 s_load_dwordx4 s[60:63], s[0:1], 64
 s_load_dwordx2 s[64:65], s[0:1], 80
 s_memrealtime s[66:67]
 s_getpc_b64 s[100:101]
L_pcref:
 s_lshr_b32 s97, s2, 3
 s_mul_i32 s97, s97, CODE_LINES*128
 v_lshlrev_b32 v250, 7, v0
 v_add_u32 v250, s97, v250
 v_min_u32 v250, L_codeend-L_pcref-4, v250
 v_mov_b32 v251, 0
 v_lshl_add_u64 v[250:251], s[100:101], 0, v[250:251]
 v_cmp_gt_u32 vcc, CODE_LINES, v0
 s_and_saveexec_b64 s[98:99], vcc
 s_cbranch_execz L_noct
 global_load_dword a255, v[250:251], off
L_noct:
 s_mov_b64 exec, -1
 s_and_b32 s96, s2, 7
 s_lshr_b32 s97, s2, 3
 s_and_b32 s42, s96, 3
 s_mul_i32 s42, s42, 4
 s_and_b32 s98, s97, 3
 s_add_u32 s42, s42, s98
 s_lshr_b32 s41, s96, 2
 s_mul_i32 s41, s41, 8
 s_lshr_b32 s98, s97, 2
 s_add_u32 s41, s41, s98
 v_lshrrev_b32 v1, 6, v0
 v_and_b32 v2, 63, v0
 v_mov_b32 v254, v0
 v_readfirstlane_b32 s40, v1
 v_lshlrev_b32 v0, 4, v2
 v_lshrrev_b32 v1, 3, v2
 v_and_b32 v3, 7, v2
 v_lshrrev_b32 v4, 1, v1
 v_xor_b32 v3, v3, v4
 s_mov_b32 s96, 73728
 v_mul_lo_u32 v1, v1, s96
 v_lshl_add_u32 v144, v3, 4, v1
 v_xor_b32 v145, 64, v144
 v_add_u32 v145, 588800, v145
 v_add_u32 v146, 1179648, v144
 v_add_u32 v147, 1179648, v145
 s_lshl_b32 s43, s41, 2
 s_add_u32 s43, s43, s40
 s_mul_i32 s96, s41, 1
 s_lshr_b32 s97, s42, 1
 s_mul_i32 s97, s97, 1
 s_add_u32 s96, s96, s97
 s_mul_i32 s97, s96, 7282
 s_lshr_b32 s97, s97, 16
 s_mul_i32 s97, s97, 9
 s_sub_u32 s96, s96, s97
 s_mul_i32 s3, s43, 1152
 s_lshl_b32 s99, s40, 11
 s_getpc_b64 s[100:101]
 s_add_u32 s100, s100, tabF@rel32@lo+4
 s_addc_u32 s101, s101, tabF@rel32@hi+12
 s_mov_b32 s6, 2359296
 s_mov_b32 s7, 0x20000
 s_lshl_b32 s68, s96, 7
 s_add_u32 s68, s68, s3
 s_mov_b32 m0, s99
 v_bfe_u32 v1, v2, 3, 2
 v_lshrrev_b32 v3, 5, v2
 v_and_b32 v5, 2, v1
 v_lshlrev_b32 v5, 1, v5
 v_and_b32 v7, 7, v2
 v_xor_b32 v7, v7, v5
 v_lshlrev_b32 v7, 4, v7
 v_lshl_add_u32 v1, v3, 3, v1
 s_lshr_b32 s70, s40, 1
 s_lshl_b32 s70, s70, 5
 s_and_b32 s71, s40, 1
 s_add_u32 s70, s70, s71
 v_lshlrev_b32 v3, 1, v1
 v_add_u32 v3, s70, v3
 v_mul_u32_u24 v3, 9216, v3
 v_add_u32 v4, v3, v7
 v_add_u32 v5, 72704, v4
 s_lshl_b32 s70, s40, 4
 v_add_u32 v1, s70, v1
 v_mul_u32_u24 v1, 1152, v1
 v_add_u32 v6, v1, v7
 v_add_u32 v7, 3584, v6
 v_lshrrev_b32 v1, 5, v2
 v_lshlrev_b32 v246, 4, v1
 v_add_u32 v246, 147456, v246
 v_bfe_u32 v3, v2, 2, 2
 v_lshl_add_u32 v1, v1, 3, v3
 v_lshlrev_b32 v1, 7, v1
 v_and_b32 v3, 2, v3
 v_lshl_add_u32 v1, v3, 5, v1
 v_bfe_u32 v3, v2, 4, 1
 v_lshl_add_u32 v1, v3, 5, v1
 v_and_b32 v3, 3, v2
 v_lshl_add_u32 v240, v3, 3, v1
 v_xor_b32 v241, 64, v240
 v_add_u32 v242, 49152, v240
 v_add_u32 v243, 49152, v241
 v_add_u32 v244, 98304, v240
 v_add_u32 v245, 98304, v241
 v_and_b32 v1, 15, v2
 v_lshlrev_b32 v1, 7, v1
 v_bfe_u32 v3, v2, 4, 1
 v_lshl_add_u32 v1, v3, 13, v1
 v_add_u32 v1, s99, v1
 v_lshrrev_b32 v3, 5, v2
 v_bfe_u32 v224, v2, 1, 3
 v_xor_b32 v3, v3, v224
 v_lshl_add_u32 v224, v3, 4, v1
 v_xor_b32 v225, 32, v224
 v_xor_b32 v226, 64, v224
 v_xor_b32 v227, 96, v224
 s_mov_b32 s69, 0x3f803f80
 v_mov_b32 v216, 0
 v_mov_b32 v217, 0
 v_mov_b32 v218, 0
 v_mov_b32 v219, 0
 v_mov_b32 v220, 0
 v_mov_b32 v221, 0
 v_mov_b32 v222, 0
 v_mov_b32 v223, 0
 s_lshl_b32 s97, s41, 2
 s_lshr_b32 s70, s42, 2
 s_add_u32 s97, s97, s70
 s_mul_i32 s97, s97, 1152
 s_and_b32 s70, s42, 3
 s_min_u32 s70, s70, 2
 s_mul_i32 s71, s40, 3
 s_add_u32 s70, s70, s71
 s_min_u32 s70, s70, 8
 s_lshl_b32 s71, s70, 6
 s_add_u32 s97, s97, s71
 v_lshrrev_b32 v152, 2, v2
 v_mul_u32_u24 v152, 4608, v152
 v_lshrrev_b32 v153, 4, v2
 v_xor_b32 v153, v153, v2
 v_and_b32 v153, 3, v153
 v_add_lshl_u32 v152, v152, v153, 4
 s_bitcmp1_b32 0xf, s70
 s_cselect_b32 s70, 576, 0
 s_cselect_b32 s71, 0, 576
 s_add_u32 s70, s70, s97
 s_add_u32 s71, s71, s97
 v_add_u32 v154, s71, v152
 v_add_u32 v152, s70, v152
 v_add_u32 v153, 1179648, v152
 v_add_u32 v155, 1179648, v154
 s_waitcnt lgkmcnt(0)
 s_mov_b32 s4, s44
 s_and_b32 s5, s45, 0xffff
 s_lshr_b32 s97, s42, 1
 s_add_u32 s98, s97, s41
 s_and_b32 s98, s98, 7
 s_bitcmp1_b32 s42, 0
 s_cselect_b32 s98, s98, 0
 s_cmp_lt_u32 s98, 5
 s_cbranch_scc1 L_nowt
 s_sub_u32 s98, s98, 5
 s_lshl_b32 s70, s98, 6
 s_add_u32 s70, s70, s43
 s_lshl_b32 s98, s98, 2
 s_add_u32 s98, s98, s40
 s_mul_i32 s98, s98, 442368
 s_mul_i32 s97, s97, 1152
 s_add_u32 s98, s98, s97
 v_mul_u32_u24 v3, 9216, v2
 v_add_u32 v3, s98, v3
 s_mul_i32 s70, s70, 1920
 v_lshlrev_b32 v250, 7, v2
 v_add_u32 v250, s70, v250
 v_mov_b32 v251, 0
 v_lshl_add_u64 v[250:251], s[100:101], 0, v[250:251]
 v_lshlrev_b32 v1, 21, v2
 s_bfm_b64 exec, 48, 0
 global_load_dword a255, v3, s[52:53]
 s_bfm_b64 exec, 15, 0
 global_load_dword a255, v[250:251], off
 s_mov_b64 exec, 7
 global_load_dword a255, v1, s[56:57]
 s_mov_b64 exec, 1
 global_load_dword a255, v1, s[54:55] offset:128
 global_load_dword a255, v1, s[58:59] offset:128
 global_load_dword a255, v1, s[46:47] offset:128
 global_load_dword a255, v1, s[48:49] offset:128
 global_load_dword a255, v1, s[62:63] offset:128
 s_mov_b64 exec, -1
L_nowt:
 buffer_load_dwordx4 v144, s[4:7], s68 offen offset:0 lds
 buffer_load_dwordx4 v145, s[4:7], s68 offen offset:1024 lds
 s_add_u32 m0, s99, 8192
 s_nop 0
 buffer_load_dwordx4 v146, s[4:7], s68 offen offset:0 lds
 buffer_load_dwordx4 v147, s[4:7], s68 offen offset:1024 lds
 s_add_u32 s97, s96, 1
 s_cmp_eq_u32 s97, 9
 s_cselect_b32 s97, 0, s97
 s_lshl_b32 s68, s97, 7
 s_add_u32 s68, s68, s3
 s_add_u32 m0, s99, 16384
 s_nop 0
 buffer_load_dwordx4 v144, s[4:7], s68 offen offset:0 lds
 buffer_load_dwordx4 v145, s[4:7], s68 offen offset:1024 lds
 s_add_u32 m0, s99, 24576
 s_nop 0
 buffer_load_dwordx4 v146, s[4:7], s68 offen offset:0 lds
 buffer_load_dwordx4 v147, s[4:7], s68 offen offset:1024 lds
 s_mov_b32 s36, s62
 s_and_b32 s37, s63, 0xffff
 s_mov_b32 s38, 256
 s_mov_b32 s39, 0x00020000
 s_mov_b32 s16, s64
 s_and_b32 s17, s65, 0xffff
 s_mov_b32 s18, 45494272
 s_mov_b32 s19, 0x00020000
 s_mov_b32 s20, s46
 s_and_b32 s21, s47, 0xffff
 s_mov_b32 s22, 1183744
 s_mov_b32 s23, 0x00020000
 s_mov_b32 s24, s48
 s_and_b32 s25, s49, 0xffff
 s_mov_b32 s26, 1183744
 s_mov_b32 s27, 0x00020000
 s_mov_b32 s8, s52
 s_and_b32 s9, s53, 0xffff
 s_mov_b32 s10, 5308416
 s_mov_b32 s11, 0x00020000
 s_mov_b32 s32, s54
 s_and_b32 s33, s55, 0xffff
 s_mov_b32 s34, 9216
 s_mov_b32 s35, 0x00020000
 s_mov_b32 s12, s56
 s_and_b32 s13, s57, 0xffff
 s_mov_b32 s14, 5308416
 s_mov_b32 s15, 0x00020000
 s_mov_b32 s28, s60
 s_and_b32 s29, s61, 0xffff
 s_mov_b32 s30, 2359296
 s_mov_b32 s31, 0x00020000
 s_mov_b64 s[0:1], s[58:59]
 s_mov_b32 s64, s99
 s_mov_b32 s55, s96
 s_add_u32 s96, s96, 1
 s_cmp_eq_u32 s96, 9
 s_cselect_b32 s96, 0, s96
 s_mov_b32 s56, s96
 s_add_u32 s96, s96, 1
 s_cmp_eq_u32 s96, 9
 s_cselect_b32 s96, 0, s96
 s_mov_b32 s57, s96
 s_lshl_b32 s68, s57, 7
 s_add_u32 s68, s68, s3
 s_add_u32 m0, s64, 32768
 s_nop 0
 buffer_load_dwordx4 v144, s[4:7], s68 offen offset:0 lds
 buffer_load_dwordx4 v145, s[4:7], s68 offen offset:1024 lds
 s_add_u32 m0, s64, 40960
 s_nop 0
 buffer_load_dwordx4 v146, s[4:7], s68 offen offset:0 lds
 buffer_load_dwordx4 v147, s[4:7], s68 offen offset:1024 lds
 s_add_u32 s96, s96, 1
 s_cmp_eq_u32 s96, 9
 s_cselect_b32 s96, 0, s96
 s_mov_b32 s58, s96
 s_add_u32 s96, s96, 1
 s_cmp_eq_u32 s96, 9
 s_cselect_b32 s96, 0, s96
 s_mov_b32 s59, s96
 s_add_u32 s96, s96, 1
 s_cmp_eq_u32 s96, 9
 s_cselect_b32 s96, 0, s96
 s_mov_b32 s60, s96
 s_add_u32 s96, s96, 1
 s_cmp_eq_u32 s96, 9
 s_cselect_b32 s96, 0, s96
 s_mov_b32 s61, s96
 s_add_u32 s96, s96, 1
 s_cmp_eq_u32 s96, 9
 s_cselect_b32 s96, 0, s96
 s_mov_b32 s62, s96
 s_add_u32 s96, s96, 1
 s_cmp_eq_u32 s96, 9
 s_cselect_b32 s96, 0, s96
 s_mov_b32 s63, s96
 s_or_b32 s66, s66, 1
 s_add_u32 s97, s2, s40
 s_cmp_lg_u32 s97, 0
 s_cbranch_scc1 L_nonon
 v_mov_b32 v1, s66
 s_mov_b64 exec, 1
 buffer_store_dword v1, off, s[36:39], 0 sc1
 s_mov_b64 exec, -1
L_nonon:
 s_lshr_b32 s96, s42, 1
 s_mul_i32 s45, s41, 1
 s_add_u32 s45, s45, s96
 s_and_b32 s45, s45, 7
 s_and_b32 s44, s42, 1
 s_cmp_lt_u32 s45, 5
 s_cselect_b32 s97, s44, 0
 s_lshl_b32 s97, s97, 1
 s_xor_b32 s98, s44, 1
 s_cmp_lt_u32 s45, 6
 s_cselect_b32 s98, s98, 0
 s_cmp_lt_u32 s40, 3
 s_cselect_b32 s99, 12, 4
 s_mul_i32 s98, s98, s99
 s_cselect_b32 s99, 48, 16
 s_or_b32 s97, s97, s98
 s_and_b32 s98, s42, 3
 s_cmp_lg_u32 s98, 2
 s_cselect_b32 s99, s99, 0
 s_or_b32 s97, s97, s99
 s_lshl_b32 s98, s44, 8
 s_or_b32 s44, s44, s97
 s_lshl_b32 s97, s45, 8
 s_or_b32 s44, s44, s97
 s_mul_i32 s97, s96, 576
 s_add_u32 s97, s97, s98
 v_add_u32 v1, s97, v254
 v_lshlrev_b32 v1, 1, v1
 v_mov_b32 v239, v1
 v_lshlrev_b32 v235, 2, v254
 v_lshlrev_b32 v198, 2, v254
 v_add_u32 v198, 147456, v198
 s_mul_i32 s65, s43, 288
 s_lshr_b32 s98, s97, 4
 s_add_u32 s65, s65, s98
 s_lshl_b32 s65, s65, 10
 s_lshl_b32 s97, s97, 1
 s_mul_i32 s46, s55, 589824
 s_add_u32 s46, s46, s97
 s_mul_i32 s47, s56, 589824
 s_add_u32 s47, s47, s97
 s_mul_i32 s48, s57, 589824
 s_add_u32 s48, s48, s97
 s_mul_i32 s49, s58, 589824
 s_add_u32 s49, s49, s97
 s_mul_i32 s50, s59, 589824
 s_add_u32 s50, s50, s97
 s_mul_i32 s51, s60, 589824
 s_add_u32 s51, s51, s97
 s_mul_i32 s52, s61, 589824
 s_add_u32 s52, s52, s97
 s_mul_i32 s53, s62, 589824
 s_add_u32 s53, s53, s97
 s_mul_i32 s54, s63, 589824
 s_add_u32 s54, s54, s97
 s_mul_i32 s66, s45, 73728
 v_add_u32 v252, s64, v0
 v_mov_b32 v253, 0
 v_lshl_add_u64 v[252:253], s[100:101], 0, v[252:253]
 s_mov_b32 s97, 0
 s_lshl_b32 s67, s43, 4
 s_add_u32 s67, s67, s42
 s_lshl_b32 s67, s67, 7
 s_add_u32 s67, s67, 42467328
 s_mov_b32 s71, 100000
 s_mov_b32 s70, 0x44e944e9
 v_mov_b32 v247, 0x37803780
 s_nop 0
 s_bfe_u32 s96, s44, 0x30008
 s_cmp_ge_u32 s96, 3
 s_cselect_b32 s98, 1, 0
 s_lshl_b32 s99, s41, 1
 s_add_u32 s99, s99, s98
 s_mul_i32 s98, s98, 3
 s_sub_u32 s96, s96, s98
 s_mul_i32 s96, s96, 3
 s_add_u32 s98, s96, s40
 s_cmp_eq_u32 s98, 4
 s_cselect_b32 s45, 64, 0
 s_bitcmp1_b32 s44, 3
 s_cselect_b32 s45, s45, 0
 s_or_b32 s44, s44, s45
 s_cmp_lt_u32 s98, 5
 s_cselect_b32 s45, 2, 0
 s_lshl_b32 s98, s98, 6
 s_add_u32 s45, s45, s98
 s_mul_i32 s99, s99, 578
 s_add_u32 s45, s45, s99
 v_lshrrev_b32 v3, 2, v2
 v_mul_u32_u24 v3, 18496, v3
 v_and_b32 v1, 3, v2
 v_lshl_add_u32 v3, v1, 4, v3
 s_lshr_b32 s98, s2, 3
 s_lshl_b32 s98, s98, 2
 s_add_u32 s98, s98, s40
 s_lshr_b32 s99, s98, 1
 s_mul_i32 s99, s99, 82944
 s_and_b32 s98, s98, 1
 s_mul_i32 s98, s98, 1152
 s_add_u32 s99, s99, s98
 s_and_b32 s98, s42, 12
 s_mul_i32 s98, s98, 576
 s_add_u32 s99, s99, s98
 v_mul_u32_u24 v1, 43, v2
 v_lshrrev_b32 v1, 8, v1
 v_mul_u32_u24 v250, 6, v1
 v_sub_u32 v250, v2, v250
 v_add_u32 v251, 1, v250
 v_lshrrev_b32 v251, 2, v251
 v_add3_u32 v250, v250, v251, 2
 v_mul_u32_u24 v1, 9216, v1
 v_lshl_add_u32 v1, v250, 7, v1
 v_add_u32 v250, s99, v1
 s_bitcmp1_b32 s44, 1
 s_cbranch_scc0 ON_1
 v_and_b32 v160, 31, v2
 v_lshrrev_b32 v161, 5, v2
 v_lshlrev_b32 v161, 8, v161
 v_add_u32 v161, s43, v161
 v_mul_u32_u24 v161, v161, v160
 v_lshlrev_b32 v160, 6, v160
 v_mad_u32_u24 v162, v160, 0, v161
 v_mad_u32_u24 v163, v160, 1, v161
 v_and_b32 v162, 0x7ff, v162
 v_and_b32 v163, 0x7ff, v163
 v_cvt_f32_u32 v162, v162
 v_cvt_f32_u32 v163, v163
 v_mul_f32 v162, 0x3a000000, v162
 v_mul_f32 v163, 0x3a000000, v163
 v_cos_f32 v164, v162
 v_cos_f32 v165, v163
 v_sin_f32 v162, v162
 v_sin_f32 v163, v163
 v_cvt_pk_bf16_f32 v164, v164, v165
 v_cvt_pk_bf16_f32 v162, v162, v163
 v_accvgpr_write_b32 a176, v164
 v_xor_b32 v163, 0x80008000, v162
 v_accvgpr_write_b32 a184, v162
 v_accvgpr_write_b32 a192, v163
 v_mad_u32_u24 v162, v160, 2, v161
 v_mad_u32_u24 v163, v160, 3, v161
 v_and_b32 v162, 0x7ff, v162
 v_and_b32 v163, 0x7ff, v163
 v_cvt_f32_u32 v162, v162
 v_cvt_f32_u32 v163, v163
 v_mul_f32 v162, 0x3a000000, v162
 v_mul_f32 v163, 0x3a000000, v163
 v_cos_f32 v164, v162
 v_cos_f32 v165, v163
 v_sin_f32 v162, v162
 v_sin_f32 v163, v163
 v_cvt_pk_bf16_f32 v164, v164, v165
 v_cvt_pk_bf16_f32 v162, v162, v163
 v_accvgpr_write_b32 a177, v164
 v_xor_b32 v163, 0x80008000, v162
 v_accvgpr_write_b32 a185, v162
 v_accvgpr_write_b32 a193, v163
 v_mad_u32_u24 v162, v160, 8, v161
 v_mad_u32_u24 v163, v160, 9, v161
 v_and_b32 v162, 0x7ff, v162
 v_and_b32 v163, 0x7ff, v163
 v_cvt_f32_u32 v162, v162
 v_cvt_f32_u32 v163, v163
 v_mul_f32 v162, 0x3a000000, v162
 v_mul_f32 v163, 0x3a000000, v163
 v_cos_f32 v164, v162
 v_cos_f32 v165, v163
 v_sin_f32 v162, v162
 v_sin_f32 v163, v163
 v_cvt_pk_bf16_f32 v164, v164, v165
 v_cvt_pk_bf16_f32 v162, v162, v163
 v_accvgpr_write_b32 a178, v164
 v_xor_b32 v163, 0x80008000, v162
 v_accvgpr_write_b32 a186, v162
 v_accvgpr_write_b32 a194, v163
 v_mad_u32_u24 v162, v160, 10, v161
 v_mad_u32_u24 v163, v160, 11, v161
 v_and_b32 v162, 0x7ff, v162
 v_and_b32 v163, 0x7ff, v163
 v_cvt_f32_u32 v162, v162
 v_cvt_f32_u32 v163, v163
 v_mul_f32 v162, 0x3a000000, v162
 v_mul_f32 v163, 0x3a000000, v163
 v_cos_f32 v164, v162
 v_cos_f32 v165, v163
 v_sin_f32 v162, v162
 v_sin_f32 v163, v163
 v_cvt_pk_bf16_f32 v164, v164, v165
 v_cvt_pk_bf16_f32 v162, v162, v163
 v_accvgpr_write_b32 a179, v164
 v_xor_b32 v163, 0x80008000, v162
 v_accvgpr_write_b32 a187, v162
 v_accvgpr_write_b32 a195, v163
 v_mad_u32_u24 v162, v160, 16, v161
 v_mad_u32_u24 v163, v160, 17, v161
 v_and_b32 v162, 0x7ff, v162
 v_and_b32 v163, 0x7ff, v163
 v_cvt_f32_u32 v162, v162
 v_cvt_f32_u32 v163, v163
 v_mul_f32 v162, 0x3a000000, v162
 v_mul_f32 v163, 0x3a000000, v163
 v_cos_f32 v164, v162
 v_cos_f32 v165, v163
 v_sin_f32 v162, v162
 v_sin_f32 v163, v163
 v_cvt_pk_bf16_f32 v164, v164, v165
 v_cvt_pk_bf16_f32 v162, v162, v163
 v_accvgpr_write_b32 a180, v164
 v_xor_b32 v163, 0x80008000, v162
 v_accvgpr_write_b32 a188, v162
 v_accvgpr_write_b32 a196, v163
 v_mad_u32_u24 v162, v160, 18, v161
 v_mad_u32_u24 v163, v160, 19, v161
 v_and_b32 v162, 0x7ff, v162
 v_and_b32 v163, 0x7ff, v163
 v_cvt_f32_u32 v162, v162
 v_cvt_f32_u32 v163, v163
 v_mul_f32 v162, 0x3a000000, v162
 v_mul_f32 v163, 0x3a000000, v163
 v_cos_f32 v164, v162
 v_cos_f32 v165, v163
 v_sin_f32 v162, v162
 v_sin_f32 v163, v163
 v_cvt_pk_bf16_f32 v164, v164, v165
 v_cvt_pk_bf16_f32 v162, v162, v163
 v_accvgpr_write_b32 a181, v164
 v_xor_b32 v163, 0x80008000, v162
 v_accvgpr_write_b32 a189, v162
 v_accvgpr_write_b32 a197, v163
 v_mad_u32_u24 v162, v160, 24, v161
 v_mad_u32_u24 v163, v160, 25, v161
 v_and_b32 v162, 0x7ff, v162
 v_and_b32 v163, 0x7ff, v163
 v_cvt_f32_u32 v162, v162
 v_cvt_f32_u32 v163, v163
 v_mul_f32 v162, 0x3a000000, v162
 v_mul_f32 v163, 0x3a000000, v163
 v_cos_f32 v164, v162
 v_cos_f32 v165, v163
 v_sin_f32 v162, v162
 v_sin_f32 v163, v163
 v_cvt_pk_bf16_f32 v164, v164, v165
 v_cvt_pk_bf16_f32 v162, v162, v163
 v_accvgpr_write_b32 a182, v164
 v_xor_b32 v163, 0x80008000, v162
 v_accvgpr_write_b32 a190, v162
 v_accvgpr_write_b32 a198, v163
 v_mad_u32_u24 v162, v160, 26, v161
 v_mad_u32_u24 v163, v160, 27, v161
 v_and_b32 v162, 0x7ff, v162
 v_and_b32 v163, 0x7ff, v163
 v_cvt_f32_u32 v162, v162
 v_cvt_f32_u32 v163, v163
 v_mul_f32 v162, 0x3a000000, v162
 v_mul_f32 v163, 0x3a000000, v163
 v_cos_f32 v164, v162
 v_cos_f32 v165, v163
 v_sin_f32 v162, v162
 v_sin_f32 v163, v163
 v_cvt_pk_bf16_f32 v164, v164, v165
 v_cvt_pk_bf16_f32 v162, v162, v163
 v_accvgpr_write_b32 a183, v164
 v_xor_b32 v163, 0x80008000, v162
 v_accvgpr_write_b32 a191, v162
 v_accvgpr_write_b32 a199, v163
ON_1:
 s_bitcmp1_b32 s44, 0
 s_cbranch_scc1 L_wo
 s_mov_b64 exec, 0
 s_cmp_eq_u32 s40, 1
 s_cbranch_scc1 ST1_1
 s_cmp_eq_u32 s40, 2
 s_cbranch_scc1 ST1_2
 s_cmp_eq_u32 s40, 3
 s_cbranch_scc1 ST1_3
 s_branch ST1_0
STB1_0:
 s_mov_b64 exec, -1
 s_branch L_main
L_wo:
 s_mov_b64 exec, 0
 s_cmp_eq_u32 s40, 1
 s_cbranch_scc1 ST2_1
 s_cmp_eq_u32 s40, 2
 s_cbranch_scc1 ST2_2
 s_cmp_eq_u32 s40, 3
 s_cbranch_scc1 ST2_3
 s_branch ST2_0
STB2_0:
 s_mov_b64 exec, -1
 s_branch L_main
 .p2align 12
L_main:
ST1_0:
 s_cbranch_execz STB1_0
ST2_0:
 s_cbranch_execz STB2_0
 s_lshl_b32 s68, s58, 7
 s_add_u32 s68, s68, s3
 s_add_u32 m0, s64, 49152
 s_nop 0
 buffer_load_dwordx4 v144, s[4:7], s68 offen offset:0 lds
 buffer_load_dwordx4 v145, s[4:7], s68 offen offset:1024 lds
 s_add_u32 m0, s64, 57344
 s_nop 0
 buffer_load_dwordx4 v146, s[4:7], s68 offen offset:0 lds
 buffer_load_dwordx4 v147, s[4:7], s68 offen offset:1024 lds
 s_waitcnt vmcnt(12)
 ds_read_b128 v[8:11], v224 offset:0
 ds_read_b128 v[12:15], v225 offset:0
 ds_read_b128 v[16:19], v226 offset:0
 ds_read_b128 v[20:23], v227 offset:0
 s_lshl_b32 s68, s59, 7
 s_add_u32 s68, s68, s3
 s_add_u32 m0, s64, 65536
 s_nop 0
 buffer_load_dwordx4 v144, s[4:7], s68 offen offset:0 lds
 buffer_load_dwordx4 v145, s[4:7], s68 offen offset:1024 lds
 s_add_u32 m0, s64, 73728
 s_nop 0
 buffer_load_dwordx4 v146, s[4:7], s68 offen offset:0 lds
 buffer_load_dwordx4 v147, s[4:7], s68 offen offset:1024 lds
 s_waitcnt vmcnt(12)
 ds_read_b128 v[24:27], v224 offset:16384
 ds_read_b128 v[28:31], v225 offset:16384
 ds_read_b128 v[32:35], v226 offset:16384
 ds_read_b128 v[36:39], v227 offset:16384
 s_lshl_b32 s68, s60, 7
 s_add_u32 s68, s68, s3
 s_add_u32 m0, s64, 81920
 s_nop 0
 buffer_load_dwordx4 v144, s[4:7], s68 offen offset:0 lds
 buffer_load_dwordx4 v145, s[4:7], s68 offen offset:1024 lds
 s_add_u32 m0, s64, 90112
 s_nop 0
 buffer_load_dwordx4 v146, s[4:7], s68 offen offset:0 lds
 buffer_load_dwordx4 v147, s[4:7], s68 offen offset:1024 lds
 s_waitcnt lgkmcnt(7)
 v_dot2c_f32_bf16 v216, s69, v8
 v_dot2c_f32_bf16 v220, v8, v8
 v_dot2c_f32_bf16 v217, s69, v9
 v_dot2c_f32_bf16 v221, v9, v9
 v_dot2c_f32_bf16 v218, s69, v10
 v_dot2c_f32_bf16 v222, v10, v10
 v_dot2c_f32_bf16 v219, s69, v11
 v_dot2c_f32_bf16 v223, v11, v11
 s_waitcnt lgkmcnt(6)
 v_dot2c_f32_bf16 v216, s69, v12
 v_dot2c_f32_bf16 v220, v12, v12
 v_dot2c_f32_bf16 v217, s69, v13
 v_dot2c_f32_bf16 v221, v13, v13
 v_dot2c_f32_bf16 v218, s69, v14
 v_dot2c_f32_bf16 v222, v14, v14
 v_dot2c_f32_bf16 v219, s69, v15
 v_dot2c_f32_bf16 v223, v15, v15
 s_waitcnt lgkmcnt(5)
 v_dot2c_f32_bf16 v216, s69, v16
 v_dot2c_f32_bf16 v220, v16, v16
 v_dot2c_f32_bf16 v217, s69, v17
 v_dot2c_f32_bf16 v221, v17, v17
 v_dot2c_f32_bf16 v218, s69, v18
 v_dot2c_f32_bf16 v222, v18, v18
 v_dot2c_f32_bf16 v219, s69, v19
 v_dot2c_f32_bf16 v223, v19, v19
 s_waitcnt lgkmcnt(4)
 v_dot2c_f32_bf16 v216, s69, v20
 v_dot2c_f32_bf16 v220, v20, v20
 v_dot2c_f32_bf16 v217, s69, v21
 v_dot2c_f32_bf16 v221, v21, v21
 v_dot2c_f32_bf16 v218, s69, v22
 v_dot2c_f32_bf16 v222, v22, v22
 v_dot2c_f32_bf16 v219, s69, v23
 v_dot2c_f32_bf16 v223, v23, v23
 s_bitcmp1_b32 s44, 0
 s_cbranch_scc1 WA_2
 s_mov_b64 exec, 0
 s_cmp_eq_u32 s40, 1
 s_cbranch_scc1 ST1_5
 s_cmp_eq_u32 s40, 2
 s_cbranch_scc1 ST1_6
 s_cmp_eq_u32 s40, 3
 s_cbranch_scc1 ST1_7
 s_branch ST1_4
STB1_1:
 s_mov_b64 exec, -1
 s_branch WB_3
WA_2:
 s_mov_b64 exec, 0
 s_cmp_eq_u32 s40, 1
 s_cbranch_scc1 ST2_5
 s_cmp_eq_u32 s40, 2
 s_cbranch_scc1 ST2_6
 s_cmp_eq_u32 s40, 3
 s_cbranch_scc1 ST2_7
 s_branch ST2_4
STB2_1:
 s_mov_b64 exec, -1
WB_3:
 s_waitcnt vmcnt(12)
 ds_read_b128 v[40:43], v224 offset:32768
 ds_read_b128 v[44:47], v225 offset:32768
 ds_read_b128 v[48:51], v226 offset:32768
 ds_read_b128 v[52:55], v227 offset:32768
 s_lshl_b32 s68, s61, 7
 s_add_u32 s68, s68, s3
 s_add_u32 m0, s64, 98304
 s_nop 0
 buffer_load_dwordx4 v144, s[4:7], s68 offen offset:0 lds
 buffer_load_dwordx4 v145, s[4:7], s68 offen offset:1024 lds
 s_add_u32 m0, s64, 106496
 s_nop 0
 buffer_load_dwordx4 v146, s[4:7], s68 offen offset:0 lds
 buffer_load_dwordx4 v147, s[4:7], s68 offen offset:1024 lds
 s_waitcnt lgkmcnt(7)
 v_dot2c_f32_bf16 v216, s69, v24
 v_dot2c_f32_bf16 v220, v24, v24
 v_dot2c_f32_bf16 v217, s69, v25
 v_dot2c_f32_bf16 v221, v25, v25
 v_dot2c_f32_bf16 v218, s69, v26
 v_dot2c_f32_bf16 v222, v26, v26
 v_dot2c_f32_bf16 v219, s69, v27
 v_dot2c_f32_bf16 v223, v27, v27
 s_waitcnt lgkmcnt(6)
 v_dot2c_f32_bf16 v216, s69, v28
 v_dot2c_f32_bf16 v220, v28, v28
 v_dot2c_f32_bf16 v217, s69, v29
 v_dot2c_f32_bf16 v221, v29, v29
 v_dot2c_f32_bf16 v218, s69, v30
 v_dot2c_f32_bf16 v222, v30, v30
 v_dot2c_f32_bf16 v219, s69, v31
 v_dot2c_f32_bf16 v223, v31, v31
 s_waitcnt lgkmcnt(5)
 v_dot2c_f32_bf16 v216, s69, v32
 v_dot2c_f32_bf16 v220, v32, v32
 v_dot2c_f32_bf16 v217, s69, v33
 v_dot2c_f32_bf16 v221, v33, v33
 v_dot2c_f32_bf16 v218, s69, v34
 v_dot2c_f32_bf16 v222, v34, v34
 v_dot2c_f32_bf16 v219, s69, v35
 v_dot2c_f32_bf16 v223, v35, v35
 s_waitcnt lgkmcnt(4)
 v_dot2c_f32_bf16 v216, s69, v36
 v_dot2c_f32_bf16 v220, v36, v36
 v_dot2c_f32_bf16 v217, s69, v37
 v_dot2c_f32_bf16 v221, v37, v37
 v_dot2c_f32_bf16 v218, s69, v38
 v_dot2c_f32_bf16 v222, v38, v38
 v_dot2c_f32_bf16 v219, s69, v39
 v_dot2c_f32_bf16 v223, v39, v39
 s_waitcnt vmcnt(12)
 ds_read_b128 v[56:59], v224 offset:49152
 ds_read_b128 v[60:63], v225 offset:49152
 ds_read_b128 v[64:67], v226 offset:49152
 ds_read_b128 v[68:71], v227 offset:49152
 s_lshl_b32 s68, s62, 7
 s_add_u32 s68, s68, s3
 s_add_u32 m0, s64, 114688
 s_nop 0
 buffer_load_dwordx4 v144, s[4:7], s68 offen offset:0 lds
 buffer_load_dwordx4 v145, s[4:7], s68 offen offset:1024 lds
 s_add_u32 m0, s64, 122880
 s_nop 0
 buffer_load_dwordx4 v146, s[4:7], s68 offen offset:0 lds
 buffer_load_dwordx4 v147, s[4:7], s68 offen offset:1024 lds
 s_waitcnt lgkmcnt(7)
 v_dot2c_f32_bf16 v216, s69, v40
 v_dot2c_f32_bf16 v220, v40, v40
 v_dot2c_f32_bf16 v217, s69, v41
 v_dot2c_f32_bf16 v221, v41, v41
 v_dot2c_f32_bf16 v218, s69, v42
 v_dot2c_f32_bf16 v222, v42, v42
 v_dot2c_f32_bf16 v219, s69, v43
 v_dot2c_f32_bf16 v223, v43, v43
 s_waitcnt lgkmcnt(6)
 v_dot2c_f32_bf16 v216, s69, v44
 v_dot2c_f32_bf16 v220, v44, v44
 v_dot2c_f32_bf16 v217, s69, v45
 v_dot2c_f32_bf16 v221, v45, v45
 v_dot2c_f32_bf16 v218, s69, v46
 v_dot2c_f32_bf16 v222, v46, v46
 v_dot2c_f32_bf16 v219, s69, v47
 v_dot2c_f32_bf16 v223, v47, v47
 s_waitcnt lgkmcnt(5)
 v_dot2c_f32_bf16 v216, s69, v48
 v_dot2c_f32_bf16 v220, v48, v48
 v_dot2c_f32_bf16 v217, s69, v49
 v_dot2c_f32_bf16 v221, v49, v49
 v_dot2c_f32_bf16 v218, s69, v50
 v_dot2c_f32_bf16 v222, v50, v50
 v_dot2c_f32_bf16 v219, s69, v51
 v_dot2c_f32_bf16 v223, v51, v51
 s_waitcnt lgkmcnt(4)
 v_dot2c_f32_bf16 v216, s69, v52
 v_dot2c_f32_bf16 v220, v52, v52
 v_dot2c_f32_bf16 v217, s69, v53
 v_dot2c_f32_bf16 v221, v53, v53
 v_dot2c_f32_bf16 v218, s69, v54
 v_dot2c_f32_bf16 v222, v54, v54
 v_dot2c_f32_bf16 v219, s69, v55
 v_dot2c_f32_bf16 v223, v55, v55
 s_bitcmp1_b32 s44, 0
 s_cbranch_scc1 WA_4
 s_mov_b64 exec, 0
 s_cmp_eq_u32 s40, 1
 s_cbranch_scc1 ST1_9
 s_cmp_eq_u32 s40, 2
 s_cbranch_scc1 ST1_10
 s_cmp_eq_u32 s40, 3
 s_cbranch_scc1 STB1_2
 s_branch ST1_8
STB1_2:
 s_mov_b64 exec, -1
 s_branch WB_5
WA_4:
 s_mov_b64 exec, 0
 s_cmp_eq_u32 s40, 1
 s_cbranch_scc1 ST2_9
 s_cmp_eq_u32 s40, 2
 s_cbranch_scc1 ST2_10
 s_cmp_eq_u32 s40, 3
 s_cbranch_scc1 ST2_11
 s_branch ST2_8
STB2_2:
 s_mov_b64 exec, -1
WB_5:
 s_waitcnt vmcnt(12)
 v_add_u32 v224, 0x10000, v224
 v_add_u32 v225, 0x10000, v225
 v_add_u32 v226, 0x10000, v226
 v_add_u32 v227, 0x10000, v227
 ds_read_b128 v[72:75], v224 offset:0
 ds_read_b128 v[76:79], v225 offset:0
 ds_read_b128 v[80:83], v226 offset:0
 ds_read_b128 v[84:87], v227 offset:0
 s_lshl_b32 s68, s63, 7
 s_add_u32 s68, s68, s3
 s_add_u32 m0, s64, 131072
 s_nop 0
 buffer_load_dwordx4 v144, s[4:7], s68 offen offset:0 lds
 buffer_load_dwordx4 v145, s[4:7], s68 offen offset:1024 lds
 s_add_u32 m0, s64, 139264
 s_nop 0
 buffer_load_dwordx4 v146, s[4:7], s68 offen offset:0 lds
 buffer_load_dwordx4 v147, s[4:7], s68 offen offset:1024 lds
 buffer_load_ushort v196, v239, s[32:35], 0 offen
 buffer_load_ushort v197, v239, s[32:35], 0 offen offset:512
 s_mov_b32 s32, s0
 s_and_b32 s33, s1, 0xffff
 s_mov_b32 s34, 1152
 s_lshl_b32 s98, s40, 8
 s_add_u32 m0, s98, 161792
 s_nop 0
 buffer_load_dword v235, s[32:35], 0 offen lds
 buffer_load_dword v235, s[32:35], 0 offen offset:1024 lds
 s_mov_b32 s35, s45
 s_waitcnt lgkmcnt(7)
 v_dot2c_f32_bf16 v216, s69, v56
 v_dot2c_f32_bf16 v220, v56, v56
 v_dot2c_f32_bf16 v217, s69, v57
 v_dot2c_f32_bf16 v221, v57, v57
 v_dot2c_f32_bf16 v218, s69, v58
 v_dot2c_f32_bf16 v222, v58, v58
 v_dot2c_f32_bf16 v219, s69, v59
 v_dot2c_f32_bf16 v223, v59, v59
 s_waitcnt lgkmcnt(6)
 v_dot2c_f32_bf16 v216, s69, v60
 v_dot2c_f32_bf16 v220, v60, v60
 v_dot2c_f32_bf16 v217, s69, v61
 v_dot2c_f32_bf16 v221, v61, v61
 v_dot2c_f32_bf16 v218, s69, v62
 v_dot2c_f32_bf16 v222, v62, v62
 v_dot2c_f32_bf16 v219, s69, v63
 v_dot2c_f32_bf16 v223, v63, v63
 s_waitcnt lgkmcnt(5)
 v_dot2c_f32_bf16 v216, s69, v64
 v_dot2c_f32_bf16 v220, v64, v64
 v_dot2c_f32_bf16 v217, s69, v65
 v_dot2c_f32_bf16 v221, v65, v65
 v_dot2c_f32_bf16 v218, s69, v66
 v_dot2c_f32_bf16 v222, v66, v66
 v_dot2c_f32_bf16 v219, s69, v67
 v_dot2c_f32_bf16 v223, v67, v67
 s_waitcnt lgkmcnt(4)
 v_dot2c_f32_bf16 v216, s69, v68
 v_dot2c_f32_bf16 v220, v68, v68
 v_dot2c_f32_bf16 v217, s69, v69
 v_dot2c_f32_bf16 v221, v69, v69
 v_dot2c_f32_bf16 v218, s69, v70
 v_dot2c_f32_bf16 v222, v70, v70
 v_dot2c_f32_bf16 v219, s69, v71
 v_dot2c_f32_bf16 v223, v71, v71
 s_waitcnt vmcnt(16)
 ds_read_b128 v[88:91], v224 offset:16384
 ds_read_b128 v[92:95], v225 offset:16384
 ds_read_b128 v[96:99], v226 offset:16384
 ds_read_b128 v[100:103], v227 offset:16384
 s_waitcnt lgkmcnt(7)
 v_dot2c_f32_bf16 v216, s69, v72
 v_dot2c_f32_bf16 v220, v72, v72
 v_dot2c_f32_bf16 v217, s69, v73
 v_dot2c_f32_bf16 v221, v73, v73
 v_dot2c_f32_bf16 v218, s69, v74
 v_dot2c_f32_bf16 v222, v74, v74
 v_dot2c_f32_bf16 v219, s69, v75
 v_dot2c_f32_bf16 v223, v75, v75
 s_waitcnt lgkmcnt(6)
 v_dot2c_f32_bf16 v216, s69, v76
 v_dot2c_f32_bf16 v220, v76, v76
 v_dot2c_f32_bf16 v217, s69, v77
 v_dot2c_f32_bf16 v221, v77, v77
 v_dot2c_f32_bf16 v218, s69, v78
 v_dot2c_f32_bf16 v222, v78, v78
 v_dot2c_f32_bf16 v219, s69, v79
 v_dot2c_f32_bf16 v223, v79, v79
 s_waitcnt lgkmcnt(5)
 v_dot2c_f32_bf16 v216, s69, v80
 v_dot2c_f32_bf16 v220, v80, v80
 v_dot2c_f32_bf16 v217, s69, v81
 v_dot2c_f32_bf16 v221, v81, v81
 v_dot2c_f32_bf16 v218, s69, v82
 v_dot2c_f32_bf16 v222, v82, v82
 v_dot2c_f32_bf16 v219, s69, v83
 v_dot2c_f32_bf16 v223, v83, v83
 s_waitcnt lgkmcnt(4)
 v_dot2c_f32_bf16 v216, s69, v84
 v_dot2c_f32_bf16 v220, v84, v84
 v_dot2c_f32_bf16 v217, s69, v85
 v_dot2c_f32_bf16 v221, v85, v85
 v_dot2c_f32_bf16 v218, s69, v86
 v_dot2c_f32_bf16 v222, v86, v86
 v_dot2c_f32_bf16 v219, s69, v87
 v_dot2c_f32_bf16 v223, v87, v87
 s_waitcnt vmcnt(12)
 ds_read_b128 v[104:107], v224 offset:32768
 ds_read_b128 v[108:111], v225 offset:32768
 ds_read_b128 v[112:115], v226 offset:32768
 ds_read_b128 v[116:119], v227 offset:32768
 s_waitcnt lgkmcnt(7)
 v_dot2c_f32_bf16 v216, s69, v88
 v_dot2c_f32_bf16 v220, v88, v88
 v_dot2c_f32_bf16 v217, s69, v89
 v_dot2c_f32_bf16 v221, v89, v89
 v_dot2c_f32_bf16 v218, s69, v90
 v_dot2c_f32_bf16 v222, v90, v90
 v_dot2c_f32_bf16 v219, s69, v91
 v_dot2c_f32_bf16 v223, v91, v91
 s_waitcnt lgkmcnt(6)
 v_dot2c_f32_bf16 v216, s69, v92
 v_dot2c_f32_bf16 v220, v92, v92
 v_dot2c_f32_bf16 v217, s69, v93
 v_dot2c_f32_bf16 v221, v93, v93
 v_dot2c_f32_bf16 v218, s69, v94
 v_dot2c_f32_bf16 v222, v94, v94
 v_dot2c_f32_bf16 v219, s69, v95
 v_dot2c_f32_bf16 v223, v95, v95
 s_waitcnt lgkmcnt(5)
 v_dot2c_f32_bf16 v216, s69, v96
 v_dot2c_f32_bf16 v220, v96, v96
 v_dot2c_f32_bf16 v217, s69, v97
 v_dot2c_f32_bf16 v221, v97, v97
 v_dot2c_f32_bf16 v218, s69, v98
 v_dot2c_f32_bf16 v222, v98, v98
 v_dot2c_f32_bf16 v219, s69, v99
 v_dot2c_f32_bf16 v223, v99, v99
 s_waitcnt lgkmcnt(4)
 v_dot2c_f32_bf16 v216, s69, v100
 v_dot2c_f32_bf16 v220, v100, v100
 v_dot2c_f32_bf16 v217, s69, v101
 v_dot2c_f32_bf16 v221, v101, v101
 v_dot2c_f32_bf16 v218, s69, v102
 v_dot2c_f32_bf16 v222, v102, v102
 v_dot2c_f32_bf16 v219, s69, v103
 v_dot2c_f32_bf16 v223, v103, v103
 s_waitcnt vmcnt(8)
 ds_read_b128 v[120:123], v224 offset:49152
 ds_read_b128 v[124:127], v225 offset:49152
 ds_read_b128 v[128:131], v226 offset:49152
 ds_read_b128 v[132:135], v227 offset:49152
 s_bitcmp1_b32 s44, 0
 s_cbranch_scc1 DA_6
 s_add_u32 m0, s64, 0
 s_nop 0
 buffer_load_dwordx4 v4, s[8:11], s46 offen offset:0  lds
 buffer_load_dwordx4 v5, s[8:11], s46 offen offset:1024  lds
 s_add_u32 m0, s64, 8192
 s_nop 0
 buffer_load_dwordx4 v4, s[8:11], s47 offen offset:0  lds
 buffer_load_dwordx4 v5, s[8:11], s47 offen offset:1024  lds
 s_branch DB_7
DA_6:
 s_bitcmp1_b32 s44, 1
 s_cbranch_scc0 DA_8
 s_add_u32 m0, s64, 0
 s_lshl_b32 s96, s55, 13
 s_add_u32 s96, s96, s66
 v_lshl_add_u64 v[254:255], s[96:97], 0, v[252:253]
 global_load_lds_dwordx4 v[254:255], off
 global_load_lds_dwordx4 v[254:255], off offset:1024
 s_add_u32 m0, s64, 8192
 s_lshl_b32 s96, s56, 13
 s_add_u32 s96, s96, s66
 v_lshl_add_u64 v[254:255], s[96:97], 0, v[252:253]
 global_load_lds_dwordx4 v[254:255], off
 global_load_lds_dwordx4 v[254:255], off offset:1024
DA_8:
DB_7:
 s_waitcnt lgkmcnt(7)
 v_dot2c_f32_bf16 v216, s69, v104
 v_dot2c_f32_bf16 v220, v104, v104
 v_dot2c_f32_bf16 v217, s69, v105
 v_dot2c_f32_bf16 v221, v105, v105
 v_dot2c_f32_bf16 v218, s69, v106
 v_dot2c_f32_bf16 v222, v106, v106
 v_dot2c_f32_bf16 v219, s69, v107
 v_dot2c_f32_bf16 v223, v107, v107
 s_waitcnt lgkmcnt(6)
 v_dot2c_f32_bf16 v216, s69, v108
 v_dot2c_f32_bf16 v220, v108, v108
 v_dot2c_f32_bf16 v217, s69, v109
 v_dot2c_f32_bf16 v221, v109, v109
 v_dot2c_f32_bf16 v218, s69, v110
 v_dot2c_f32_bf16 v222, v110, v110
 v_dot2c_f32_bf16 v219, s69, v111
 v_dot2c_f32_bf16 v223, v111, v111
 s_waitcnt lgkmcnt(5)
 v_dot2c_f32_bf16 v216, s69, v112
 v_dot2c_f32_bf16 v220, v112, v112
 v_dot2c_f32_bf16 v217, s69, v113
 v_dot2c_f32_bf16 v221, v113, v113
 v_dot2c_f32_bf16 v218, s69, v114
 v_dot2c_f32_bf16 v222, v114, v114
 v_dot2c_f32_bf16 v219, s69, v115
 v_dot2c_f32_bf16 v223, v115, v115
 s_waitcnt lgkmcnt(4)
 v_dot2c_f32_bf16 v216, s69, v116
 v_dot2c_f32_bf16 v220, v116, v116
 v_dot2c_f32_bf16 v217, s69, v117
 v_dot2c_f32_bf16 v221, v117, v117
 v_dot2c_f32_bf16 v218, s69, v118
 v_dot2c_f32_bf16 v222, v118, v118
 v_dot2c_f32_bf16 v219, s69, v119
 v_dot2c_f32_bf16 v223, v119, v119
 s_waitcnt vmcnt(4)
 v_add_u32 v224, 0x10000, v224
 v_add_u32 v225, 0x10000, v225
 v_add_u32 v226, 0x10000, v226
 v_add_u32 v227, 0x10000, v227
 ds_read_b128 v[136:139], v224 offset:0
 ds_read_b128 v[140:143], v225 offset:0
 ds_read_b128 v[144:147], v226 offset:0
 ds_read_b128 v[148:151], v227 offset:0
 s_bitcmp1_b32 s44, 0
 s_cbranch_scc1 DA_10
 s_add_u32 m0, s64, 16384
 s_nop 0
 buffer_load_dwordx4 v4, s[8:11], s48 offen offset:0  lds
 buffer_load_dwordx4 v5, s[8:11], s48 offen offset:1024  lds
 s_add_u32 m0, s64, 24576
 s_nop 0
 buffer_load_dwordx4 v4, s[8:11], s49 offen offset:0  lds
 buffer_load_dwordx4 v5, s[8:11], s49 offen offset:1024  lds
 s_branch DB_11
DA_10:
 s_bitcmp1_b32 s44, 1
 s_cbranch_scc0 DA_12
 s_add_u32 m0, s64, 16384
 s_lshl_b32 s96, s57, 13
 s_add_u32 s96, s96, s66
 v_lshl_add_u64 v[254:255], s[96:97], 0, v[252:253]
 global_load_lds_dwordx4 v[254:255], off
 global_load_lds_dwordx4 v[254:255], off offset:1024
 s_add_u32 m0, s64, 24576
 s_lshl_b32 s96, s58, 13
 s_add_u32 s96, s96, s66
 v_lshl_add_u64 v[254:255], s[96:97], 0, v[252:253]
 global_load_lds_dwordx4 v[254:255], off
 global_load_lds_dwordx4 v[254:255], off offset:1024
DA_12:
DB_11:
 s_waitcnt lgkmcnt(7)
 v_dot2c_f32_bf16 v216, s69, v120
 v_dot2c_f32_bf16 v220, v120, v120
 v_dot2c_f32_bf16 v217, s69, v121
 v_dot2c_f32_bf16 v221, v121, v121
 v_dot2c_f32_bf16 v218, s69, v122
 v_dot2c_f32_bf16 v222, v122, v122
 v_dot2c_f32_bf16 v219, s69, v123
 v_dot2c_f32_bf16 v223, v123, v123
 s_waitcnt lgkmcnt(6)
 v_dot2c_f32_bf16 v216, s69, v124
 v_dot2c_f32_bf16 v220, v124, v124
 v_dot2c_f32_bf16 v217, s69, v125
 v_dot2c_f32_bf16 v221, v125, v125
 v_dot2c_f32_bf16 v218, s69, v126
 v_dot2c_f32_bf16 v222, v126, v126
 v_dot2c_f32_bf16 v219, s69, v127
 v_dot2c_f32_bf16 v223, v127, v127
 s_waitcnt lgkmcnt(5)
 v_dot2c_f32_bf16 v216, s69, v128
 v_dot2c_f32_bf16 v220, v128, v128
 v_dot2c_f32_bf16 v217, s69, v129
 v_dot2c_f32_bf16 v221, v129, v129
 v_dot2c_f32_bf16 v218, s69, v130
 v_dot2c_f32_bf16 v222, v130, v130
 v_dot2c_f32_bf16 v219, s69, v131
 v_dot2c_f32_bf16 v223, v131, v131
 s_waitcnt lgkmcnt(4)
 v_dot2c_f32_bf16 v216, s69, v132
 v_dot2c_f32_bf16 v220, v132, v132
 v_dot2c_f32_bf16 v217, s69, v133
 v_dot2c_f32_bf16 v221, v133, v133
 v_dot2c_f32_bf16 v218, s69, v134
 v_dot2c_f32_bf16 v222, v134, v134
 v_dot2c_f32_bf16 v219, s69, v135
 v_dot2c_f32_bf16 v223, v135, v135
 s_bitcmp1_b32 s44, 0
 s_cbranch_scc1 DA_14
 s_add_u32 m0, s64, 32768
 s_nop 0
 buffer_load_dwordx4 v4, s[8:11], s50 offen offset:0  lds
 buffer_load_dwordx4 v5, s[8:11], s50 offen offset:1024  lds
 s_add_u32 m0, s64, 40960
 s_nop 0
 buffer_load_dwordx4 v4, s[8:11], s51 offen offset:0  lds
 buffer_load_dwordx4 v5, s[8:11], s51 offen offset:1024  lds
 s_branch DB_15
DA_14:
 s_bitcmp1_b32 s44, 1
 s_cbranch_scc0 DA_16
 s_add_u32 m0, s64, 32768
 s_lshl_b32 s96, s59, 13
 s_add_u32 s96, s96, s66
 v_lshl_add_u64 v[254:255], s[96:97], 0, v[252:253]
 global_load_lds_dwordx4 v[254:255], off
 global_load_lds_dwordx4 v[254:255], off offset:1024
 s_add_u32 m0, s64, 40960
 s_lshl_b32 s96, s60, 13
 s_add_u32 s96, s96, s66
 v_lshl_add_u64 v[254:255], s[96:97], 0, v[252:253]
 global_load_lds_dwordx4 v[254:255], off
 global_load_lds_dwordx4 v[254:255], off offset:1024
DA_16:
DB_15:
 s_bitcmp1_b32 s44, 5
 s_cbranch_scc0 ON_18
 s_lshl_b32 s98, s40, 12
 s_add_u32 m0, s98, 149504
 s_nop 0
 buffer_load_dwordx4 v152, s[4:7], 0 offen lds
 s_add_u32 m0, s98, 150528
 s_nop 0
 buffer_load_dwordx4 v153, s[4:7], 0 offen lds
 s_add_u32 m0, s98, 151552
 s_nop 0
 buffer_load_dwordx4 v154, s[4:7], 0 offen lds
 s_add_u32 m0, s98, 152576
 s_nop 0
 buffer_load_dwordx4 v155, s[4:7], 0 offen lds
ON_18:
 s_waitcnt lgkmcnt(3)
 v_dot2c_f32_bf16 v216, s69, v136
 v_dot2c_f32_bf16 v220, v136, v136
 v_dot2c_f32_bf16 v217, s69, v137
 v_dot2c_f32_bf16 v221, v137, v137
 v_dot2c_f32_bf16 v218, s69, v138
 v_dot2c_f32_bf16 v222, v138, v138
 v_dot2c_f32_bf16 v219, s69, v139
 v_dot2c_f32_bf16 v223, v139, v139
 s_waitcnt lgkmcnt(2)
 v_dot2c_f32_bf16 v216, s69, v140
 v_dot2c_f32_bf16 v220, v140, v140
 v_dot2c_f32_bf16 v217, s69, v141
 v_dot2c_f32_bf16 v221, v141, v141
 v_dot2c_f32_bf16 v218, s69, v142
 v_dot2c_f32_bf16 v222, v142, v142
 v_dot2c_f32_bf16 v219, s69, v143
 v_dot2c_f32_bf16 v223, v143, v143
 s_waitcnt lgkmcnt(1)
 v_dot2c_f32_bf16 v216, s69, v144
 v_dot2c_f32_bf16 v220, v144, v144
 v_dot2c_f32_bf16 v217, s69, v145
 v_dot2c_f32_bf16 v221, v145, v145
 v_dot2c_f32_bf16 v218, s69, v146
 v_dot2c_f32_bf16 v222, v146, v146
 v_dot2c_f32_bf16 v219, s69, v147
 v_dot2c_f32_bf16 v223, v147, v147
 s_waitcnt lgkmcnt(0)
 v_dot2c_f32_bf16 v216, s69, v148
 v_dot2c_f32_bf16 v220, v148, v148
 v_dot2c_f32_bf16 v217, s69, v149
 v_dot2c_f32_bf16 v221, v149, v149
 v_dot2c_f32_bf16 v218, s69, v150
 v_dot2c_f32_bf16 v222, v150, v150
 v_dot2c_f32_bf16 v219, s69, v151
 v_dot2c_f32_bf16 v223, v151, v151
 s_nop 2
 v_add_f32 v216, v216, v217
 v_add_f32 v218, v218, v219
 v_add_f32 v220, v220, v221
 v_add_f32 v222, v222, v223
 v_add_f32 v216, v216, v218
 v_add_f32 v220, v220, v222
 v_mov_b32 v217, v216
 v_mov_b32 v221, v220
 s_nop 1
 v_permlane32_swap_b32 v216, v217
 v_permlane32_swap_b32 v220, v221
 s_nop 0
 v_add_f32 v216, v216, v217
 v_add_f32 v220, v220, v221
 v_mul_f32 v216, 0x3ae38e39, v216
 v_mul_f32 v220, 0x3ae38e39, v220
 v_fma_f32 v220, -v216, v216, v220
 v_max_f32 v220, 0, v220
 v_cvt_pk_bf16_f32 v216, v216, v220
 v_and_b32 v220, 0xffff0000, v216
 v_lshlrev_b32 v216, 16, v216
 v_add_f32 v220, 0x3727c5ac, v220
 v_cvt_pk_bf16_f32 v220, v220, v220
 v_and_b32 v220, 0xffff0000, v220
 v_sqrt_f32 v220, v220
 s_nop 0
 v_cvt_pk_bf16_f32 v220, v220, v220
 v_and_b32 v220, 0xffff0000, v220
 v_rcp_f32 v220, v220
 s_nop 0
 v_mul_f32 v220, 0x3ef00000, v220
 v_cvt_pk_bf16_f32 v220, v220, v220
 v_and_b32 v221, 0xffff0000, v220
 v_lshrrev_b32 v220, 16, v220
 v_mul_f32 v216, v216, v221
 v_sub_f32 v216, 0, v216
 .p2align 3
 v_dot2_f32_bf16 v224, v8, v220, v216
 v_dot2_f32_bf16 v225, v9, v220, v216
 v_dot2_f32_bf16 v226, v10, v220, v216
 v_dot2_f32_bf16 v227, v11, v220, v216
 v_dot2_f32_bf16 v228, v12, v220, v216
 v_dot2_f32_bf16 v229, v13, v220, v216
 v_dot2_f32_bf16 v230, v14, v220, v216
 v_dot2_f32_bf16 v231, v15, v220, v216
 v_dot2_f32_bf16 v232, v8, v221, v216
 v_dot2_f32_bf16 v233, v9, v221, v216
 v_dot2_f32_bf16 v234, v10, v221, v216
 buffer_load_dword v248, off, s[36:39], 0 sc1
 .p2align 3
 v_dot2_f32_bf16 v235, v11, v221, v216
 v_dot2_f32_bf16 v236, v12, v221, v216
 v_dot2_f32_bf16 v237, v13, v221, v216
 v_dot2_f32_bf16 v238, v14, v221, v216
 v_dot2_f32_bf16 v239, v15, v221, v216
 v_cvt_pk_bf16_f32 v8, v224, v225
 v_cvt_pk_bf16_f32 v9, v226, v227
 v_cvt_pk_bf16_f32 v10, v228, v229
 v_cvt_pk_bf16_f32 v11, v230, v231
 v_cvt_pk_bf16_f32 v12, v232, v233
 v_subrev_u32 v251, 128, v250
 s_mov_b32 exec_lo, 0x49249249
 s_mov_b32 exec_hi, 0x92492
 buffer_load_dword a255, v251, s[8:11], 0 offen
 s_bfm_b64 exec, 54, 0
 buffer_load_dword a255, v250, s[8:11], 0 offen
 s_mov_b64 exec, -1
 .p2align 3
 v_cvt_pk_bf16_f32 v13, v234, v235
 v_cvt_pk_bf16_f32 v14, v236, v237
 v_cvt_pk_bf16_f32 v15, v238, v239
 v_dot2_f32_bf16 v224, v16, v220, v216
 v_dot2_f32_bf16 v225, v17, v220, v216
 v_dot2_f32_bf16 v226, v18, v220, v216
 v_dot2_f32_bf16 v227, v19, v220, v216
 v_dot2_f32_bf16 v228, v20, v220, v216
 v_dot2_f32_bf16 v229, v21, v220, v216
 v_dot2_f32_bf16 v230, v22, v220, v216
 v_dot2_f32_bf16 v231, v23, v220, v216
 v_dot2_f32_bf16 v232, v16, v221, v216
 v_dot2_f32_bf16 v233, v17, v221, v216
 v_dot2_f32_bf16 v234, v18, v221, v216
 v_dot2_f32_bf16 v235, v19, v221, v216
 v_dot2_f32_bf16 v236, v20, v221, v216
 v_dot2_f32_bf16 v237, v21, v221, v216
 v_dot2_f32_bf16 v238, v22, v221, v216
 v_dot2_f32_bf16 v239, v23, v221, v216
 v_cvt_pk_bf16_f32 v16, v224, v225
 v_cvt_pk_bf16_f32 v17, v226, v227
 v_cvt_pk_bf16_f32 v18, v228, v229
 v_cvt_pk_bf16_f32 v19, v230, v231
 v_cvt_pk_bf16_f32 v20, v232, v233
 v_cvt_pk_bf16_f32 v21, v234, v235
 v_cvt_pk_bf16_f32 v22, v236, v237
 v_cvt_pk_bf16_f32 v23, v238, v239
 v_dot2_f32_bf16 v224, v24, v220, v216
 v_dot2_f32_bf16 v225, v25, v220, v216
 v_dot2_f32_bf16 v226, v26, v220, v216
 v_dot2_f32_bf16 v227, v27, v220, v216
 v_dot2_f32_bf16 v228, v28, v220, v216
 v_dot2_f32_bf16 v229, v29, v220, v216
 v_dot2_f32_bf16 v230, v30, v220, v216
 v_dot2_f32_bf16 v231, v31, v220, v216
 v_dot2_f32_bf16 v232, v24, v221, v216
 v_dot2_f32_bf16 v233, v25, v221, v216
 v_dot2_f32_bf16 v234, v26, v221, v216
 v_dot2_f32_bf16 v235, v27, v221, v216
 v_dot2_f32_bf16 v236, v28, v221, v216
 v_dot2_f32_bf16 v237, v29, v221, v216
 v_dot2_f32_bf16 v238, v30, v221, v216
 v_dot2_f32_bf16 v239, v31, v221, v216
 v_cvt_pk_bf16_f32 v24, v224, v225
 v_cvt_pk_bf16_f32 v25, v226, v227
 v_cvt_pk_bf16_f32 v26, v228, v229
 v_cvt_pk_bf16_f32 v27, v230, v231
 v_cvt_pk_bf16_f32 v28, v232, v233
 v_cvt_pk_bf16_f32 v29, v234, v235
 v_cvt_pk_bf16_f32 v30, v236, v237
 v_cvt_pk_bf16_f32 v31, v238, v239
 v_dot2_f32_bf16 v224, v32, v220, v216
 v_dot2_f32_bf16 v225, v33, v220, v216
 v_dot2_f32_bf16 v226, v34, v220, v216
 v_dot2_f32_bf16 v227, v35, v220, v216
 v_dot2_f32_bf16 v228, v36, v220, v216
 v_dot2_f32_bf16 v229, v37, v220, v216
 v_dot2_f32_bf16 v230, v38, v220, v216
 v_dot2_f32_bf16 v231, v39, v220, v216
 v_dot2_f32_bf16 v232, v32, v221, v216
 v_dot2_f32_bf16 v233, v33, v221, v216
 v_dot2_f32_bf16 v234, v34, v221, v216
 v_dot2_f32_bf16 v235, v35, v221, v216
 v_dot2_f32_bf16 v236, v36, v221, v216
 v_dot2_f32_bf16 v237, v37, v221, v216
 v_dot2_f32_bf16 v238, v38, v221, v216
 v_dot2_f32_bf16 v239, v39, v221, v216
 v_cvt_pk_bf16_f32 v32, v224, v225
 v_cvt_pk_bf16_f32 v33, v226, v227
 v_cvt_pk_bf16_f32 v34, v228, v229
 v_cvt_pk_bf16_f32 v35, v230, v231
 v_cvt_pk_bf16_f32 v36, v232, v233
 v_cvt_pk_bf16_f32 v37, v234, v235
 v_cvt_pk_bf16_f32 v38, v236, v237
 v_cvt_pk_bf16_f32 v39, v238, v239
 v_dot2_f32_bf16 v224, v40, v220, v216
 v_dot2_f32_bf16 v225, v41, v220, v216
 v_dot2_f32_bf16 v226, v42, v220, v216
 v_dot2_f32_bf16 v227, v43, v220, v216
 v_dot2_f32_bf16 v228, v44, v220, v216
 v_dot2_f32_bf16 v229, v45, v220, v216
 v_dot2_f32_bf16 v230, v46, v220, v216
 v_dot2_f32_bf16 v231, v47, v220, v216
 v_dot2_f32_bf16 v232, v40, v221, v216
 v_dot2_f32_bf16 v233, v41, v221, v216
 v_dot2_f32_bf16 v234, v42, v221, v216
 v_dot2_f32_bf16 v235, v43, v221, v216
 v_dot2_f32_bf16 v236, v44, v221, v216
 v_dot2_f32_bf16 v237, v45, v221, v216
 v_dot2_f32_bf16 v238, v46, v221, v216
 v_dot2_f32_bf16 v239, v47, v221, v216
 v_cvt_pk_bf16_f32 v40, v224, v225
 v_cvt_pk_bf16_f32 v41, v226, v227
 v_cvt_pk_bf16_f32 v42, v228, v229
 v_cvt_pk_bf16_f32 v43, v230, v231
 v_cvt_pk_bf16_f32 v44, v232, v233
 v_cvt_pk_bf16_f32 v45, v234, v235
 v_cvt_pk_bf16_f32 v46, v236, v237
 v_cvt_pk_bf16_f32 v47, v238, v239
 v_dot2_f32_bf16 v224, v48, v220, v216
ST1_1:
 s_cbranch_execz STB1_0
ST2_1:
 s_cbranch_execz STB2_0
 v_dot2_f32_bf16 v225, v49, v220, v216
 v_dot2_f32_bf16 v226, v50, v220, v216
 v_dot2_f32_bf16 v227, v51, v220, v216
 v_dot2_f32_bf16 v228, v52, v220, v216
 v_dot2_f32_bf16 v229, v53, v220, v216
 v_dot2_f32_bf16 v230, v54, v220, v216
 v_dot2_f32_bf16 v231, v55, v220, v216
 v_dot2_f32_bf16 v232, v48, v221, v216
 v_dot2_f32_bf16 v233, v49, v221, v216
 v_dot2_f32_bf16 v234, v50, v221, v216
 v_dot2_f32_bf16 v235, v51, v221, v216
 v_dot2_f32_bf16 v236, v52, v221, v216
 v_dot2_f32_bf16 v237, v53, v221, v216
 v_dot2_f32_bf16 v238, v54, v221, v216
 v_dot2_f32_bf16 v239, v55, v221, v216
 v_cvt_pk_bf16_f32 v48, v224, v225
 v_cvt_pk_bf16_f32 v49, v226, v227
 v_cvt_pk_bf16_f32 v50, v228, v229
 v_cvt_pk_bf16_f32 v51, v230, v231
 v_cvt_pk_bf16_f32 v52, v232, v233
 v_cvt_pk_bf16_f32 v53, v234, v235
 v_cvt_pk_bf16_f32 v54, v236, v237
 v_cvt_pk_bf16_f32 v55, v238, v239
 v_dot2_f32_bf16 v224, v56, v220, v216
 v_dot2_f32_bf16 v225, v57, v220, v216
 v_dot2_f32_bf16 v226, v58, v220, v216
 v_dot2_f32_bf16 v227, v59, v220, v216
 v_dot2_f32_bf16 v228, v60, v220, v216
 v_dot2_f32_bf16 v229, v61, v220, v216
 v_dot2_f32_bf16 v230, v62, v220, v216
 v_dot2_f32_bf16 v231, v63, v220, v216
 v_dot2_f32_bf16 v232, v56, v221, v216
 v_dot2_f32_bf16 v233, v57, v221, v216
 v_dot2_f32_bf16 v234, v58, v221, v216
 v_dot2_f32_bf16 v235, v59, v221, v216
 v_dot2_f32_bf16 v236, v60, v221, v216
 v_dot2_f32_bf16 v237, v61, v221, v216
 v_dot2_f32_bf16 v238, v62, v221, v216
 v_dot2_f32_bf16 v239, v63, v221, v216
 v_cvt_pk_bf16_f32 v56, v224, v225
 v_cvt_pk_bf16_f32 v57, v226, v227
 v_cvt_pk_bf16_f32 v58, v228, v229
 v_cvt_pk_bf16_f32 v59, v230, v231
 v_cvt_pk_bf16_f32 v60, v232, v233
 v_cvt_pk_bf16_f32 v61, v234, v235
 v_cvt_pk_bf16_f32 v62, v236, v237
 v_cvt_pk_bf16_f32 v63, v238, v239
 v_dot2_f32_bf16 v224, v64, v220, v216
 v_dot2_f32_bf16 v225, v65, v220, v216
 v_dot2_f32_bf16 v226, v66, v220, v216
 v_dot2_f32_bf16 v227, v67, v220, v216
 v_dot2_f32_bf16 v228, v68, v220, v216
 v_dot2_f32_bf16 v229, v69, v220, v216
 v_dot2_f32_bf16 v230, v70, v220, v216
 v_dot2_f32_bf16 v231, v71, v220, v216
 v_dot2_f32_bf16 v232, v64, v221, v216
 v_dot2_f32_bf16 v233, v65, v221, v216
 v_dot2_f32_bf16 v234, v66, v221, v216
 v_dot2_f32_bf16 v235, v67, v221, v216
 v_dot2_f32_bf16 v236, v68, v221, v216
 v_dot2_f32_bf16 v237, v69, v221, v216
 v_dot2_f32_bf16 v238, v70, v221, v216
 v_dot2_f32_bf16 v239, v71, v221, v216
 v_cvt_pk_bf16_f32 v64, v224, v225
 v_cvt_pk_bf16_f32 v65, v226, v227
 v_cvt_pk_bf16_f32 v66, v228, v229
 v_cvt_pk_bf16_f32 v67, v230, v231
 v_cvt_pk_bf16_f32 v68, v232, v233
 v_cvt_pk_bf16_f32 v69, v234, v235
 v_cvt_pk_bf16_f32 v70, v236, v237
 v_cvt_pk_bf16_f32 v71, v238, v239
 v_dot2_f32_bf16 v224, v72, v220, v216
 v_dot2_f32_bf16 v225, v73, v220, v216
 v_dot2_f32_bf16 v226, v74, v220, v216
 v_dot2_f32_bf16 v227, v75, v220, v216
 v_dot2_f32_bf16 v228, v76, v220, v216
 v_dot2_f32_bf16 v229, v77, v220, v216
 v_dot2_f32_bf16 v230, v78, v220, v216
 v_dot2_f32_bf16 v231, v79, v220, v216
 v_dot2_f32_bf16 v232, v72, v221, v216
 v_dot2_f32_bf16 v233, v73, v221, v216
 v_dot2_f32_bf16 v234, v74, v221, v216
 v_dot2_f32_bf16 v235, v75, v221, v216
 v_dot2_f32_bf16 v236, v76, v221, v216
 v_dot2_f32_bf16 v237, v77, v221, v216
 v_dot2_f32_bf16 v238, v78, v221, v216
 v_dot2_f32_bf16 v239, v79, v221, v216
 v_cvt_pk_bf16_f32 v72, v224, v225
 v_cvt_pk_bf16_f32 v73, v226, v227
 v_cvt_pk_bf16_f32 v74, v228, v229
 v_cvt_pk_bf16_f32 v75, v230, v231
 v_cvt_pk_bf16_f32 v76, v232, v233
 v_cvt_pk_bf16_f32 v77, v234, v235
 v_cvt_pk_bf16_f32 v78, v236, v237
 v_cvt_pk_bf16_f32 v79, v238, v239
 v_dot2_f32_bf16 v224, v80, v220, v216
 v_dot2_f32_bf16 v225, v81, v220, v216
 v_dot2_f32_bf16 v226, v82, v220, v216
 v_dot2_f32_bf16 v227, v83, v220, v216
 v_dot2_f32_bf16 v228, v84, v220, v216
 v_dot2_f32_bf16 v229, v85, v220, v216
 v_dot2_f32_bf16 v230, v86, v220, v216
 v_dot2_f32_bf16 v231, v87, v220, v216
 v_dot2_f32_bf16 v232, v80, v221, v216
 v_dot2_f32_bf16 v233, v81, v221, v216
 v_dot2_f32_bf16 v234, v82, v221, v216
 v_dot2_f32_bf16 v235, v83, v221, v216
 v_dot2_f32_bf16 v236, v84, v221, v216
 v_dot2_f32_bf16 v237, v85, v221, v216
 v_dot2_f32_bf16 v238, v86, v221, v216
 v_dot2_f32_bf16 v239, v87, v221, v216
 v_cvt_pk_bf16_f32 v80, v224, v225
 v_cvt_pk_bf16_f32 v81, v226, v227
 v_cvt_pk_bf16_f32 v82, v228, v229
 v_cvt_pk_bf16_f32 v83, v230, v231
 v_cvt_pk_bf16_f32 v84, v232, v233
 v_cvt_pk_bf16_f32 v85, v234, v235
 v_cvt_pk_bf16_f32 v86, v236, v237
 v_cvt_pk_bf16_f32 v87, v238, v239
 v_dot2_f32_bf16 v224, v88, v220, v216
 v_dot2_f32_bf16 v225, v89, v220, v216
 v_dot2_f32_bf16 v226, v90, v220, v216
 v_dot2_f32_bf16 v227, v91, v220, v216
 v_dot2_f32_bf16 v228, v92, v220, v216
 v_dot2_f32_bf16 v229, v93, v220, v216
 v_dot2_f32_bf16 v230, v94, v220, v216
 v_dot2_f32_bf16 v231, v95, v220, v216
 v_dot2_f32_bf16 v232, v88, v221, v216
 v_dot2_f32_bf16 v233, v89, v221, v216
 v_dot2_f32_bf16 v234, v90, v221, v216
 v_dot2_f32_bf16 v235, v91, v221, v216
 v_dot2_f32_bf16 v236, v92, v221, v216
 v_dot2_f32_bf16 v237, v93, v221, v216
 v_dot2_f32_bf16 v238, v94, v221, v216
 v_dot2_f32_bf16 v239, v95, v221, v216
 v_cvt_pk_bf16_f32 v88, v224, v225
 v_cvt_pk_bf16_f32 v89, v226, v227
 v_cvt_pk_bf16_f32 v90, v228, v229
 v_cvt_pk_bf16_f32 v91, v230, v231
 v_cvt_pk_bf16_f32 v92, v232, v233
 v_cvt_pk_bf16_f32 v93, v234, v235
 v_cvt_pk_bf16_f32 v94, v236, v237
 v_cvt_pk_bf16_f32 v95, v238, v239
 v_dot2_f32_bf16 v224, v96, v220, v216
 v_dot2_f32_bf16 v225, v97, v220, v216
 v_dot2_f32_bf16 v226, v98, v220, v216
 v_dot2_f32_bf16 v227, v99, v220, v216
 v_dot2_f32_bf16 v228, v100, v220, v216
 v_dot2_f32_bf16 v229, v101, v220, v216
 v_dot2_f32_bf16 v230, v102, v220, v216
 v_dot2_f32_bf16 v231, v103, v220, v216
 v_dot2_f32_bf16 v232, v96, v221, v216
 v_dot2_f32_bf16 v233, v97, v221, v216
 v_dot2_f32_bf16 v234, v98, v221, v216
 v_dot2_f32_bf16 v235, v99, v221, v216
 v_dot2_f32_bf16 v236, v100, v221, v216
 v_dot2_f32_bf16 v237, v101, v221, v216
 v_dot2_f32_bf16 v238, v102, v221, v216
 v_dot2_f32_bf16 v239, v103, v221, v216
 v_cvt_pk_bf16_f32 v96, v224, v225
 v_cvt_pk_bf16_f32 v97, v226, v227
 v_cvt_pk_bf16_f32 v98, v228, v229
 v_cvt_pk_bf16_f32 v99, v230, v231
 v_cvt_pk_bf16_f32 v100, v232, v233
 v_cvt_pk_bf16_f32 v101, v234, v235
 v_cvt_pk_bf16_f32 v102, v236, v237
 v_cvt_pk_bf16_f32 v103, v238, v239
 v_dot2_f32_bf16 v224, v104, v220, v216
 v_dot2_f32_bf16 v225, v105, v220, v216
 v_dot2_f32_bf16 v226, v106, v220, v216
 v_dot2_f32_bf16 v227, v107, v220, v216
 v_dot2_f32_bf16 v228, v108, v220, v216
 v_dot2_f32_bf16 v229, v109, v220, v216
 v_dot2_f32_bf16 v230, v110, v220, v216
 v_dot2_f32_bf16 v231, v111, v220, v216
 v_dot2_f32_bf16 v232, v104, v221, v216
 v_dot2_f32_bf16 v233, v105, v221, v216
 v_dot2_f32_bf16 v234, v106, v221, v216
 v_dot2_f32_bf16 v235, v107, v221, v216
 v_dot2_f32_bf16 v236, v108, v221, v216
 v_dot2_f32_bf16 v237, v109, v221, v216
 v_dot2_f32_bf16 v238, v110, v221, v216
 v_dot2_f32_bf16 v239, v111, v221, v216
 v_cvt_pk_bf16_f32 v104, v224, v225
 v_cvt_pk_bf16_f32 v105, v226, v227
 v_cvt_pk_bf16_f32 v106, v228, v229
 v_cvt_pk_bf16_f32 v107, v230, v231
 v_cvt_pk_bf16_f32 v108, v232, v233
 v_cvt_pk_bf16_f32 v109, v234, v235
 v_cvt_pk_bf16_f32 v110, v236, v237
 v_cvt_pk_bf16_f32 v111, v238, v239
 v_dot2_f32_bf16 v224, v112, v220, v216
 v_dot2_f32_bf16 v225, v113, v220, v216
 v_dot2_f32_bf16 v226, v114, v220, v216
 v_dot2_f32_bf16 v227, v115, v220, v216
 v_dot2_f32_bf16 v228, v116, v220, v216
 v_dot2_f32_bf16 v229, v117, v220, v216
 v_dot2_f32_bf16 v230, v118, v220, v216
 v_dot2_f32_bf16 v231, v119, v220, v216
 v_dot2_f32_bf16 v232, v112, v221, v216
 v_dot2_f32_bf16 v233, v113, v221, v216
 v_dot2_f32_bf16 v234, v114, v221, v216
 v_dot2_f32_bf16 v235, v115, v221, v216
 v_dot2_f32_bf16 v236, v116, v221, v216
 v_dot2_f32_bf16 v237, v117, v221, v216
 v_dot2_f32_bf16 v238, v118, v221, v216
 v_dot2_f32_bf16 v239, v119, v221, v216
 v_cvt_pk_bf16_f32 v112, v224, v225
 v_cvt_pk_bf16_f32 v113, v226, v227
 v_cvt_pk_bf16_f32 v114, v228, v229
 v_cvt_pk_bf16_f32 v115, v230, v231
 v_cvt_pk_bf16_f32 v116, v232, v233
 v_cvt_pk_bf16_f32 v117, v234, v235
 v_cvt_pk_bf16_f32 v118, v236, v237
 v_cvt_pk_bf16_f32 v119, v238, v239
 v_dot2_f32_bf16 v224, v120, v220, v216
 v_dot2_f32_bf16 v225, v121, v220, v216
 v_dot2_f32_bf16 v226, v122, v220, v216
 v_dot2_f32_bf16 v227, v123, v220, v216
 v_dot2_f32_bf16 v228, v124, v220, v216
 v_dot2_f32_bf16 v229, v125, v220, v216
 v_dot2_f32_bf16 v230, v126, v220, v216
 v_dot2_f32_bf16 v231, v127, v220, v216
 v_dot2_f32_bf16 v232, v120, v221, v216
 v_dot2_f32_bf16 v233, v121, v221, v216
 v_dot2_f32_bf16 v234, v122, v221, v216
 v_dot2_f32_bf16 v235, v123, v221, v216
 v_dot2_f32_bf16 v236, v124, v221, v216
 v_dot2_f32_bf16 v237, v125, v221, v216
 v_dot2_f32_bf16 v238, v126, v221, v216
 v_dot2_f32_bf16 v239, v127, v221, v216
 v_cvt_pk_bf16_f32 v120, v224, v225
 v_cvt_pk_bf16_f32 v121, v226, v227
 v_cvt_pk_bf16_f32 v122, v228, v229
 v_cvt_pk_bf16_f32 v123, v230, v231
 v_cvt_pk_bf16_f32 v124, v232, v233
 v_cvt_pk_bf16_f32 v125, v234, v235
 v_cvt_pk_bf16_f32 v126, v236, v237
 v_cvt_pk_bf16_f32 v127, v238, v239
 s_waitcnt vmcnt(3)
 v_lshlrev_b32 v196, 16, v196
 v_lshlrev_b32 v197, 16, v197
 v_mul_f32 v196, 0x3ef00000, v196
 v_mul_f32 v197, 0x3ef00000, v197
 ds_write_b32 v198, v196
 ds_write_b32 v198, v197 offset:1024
 .p2align 3
 v_dot2_f32_bf16 v224, v128, v220, v216
 v_dot2_f32_bf16 v225, v129, v220, v216
 v_dot2_f32_bf16 v226, v130, v220, v216
 v_dot2_f32_bf16 v227, v131, v220, v216
 v_dot2_f32_bf16 v228, v132, v220, v216
 v_dot2_f32_bf16 v229, v133, v220, v216
 v_dot2_f32_bf16 v230, v134, v220, v216
 v_dot2_f32_bf16 v231, v135, v220, v216
 v_dot2_f32_bf16 v232, v128, v221, v216
 v_dot2_f32_bf16 v233, v129, v221, v216
 v_dot2_f32_bf16 v234, v130, v221, v216
 v_dot2_f32_bf16 v235, v131, v221, v216
 v_dot2_f32_bf16 v236, v132, v221, v216
 v_dot2_f32_bf16 v237, v133, v221, v216
 v_dot2_f32_bf16 v238, v134, v221, v216
 v_dot2_f32_bf16 v239, v135, v221, v216
 v_cvt_pk_bf16_f32 v128, v224, v225
 v_cvt_pk_bf16_f32 v129, v226, v227
 v_cvt_pk_bf16_f32 v130, v228, v229
 v_cvt_pk_bf16_f32 v131, v230, v231
 v_cvt_pk_bf16_f32 v132, v232, v233
 v_cvt_pk_bf16_f32 v133, v234, v235
 v_cvt_pk_bf16_f32 v134, v236, v237
 v_cvt_pk_bf16_f32 v135, v238, v239
 s_waitcnt lgkmcnt(0)
 s_bitcmp1_b32 s44, 0
 s_cbranch_scc1 L_odd
 s_barrier
 ds_read_b128 v[152:155], v246 offset:0
 ds_read_b128 v[156:159], v246 offset:32
 ds_read_b128 v[160:163], v246 offset:64
 ds_read_b128 v[164:167], v246 offset:96
 ds_read_b128 v[168:171], v246 offset:128
 ds_read_b128 v[172:175], v246 offset:160
 ds_read_b128 v[176:179], v246 offset:192
 ds_read_b128 v[180:183], v246 offset:224
 ds_read_b64_tr_b16 a[0:1], v240 offset:0
 ds_read_b64_tr_b16 a[2:3], v240 offset:512
 ds_read_b64_tr_b16 a[4:5], v241 offset:0
 ds_read_b64_tr_b16 a[6:7], v241 offset:512
 ds_read_b64_tr_b16 a[8:9], v240 offset:2048
 ds_read_b64_tr_b16 a[10:11], v240 offset:2560
 ds_read_b64_tr_b16 a[12:13], v241 offset:2048
 ds_read_b64_tr_b16 a[14:15], v241 offset:2560
 ds_read_b64_tr_b16 a[16:17], v240 offset:4096
 ds_read_b64_tr_b16 a[18:19], v240 offset:4608
 ds_read_b64_tr_b16 a[20:21], v241 offset:4096
 ds_read_b64_tr_b16 a[22:23], v241 offset:4608
 .p2align 3
 v_dot2_f32_bf16 v224, v136, v220, v216
 v_dot2_f32_bf16 v225, v137, v220, v216
 v_dot2_f32_bf16 v226, v138, v220, v216
 v_dot2_f32_bf16 v227, v139, v220, v216
 v_dot2_f32_bf16 v228, v140, v220, v216
 v_dot2_f32_bf16 v229, v141, v220, v216
 v_dot2_f32_bf16 v230, v142, v220, v216
 v_dot2_f32_bf16 v231, v143, v220, v216
 v_dot2_f32_bf16 v232, v136, v221, v216
 v_dot2_f32_bf16 v233, v137, v221, v216
 v_dot2_f32_bf16 v234, v138, v221, v216
 v_dot2_f32_bf16 v235, v139, v221, v216
 v_dot2_f32_bf16 v236, v140, v221, v216
 v_dot2_f32_bf16 v237, v141, v221, v216
 v_dot2_f32_bf16 v238, v142, v221, v216
 v_dot2_f32_bf16 v239, v143, v221, v216
 v_cvt_pk_bf16_f32 v136, v224, v225
 v_cvt_pk_bf16_f32 v137, v226, v227
 v_cvt_pk_bf16_f32 v138, v228, v229
 v_cvt_pk_bf16_f32 v139, v230, v231
 v_cvt_pk_bf16_f32 v140, v232, v233
 v_cvt_pk_bf16_f32 v141, v234, v235
 v_cvt_pk_bf16_f32 v142, v236, v237
 v_cvt_pk_bf16_f32 v143, v238, v239
 v_dot2_f32_bf16 v224, v144, v220, v216
 v_dot2_f32_bf16 v225, v145, v220, v216
 v_dot2_f32_bf16 v226, v146, v220, v216
 v_dot2_f32_bf16 v227, v147, v220, v216
 v_dot2_f32_bf16 v228, v148, v220, v216
 v_dot2_f32_bf16 v229, v149, v220, v216
 v_dot2_f32_bf16 v230, v150, v220, v216
 v_dot2_f32_bf16 v231, v151, v220, v216
 v_dot2_f32_bf16 v232, v144, v221, v216
 v_dot2_f32_bf16 v233, v145, v221, v216
 v_dot2_f32_bf16 v234, v146, v221, v216
 v_dot2_f32_bf16 v235, v147, v221, v216
 v_dot2_f32_bf16 v236, v148, v221, v216
 v_dot2_f32_bf16 v237, v149, v221, v216
 v_dot2_f32_bf16 v238, v150, v221, v216
 v_dot2_f32_bf16 v239, v151, v221, v216
 v_cvt_pk_bf16_f32 v144, v224, v225
 v_cvt_pk_bf16_f32 v145, v226, v227
 v_cvt_pk_bf16_f32 v146, v228, v229
 v_cvt_pk_bf16_f32 v147, v230, v231
 v_cvt_pk_bf16_f32 v148, v232, v233
 v_cvt_pk_bf16_f32 v149, v234, v235
 v_cvt_pk_bf16_f32 v150, v236, v237
 v_cvt_pk_bf16_f32 v151, v238, v239
 s_waitcnt lgkmcnt(4)
 v_mfma_f32_32x32x16_bf16 v[152:167], a[0:3], v[8:11], v[152:167]
 ds_read_b64_tr_b16 a[24:25], v240 offset:6144
 ds_read_b64_tr_b16 a[26:27], v240 offset:6656
 v_mfma_f32_32x32x16_bf16 v[168:183], a[4:7], v[8:11], v[168:183]
 ds_read_b64_tr_b16 a[28:29], v241 offset:6144
 s_add_u32 m0, s64, 49152
 ds_read_b64_tr_b16 a[30:31], v241 offset:6656
 buffer_load_dwordx4 v4, s[8:11], s52 offen offset:0  lds
 v_mfma_f32_32x32x16_bf16 v[152:167], a[8:11], v[12:15], v[152:167]
 ds_read_b64_tr_b16 a[0:1], v240 offset:8192
 ds_read_b64_tr_b16 a[2:3], v240 offset:8704
 v_mfma_f32_32x32x16_bf16 v[168:183], a[12:15], v[12:15], v[168:183]
 ds_read_b64_tr_b16 a[4:5], v241 offset:8192
 ds_read_b64_tr_b16 a[6:7], v241 offset:8704
 buffer_load_dwordx4 v5, s[8:11], s52 offen offset:1024  lds
 s_waitcnt lgkmcnt(4)
 v_mfma_f32_32x32x16_bf16 v[152:167], a[16:19], v[16:19], v[152:167]
 ds_read_b64_tr_b16 a[8:9], v240 offset:10240
 ds_read_b64_tr_b16 a[10:11], v240 offset:10752
 v_mfma_f32_32x32x16_bf16 v[168:183], a[20:23], v[16:19], v[168:183]
 ds_read_b64_tr_b16 a[12:13], v241 offset:10240
 s_add_u32 m0, s64, 57344
 ds_read_b64_tr_b16 a[14:15], v241 offset:10752
 buffer_load_dwordx4 v4, s[8:11], s53 offen offset:0  lds
 v_mfma_f32_32x32x16_bf16 v[152:167], a[24:27], v[20:23], v[152:167]
 ds_read_b64_tr_b16 a[16:17], v240 offset:12288
 ds_read_b64_tr_b16 a[18:19], v240 offset:12800
 v_mfma_f32_32x32x16_bf16 v[168:183], a[28:31], v[20:23], v[168:183]
 ds_read_b64_tr_b16 a[20:21], v241 offset:12288
 ds_read_b64_tr_b16 a[22:23], v241 offset:12800
 buffer_load_dwordx4 v5, s[8:11], s53 offen offset:1024  lds
 s_waitcnt lgkmcnt(4)
 v_mfma_f32_32x32x16_bf16 v[152:167], a[0:3], v[24:27], v[152:167]
 ds_read_b64_tr_b16 a[24:25], v240 offset:14336
 ds_read_b64_tr_b16 a[26:27], v240 offset:14848
 v_mfma_f32_32x32x16_bf16 v[168:183], a[4:7], v[24:27], v[168:183]
 ds_read_b64_tr_b16 a[28:29], v241 offset:14336
 s_add_u32 m0, s64, 65536
 ds_read_b64_tr_b16 a[30:31], v241 offset:14848
 buffer_load_dwordx4 v4, s[8:11], s54 offen offset:0  lds
 v_mfma_f32_32x32x16_bf16 v[152:167], a[8:11], v[28:31], v[152:167]
 ds_read_b64_tr_b16 a[0:1], v240 offset:16384
 ds_read_b64_tr_b16 a[2:3], v240 offset:16896
 v_mfma_f32_32x32x16_bf16 v[168:183], a[12:15], v[28:31], v[168:183]
 ds_read_b64_tr_b16 a[4:5], v241 offset:16384
 ds_read_b64_tr_b16 a[6:7], v241 offset:16896
 buffer_load_dwordx4 v5, s[8:11], s54 offen offset:1024  lds
 s_waitcnt lgkmcnt(4)
 v_mfma_f32_32x32x16_bf16 v[152:167], a[16:19], v[32:35], v[152:167]
 ds_read_b64_tr_b16 a[8:9], v240 offset:18432
 ds_read_b64_tr_b16 a[10:11], v240 offset:18944
 v_mfma_f32_32x32x16_bf16 v[168:183], a[20:23], v[32:35], v[168:183]
 ds_read_b64_tr_b16 a[12:13], v241 offset:18432
 s_add_u32 m0, s64, 73600
 ds_read_b64_tr_b16 a[14:15], v241 offset:18944
 buffer_load_dwordx4 v4, s[8:11], s46 offen offset:128  lds
 v_mfma_f32_32x32x16_bf16 v[152:167], a[24:27], v[36:39], v[152:167]
 ds_read_b64_tr_b16 a[16:17], v240 offset:20480
 ds_read_b64_tr_b16 a[18:19], v240 offset:20992
 v_mfma_f32_32x32x16_bf16 v[168:183], a[28:31], v[36:39], v[168:183]
 ds_read_b64_tr_b16 a[20:21], v241 offset:20480
 ds_read_b64_tr_b16 a[22:23], v241 offset:20992
 buffer_load_dwordx4 v5, s[8:11], s46 offen offset:1152  lds
 s_waitcnt lgkmcnt(4)
 v_mfma_f32_32x32x16_bf16 v[152:167], a[0:3], v[40:43], v[152:167]
 ds_read_b64_tr_b16 a[24:25], v240 offset:22528
 ds_read_b64_tr_b16 a[26:27], v240 offset:23040
 v_mfma_f32_32x32x16_bf16 v[168:183], a[4:7], v[40:43], v[168:183]
 ds_read_b64_tr_b16 a[28:29], v241 offset:22528
 s_add_u32 m0, s64, 81792
 ds_read_b64_tr_b16 a[30:31], v241 offset:23040
 buffer_load_dwordx4 v4, s[8:11], s47 offen offset:128  lds
 v_mfma_f32_32x32x16_bf16 v[152:167], a[8:11], v[44:47], v[152:167]
 s_barrier
 ds_read_b64_tr_b16 a[0:1], v240 offset:24576
 ds_read_b64_tr_b16 a[2:3], v240 offset:25088
 v_mfma_f32_32x32x16_bf16 v[168:183], a[12:15], v[44:47], v[168:183]
 ds_read_b64_tr_b16 a[4:5], v241 offset:24576
 ds_read_b64_tr_b16 a[6:7], v241 offset:25088
 buffer_load_dwordx4 v5, s[8:11], s47 offen offset:1152  lds
 s_waitcnt lgkmcnt(4)
 v_mfma_f32_32x32x16_bf16 v[152:167], a[16:19], v[48:51], v[152:167]
 ds_read_b64_tr_b16 a[8:9], v240 offset:26624
 ds_read_b64_tr_b16 a[10:11], v240 offset:27136
 v_mfma_f32_32x32x16_bf16 v[168:183], a[20:23], v[48:51], v[168:183]
 ds_read_b64_tr_b16 a[12:13], v241 offset:26624
 s_add_u32 m0, s64, 89984
 ds_read_b64_tr_b16 a[14:15], v241 offset:27136
 buffer_load_dwordx4 v4, s[8:11], s48 offen offset:128  lds
 v_mfma_f32_32x32x16_bf16 v[152:167], a[24:27], v[52:55], v[152:167]
 ds_read_b64_tr_b16 a[16:17], v240 offset:28672
 ds_read_b64_tr_b16 a[18:19], v240 offset:29184
 v_mfma_f32_32x32x16_bf16 v[168:183], a[28:31], v[52:55], v[168:183]
 ds_read_b64_tr_b16 a[20:21], v241 offset:28672
 ds_read_b64_tr_b16 a[22:23], v241 offset:29184
 buffer_load_dwordx4 v5, s[8:11], s48 offen offset:1152  lds
 s_waitcnt lgkmcnt(4)
 v_mfma_f32_32x32x16_bf16 v[152:167], a[0:3], v[56:59], v[152:167]
 ds_read_b64_tr_b16 a[24:25], v240 offset:30720
 ds_read_b64_tr_b16 a[26:27], v240 offset:31232
 v_mfma_f32_32x32x16_bf16 v[168:183], a[4:7], v[56:59], v[168:183]
 ds_read_b64_tr_b16 a[28:29], v241 offset:30720
 s_add_u32 m0, s64, 98176
 ds_read_b64_tr_b16 a[30:31], v241 offset:31232
 buffer_load_dwordx4 v4, s[8:11], s49 offen offset:128  lds
 v_mfma_f32_32x32x16_bf16 v[152:167], a[8:11], v[60:63], v[152:167]
 ds_read_b64_tr_b16 a[0:1], v240 offset:32768
 ds_read_b64_tr_b16 a[2:3], v240 offset:33280
 s_lshr_b32 s96, s42, 1
 v_mfma_f32_32x32x16_bf16 v[168:183], a[12:15], v[60:63], v[168:183]
 ds_read_b64_tr_b16 a[4:5], v241 offset:32768
 ds_read_b64_tr_b16 a[6:7], v241 offset:33280
 buffer_load_dwordx4 v5, s[8:11], s49 offen offset:1152  lds
 s_and_b32 s98, s42, 1
 s_mul_i32 s55, s96, 663552
 s_waitcnt lgkmcnt(4)
 v_mfma_f32_32x32x16_bf16 v[152:167], a[16:19], v[64:67], v[152:167]
 ds_read_b64_tr_b16 a[8:9], v240 offset:34816
 ds_read_b64_tr_b16 a[10:11], v240 offset:35328
 s_lshl_b32 s99, s98, 8
 v_mfma_f32_32x32x16_bf16 v[168:183], a[20:23], v[64:67], v[168:183]
 ds_read_b64_tr_b16 a[12:13], v241 offset:34816
 s_add_u32 m0, s64, 106368
 ds_read_b64_tr_b16 a[14:15], v241 offset:35328
 buffer_load_dwordx4 v4, s[8:11], s50 offen offset:128  lds
 s_add_u32 s55, s55, s99
 v_mfma_f32_32x32x16_bf16 v[152:167], a[24:27], v[68:71], v[152:167]
 ds_read_b64_tr_b16 a[16:17], v240 offset:36864
 ds_read_b64_tr_b16 a[18:19], v240 offset:37376
 s_mul_i32 s99, s98, 294912
 s_add_u32 s56, s55, 73728
 v_mfma_f32_32x32x16_bf16 v[168:183], a[28:31], v[68:71], v[168:183]
 ds_read_b64_tr_b16 a[20:21], v241 offset:36864
 ds_read_b64_tr_b16 a[22:23], v241 offset:37376
 buffer_load_dwordx4 v5, s[8:11], s50 offen offset:1152  lds
 s_add_u32 s56, s56, s99
 s_waitcnt lgkmcnt(4)
 v_mfma_f32_32x32x16_bf16 v[152:167], a[0:3], v[72:75], v[152:167]
 ds_read_b64_tr_b16 a[24:25], v240 offset:38912
 ds_read_b64_tr_b16 a[26:27], v240 offset:39424
 s_add_u32 s57, s55, 147456
 v_mfma_f32_32x32x16_bf16 v[168:183], a[4:7], v[72:75], v[168:183]
 ds_read_b64_tr_b16 a[28:29], v241 offset:38912
 s_add_u32 m0, s64, 114560
 ds_read_b64_tr_b16 a[30:31], v241 offset:39424
 buffer_load_dwordx4 v4, s[8:11], s51 offen offset:128  lds
 s_add_u32 s57, s57, s99
 s_add_u32 s58, s55, 221184
 v_mfma_f32_32x32x16_bf16 v[152:167], a[8:11], v[76:79], v[152:167]
 ds_read_b64_tr_b16 a[0:1], v240 offset:40960
 ds_read_b64_tr_b16 a[2:3], v240 offset:41472
 s_add_u32 s58, s58, s99
 v_mfma_f32_32x32x16_bf16 v[168:183], a[12:15], v[76:79], v[168:183]
 ds_read_b64_tr_b16 a[4:5], v241 offset:40960
 ds_read_b64_tr_b16 a[6:7], v241 offset:41472
 buffer_load_dwordx4 v5, s[8:11], s51 offen offset:1152  lds
 s_add_u32 s59, s55, 294912
 s_waitcnt lgkmcnt(4)
 v_mfma_f32_32x32x16_bf16 v[152:167], a[16:19], v[80:83], v[152:167]
 ds_read_b64_tr_b16 a[8:9], v240 offset:43008
 ds_read_b64_tr_b16 a[10:11], v240 offset:43520
 s_add_u32 s59, s59, s99
 s_add_u32 s60, s55, 368640
 v_mfma_f32_32x32x16_bf16 v[168:183], a[20:23], v[80:83], v[168:183]
 ds_read_b64_tr_b16 a[12:13], v241 offset:43008
 s_add_u32 m0, s64, 122752
 ds_read_b64_tr_b16 a[14:15], v241 offset:43520
 buffer_load_dwordx4 v4, s[8:11], s52 offen offset:128  lds
 s_sub_u32 s60, s60, s99
 v_mfma_f32_32x32x16_bf16 v[152:167], a[24:27], v[84:87], v[152:167]
 ds_read_b64_tr_b16 a[16:17], v240 offset:45056
 ds_read_b64_tr_b16 a[18:19], v240 offset:45568
 s_add_u32 s61, s55, 442368
 v_mfma_f32_32x32x16_bf16 v[168:183], a[28:31], v[84:87], v[168:183]
 ds_read_b64_tr_b16 a[20:21], v241 offset:45056
 ds_read_b64_tr_b16 a[22:23], v241 offset:45568
 buffer_load_dwordx4 v5, s[8:11], s52 offen offset:1152  lds
 s_sub_u32 s61, s61, s99
 s_add_u32 s62, s55, 516096
 s_waitcnt lgkmcnt(4)
 v_mfma_f32_32x32x16_bf16 v[152:167], a[0:3], v[88:91], v[152:167]
 ds_read_b64_tr_b16 a[24:25], v240 offset:47104
ST1_2:
 s_cbranch_execz STB1_0
 ds_read_b64_tr_b16 a[26:27], v240 offset:47616
 s_sub_u32 s62, s62, s99
 v_mfma_f32_32x32x16_bf16 v[168:183], a[4:7], v[88:91], v[168:183]
 ds_read_b64_tr_b16 a[28:29], v241 offset:47104
 s_add_u32 m0, s64, 130944
 ds_read_b64_tr_b16 a[30:31], v241 offset:47616
 buffer_load_dwordx4 v4, s[8:11], s53 offen offset:128  lds
 s_add_u32 s63, s55, 589824
 ds_read_b128 v[184:187], v246 offset:256
 v_mfma_f32_32x32x16_bf16 v[152:167], a[8:11], v[92:95], v[152:167]
 s_waitcnt vmcnt(15)
 s_barrier
 ds_read_b64_tr_b16 a[0:1], v242 offset:0
 ds_read_b64_tr_b16 a[2:3], v242 offset:512
 s_sub_u32 s63, s63, s99
 v_mfma_f32_32x32x16_bf16 v[168:183], a[12:15], v[92:95], v[168:183]
 ds_read_b64_tr_b16 a[4:5], v243 offset:0
 ds_read_b64_tr_b16 a[6:7], v243 offset:512
 buffer_load_dwordx4 v5, s[8:11], s53 offen offset:1152  lds
 s_mul_i32 s66, s43, 18
 s_lshl_b32 s98, s98, 2
 s_waitcnt lgkmcnt(5)
 v_mfma_f32_32x32x16_bf16 v[152:167], a[16:19], v[96:99], v[152:167]
 ds_read_b64_tr_b16 a[8:9], v242 offset:2048
 ds_read_b64_tr_b16 a[10:11], v242 offset:2560
 s_add_u32 s66, s66, s98
 ds_read_b128 v[188:191], v246 offset:288
 v_mfma_f32_32x32x16_bf16 v[168:183], a[20:23], v[96:99], v[168:183]
 ds_read_b64_tr_b16 a[12:13], v243 offset:2048
 s_add_u32 m0, s64, 139136
 ds_read_b64_tr_b16 a[14:15], v243 offset:2560
 buffer_load_dwordx4 v4, s[8:11], s54 offen offset:128  lds
 s_lshl_b32 s66, s66, 3
 v_mfma_f32_32x32x16_bf16 v[152:167], a[24:27], v[100:103], v[152:167]
 ds_read_b64_tr_b16 a[16:17], v242 offset:4096
 ds_read_b64_tr_b16 a[18:19], v242 offset:4608
 s_add_u32 s66, s66, s96
 s_lshl_b32 s66, s66, 11
 v_mfma_f32_32x32x16_bf16 v[168:183], a[28:31], v[100:103], v[168:183]
 ds_read_b64_tr_b16 a[20:21], v243 offset:4096
 ds_read_b64_tr_b16 a[22:23], v243 offset:4608
 s_add_u32 s66, s66, 18874368
 s_waitcnt lgkmcnt(4)
 v_mfma_f32_32x32x16_bf16 v[152:167], a[0:3], v[104:107], v[152:167]
 ds_read_b64_tr_b16 a[24:25], v242 offset:6144
 ds_read_b64_tr_b16 a[26:27], v242 offset:6656
 s_and_b32 s98, s42, 1
 ds_read_b128 v[192:195], v246 offset:320
 v_mfma_f32_32x32x16_bf16 v[168:183], a[4:7], v[104:107], v[168:183]
 ds_read_b64_tr_b16 a[28:29], v243 offset:6144
 ds_read_b64_tr_b16 a[30:31], v243 offset:6656
 buffer_load_dwordx4 v5, s[8:11], s54 offen offset:1152  lds
 s_mul_i32 s32, s43, 288
 s_mul_i32 s99, s96, 36
 v_mfma_f32_32x32x16_bf16 v[152:167], a[8:11], v[108:111], v[152:167]
 ds_read_b64_tr_b16 a[0:1], v242 offset:8192
 ds_read_b64_tr_b16 a[2:3], v242 offset:8704
 s_add_u32 s32, s32, s99
 v_mfma_f32_32x32x16_bf16 v[168:183], a[12:15], v[108:111], v[168:183]
 ds_read_b64_tr_b16 a[4:5], v243 offset:8192
 ds_read_b64_tr_b16 a[6:7], v243 offset:8704
 s_lshl_b32 s32, s32, 10
 ds_read_b128 v[196:199], v246 offset:352
 s_waitcnt lgkmcnt(5)
 v_mfma_f32_32x32x16_bf16 v[152:167], a[16:19], v[112:115], v[152:167]
 ds_read_b64_tr_b16 a[8:9], v242 offset:10240
 ds_read_b64_tr_b16 a[10:11], v242 offset:10752
 s_lshl_b32 s99, s98, 14
 s_sub_u32 s33, s32, s99
 v_mfma_f32_32x32x16_bf16 v[168:183], a[20:23], v[112:115], v[168:183]
 ds_read_b64_tr_b16 a[12:13], v243 offset:10240
 ds_read_b64_tr_b16 a[14:15], v243 offset:10752
 s_add_u32 m0, s64, 0
 s_add_u32 s68, s46, 256
 buffer_load_dwordx4 v4, s[8:11], s68 offen  lds
 s_xor_b32 s34, s67, 128
 v_mfma_f32_32x32x16_bf16 v[152:167], a[24:27], v[116:119], v[152:167]
 ds_read_b64_tr_b16 a[16:17], v242 offset:12288
 ds_read_b64_tr_b16 a[18:19], v242 offset:12800
 ds_read_b128 v[200:203], v246 offset:384
 v_mfma_f32_32x32x16_bf16 v[168:183], a[28:31], v[116:119], v[168:183]
 ds_read_b64_tr_b16 a[20:21], v243 offset:12288
 ds_read_b64_tr_b16 a[22:23], v243 offset:12800
 s_waitcnt lgkmcnt(5)
 v_mfma_f32_32x32x16_bf16 v[152:167], a[0:3], v[120:123], v[152:167]
 ds_read_b64_tr_b16 a[24:25], v242 offset:14336
 ds_read_b64_tr_b16 a[26:27], v242 offset:14848
 s_lshr_b32 s0, s2, 4
 s_lshl_b32 s0, s0, 2
 v_mfma_f32_32x32x16_bf16 v[168:183], a[4:7], v[120:123], v[168:183]
 ds_read_b64_tr_b16 a[28:29], v243 offset:14336
 ds_read_b64_tr_b16 a[30:31], v243 offset:14848
 buffer_load_dwordx4 v5, s[8:11], s68 offen offset:1024  lds
 ds_read_b128 v[204:207], v246 offset:416
 s_add_u32 s0, s0, s40
 v_mfma_f32_32x32x16_bf16 v[152:167], a[8:11], v[124:127], v[152:167]
 ds_read_b64_tr_b16 a[0:1], v242 offset:16384
 ds_read_b64_tr_b16 a[2:3], v242 offset:16896
 s_mul_i32 s0, s0, 5248
 s_lshr_b32 s1, s41, 3
 v_mfma_f32_32x32x16_bf16 v[168:183], a[12:15], v[124:127], v[168:183]
 ds_read_b64_tr_b16 a[4:5], v243 offset:16384
 ds_read_b64_tr_b16 a[6:7], v243 offset:16896
 s_xor_b32 s1, s1, 0
 s_waitcnt lgkmcnt(5)
 v_mfma_f32_32x32x16_bf16 v[152:167], a[16:19], v[128:131], v[152:167]
 ds_read_b64_tr_b16 a[8:9], v242 offset:18432
 ds_read_b64_tr_b16 a[10:11], v242 offset:18944
 s_mul_i32 s1, s1, 663552
 s_add_u32 s0, s0, s1
 v_mfma_f32_32x32x16_bf16 v[168:183], a[20:23], v[128:131], v[168:183]
 ds_read_b64_tr_b16 a[12:13], v243 offset:18432
 s_add_u32 m0, s64, 7936
 ds_read_b64_tr_b16 a[14:15], v243 offset:18944
 buffer_load_dwordx4 v4, s[8:11], s47 offen offset:256  lds
 ds_read_b128 v[208:211], v246 offset:448
 s_lshr_b32 s1, s42, 2
 v_mfma_f32_32x32x16_bf16 v[152:167], a[24:27], v[132:135], v[152:167]
 ds_read_b64_tr_b16 a[16:17], v242 offset:20480
 ds_read_b64_tr_b16 a[18:19], v242 offset:20992
 s_mul_i32 s1, s1, 1327104
 s_add_u32 s0, s0, s1
 v_mfma_f32_32x32x16_bf16 v[168:183], a[28:31], v[132:135], v[168:183]
 ds_read_b64_tr_b16 a[20:21], v243 offset:20480
 ds_read_b64_tr_b16 a[22:23], v243 offset:20992
 s_add_u32 s0, s0, 331776
 v_lshlrev_b32 v254, 7, v2
 s_waitcnt lgkmcnt(5)
 v_mfma_f32_32x32x16_bf16 v[152:167], a[0:3], v[136:139], v[152:167]
 ds_read_b64_tr_b16 a[24:25], v242 offset:22528
 ds_read_b64_tr_b16 a[26:27], v242 offset:23040
 ds_read_b128 v[212:215], v246 offset:480
 s_lshr_b32 s69, s2, 4
 v_mfma_f32_32x32x16_bf16 v[168:183], a[4:7], v[136:139], v[168:183]
 ds_read_b64_tr_b16 a[28:29], v243 offset:22528
 ds_read_b64_tr_b16 a[30:31], v243 offset:23040
 buffer_load_dwordx4 v5, s[8:11], s47 offen offset:1280  lds
 s_lshl_b32 s69, s69, 3
 s_and_b32 s3, s2, 7
 v_mfma_f32_32x32x16_bf16 v[152:167], a[8:11], v[140:143], v[152:167]
 s_waitcnt vmcnt(16)
 s_barrier
 ds_read_b64_tr_b16 a[0:1], v242 offset:24576
 ds_read_b64_tr_b16 a[2:3], v242 offset:25088
 s_add_u32 s69, s69, s3
 v_mfma_f32_32x32x16_bf16 v[168:183], a[12:15], v[140:143], v[168:183]
 ds_read_b64_tr_b16 a[4:5], v243 offset:24576
 ds_read_b64_tr_b16 a[6:7], v243 offset:25088
 s_lshl_b32 s69, s69, 2
 s_add_u32 s69, s69, s40
 s_waitcnt lgkmcnt(4)
 v_mfma_f32_32x32x16_bf16 v[152:167], a[16:19], v[144:147], v[152:167]
 ds_read_b64_tr_b16 a[8:9], v242 offset:26624
 s_add_u32 m0, s64, 16128
 ds_read_b64_tr_b16 a[10:11], v242 offset:27136
 buffer_load_dwordx4 v4, s[8:11], s48 offen offset:256  lds
 s_min_u32 s69, s69, 486
 v_mfma_f32_32x32x16_bf16 v[168:183], a[20:23], v[144:147], v[168:183]
 ds_read_b64_tr_b16 a[12:13], v243 offset:26624
 ds_read_b64_tr_b16 a[14:15], v243 offset:27136
 buffer_load_dwordx4 v5, s[8:11], s48 offen offset:1280  lds
 s_mul_i32 s69, s69, 2432
 v_lshlrev_b32 v254, 7, v2
 v_mfma_f32_32x32x16_bf16 v[152:167], a[24:27], v[148:151], v[152:167]
 ds_read_b64_tr_b16 a[16:17], v242 offset:28672
 ds_read_b64_tr_b16 a[18:19], v242 offset:29184
 v_mfma_f32_32x32x16_bf16 v[168:183], a[28:31], v[148:151], v[168:183]
 ds_read_b64_tr_b16 a[20:21], v243 offset:28672
 ds_read_b64_tr_b16 a[22:23], v243 offset:29184
 s_bitcmp1_b32 s40, 0
 s_mov_b64 exec, 0x7ffff
 buffer_load_dword a255, v254, s[20:23], s69 offen
 buffer_load_dword a255, v254, s[24:27], s69 offen
 s_mov_b64 exec, -1
 s_nop 0
 s_bfm_b64 exec, 41, 0
 buffer_load_dword a255, v254, s[12:15], s0 offen
 s_mov_b64 exec, -1
 s_nop 0
 s_waitcnt lgkmcnt(4)
 v_mfma_f32_32x32x16_bf16 v[184:199], a[0:3], v[8:11], v[184:199]
 ds_read_b64_tr_b16 a[24:25], v242 offset:30720
 ds_read_b64_tr_b16 a[26:27], v242 offset:31232
 v_mfma_f32_32x32x16_bf16 v[200:215], a[4:7], v[8:11], v[200:215]
 ds_read_b64_tr_b16 a[28:29], v243 offset:30720
 ds_read_b64_tr_b16 a[30:31], v243 offset:31232
 v_cvt_pk_f16_f32 v220, v152, v153
 v_cvt_pk_f16_f32 v221, v154, v155
 v_pk_fma_f16 v222, v220, v220, s70
 v_pk_fma_f16 v223, v221, v221, s70
 v_mfma_f32_32x32x16_bf16 v[184:199], a[8:11], v[12:15], v[184:199]
 ds_read_b64_tr_b16 a[0:1], v242 offset:32768
 ds_read_b64_tr_b16 a[2:3], v242 offset:33280
 v_pk_mul_f16 v220, v222, v220 neg_lo:[1,0] neg_hi:[1,0]
 v_pk_mul_f16 v221, v223, v221 neg_lo:[1,0] neg_hi:[1,0]
 v_exp_f16 v222, v220
NC_19:
 v_readfirstlane_b32 s45, v248
 s_nop 3
 s_cmp_eq_u32 s45, 0
 s_cbranch_scc1 NS_20
NK_21:
 v_mfma_f32_32x32x16_bf16 v[200:215], a[12:15], v[12:15], v[200:215]
 ds_read_b64_tr_b16 a[4:5], v243 offset:32768
 ds_read_b64_tr_b16 a[6:7], v243 offset:33280
 v_exp_f16 v223, v221
 v_exp_f16_sdwa v222, v220 dst_sel:WORD_1 dst_unused:UNUSED_PRESERVE src0_sel:WORD_1
 s_waitcnt lgkmcnt(4)
 v_mfma_f32_32x32x16_bf16 v[184:199], a[16:19], v[16:19], v[184:199]
 ds_read_b64_tr_b16 a[8:9], v242 offset:34816
 ds_read_b64_tr_b16 a[10:11], v242 offset:35328
 v_exp_f16_sdwa v223, v221 dst_sel:WORD_1 dst_unused:UNUSED_PRESERVE src0_sel:WORD_1
 v_pk_fma_f16 v220, v222, v247, v247
 v_pk_fma_f16 v221, v223, v247, v247
 v_mfma_f32_32x32x16_bf16 v[200:215], a[20:23], v[16:19], v[200:215]
 ds_read_b64_tr_b16 a[12:13], v243 offset:34816
 ds_read_b64_tr_b16 a[14:15], v243 offset:35328
 v_rcp_f16 v216, v220
 v_rcp_f16 v218, v221
 v_mfma_f32_32x32x16_bf16 v[184:199], a[24:27], v[20:23], v[184:199]
 ds_read_b64_tr_b16 a[16:17], v242 offset:36864
 ds_read_b64_tr_b16 a[18:19], v242 offset:37376
 v_rcp_f16_sdwa v217, v220 dst_sel:WORD_0 dst_unused:UNUSED_PAD src0_sel:WORD_1
 v_rcp_f16_sdwa v219, v221 dst_sel:WORD_0 dst_unused:UNUSED_PAD src0_sel:WORD_1
 v_mfma_f32_32x32x16_bf16 v[200:215], a[28:31], v[20:23], v[200:215]
 ds_read_b64_tr_b16 a[20:21], v243 offset:36864
 ds_read_b64_tr_b16 a[22:23], v243 offset:37376
 v_fma_mix_f32 v216, v152, v216, 0 op_sel_hi:[0,1,0]
 v_fma_mix_f32 v218, v154, v218, 0 op_sel_hi:[0,1,0]
 v_fma_mix_f32 v217, v153, v217, 0 op_sel_hi:[0,1,0]
 v_fma_mix_f32 v219, v155, v219, 0 op_sel_hi:[0,1,0]
 s_waitcnt lgkmcnt(4)
 v_mfma_f32_32x32x16_bf16 v[184:199], a[0:3], v[24:27], v[184:199]
 ds_read_b64_tr_b16 a[24:25], v242 offset:38912
 ds_read_b64_tr_b16 a[26:27], v242 offset:39424
 ds_read_b128 v[152:155], v246 offset:512
 v_cvt_pk_bf16_f32 v224, v216, v217
 v_cvt_pk_bf16_f32 v225, v218, v219
 v_mfma_f32_32x32x16_bf16 v[200:215], a[4:7], v[24:27], v[200:215]
 ds_read_b64_tr_b16 a[28:29], v243 offset:38912
 ds_read_b64_tr_b16 a[30:31], v243 offset:39424
 v_accvgpr_write_b32 a32, v224
 v_accvgpr_write_b32 a33, v225
 v_cvt_pk_f16_f32 v220, v156, v157
 v_cvt_pk_f16_f32 v221, v158, v159
 v_mfma_f32_32x32x16_bf16 v[184:199], a[8:11], v[28:31], v[184:199]
 ds_read_b64_tr_b16 a[0:1], v242 offset:40960
 ds_read_b64_tr_b16 a[2:3], v242 offset:41472
 v_pk_fma_f16 v222, v220, v220, s70
 v_pk_fma_f16 v223, v221, v221, s70
 v_pk_mul_f16 v220, v222, v220 neg_lo:[1,0] neg_hi:[1,0]
 v_pk_mul_f16 v221, v223, v221 neg_lo:[1,0] neg_hi:[1,0]
 v_mfma_f32_32x32x16_bf16 v[200:215], a[12:15], v[28:31], v[200:215]
 ds_read_b64_tr_b16 a[4:5], v243 offset:40960
 ds_read_b64_tr_b16 a[6:7], v243 offset:41472
 v_exp_f16 v222, v220
 v_exp_f16 v223, v221
 s_waitcnt lgkmcnt(4)
 v_mfma_f32_32x32x16_bf16 v[184:199], a[16:19], v[32:35], v[184:199]
 ds_read_b64_tr_b16 a[8:9], v242 offset:43008
 ds_read_b64_tr_b16 a[10:11], v242 offset:43520
 v_exp_f16_sdwa v222, v220 dst_sel:WORD_1 dst_unused:UNUSED_PRESERVE src0_sel:WORD_1
 v_exp_f16_sdwa v223, v221 dst_sel:WORD_1 dst_unused:UNUSED_PRESERVE src0_sel:WORD_1
 v_mfma_f32_32x32x16_bf16 v[200:215], a[20:23], v[32:35], v[200:215]
 ds_read_b64_tr_b16 a[12:13], v243 offset:43008
 ds_read_b64_tr_b16 a[14:15], v243 offset:43520
 v_pk_fma_f16 v220, v222, v247, v247
 v_pk_fma_f16 v221, v223, v247, v247
 v_rcp_f16 v216, v220
 v_mfma_f32_32x32x16_bf16 v[184:199], a[24:27], v[36:39], v[184:199]
 ds_read_b64_tr_b16 a[16:17], v242 offset:45056
 ds_read_b64_tr_b16 a[18:19], v242 offset:45568
 v_rcp_f16 v218, v221
 v_rcp_f16_sdwa v217, v220 dst_sel:WORD_0 dst_unused:UNUSED_PAD src0_sel:WORD_1
 v_mfma_f32_32x32x16_bf16 v[200:215], a[28:31], v[36:39], v[200:215]
 ds_read_b64_tr_b16 a[20:21], v243 offset:45056
 ds_read_b64_tr_b16 a[22:23], v243 offset:45568
 v_rcp_f16_sdwa v219, v221 dst_sel:WORD_0 dst_unused:UNUSED_PAD src0_sel:WORD_1
 v_fma_mix_f32 v216, v156, v216, 0 op_sel_hi:[0,1,0]
 s_waitcnt lgkmcnt(4)
 v_mfma_f32_32x32x16_bf16 v[184:199], a[0:3], v[40:43], v[184:199]
 ds_read_b64_tr_b16 a[24:25], v242 offset:47104
 ds_read_b64_tr_b16 a[26:27], v242 offset:47616
 v_fma_mix_f32 v218, v158, v218, 0 op_sel_hi:[0,1,0]
 v_fma_mix_f32 v217, v157, v217, 0 op_sel_hi:[0,1,0]
 v_fma_mix_f32 v219, v159, v219, 0 op_sel_hi:[0,1,0]
 ds_read_b128 v[156:159], v246 offset:544
 v_mfma_f32_32x32x16_bf16 v[200:215], a[4:7], v[40:43], v[200:215]
 ds_read_b64_tr_b16 a[28:29], v243 offset:47104
 ds_read_b64_tr_b16 a[30:31], v243 offset:47616
 v_cvt_pk_bf16_f32 v226, v216, v217
 v_cvt_pk_bf16_f32 v227, v218, v219
 v_accvgpr_write_b32 a34, v226
 v_mfma_f32_32x32x16_bf16 v[184:199], a[8:11], v[44:47], v[184:199]
 s_waitcnt vmcnt(14)
 s_barrier
 ds_read_b64_tr_b16 a[0:1], v244 offset:0
 ds_read_b64_tr_b16 a[2:3], v244 offset:512
 v_accvgpr_write_b32 a35, v227
 s_add_u32 s69, s65, 0
 v_cvt_pk_f16_f32 v220, v160, v161
 v_cvt_pk_f16_f32 v221, v162, v163
 v_mfma_f32_32x32x16_bf16 v[200:215], a[12:15], v[44:47], v[200:215]
 ds_read_b64_tr_b16 a[4:5], v245 offset:0
 ds_read_b64_tr_b16 a[6:7], v245 offset:512
 v_pk_fma_f16 v222, v220, v220, s70
 v_pk_fma_f16 v223, v221, v221, s70
 v_pk_mul_f16 v220, v222, v220 neg_lo:[1,0] neg_hi:[1,0]
 v_pk_mul_f16 v221, v223, v221 neg_lo:[1,0] neg_hi:[1,0]
 s_waitcnt lgkmcnt(4)
 v_mfma_f32_32x32x16_bf16 v[184:199], a[16:19], v[48:51], v[184:199]
 ds_read_b64_tr_b16 a[8:9], v244 offset:2048
 ds_read_b64_tr_b16 a[10:11], v244 offset:2560
 v_exp_f16 v222, v220
 v_exp_f16 v223, v221
 v_mfma_f32_32x32x16_bf16 v[200:215], a[20:23], v[48:51], v[200:215]
 ds_read_b64_tr_b16 a[12:13], v245 offset:2048
 ds_read_b64_tr_b16 a[14:15], v245 offset:2560
 v_exp_f16_sdwa v222, v220 dst_sel:WORD_1 dst_unused:UNUSED_PRESERVE src0_sel:WORD_1
 v_exp_f16_sdwa v223, v221 dst_sel:WORD_1 dst_unused:UNUSED_PRESERVE src0_sel:WORD_1
 v_mfma_f32_32x32x16_bf16 v[184:199], a[24:27], v[52:55], v[184:199]
 ds_read_b64_tr_b16 a[16:17], v244 offset:4096
 ds_read_b64_tr_b16 a[18:19], v244 offset:4608
 v_pk_fma_f16 v220, v222, v247, v247
 v_pk_fma_f16 v221, v223, v247, v247
 v_rcp_f16 v216, v220
 v_mfma_f32_32x32x16_bf16 v[200:215], a[28:31], v[52:55], v[200:215]
 ds_read_b64_tr_b16 a[20:21], v245 offset:4096
 ds_read_b64_tr_b16 a[22:23], v245 offset:4608
 v_rcp_f16 v218, v221
 v_rcp_f16_sdwa v217, v220 dst_sel:WORD_0 dst_unused:UNUSED_PAD src0_sel:WORD_1
 s_waitcnt lgkmcnt(4)
 v_mfma_f32_32x32x16_bf16 v[184:199], a[0:3], v[56:59], v[184:199]
 ds_read_b64_tr_b16 a[24:25], v244 offset:6144
 ds_read_b64_tr_b16 a[26:27], v244 offset:6656
 v_rcp_f16_sdwa v219, v221 dst_sel:WORD_0 dst_unused:UNUSED_PAD src0_sel:WORD_1
 v_fma_mix_f32 v216, v160, v216, 0 op_sel_hi:[0,1,0]
 v_fma_mix_f32 v218, v162, v218, 0 op_sel_hi:[0,1,0]
 v_mfma_f32_32x32x16_bf16 v[200:215], a[4:7], v[56:59], v[200:215]
 ds_read_b64_tr_b16 a[28:29], v245 offset:6144
 ds_read_b64_tr_b16 a[30:31], v245 offset:6656
 v_fma_mix_f32 v217, v161, v217, 0 op_sel_hi:[0,1,0]
 v_fma_mix_f32 v219, v163, v219, 0 op_sel_hi:[0,1,0]
 ds_read_b128 v[160:163], v246 offset:576
 v_mfma_f32_32x32x16_bf16 v[184:199], a[8:11], v[60:63], v[184:199]
 ds_read_b64_tr_b16 a[0:1], v244 offset:8192
 ds_read_b64_tr_b16 a[2:3], v244 offset:8704
 v_cvt_pk_bf16_f32 v228, v216, v217
 v_cvt_pk_bf16_f32 v229, v218, v219
 v_accvgpr_write_b32 a36, v228
 v_accvgpr_write_b32 a37, v229
 v_mfma_f32_32x32x16_bf16 v[200:215], a[12:15], v[60:63], v[200:215]
 ds_read_b64_tr_b16 a[4:5], v245 offset:8192
 ds_read_b64_tr_b16 a[6:7], v245 offset:8704
 v_cvt_pk_f16_f32 v220, v164, v165
 v_cvt_pk_f16_f32 v221, v166, v167
 v_pk_fma_f16 v222, v220, v220, s70
 v_pk_fma_f16 v223, v221, v221, s70
 s_waitcnt lgkmcnt(5)
 v_mfma_f32_32x32x16_bf16 v[184:199], a[16:19], v[64:67], v[184:199]
 ds_read_b64_tr_b16 a[8:9], v244 offset:10240
 ds_read_b64_tr_b16 a[10:11], v244 offset:10752
 v_pk_mul_f16 v220, v222, v220 neg_lo:[1,0] neg_hi:[1,0]
 v_pk_mul_f16 v221, v223, v221 neg_lo:[1,0] neg_hi:[1,0]
 v_exp_f16 v222, v220
 v_mfma_f32_32x32x16_bf16 v[200:215], a[20:23], v[64:67], v[200:215]
 ds_read_b64_tr_b16 a[12:13], v245 offset:10240
 ds_read_b64_tr_b16 a[14:15], v245 offset:10752
 v_exp_f16 v223, v221
 v_exp_f16_sdwa v222, v220 dst_sel:WORD_1 dst_unused:UNUSED_PRESERVE src0_sel:WORD_1
 v_mfma_f32_32x32x16_bf16 v[184:199], a[24:27], v[68:71], v[184:199]
 ds_read_b64_tr_b16 a[16:17], v244 offset:12288
 ds_read_b64_tr_b16 a[18:19], v244 offset:12800
 v_exp_f16_sdwa v223, v221 dst_sel:WORD_1 dst_unused:UNUSED_PRESERVE src0_sel:WORD_1
 v_pk_fma_f16 v220, v222, v247, v247
 v_pk_fma_f16 v221, v223, v247, v247
 v_mfma_f32_32x32x16_bf16 v[200:215], a[28:31], v[68:71], v[200:215]
 ds_read_b64_tr_b16 a[20:21], v245 offset:12288
 ds_read_b64_tr_b16 a[22:23], v245 offset:12800
 v_rcp_f16 v216, v220
 v_rcp_f16 v218, v221
 s_waitcnt lgkmcnt(4)
 v_mfma_f32_32x32x16_bf16 v[184:199], a[0:3], v[72:75], v[184:199]
 ds_read_b64_tr_b16 a[24:25], v244 offset:14336
 ds_read_b64_tr_b16 a[26:27], v244 offset:14848
 v_rcp_f16_sdwa v217, v220 dst_sel:WORD_0 dst_unused:UNUSED_PAD src0_sel:WORD_1
 v_rcp_f16_sdwa v219, v221 dst_sel:WORD_0 dst_unused:UNUSED_PAD src0_sel:WORD_1
 v_mfma_f32_32x32x16_bf16 v[200:215], a[4:7], v[72:75], v[200:215]
 ds_read_b64_tr_b16 a[28:29], v245 offset:14336
 s_add_u32 m0, s64, 24320
 ds_read_b64_tr_b16 a[30:31], v245 offset:14848
 buffer_load_dwordx4 v4, s[8:11], s49 offen offset:256  lds
 v_fma_mix_f32 v216, v164, v216, 0 op_sel_hi:[0,1,0]
 v_fma_mix_f32 v218, v166, v218, 0 op_sel_hi:[0,1,0]
 v_fma_mix_f32 v217, v165, v217, 0 op_sel_hi:[0,1,0]
 v_fma_mix_f32 v219, v167, v219, 0 op_sel_hi:[0,1,0]
 v_mfma_f32_32x32x16_bf16 v[184:199], a[8:11], v[76:79], v[184:199]
 ds_read_b64_tr_b16 a[0:1], v244 offset:16384
 ds_read_b64_tr_b16 a[2:3], v244 offset:16896
 ds_read_b128 v[164:167], v246 offset:608
 v_cvt_pk_bf16_f32 v230, v216, v217
 v_cvt_pk_bf16_f32 v231, v218, v219
 v_mfma_f32_32x32x16_bf16 v[200:215], a[12:15], v[76:79], v[200:215]
 ds_read_b64_tr_b16 a[4:5], v245 offset:16384
 ds_read_b64_tr_b16 a[6:7], v245 offset:16896
 buffer_load_dwordx4 v5, s[8:11], s49 offen offset:1280  lds
 v_accvgpr_write_b32 a38, v230
 v_accvgpr_write_b32 a39, v231
 v_cvt_pk_f16_f32 v220, v168, v169
 v_cvt_pk_f16_f32 v221, v170, v171
 s_waitcnt lgkmcnt(5)
 v_mfma_f32_32x32x16_bf16 v[184:199], a[16:19], v[80:83], v[184:199]
 ds_read_b64_tr_b16 a[8:9], v244 offset:18432
 ds_read_b64_tr_b16 a[10:11], v244 offset:18944
 v_pk_fma_f16 v222, v220, v220, s70
 v_pk_fma_f16 v223, v221, v221, s70
 v_pk_mul_f16 v220, v222, v220 neg_lo:[1,0] neg_hi:[1,0]
 v_mfma_f32_32x32x16_bf16 v[200:215], a[20:23], v[80:83], v[200:215]
 ds_read_b64_tr_b16 a[12:13], v245 offset:18432
 s_add_u32 m0, s64, 32512
 ds_read_b64_tr_b16 a[14:15], v245 offset:18944
 buffer_load_dwordx4 v4, s[8:11], s50 offen offset:256  lds
 v_pk_mul_f16 v221, v223, v221 neg_lo:[1,0] neg_hi:[1,0]
 v_exp_f16 v222, v220
 v_exp_f16 v223, v221
 v_mfma_f32_32x32x16_bf16 v[184:199], a[24:27], v[84:87], v[184:199]
 ds_read_b64_tr_b16 a[16:17], v244 offset:20480
 ds_read_b64_tr_b16 a[18:19], v244 offset:20992
 v_exp_f16_sdwa v222, v220 dst_sel:WORD_1 dst_unused:UNUSED_PRESERVE src0_sel:WORD_1
 v_exp_f16_sdwa v223, v221 dst_sel:WORD_1 dst_unused:UNUSED_PRESERVE src0_sel:WORD_1
 v_mfma_f32_32x32x16_bf16 v[200:215], a[28:31], v[84:87], v[200:215]
 ds_read_b64_tr_b16 a[20:21], v245 offset:20480
 ds_read_b64_tr_b16 a[22:23], v245 offset:20992
 buffer_load_dwordx4 v5, s[8:11], s50 offen offset:1280  lds
 v_pk_fma_f16 v220, v222, v247, v247
 v_pk_fma_f16 v221, v223, v247, v247
 v_rcp_f16 v216, v220
 s_waitcnt lgkmcnt(4)
 v_mfma_f32_32x32x16_bf16 v[184:199], a[0:3], v[88:91], v[184:199]
 ds_read_b64_tr_b16 a[24:25], v244 offset:22528
 ds_read_b64_tr_b16 a[26:27], v244 offset:23040
 v_rcp_f16 v218, v221
 v_rcp_f16_sdwa v217, v220 dst_sel:WORD_0 dst_unused:UNUSED_PAD src0_sel:WORD_1
 v_mfma_f32_32x32x16_bf16 v[200:215], a[4:7], v[88:91], v[200:215]
 ds_read_b64_tr_b16 a[28:29], v245 offset:22528
 s_add_u32 m0, s64, 40704
 ds_read_b64_tr_b16 a[30:31], v245 offset:23040
 buffer_load_dwordx4 v4, s[8:11], s51 offen offset:256  lds
 v_rcp_f16_sdwa v219, v221 dst_sel:WORD_0 dst_unused:UNUSED_PAD src0_sel:WORD_1
 v_fma_mix_f32 v216, v168, v216, 0 op_sel_hi:[0,1,0]
 v_mfma_f32_32x32x16_bf16 v[184:199], a[8:11], v[92:95], v[184:199]
 s_waitcnt vmcnt(13)
 s_barrier
 ds_read_b64_tr_b16 a[0:1], v244 offset:24576
 ds_read_b64_tr_b16 a[2:3], v244 offset:25088
 v_fma_mix_f32 v218, v170, v218, 0 op_sel_hi:[0,1,0]
 v_fma_mix_f32 v217, v169, v217, 0 op_sel_hi:[0,1,0]
 v_fma_mix_f32 v219, v171, v219, 0 op_sel_hi:[0,1,0]
 ds_read_b128 v[168:171], v246 offset:640
 v_mfma_f32_32x32x16_bf16 v[200:215], a[12:15], v[92:95], v[200:215]
 ds_read_b64_tr_b16 a[4:5], v245 offset:24576
 ds_read_b64_tr_b16 a[6:7], v245 offset:25088
 buffer_load_dwordx4 v5, s[8:11], s51 offen offset:1280  lds
 v_cvt_pk_bf16_f32 v232, v216, v217
 v_cvt_pk_bf16_f32 v233, v218, v219
 v_accvgpr_write_b32 a40, v232
 s_waitcnt lgkmcnt(5)
 v_mfma_f32_32x32x16_bf16 v[184:199], a[16:19], v[96:99], v[184:199]
 ds_read_b64_tr_b16 a[8:9], v244 offset:26624
 ds_read_b64_tr_b16 a[10:11], v244 offset:27136
 v_accvgpr_write_b32 a41, v233
 buffer_store_dwordx4 v[224:227], v0, s[16:19], s69 offen offset:0 sc1
 v_cvt_pk_f16_f32 v220, v172, v173
 v_cvt_pk_f16_f32 v221, v174, v175
 v_mfma_f32_32x32x16_bf16 v[200:215], a[20:23], v[96:99], v[200:215]
 ds_read_b64_tr_b16 a[12:13], v245 offset:26624
 s_add_u32 m0, s64, 48896
 ds_read_b64_tr_b16 a[14:15], v245 offset:27136
 buffer_load_dwordx4 v4, s[8:11], s52 offen offset:256  lds
 v_pk_fma_f16 v222, v220, v220, s70
 v_pk_fma_f16 v223, v221, v221, s70
 v_pk_mul_f16 v220, v222, v220 neg_lo:[1,0] neg_hi:[1,0]
 v_pk_mul_f16 v221, v223, v221 neg_lo:[1,0] neg_hi:[1,0]
 v_mfma_f32_32x32x16_bf16 v[184:199], a[24:27], v[100:103], v[184:199]
 ds_read_b64_tr_b16 a[16:17], v244 offset:28672
 ds_read_b64_tr_b16 a[18:19], v244 offset:29184
 v_exp_f16 v222, v220
 v_exp_f16 v223, v221
 v_mfma_f32_32x32x16_bf16 v[200:215], a[28:31], v[100:103], v[200:215]
 ds_read_b64_tr_b16 a[20:21], v245 offset:28672
 ds_read_b64_tr_b16 a[22:23], v245 offset:29184
 buffer_load_dwordx4 v5, s[8:11], s52 offen offset:1280  lds
 v_exp_f16_sdwa v222, v220 dst_sel:WORD_1 dst_unused:UNUSED_PRESERVE src0_sel:WORD_1
 v_exp_f16_sdwa v223, v221 dst_sel:WORD_1 dst_unused:UNUSED_PRESERVE src0_sel:WORD_1
 s_waitcnt lgkmcnt(4)
 v_mfma_f32_32x32x16_bf16 v[184:199], a[0:3], v[104:107], v[184:199]
 ds_read_b64_tr_b16 a[24:25], v244 offset:30720
 ds_read_b64_tr_b16 a[26:27], v244 offset:31232
 v_pk_fma_f16 v220, v222, v247, v247
 v_pk_fma_f16 v221, v223, v247, v247
 v_rcp_f16 v216, v220
 v_mfma_f32_32x32x16_bf16 v[200:215], a[4:7], v[104:107], v[200:215]
 ds_read_b64_tr_b16 a[28:29], v245 offset:30720
 s_add_u32 m0, s64, 57088
 ds_read_b64_tr_b16 a[30:31], v245 offset:31232
 buffer_load_dwordx4 v4, s[8:11], s53 offen offset:256  lds
 v_rcp_f16 v218, v221
 v_rcp_f16_sdwa v217, v220 dst_sel:WORD_0 dst_unused:UNUSED_PAD src0_sel:WORD_1
 v_mfma_f32_32x32x16_bf16 v[184:199], a[8:11], v[108:111], v[184:199]
 ds_read_b64_tr_b16 a[0:1], v244 offset:32768
 ds_read_b64_tr_b16 a[2:3], v244 offset:33280
 v_rcp_f16_sdwa v219, v221 dst_sel:WORD_0 dst_unused:UNUSED_PAD src0_sel:WORD_1
 v_fma_mix_f32 v216, v172, v216, 0 op_sel_hi:[0,1,0]
 v_fma_mix_f32 v218, v174, v218, 0 op_sel_hi:[0,1,0]
 v_mfma_f32_32x32x16_bf16 v[200:215], a[12:15], v[108:111], v[200:215]
 ds_read_b64_tr_b16 a[4:5], v245 offset:32768
 ds_read_b64_tr_b16 a[6:7], v245 offset:33280
 buffer_load_dwordx4 v5, s[8:11], s53 offen offset:1280  lds
 v_fma_mix_f32 v217, v173, v217, 0 op_sel_hi:[0,1,0]
 v_fma_mix_f32 v219, v175, v219, 0 op_sel_hi:[0,1,0]
 ds_read_b128 v[172:175], v246 offset:672
 s_waitcnt lgkmcnt(5)
 v_mfma_f32_32x32x16_bf16 v[184:199], a[16:19], v[112:115], v[184:199]
 ds_read_b64_tr_b16 a[8:9], v244 offset:34816
 ds_read_b64_tr_b16 a[10:11], v244 offset:35328
 v_cvt_pk_bf16_f32 v234, v216, v217
 v_cvt_pk_bf16_f32 v235, v218, v219
 v_accvgpr_write_b32 a42, v234
 v_accvgpr_write_b32 a43, v235
 v_mfma_f32_32x32x16_bf16 v[200:215], a[20:23], v[112:115], v[200:215]
 ds_read_b64_tr_b16 a[12:13], v245 offset:34816
 s_add_u32 m0, s64, 65280
 ds_read_b64_tr_b16 a[14:15], v245 offset:35328
 buffer_load_dwordx4 v4, s[8:11], s54 offen offset:256  lds
 buffer_store_dwordx4 v[228:231], v0, s[16:19], s69 offen offset:1024 sc1
 v_cvt_pk_f16_f32 v220, v176, v177
 v_cvt_pk_f16_f32 v221, v178, v179
 v_pk_fma_f16 v222, v220, v220, s70
 v_mfma_f32_32x32x16_bf16 v[184:199], a[24:27], v[116:119], v[184:199]
 ds_read_b64_tr_b16 a[16:17], v244 offset:36864
 ds_read_b64_tr_b16 a[18:19], v244 offset:37376
 v_pk_fma_f16 v223, v221, v221, s70
 v_pk_mul_f16 v220, v222, v220 neg_lo:[1,0] neg_hi:[1,0]
 v_pk_mul_f16 v221, v223, v221 neg_lo:[1,0] neg_hi:[1,0]
 v_mfma_f32_32x32x16_bf16 v[200:215], a[28:31], v[116:119], v[200:215]
 ds_read_b64_tr_b16 a[20:21], v245 offset:36864
 ds_read_b64_tr_b16 a[22:23], v245 offset:37376
 buffer_load_dwordx4 v5, s[8:11], s54 offen offset:1280  lds
 v_exp_f16 v222, v220
 v_exp_f16 v223, v221
 s_waitcnt lgkmcnt(4)
 v_mfma_f32_32x32x16_bf16 v[184:199], a[0:3], v[120:123], v[184:199]
 ds_read_b64_tr_b16 a[24:25], v244 offset:38912
 ds_read_b64_tr_b16 a[26:27], v244 offset:39424
 v_exp_f16_sdwa v222, v220 dst_sel:WORD_1 dst_unused:UNUSED_PRESERVE src0_sel:WORD_1
 v_exp_f16_sdwa v223, v221 dst_sel:WORD_1 dst_unused:UNUSED_PRESERVE src0_sel:WORD_1
 v_pk_fma_f16 v220, v222, v247, v247
 v_mfma_f32_32x32x16_bf16 v[200:215], a[4:7], v[120:123], v[200:215]
 ds_read_b64_tr_b16 a[28:29], v245 offset:38912
 s_add_u32 m0, s64, 73344
 ds_read_b64_tr_b16 a[30:31], v245 offset:39424
 buffer_load_dwordx4 v4, s[8:11], s46 offen offset:384  lds
 v_pk_fma_f16 v221, v223, v247, v247
ST1_3:
 s_cbranch_execz STB1_0
 v_rcp_f16 v216, v220
 v_mfma_f32_32x32x16_bf16 v[184:199], a[8:11], v[124:127], v[184:199]
 ds_read_b64_tr_b16 a[0:1], v244 offset:40960
 ds_read_b64_tr_b16 a[2:3], v244 offset:41472
 v_rcp_f16 v218, v221
 v_rcp_f16_sdwa v217, v220 dst_sel:WORD_0 dst_unused:UNUSED_PAD src0_sel:WORD_1
 v_mfma_f32_32x32x16_bf16 v[200:215], a[12:15], v[124:127], v[200:215]
 ds_read_b64_tr_b16 a[4:5], v245 offset:40960
 ds_read_b64_tr_b16 a[6:7], v245 offset:41472
 buffer_load_dwordx4 v5, s[8:11], s46 offen offset:1408  lds
 v_rcp_f16_sdwa v219, v221 dst_sel:WORD_0 dst_unused:UNUSED_PAD src0_sel:WORD_1
 v_fma_mix_f32 v216, v176, v216, 0 op_sel_hi:[0,1,0]
 v_fma_mix_f32 v218, v178, v218, 0 op_sel_hi:[0,1,0]
 s_waitcnt lgkmcnt(4)
 v_mfma_f32_32x32x16_bf16 v[184:199], a[16:19], v[128:131], v[184:199]
 ds_read_b64_tr_b16 a[8:9], v244 offset:43008
 ds_read_b64_tr_b16 a[10:11], v244 offset:43520
 v_fma_mix_f32 v217, v177, v217, 0 op_sel_hi:[0,1,0]
 v_fma_mix_f32 v219, v179, v219, 0 op_sel_hi:[0,1,0]
 ds_read_b128 v[176:179], v246 offset:704
 v_mfma_f32_32x32x16_bf16 v[200:215], a[20:23], v[128:131], v[200:215]
 ds_read_b64_tr_b16 a[12:13], v245 offset:43008
 s_add_u32 m0, s64, 81536
 ds_read_b64_tr_b16 a[14:15], v245 offset:43520
 buffer_load_dwordx4 v4, s[8:11], s47 offen offset:384  lds
 v_cvt_pk_bf16_f32 v236, v216, v217
 v_cvt_pk_bf16_f32 v237, v218, v219
 v_accvgpr_write_b32 a44, v236
 v_accvgpr_write_b32 a45, v237
 v_mfma_f32_32x32x16_bf16 v[184:199], a[24:27], v[132:135], v[184:199]
 ds_read_b64_tr_b16 a[16:17], v244 offset:45056
 ds_read_b64_tr_b16 a[18:19], v244 offset:45568
 buffer_store_dwordx4 v[232:235], v0, s[16:19], s69 offen offset:2048 sc1
 v_cvt_pk_f16_f32 v220, v180, v181
 v_cvt_pk_f16_f32 v221, v182, v183
 v_pk_fma_f16 v222, v220, v220, s70
 v_mfma_f32_32x32x16_bf16 v[200:215], a[28:31], v[132:135], v[200:215]
 ds_read_b64_tr_b16 a[20:21], v245 offset:45056
 ds_read_b64_tr_b16 a[22:23], v245 offset:45568
 v_pk_fma_f16 v223, v221, v221, s70
 v_pk_mul_f16 v220, v222, v220 neg_lo:[1,0] neg_hi:[1,0]
 v_pk_mul_f16 v221, v223, v221 neg_lo:[1,0] neg_hi:[1,0]
 v_exp_f16 v222, v220
 s_waitcnt lgkmcnt(4)
 v_mfma_f32_32x32x16_bf16 v[184:199], a[0:3], v[136:139], v[184:199]
 ds_read_b64_tr_b16 a[24:25], v244 offset:47104
 ds_read_b64_tr_b16 a[26:27], v244 offset:47616
 v_exp_f16 v223, v221
 v_exp_f16_sdwa v222, v220 dst_sel:WORD_1 dst_unused:UNUSED_PRESERVE src0_sel:WORD_1
 v_mfma_f32_32x32x16_bf16 v[200:215], a[4:7], v[136:139], v[200:215]
 ds_read_b64_tr_b16 a[28:29], v245 offset:47104
 ds_read_b64_tr_b16 a[30:31], v245 offset:47616
 buffer_load_dwordx4 v5, s[8:11], s47 offen offset:1408  lds
 v_exp_f16_sdwa v223, v221 dst_sel:WORD_1 dst_unused:UNUSED_PRESERVE src0_sel:WORD_1
 v_pk_fma_f16 v220, v222, v247, v247
 v_mfma_f32_32x32x16_bf16 v[184:199], a[8:11], v[140:143], v[184:199]
 s_waitcnt vmcnt(21)
 s_barrier
 ds_read_b64_tr_b16 a[0:1], v240 offset:0
 ds_read_b64_tr_b16 a[2:3], v240 offset:512
 v_pk_fma_f16 v221, v223, v247, v247
 v_rcp_f16 v216, v220
 v_rcp_f16 v218, v221
 v_mfma_f32_32x32x16_bf16 v[200:215], a[12:15], v[140:143], v[200:215]
 ds_read_b64_tr_b16 a[4:5], v241 offset:0
 ds_read_b64_tr_b16 a[6:7], v241 offset:512
 v_rcp_f16_sdwa v217, v220 dst_sel:WORD_0 dst_unused:UNUSED_PAD src0_sel:WORD_1
 v_rcp_f16_sdwa v219, v221 dst_sel:WORD_0 dst_unused:UNUSED_PAD src0_sel:WORD_1
 s_waitcnt lgkmcnt(4)
 v_mfma_f32_32x32x16_bf16 v[184:199], a[16:19], v[144:147], v[184:199]
 ds_read_b64_tr_b16 a[8:9], v240 offset:2048
 s_add_u32 m0, s64, 89728
 ds_read_b64_tr_b16 a[10:11], v240 offset:2560
 buffer_load_dwordx4 v4, s[8:11], s48 offen offset:384  lds
 v_fma_mix_f32 v216, v180, v216, 0 op_sel_hi:[0,1,0]
 v_fma_mix_f32 v218, v182, v218, 0 op_sel_hi:[0,1,0]
 v_fma_mix_f32 v217, v181, v217, 0 op_sel_hi:[0,1,0]
 v_mfma_f32_32x32x16_bf16 v[200:215], a[20:23], v[144:147], v[200:215]
 ds_read_b64_tr_b16 a[12:13], v241 offset:2048
 ds_read_b64_tr_b16 a[14:15], v241 offset:2560
 buffer_load_dwordx4 v5, s[8:11], s48 offen offset:1408  lds
 v_fma_mix_f32 v219, v183, v219, 0 op_sel_hi:[0,1,0]
 ds_read_b128 v[180:183], v246 offset:736
 v_cvt_pk_bf16_f32 v238, v216, v217
 v_mfma_f32_32x32x16_bf16 v[184:199], a[24:27], v[148:151], v[184:199]
 ds_read_b64_tr_b16 a[16:17], v240 offset:4096
 ds_read_b64_tr_b16 a[18:19], v240 offset:4608
 v_cvt_pk_bf16_f32 v239, v218, v219
 v_accvgpr_write_b32 a46, v238
 v_accvgpr_write_b32 a47, v239
 buffer_store_dwordx4 v[236:239], v0, s[16:19], s69 offen offset:3072 sc1
 v_mfma_f32_32x32x16_bf16 v[200:215], a[28:31], v[148:151], v[200:215]
 ds_read_b64_tr_b16 a[20:21], v241 offset:4096
 ds_read_b64_tr_b16 a[22:23], v241 offset:4608
 s_waitcnt lgkmcnt(4)
 v_mfma_f32_32x32x16_bf16 v[152:167], a[0:3], v[8:11], v[152:167]
 ds_read_b64_tr_b16 a[24:25], v240 offset:6144
 ds_read_b64_tr_b16 a[26:27], v240 offset:6656
 v_mfma_f32_32x32x16_bf16 v[168:183], a[4:7], v[8:11], v[168:183]
 ds_read_b64_tr_b16 a[28:29], v241 offset:6144
 s_add_u32 m0, s64, 97920
 ds_read_b64_tr_b16 a[30:31], v241 offset:6656
 buffer_load_dwordx4 v4, s[8:11], s49 offen offset:384  lds
 v_cvt_pk_f16_f32 v220, v184, v185
 v_cvt_pk_f16_f32 v221, v186, v187
 v_pk_fma_f16 v222, v220, v220, s70
 v_pk_fma_f16 v223, v221, v221, s70
 v_mfma_f32_32x32x16_bf16 v[152:167], a[8:11], v[12:15], v[152:167]
 ds_read_b64_tr_b16 a[0:1], v240 offset:8192
 ds_read_b64_tr_b16 a[2:3], v240 offset:8704
 v_pk_mul_f16 v220, v222, v220 neg_lo:[1,0] neg_hi:[1,0]
 v_pk_mul_f16 v221, v223, v221 neg_lo:[1,0] neg_hi:[1,0]
 v_exp_f16 v222, v220
 v_mfma_f32_32x32x16_bf16 v[168:183], a[12:15], v[12:15], v[168:183]
 ds_read_b64_tr_b16 a[4:5], v241 offset:8192
 ds_read_b64_tr_b16 a[6:7], v241 offset:8704
 v_exp_f16 v223, v221
 v_exp_f16_sdwa v222, v220 dst_sel:WORD_1 dst_unused:UNUSED_PRESERVE src0_sel:WORD_1
 s_waitcnt lgkmcnt(4)
 v_mfma_f32_32x32x16_bf16 v[152:167], a[16:19], v[16:19], v[152:167]
 ds_read_b64_tr_b16 a[8:9], v240 offset:10240
 ds_read_b64_tr_b16 a[10:11], v240 offset:10752
 v_exp_f16_sdwa v223, v221 dst_sel:WORD_1 dst_unused:UNUSED_PRESERVE src0_sel:WORD_1
 v_pk_fma_f16 v220, v222, v247, v247
 v_pk_fma_f16 v221, v223, v247, v247
 v_mfma_f32_32x32x16_bf16 v[168:183], a[20:23], v[16:19], v[168:183]
 ds_read_b64_tr_b16 a[12:13], v241 offset:10240
 ds_read_b64_tr_b16 a[14:15], v241 offset:10752
 buffer_load_dwordx4 v5, s[8:11], s49 offen offset:1408  lds
 v_rcp_f16 v216, v220
 v_rcp_f16 v218, v221
 v_mfma_f32_32x32x16_bf16 v[152:167], a[24:27], v[20:23], v[152:167]
 ds_read_b64_tr_b16 a[16:17], v240 offset:12288
 ds_read_b64_tr_b16 a[18:19], v240 offset:12800
 v_rcp_f16_sdwa v217, v220 dst_sel:WORD_0 dst_unused:UNUSED_PAD src0_sel:WORD_1
 v_rcp_f16_sdwa v219, v221 dst_sel:WORD_0 dst_unused:UNUSED_PAD src0_sel:WORD_1
 v_mfma_f32_32x32x16_bf16 v[168:183], a[28:31], v[20:23], v[168:183]
 ds_read_b64_tr_b16 a[20:21], v241 offset:12288
 ds_read_b64_tr_b16 a[22:23], v241 offset:12800
 v_fma_mix_f32 v216, v184, v216, 0 op_sel_hi:[0,1,0]
 v_fma_mix_f32 v218, v186, v218, 0 op_sel_hi:[0,1,0]
 v_fma_mix_f32 v217, v185, v217, 0 op_sel_hi:[0,1,0]
 v_fma_mix_f32 v219, v187, v219, 0 op_sel_hi:[0,1,0]
 s_waitcnt lgkmcnt(4)
 v_mfma_f32_32x32x16_bf16 v[152:167], a[0:3], v[24:27], v[152:167]
 ds_read_b64_tr_b16 a[24:25], v240 offset:14336
 ds_read_b64_tr_b16 a[26:27], v240 offset:14848
 ds_read_b128 v[184:187], v246 offset:768
 v_cvt_pk_bf16_f32 v224, v216, v217
 v_cvt_pk_bf16_f32 v225, v218, v219
 v_mfma_f32_32x32x16_bf16 v[168:183], a[4:7], v[24:27], v[168:183]
 ds_read_b64_tr_b16 a[28:29], v241 offset:14336
 s_add_u32 m0, s64, 106112
 ds_read_b64_tr_b16 a[30:31], v241 offset:14848
 buffer_load_dwordx4 v4, s[8:11], s50 offen offset:384  lds
 v_accvgpr_write_b32 a48, v224
 v_accvgpr_write_b32 a49, v225
 v_cvt_pk_f16_f32 v220, v188, v189
 v_cvt_pk_f16_f32 v221, v190, v191
 v_mfma_f32_32x32x16_bf16 v[152:167], a[8:11], v[28:31], v[152:167]
 ds_read_b64_tr_b16 a[0:1], v240 offset:16384
 ds_read_b64_tr_b16 a[2:3], v240 offset:16896
 v_pk_fma_f16 v222, v220, v220, s70
 v_pk_fma_f16 v223, v221, v221, s70
 v_pk_mul_f16 v220, v222, v220 neg_lo:[1,0] neg_hi:[1,0]
 v_pk_mul_f16 v221, v223, v221 neg_lo:[1,0] neg_hi:[1,0]
 v_mfma_f32_32x32x16_bf16 v[168:183], a[12:15], v[28:31], v[168:183]
 ds_read_b64_tr_b16 a[4:5], v241 offset:16384
 ds_read_b64_tr_b16 a[6:7], v241 offset:16896
 v_exp_f16 v222, v220
 v_exp_f16 v223, v221
 s_waitcnt lgkmcnt(4)
 v_mfma_f32_32x32x16_bf16 v[152:167], a[16:19], v[32:35], v[152:167]
 ds_read_b64_tr_b16 a[8:9], v240 offset:18432
 ds_read_b64_tr_b16 a[10:11], v240 offset:18944
 v_exp_f16_sdwa v222, v220 dst_sel:WORD_1 dst_unused:UNUSED_PRESERVE src0_sel:WORD_1
 v_exp_f16_sdwa v223, v221 dst_sel:WORD_1 dst_unused:UNUSED_PRESERVE src0_sel:WORD_1
 v_mfma_f32_32x32x16_bf16 v[168:183], a[20:23], v[32:35], v[168:183]
 ds_read_b64_tr_b16 a[12:13], v241 offset:18432
 ds_read_b64_tr_b16 a[14:15], v241 offset:18944
 buffer_load_dwordx4 v5, s[8:11], s50 offen offset:1408  lds
 v_pk_fma_f16 v220, v222, v247, v247
 v_pk_fma_f16 v221, v223, v247, v247
 v_rcp_f16 v216, v220
 s_bitcmp1_b32 s44, 3
 s_cbranch_scc0 ON_28
 s_add_u32 s3, s35, 0
 buffer_load_dwordx4 a[216:219], v3, s[20:23], s3 offen
ON_28:
 v_mfma_f32_32x32x16_bf16 v[152:167], a[24:27], v[36:39], v[152:167]
 ds_read_b64_tr_b16 a[16:17], v240 offset:20480
 ds_read_b64_tr_b16 a[18:19], v240 offset:20992
 v_rcp_f16 v218, v221
 v_rcp_f16_sdwa v217, v220 dst_sel:WORD_0 dst_unused:UNUSED_PAD src0_sel:WORD_1
 v_mfma_f32_32x32x16_bf16 v[168:183], a[28:31], v[36:39], v[168:183]
 ds_read_b64_tr_b16 a[20:21], v241 offset:20480
 ds_read_b64_tr_b16 a[22:23], v241 offset:20992
 v_rcp_f16_sdwa v219, v221 dst_sel:WORD_0 dst_unused:UNUSED_PAD src0_sel:WORD_1
 v_fma_mix_f32 v216, v188, v216, 0 op_sel_hi:[0,1,0]
 s_waitcnt lgkmcnt(4)
 v_mfma_f32_32x32x16_bf16 v[152:167], a[0:3], v[40:43], v[152:167]
 ds_read_b64_tr_b16 a[24:25], v240 offset:22528
 ds_read_b64_tr_b16 a[26:27], v240 offset:23040
 v_fma_mix_f32 v218, v190, v218, 0 op_sel_hi:[0,1,0]
 v_fma_mix_f32 v217, v189, v217, 0 op_sel_hi:[0,1,0]
 v_fma_mix_f32 v219, v191, v219, 0 op_sel_hi:[0,1,0]
 ds_read_b128 v[188:191], v246 offset:800
 v_mfma_f32_32x32x16_bf16 v[168:183], a[4:7], v[40:43], v[168:183]
 ds_read_b64_tr_b16 a[28:29], v241 offset:22528
 s_add_u32 m0, s64, 114304
 ds_read_b64_tr_b16 a[30:31], v241 offset:23040
 buffer_load_dwordx4 v4, s[8:11], s51 offen offset:384  lds
 v_cvt_pk_bf16_f32 v226, v216, v217
 v_cvt_pk_bf16_f32 v227, v218, v219
 v_accvgpr_write_b32 a50, v226
 v_mfma_f32_32x32x16_bf16 v[152:167], a[8:11], v[44:47], v[152:167]
 s_waitcnt vmcnt(21)
 s_barrier
 ds_read_b64_tr_b16 a[0:1], v240 offset:24576
 ds_read_b64_tr_b16 a[2:3], v240 offset:25088
 v_accvgpr_write_b32 a51, v227
 s_add_u32 s69, s65, 4096
 buffer_store_dwordx4 v[224:227], v0, s[16:19], s69 offen offset:0 sc1
 v_cvt_pk_f16_f32 v220, v192, v193
 v_mfma_f32_32x32x16_bf16 v[168:183], a[12:15], v[44:47], v[168:183]
 ds_read_b64_tr_b16 a[4:5], v241 offset:24576
 ds_read_b64_tr_b16 a[6:7], v241 offset:25088
 v_cvt_pk_f16_f32 v221, v194, v195
 v_pk_fma_f16 v222, v220, v220, s70
 v_pk_fma_f16 v223, v221, v221, s70
 v_pk_mul_f16 v220, v222, v220 neg_lo:[1,0] neg_hi:[1,0]
 s_waitcnt lgkmcnt(4)
 v_mfma_f32_32x32x16_bf16 v[152:167], a[16:19], v[48:51], v[152:167]
 ds_read_b64_tr_b16 a[8:9], v240 offset:26624
 ds_read_b64_tr_b16 a[10:11], v240 offset:27136
 v_pk_mul_f16 v221, v223, v221 neg_lo:[1,0] neg_hi:[1,0]
 v_exp_f16 v222, v220
 v_exp_f16 v223, v221
 v_mfma_f32_32x32x16_bf16 v[168:183], a[20:23], v[48:51], v[168:183]
 ds_read_b64_tr_b16 a[12:13], v241 offset:26624
 ds_read_b64_tr_b16 a[14:15], v241 offset:27136
 buffer_load_dwordx4 v5, s[8:11], s51 offen offset:1408  lds
 v_exp_f16_sdwa v222, v220 dst_sel:WORD_1 dst_unused:UNUSED_PRESERVE src0_sel:WORD_1
 v_exp_f16_sdwa v223, v221 dst_sel:WORD_1 dst_unused:UNUSED_PRESERVE src0_sel:WORD_1
 v_mfma_f32_32x32x16_bf16 v[152:167], a[24:27], v[52:55], v[152:167]
 ds_read_b64_tr_b16 a[16:17], v240 offset:28672
 ds_read_b64_tr_b16 a[18:19], v240 offset:29184
 v_pk_fma_f16 v220, v222, v247, v247
 v_pk_fma_f16 v221, v223, v247, v247
 v_rcp_f16 v216, v220
 v_mfma_f32_32x32x16_bf16 v[168:183], a[28:31], v[52:55], v[168:183]
 ds_read_b64_tr_b16 a[20:21], v241 offset:28672
 ds_read_b64_tr_b16 a[22:23], v241 offset:29184
 v_rcp_f16 v218, v221
 v_rcp_f16_sdwa v217, v220 dst_sel:WORD_0 dst_unused:UNUSED_PAD src0_sel:WORD_1
 s_waitcnt lgkmcnt(4)
 v_mfma_f32_32x32x16_bf16 v[152:167], a[0:3], v[56:59], v[152:167]
 ds_read_b64_tr_b16 a[24:25], v240 offset:30720
 ds_read_b64_tr_b16 a[26:27], v240 offset:31232
 v_rcp_f16_sdwa v219, v221 dst_sel:WORD_0 dst_unused:UNUSED_PAD src0_sel:WORD_1
 v_fma_mix_f32 v216, v192, v216, 0 op_sel_hi:[0,1,0]
 v_mov_b32 v249, 1
 s_waitcnt vmcnt(7)
 s_mov_b64 exec, 1
 buffer_store_dwordx2 v[248:249], off, s[16:19], s67 sc1
 s_mov_b64 exec, -1
 v_mfma_f32_32x32x16_bf16 v[168:183], a[4:7], v[56:59], v[168:183]
 ds_read_b64_tr_b16 a[28:29], v241 offset:30720
 s_add_u32 m0, s64, 122496
 ds_read_b64_tr_b16 a[30:31], v241 offset:31232
 buffer_load_dwordx4 v4, s[8:11], s52 offen offset:384  lds
 v_fma_mix_f32 v218, v194, v218, 0 op_sel_hi:[0,1,0]
 v_fma_mix_f32 v217, v193, v217, 0 op_sel_hi:[0,1,0]
 v_fma_mix_f32 v219, v195, v219, 0 op_sel_hi:[0,1,0]
 v_mfma_f32_32x32x16_bf16 v[152:167], a[8:11], v[60:63], v[152:167]
 ds_read_b64_tr_b16 a[0:1], v240 offset:32768
 ds_read_b64_tr_b16 a[2:3], v240 offset:33280
 ds_read_b128 v[192:195], v246 offset:832
 v_cvt_pk_bf16_f32 v228, v216, v217
 v_cvt_pk_bf16_f32 v229, v218, v219
 v_accvgpr_write_b32 a52, v228
 v_mfma_f32_32x32x16_bf16 v[168:183], a[12:15], v[60:63], v[168:183]
 ds_read_b64_tr_b16 a[4:5], v241 offset:32768
 ds_read_b64_tr_b16 a[6:7], v241 offset:33280
 v_accvgpr_write_b32 a53, v229
 v_cvt_pk_f16_f32 v220, v196, v197
 v_cvt_pk_f16_f32 v221, v198, v199
 v_pk_fma_f16 v222, v220, v220, s70
 s_bitcmp1_b32 s44, 3
 s_cbranch_scc0 ON_29
 s_add_u32 s3, s35, 0
 buffer_load_dwordx4 a[220:223], v3, s[24:27], s3 offen
ON_29:
 s_waitcnt lgkmcnt(5)
 v_mfma_f32_32x32x16_bf16 v[152:167], a[16:19], v[64:67], v[152:167]
 ds_read_b64_tr_b16 a[8:9], v240 offset:34816
 ds_read_b64_tr_b16 a[10:11], v240 offset:35328
 v_pk_fma_f16 v223, v221, v221, s70
 v_pk_mul_f16 v220, v222, v220 neg_lo:[1,0] neg_hi:[1,0]
 v_pk_mul_f16 v221, v223, v221 neg_lo:[1,0] neg_hi:[1,0]
 v_mfma_f32_32x32x16_bf16 v[168:183], a[20:23], v[64:67], v[168:183]
 ds_read_b64_tr_b16 a[12:13], v241 offset:34816
 ds_read_b64_tr_b16 a[14:15], v241 offset:35328
 buffer_load_dwordx4 v5, s[8:11], s52 offen offset:1408  lds
 v_exp_f16 v222, v220
 v_exp_f16 v223, v221
 v_mfma_f32_32x32x16_bf16 v[152:167], a[24:27], v[68:71], v[152:167]
 ds_read_b64_tr_b16 a[16:17], v240 offset:36864
 ds_read_b64_tr_b16 a[18:19], v240 offset:37376
 v_exp_f16_sdwa v222, v220 dst_sel:WORD_1 dst_unused:UNUSED_PRESERVE src0_sel:WORD_1
 v_exp_f16_sdwa v223, v221 dst_sel:WORD_1 dst_unused:UNUSED_PRESERVE src0_sel:WORD_1
 v_pk_fma_f16 v220, v222, v247, v247
 v_mfma_f32_32x32x16_bf16 v[168:183], a[28:31], v[68:71], v[168:183]
 ds_read_b64_tr_b16 a[20:21], v241 offset:36864
 ds_read_b64_tr_b16 a[22:23], v241 offset:37376
 v_pk_fma_f16 v221, v223, v247, v247
 v_rcp_f16 v216, v220
 s_waitcnt lgkmcnt(4)
 v_mfma_f32_32x32x16_bf16 v[152:167], a[0:3], v[72:75], v[152:167]
 ds_read_b64_tr_b16 a[24:25], v240 offset:38912
 ds_read_b64_tr_b16 a[26:27], v240 offset:39424
 v_rcp_f16 v218, v221
 v_rcp_f16_sdwa v217, v220 dst_sel:WORD_0 dst_unused:UNUSED_PAD src0_sel:WORD_1
 v_mfma_f32_32x32x16_bf16 v[168:183], a[4:7], v[72:75], v[168:183]
 ds_read_b64_tr_b16 a[28:29], v241 offset:38912
 s_add_u32 m0, s64, 130688
 ds_read_b64_tr_b16 a[30:31], v241 offset:39424
 buffer_load_dwordx4 v4, s[8:11], s53 offen offset:384  lds
 v_rcp_f16_sdwa v219, v221 dst_sel:WORD_0 dst_unused:UNUSED_PAD src0_sel:WORD_1
 v_fma_mix_f32 v216, v196, v216, 0 op_sel_hi:[0,1,0]
 v_fma_mix_f32 v218, v198, v218, 0 op_sel_hi:[0,1,0]
 v_fma_mix_f32 v217, v197, v217, 0 op_sel_hi:[0,1,0]
 v_mfma_f32_32x32x16_bf16 v[152:167], a[8:11], v[76:79], v[152:167]
 ds_read_b64_tr_b16 a[0:1], v240 offset:40960
 ds_read_b64_tr_b16 a[2:3], v240 offset:41472
 v_fma_mix_f32 v219, v199, v219, 0 op_sel_hi:[0,1,0]
 ds_read_b128 v[196:199], v246 offset:864
 v_cvt_pk_bf16_f32 v230, v216, v217
 v_mfma_f32_32x32x16_bf16 v[168:183], a[12:15], v[76:79], v[168:183]
 ds_read_b64_tr_b16 a[4:5], v241 offset:40960
 ds_read_b64_tr_b16 a[6:7], v241 offset:41472
 v_cvt_pk_bf16_f32 v231, v218, v219
 v_accvgpr_write_b32 a54, v230
 v_accvgpr_write_b32 a55, v231
 buffer_store_dwordx4 v[228:231], v0, s[16:19], s69 offen offset:1024 sc1
 s_waitcnt lgkmcnt(5)
 v_mfma_f32_32x32x16_bf16 v[152:167], a[16:19], v[80:83], v[152:167]
 ds_read_b64_tr_b16 a[8:9], v240 offset:43008
 ds_read_b64_tr_b16 a[10:11], v240 offset:43520
 v_cvt_pk_f16_f32 v220, v200, v201
 v_cvt_pk_f16_f32 v221, v202, v203
 v_pk_fma_f16 v222, v220, v220, s70
 v_mfma_f32_32x32x16_bf16 v[168:183], a[20:23], v[80:83], v[168:183]
 ds_read_b64_tr_b16 a[12:13], v241 offset:43008
 ds_read_b64_tr_b16 a[14:15], v241 offset:43520
 buffer_load_dwordx4 v5, s[8:11], s53 offen offset:1408  lds
 v_pk_fma_f16 v223, v221, v221, s70
 v_pk_mul_f16 v220, v222, v220 neg_lo:[1,0] neg_hi:[1,0]
 v_pk_mul_f16 v221, v223, v221 neg_lo:[1,0] neg_hi:[1,0]
 v_exp_f16 v222, v220
 v_mfma_f32_32x32x16_bf16 v[152:167], a[24:27], v[84:87], v[152:167]
 ds_read_b64_tr_b16 a[16:17], v240 offset:45056
 ds_read_b64_tr_b16 a[18:19], v240 offset:45568
 v_exp_f16 v223, v221
 v_exp_f16_sdwa v222, v220 dst_sel:WORD_1 dst_unused:UNUSED_PRESERVE src0_sel:WORD_1
 v_mfma_f32_32x32x16_bf16 v[168:183], a[28:31], v[84:87], v[168:183]
 ds_read_b64_tr_b16 a[20:21], v241 offset:45056
 ds_read_b64_tr_b16 a[22:23], v241 offset:45568
 v_exp_f16_sdwa v223, v221 dst_sel:WORD_1 dst_unused:UNUSED_PRESERVE src0_sel:WORD_1
 v_pk_fma_f16 v220, v222, v247, v247
 s_waitcnt lgkmcnt(4)
 v_mfma_f32_32x32x16_bf16 v[152:167], a[0:3], v[88:91], v[152:167]
 ds_read_b64_tr_b16 a[24:25], v240 offset:47104
 ds_read_b64_tr_b16 a[26:27], v240 offset:47616
 v_pk_fma_f16 v221, v223, v247, v247
 v_rcp_f16 v216, v220
 v_rcp_f16 v218, v221
 v_mfma_f32_32x32x16_bf16 v[168:183], a[4:7], v[88:91], v[168:183]
 ds_read_b64_tr_b16 a[28:29], v241 offset:47104
 s_add_u32 m0, s64, 138880
 ds_read_b64_tr_b16 a[30:31], v241 offset:47616
 buffer_load_dwordx4 v4, s[8:11], s54 offen offset:384  lds
 v_rcp_f16_sdwa v217, v220 dst_sel:WORD_0 dst_unused:UNUSED_PAD src0_sel:WORD_1
 v_rcp_f16_sdwa v219, v221 dst_sel:WORD_0 dst_unused:UNUSED_PAD src0_sel:WORD_1
 v_mfma_f32_32x32x16_bf16 v[152:167], a[8:11], v[92:95], v[152:167]
 s_barrier
 ds_read_b64_tr_b16 a[0:1], v242 offset:0
 ds_read_b64_tr_b16 a[2:3], v242 offset:512
 v_fma_mix_f32 v216, v200, v216, 0 op_sel_hi:[0,1,0]
 v_fma_mix_f32 v218, v202, v218, 0 op_sel_hi:[0,1,0]
 v_fma_mix_f32 v217, v201, v217, 0 op_sel_hi:[0,1,0]
 s_bitcmp1_b32 s44, 3
 s_cbranch_scc0 ON_30
 s_add_u32 s3, s35, 295936
 buffer_load_dwordx4 a[224:227], v3, s[20:23], s3 offen
ON_30:
 v_mfma_f32_32x32x16_bf16 v[168:183], a[12:15], v[92:95], v[168:183]
 ds_read_b64_tr_b16 a[4:5], v243 offset:0
 ds_read_b64_tr_b16 a[6:7], v243 offset:512
 v_fma_mix_f32 v219, v203, v219, 0 op_sel_hi:[0,1,0]
 ds_read_b128 v[200:203], v246 offset:896
 v_cvt_pk_bf16_f32 v232, v216, v217
 s_waitcnt lgkmcnt(5)
 v_mfma_f32_32x32x16_bf16 v[152:167], a[16:19], v[96:99], v[152:167]
 ds_read_b64_tr_b16 a[8:9], v242 offset:2048
 ds_read_b64_tr_b16 a[10:11], v242 offset:2560
 v_cvt_pk_bf16_f32 v233, v218, v219
 v_accvgpr_write_b32 a56, v232
 v_accvgpr_write_b32 a57, v233
 v_cvt_pk_f16_f32 v220, v204, v205
 v_mfma_f32_32x32x16_bf16 v[168:183], a[20:23], v[96:99], v[168:183]
 ds_read_b64_tr_b16 a[12:13], v243 offset:2048
 ds_read_b64_tr_b16 a[14:15], v243 offset:2560
 buffer_load_dwordx4 v5, s[8:11], s54 offen offset:1408  lds
 v_cvt_pk_f16_f32 v221, v206, v207
 v_pk_fma_f16 v222, v220, v220, s70
 v_pk_fma_f16 v223, v221, v221, s70
 v_pk_mul_f16 v220, v222, v220 neg_lo:[1,0] neg_hi:[1,0]
 v_mfma_f32_32x32x16_bf16 v[152:167], a[24:27], v[100:103], v[152:167]
 ds_read_b64_tr_b16 a[16:17], v242 offset:4096
 ds_read_b64_tr_b16 a[18:19], v242 offset:4608
 v_pk_mul_f16 v221, v223, v221 neg_lo:[1,0] neg_hi:[1,0]
 v_exp_f16 v222, v220
 v_exp_f16 v223, v221
 v_mfma_f32_32x32x16_bf16 v[168:183], a[28:31], v[100:103], v[168:183]
 ds_read_b64_tr_b16 a[20:21], v243 offset:4096
 ds_read_b64_tr_b16 a[22:23], v243 offset:4608
 v_exp_f16_sdwa v222, v220 dst_sel:WORD_1 dst_unused:UNUSED_PRESERVE src0_sel:WORD_1
 s_waitcnt lgkmcnt(4)
 v_mfma_f32_32x32x16_bf16 v[152:167], a[0:3], v[104:107], v[152:167]
 ds_read_b64_tr_b16 a[24:25], v242 offset:6144
 ds_read_b64_tr_b16 a[26:27], v242 offset:6656
 v_exp_f16_sdwa v223, v221 dst_sel:WORD_1 dst_unused:UNUSED_PRESERVE src0_sel:WORD_1
 v_pk_fma_f16 v220, v222, v247, v247
 v_pk_fma_f16 v221, v223, v247, v247
 v_mfma_f32_32x32x16_bf16 v[168:183], a[4:7], v[104:107], v[168:183]
 ds_read_b64_tr_b16 a[28:29], v243 offset:6144
 ds_read_b64_tr_b16 a[30:31], v243 offset:6656
 s_add_u32 m0, s64, 0
 s_add_u32 s68, s46, 512
 buffer_load_dwordx4 v4, s[8:11], s68 offen  lds
 v_rcp_f16 v216, v220
 v_rcp_f16 v218, v221
 v_mfma_f32_32x32x16_bf16 v[152:167], a[8:11], v[108:111], v[152:167]
 ds_read_b64_tr_b16 a[0:1], v242 offset:8192
 ds_read_b64_tr_b16 a[2:3], v242 offset:8704
 v_rcp_f16_sdwa v217, v220 dst_sel:WORD_0 dst_unused:UNUSED_PAD src0_sel:WORD_1
 v_rcp_f16_sdwa v219, v221 dst_sel:WORD_0 dst_unused:UNUSED_PAD src0_sel:WORD_1
 v_fma_mix_f32 v216, v204, v216, 0 op_sel_hi:[0,1,0]
 v_mfma_f32_32x32x16_bf16 v[168:183], a[12:15], v[108:111], v[168:183]
 ds_read_b64_tr_b16 a[4:5], v243 offset:8192
 ds_read_b64_tr_b16 a[6:7], v243 offset:8704
 v_fma_mix_f32 v218, v206, v218, 0 op_sel_hi:[0,1,0]
 v_fma_mix_f32 v217, v205, v217, 0 op_sel_hi:[0,1,0]
 v_fma_mix_f32 v219, v207, v219, 0 op_sel_hi:[0,1,0]
 s_waitcnt lgkmcnt(4)
 v_mfma_f32_32x32x16_bf16 v[152:167], a[16:19], v[112:115], v[152:167]
 ds_read_b64_tr_b16 a[8:9], v242 offset:10240
 ds_read_b64_tr_b16 a[10:11], v242 offset:10752
 ds_read_b128 v[204:207], v246 offset:928
 v_cvt_pk_bf16_f32 v234, v216, v217
 v_cvt_pk_bf16_f32 v235, v218, v219
 v_accvgpr_write_b32 a58, v234
 v_mfma_f32_32x32x16_bf16 v[168:183], a[20:23], v[112:115], v[168:183]
 ds_read_b64_tr_b16 a[12:13], v243 offset:10240
 ds_read_b64_tr_b16 a[14:15], v243 offset:10752
 buffer_load_dwordx4 v5, s[8:11], s68 offen offset:1024  lds
 v_accvgpr_write_b32 a59, v235
 buffer_store_dwordx4 v[232:235], v0, s[16:19], s69 offen offset:2048 sc1
 v_cvt_pk_f16_f32 v220, v208, v209
 v_cvt_pk_f16_f32 v221, v210, v211
 v_mfma_f32_32x32x16_bf16 v[152:167], a[24:27], v[116:119], v[152:167]
 ds_read_b64_tr_b16 a[16:17], v242 offset:12288
 ds_read_b64_tr_b16 a[18:19], v242 offset:12800
 v_pk_fma_f16 v222, v220, v220, s70
 v_pk_fma_f16 v223, v221, v221, s70
 v_pk_mul_f16 v220, v222, v220 neg_lo:[1,0] neg_hi:[1,0]
 v_pk_mul_f16 v221, v223, v221 neg_lo:[1,0] neg_hi:[1,0]
 v_mfma_f32_32x32x16_bf16 v[168:183], a[28:31], v[116:119], v[168:183]
 ds_read_b64_tr_b16 a[20:21], v243 offset:12288
 ds_read_b64_tr_b16 a[22:23], v243 offset:12800
 v_exp_f16 v222, v220
 v_exp_f16 v223, v221
 s_waitcnt lgkmcnt(4)
 v_mfma_f32_32x32x16_bf16 v[152:167], a[0:3], v[120:123], v[152:167]
 ds_read_b64_tr_b16 a[24:25], v242 offset:14336
 ds_read_b64_tr_b16 a[26:27], v242 offset:14848
 v_exp_f16_sdwa v222, v220 dst_sel:WORD_1 dst_unused:UNUSED_PRESERVE src0_sel:WORD_1
 v_exp_f16_sdwa v223, v221 dst_sel:WORD_1 dst_unused:UNUSED_PRESERVE src0_sel:WORD_1
 s_bitcmp1_b32 s44, 3
 s_cbranch_scc0 ON_31
 s_add_u32 s3, s35, 295936
 buffer_load_dwordx4 a[228:231], v3, s[24:27], s3 offen
ON_31:
 v_mfma_f32_32x32x16_bf16 v[168:183], a[4:7], v[120:123], v[168:183]
 ds_read_b64_tr_b16 a[28:29], v243 offset:14336
 s_add_u32 m0, s64, 7680
 ds_read_b64_tr_b16 a[30:31], v243 offset:14848
 buffer_load_dwordx4 v4, s[8:11], s47 offen offset:512  lds
 v_pk_fma_f16 v220, v222, v247, v247
 v_pk_fma_f16 v221, v223, v247, v247
 v_rcp_f16 v216, v220
 v_mfma_f32_32x32x16_bf16 v[152:167], a[8:11], v[124:127], v[152:167]
 ds_read_b64_tr_b16 a[0:1], v242 offset:16384
 ds_read_b64_tr_b16 a[2:3], v242 offset:16896
 v_rcp_f16 v218, v221
 v_rcp_f16_sdwa v217, v220 dst_sel:WORD_0 dst_unused:UNUSED_PAD src0_sel:WORD_1
 v_mfma_f32_32x32x16_bf16 v[168:183], a[12:15], v[124:127], v[168:183]
 ds_read_b64_tr_b16 a[4:5], v243 offset:16384
 ds_read_b64_tr_b16 a[6:7], v243 offset:16896
 v_rcp_f16_sdwa v219, v221 dst_sel:WORD_0 dst_unused:UNUSED_PAD src0_sel:WORD_1
 v_fma_mix_f32 v216, v208, v216, 0 op_sel_hi:[0,1,0]
 s_waitcnt lgkmcnt(4)
 v_mfma_f32_32x32x16_bf16 v[152:167], a[16:19], v[128:131], v[152:167]
 ds_read_b64_tr_b16 a[8:9], v242 offset:18432
 ds_read_b64_tr_b16 a[10:11], v242 offset:18944
 v_fma_mix_f32 v218, v210, v218, 0 op_sel_hi:[0,1,0]
 v_fma_mix_f32 v217, v209, v217, 0 op_sel_hi:[0,1,0]
 v_fma_mix_f32 v219, v211, v219, 0 op_sel_hi:[0,1,0]
 ds_read_b128 v[208:211], v246 offset:960
 v_mfma_f32_32x32x16_bf16 v[168:183], a[20:23], v[128:131], v[168:183]
 ds_read_b64_tr_b16 a[12:13], v243 offset:18432
 ds_read_b64_tr_b16 a[14:15], v243 offset:18944
 buffer_load_dwordx4 v5, s[8:11], s47 offen offset:1536  lds
 v_cvt_pk_bf16_f32 v236, v216, v217
 v_cvt_pk_bf16_f32 v237, v218, v219
 v_accvgpr_write_b32 a60, v236
 v_mfma_f32_32x32x16_bf16 v[152:167], a[24:27], v[132:135], v[152:167]
 ds_read_b64_tr_b16 a[16:17], v242 offset:20480
 ds_read_b64_tr_b16 a[18:19], v242 offset:20992
 v_accvgpr_write_b32 a61, v237
 v_cvt_pk_f16_f32 v220, v212, v213
 v_cvt_pk_f16_f32 v221, v214, v215
 v_pk_fma_f16 v222, v220, v220, s70
 v_mfma_f32_32x32x16_bf16 v[168:183], a[28:31], v[132:135], v[168:183]
 ds_read_b64_tr_b16 a[20:21], v243 offset:20480
 ds_read_b64_tr_b16 a[22:23], v243 offset:20992
 v_pk_fma_f16 v223, v221, v221, s70
 v_pk_mul_f16 v220, v222, v220 neg_lo:[1,0] neg_hi:[1,0]
 v_pk_mul_f16 v221, v223, v221 neg_lo:[1,0] neg_hi:[1,0]
 v_exp_f16 v222, v220
 s_waitcnt lgkmcnt(4)
 v_mfma_f32_32x32x16_bf16 v[152:167], a[0:3], v[136:139], v[152:167]
 ds_read_b64_tr_b16 a[24:25], v242 offset:22528
 ds_read_b64_tr_b16 a[26:27], v242 offset:23040
 v_exp_f16 v223, v221
 v_exp_f16_sdwa v222, v220 dst_sel:WORD_1 dst_unused:UNUSED_PRESERVE src0_sel:WORD_1
 v_mfma_f32_32x32x16_bf16 v[168:183], a[4:7], v[136:139], v[168:183]
 ds_read_b64_tr_b16 a[28:29], v243 offset:22528
 s_add_u32 m0, s64, 15872
 ds_read_b64_tr_b16 a[30:31], v243 offset:23040
 buffer_load_dwordx4 v4, s[8:11], s48 offen offset:512  lds
 v_exp_f16_sdwa v223, v221 dst_sel:WORD_1 dst_unused:UNUSED_PRESERVE src0_sel:WORD_1
ST1_4:
 s_cbranch_execz STB1_1
 v_pk_fma_f16 v220, v222, v247, v247
 v_mfma_f32_32x32x16_bf16 v[152:167], a[8:11], v[140:143], v[152:167]
 s_barrier
 ds_read_b64_tr_b16 a[0:1], v242 offset:24576
 ds_read_b64_tr_b16 a[2:3], v242 offset:25088
 v_pk_fma_f16 v221, v223, v247, v247
 v_rcp_f16 v216, v220
 v_rcp_f16 v218, v221
 v_mfma_f32_32x32x16_bf16 v[168:183], a[12:15], v[140:143], v[168:183]
 ds_read_b64_tr_b16 a[4:5], v243 offset:24576
 ds_read_b64_tr_b16 a[6:7], v243 offset:25088
 v_rcp_f16_sdwa v217, v220 dst_sel:WORD_0 dst_unused:UNUSED_PAD src0_sel:WORD_1
 v_rcp_f16_sdwa v219, v221 dst_sel:WORD_0 dst_unused:UNUSED_PAD src0_sel:WORD_1
 s_waitcnt lgkmcnt(4)
 v_mfma_f32_32x32x16_bf16 v[152:167], a[16:19], v[144:147], v[152:167]
 ds_read_b64_tr_b16 a[8:9], v242 offset:26624
 ds_read_b64_tr_b16 a[10:11], v242 offset:27136
 v_fma_mix_f32 v216, v212, v216, 0 op_sel_hi:[0,1,0]
 v_fma_mix_f32 v218, v214, v218, 0 op_sel_hi:[0,1,0]
 v_fma_mix_f32 v217, v213, v217, 0 op_sel_hi:[0,1,0]
 v_mfma_f32_32x32x16_bf16 v[168:183], a[20:23], v[144:147], v[168:183]
 ds_read_b64_tr_b16 a[12:13], v243 offset:26624
 ds_read_b64_tr_b16 a[14:15], v243 offset:27136
 buffer_load_dwordx4 v5, s[8:11], s48 offen offset:1536  lds
 v_fma_mix_f32 v219, v215, v219, 0 op_sel_hi:[0,1,0]
 ds_read_b128 v[212:215], v246 offset:992
 v_cvt_pk_bf16_f32 v238, v216, v217
 v_mfma_f32_32x32x16_bf16 v[152:167], a[24:27], v[148:151], v[152:167]
 ds_read_b64_tr_b16 a[16:17], v242 offset:28672
 ds_read_b64_tr_b16 a[18:19], v242 offset:29184
 v_cvt_pk_bf16_f32 v239, v218, v219
 v_accvgpr_write_b32 a62, v238
 v_accvgpr_write_b32 a63, v239
 buffer_store_dwordx4 v[236:239], v0, s[16:19], s69 offen offset:3072 sc1
 v_mfma_f32_32x32x16_bf16 v[168:183], a[28:31], v[148:151], v[168:183]
 ds_read_b64_tr_b16 a[20:21], v243 offset:28672
 ds_read_b64_tr_b16 a[22:23], v243 offset:29184
 s_waitcnt lgkmcnt(4)
 v_mfma_f32_32x32x16_bf16 v[184:199], a[0:3], v[8:11], v[184:199]
 ds_read_b64_tr_b16 a[24:25], v242 offset:30720
 ds_read_b64_tr_b16 a[26:27], v242 offset:31232
 v_mfma_f32_32x32x16_bf16 v[200:215], a[4:7], v[8:11], v[200:215]
 ds_read_b64_tr_b16 a[28:29], v243 offset:30720
 s_add_u32 m0, s64, 24064
 ds_read_b64_tr_b16 a[30:31], v243 offset:31232
 buffer_load_dwordx4 v4, s[8:11], s49 offen offset:512  lds
 v_cvt_pk_f16_f32 v220, v152, v153
 v_cvt_pk_f16_f32 v221, v154, v155
 v_pk_fma_f16 v222, v220, v220, s70
 v_pk_fma_f16 v223, v221, v221, s70
 v_mfma_f32_32x32x16_bf16 v[184:199], a[8:11], v[12:15], v[184:199]
 ds_read_b64_tr_b16 a[0:1], v242 offset:32768
 ds_read_b64_tr_b16 a[2:3], v242 offset:33280
 v_pk_mul_f16 v220, v222, v220 neg_lo:[1,0] neg_hi:[1,0]
 v_pk_mul_f16 v221, v223, v221 neg_lo:[1,0] neg_hi:[1,0]
 v_exp_f16 v222, v220
 v_mfma_f32_32x32x16_bf16 v[200:215], a[12:15], v[12:15], v[200:215]
 ds_read_b64_tr_b16 a[4:5], v243 offset:32768
 ds_read_b64_tr_b16 a[6:7], v243 offset:33280
 v_exp_f16 v223, v221
 v_exp_f16_sdwa v222, v220 dst_sel:WORD_1 dst_unused:UNUSED_PRESERVE src0_sel:WORD_1
 s_waitcnt lgkmcnt(4)
 v_mfma_f32_32x32x16_bf16 v[184:199], a[16:19], v[16:19], v[184:199]
 ds_read_b64_tr_b16 a[8:9], v242 offset:34816
 ds_read_b64_tr_b16 a[10:11], v242 offset:35328
 v_exp_f16_sdwa v223, v221 dst_sel:WORD_1 dst_unused:UNUSED_PRESERVE src0_sel:WORD_1
 v_pk_fma_f16 v220, v222, v247, v247
 v_pk_fma_f16 v221, v223, v247, v247
 s_bitcmp1_b32 s44, 6
 s_cbranch_scc0 ON_32
 v_mul_u32_u24 v1, 18496, v2
 buffer_load_ushort a253, v1, s[20:23], s35 offen offset:318
 buffer_load_ushort a254, v1, s[24:27], s35 offen offset:318
ON_32:
 v_mfma_f32_32x32x16_bf16 v[200:215], a[20:23], v[16:19], v[200:215]
 ds_read_b64_tr_b16 a[12:13], v243 offset:34816
 ds_read_b64_tr_b16 a[14:15], v243 offset:35328
 buffer_load_dwordx4 v5, s[8:11], s49 offen offset:1536  lds
 v_rcp_f16 v216, v220
 v_rcp_f16 v218, v221
 v_mfma_f32_32x32x16_bf16 v[184:199], a[24:27], v[20:23], v[184:199]
 ds_read_b64_tr_b16 a[16:17], v242 offset:36864
 ds_read_b64_tr_b16 a[18:19], v242 offset:37376
 v_rcp_f16_sdwa v217, v220 dst_sel:WORD_0 dst_unused:UNUSED_PAD src0_sel:WORD_1
 v_rcp_f16_sdwa v219, v221 dst_sel:WORD_0 dst_unused:UNUSED_PAD src0_sel:WORD_1
 v_mfma_f32_32x32x16_bf16 v[200:215], a[28:31], v[20:23], v[200:215]
 ds_read_b64_tr_b16 a[20:21], v243 offset:36864
 ds_read_b64_tr_b16 a[22:23], v243 offset:37376
 v_fma_mix_f32 v216, v152, v216, 0 op_sel_hi:[0,1,0]
 v_fma_mix_f32 v218, v154, v218, 0 op_sel_hi:[0,1,0]
 v_fma_mix_f32 v217, v153, v217, 0 op_sel_hi:[0,1,0]
 v_fma_mix_f32 v219, v155, v219, 0 op_sel_hi:[0,1,0]
 s_waitcnt lgkmcnt(4)
 v_mfma_f32_32x32x16_bf16 v[184:199], a[0:3], v[24:27], v[184:199]
 ds_read_b64_tr_b16 a[24:25], v242 offset:38912
 ds_read_b64_tr_b16 a[26:27], v242 offset:39424
 ds_read_b128 v[152:155], v246 offset:1024
 v_cvt_pk_bf16_f32 v224, v216, v217
 v_cvt_pk_bf16_f32 v225, v218, v219
 v_mfma_f32_32x32x16_bf16 v[200:215], a[4:7], v[24:27], v[200:215]
 ds_read_b64_tr_b16 a[28:29], v243 offset:38912
 s_add_u32 m0, s64, 32256
 ds_read_b64_tr_b16 a[30:31], v243 offset:39424
 buffer_load_dwordx4 v4, s[8:11], s50 offen offset:512  lds
 v_accvgpr_write_b32 a64, v224
 v_accvgpr_write_b32 a65, v225
 v_cvt_pk_f16_f32 v220, v156, v157
 v_cvt_pk_f16_f32 v221, v158, v159
 v_mfma_f32_32x32x16_bf16 v[184:199], a[8:11], v[28:31], v[184:199]
 ds_read_b64_tr_b16 a[0:1], v242 offset:40960
 ds_read_b64_tr_b16 a[2:3], v242 offset:41472
 v_pk_fma_f16 v222, v220, v220, s70
 v_pk_fma_f16 v223, v221, v221, s70
 v_pk_mul_f16 v220, v222, v220 neg_lo:[1,0] neg_hi:[1,0]
 v_pk_mul_f16 v221, v223, v221 neg_lo:[1,0] neg_hi:[1,0]
 v_mfma_f32_32x32x16_bf16 v[200:215], a[12:15], v[28:31], v[200:215]
 ds_read_b64_tr_b16 a[4:5], v243 offset:40960
 ds_read_b64_tr_b16 a[6:7], v243 offset:41472
 v_exp_f16 v222, v220
 v_exp_f16 v223, v221
 s_waitcnt lgkmcnt(4)
 v_mfma_f32_32x32x16_bf16 v[184:199], a[16:19], v[32:35], v[184:199]
 ds_read_b64_tr_b16 a[8:9], v242 offset:43008
 ds_read_b64_tr_b16 a[10:11], v242 offset:43520
 v_exp_f16_sdwa v222, v220 dst_sel:WORD_1 dst_unused:UNUSED_PRESERVE src0_sel:WORD_1
 v_exp_f16_sdwa v223, v221 dst_sel:WORD_1 dst_unused:UNUSED_PRESERVE src0_sel:WORD_1
 v_mfma_f32_32x32x16_bf16 v[200:215], a[20:23], v[32:35], v[200:215]
 ds_read_b64_tr_b16 a[12:13], v243 offset:43008
 ds_read_b64_tr_b16 a[14:15], v243 offset:43520
 buffer_load_dwordx4 v5, s[8:11], s50 offen offset:1536  lds
 v_pk_fma_f16 v220, v222, v247, v247
 v_pk_fma_f16 v221, v223, v247, v247
 v_rcp_f16 v216, v220
 s_bitcmp1_b32 s44, 3
 s_cbranch_scc0 ON_33
 s_add_u32 s3, s35, 591872
 buffer_load_dwordx4 a[232:235], v3, s[20:23], s3 offen
ON_33:
 v_mfma_f32_32x32x16_bf16 v[184:199], a[24:27], v[36:39], v[184:199]
 ds_read_b64_tr_b16 a[16:17], v242 offset:45056
 ds_read_b64_tr_b16 a[18:19], v242 offset:45568
 v_rcp_f16 v218, v221
 v_rcp_f16_sdwa v217, v220 dst_sel:WORD_0 dst_unused:UNUSED_PAD src0_sel:WORD_1
 v_mfma_f32_32x32x16_bf16 v[200:215], a[28:31], v[36:39], v[200:215]
 ds_read_b64_tr_b16 a[20:21], v243 offset:45056
 ds_read_b64_tr_b16 a[22:23], v243 offset:45568
 v_rcp_f16_sdwa v219, v221 dst_sel:WORD_0 dst_unused:UNUSED_PAD src0_sel:WORD_1
 v_fma_mix_f32 v216, v156, v216, 0 op_sel_hi:[0,1,0]
 s_waitcnt lgkmcnt(4)
 v_mfma_f32_32x32x16_bf16 v[184:199], a[0:3], v[40:43], v[184:199]
 ds_read_b64_tr_b16 a[24:25], v242 offset:47104
 ds_read_b64_tr_b16 a[26:27], v242 offset:47616
 v_fma_mix_f32 v218, v158, v218, 0 op_sel_hi:[0,1,0]
 v_fma_mix_f32 v217, v157, v217, 0 op_sel_hi:[0,1,0]
 v_fma_mix_f32 v219, v159, v219, 0 op_sel_hi:[0,1,0]
 ds_read_b128 v[156:159], v246 offset:1056
 v_mfma_f32_32x32x16_bf16 v[200:215], a[4:7], v[40:43], v[200:215]
 ds_read_b64_tr_b16 a[28:29], v243 offset:47104
 s_add_u32 m0, s64, 40448
 ds_read_b64_tr_b16 a[30:31], v243 offset:47616
 buffer_load_dwordx4 v4, s[8:11], s51 offen offset:512  lds
 v_cvt_pk_bf16_f32 v226, v216, v217
 v_cvt_pk_bf16_f32 v227, v218, v219
 v_accvgpr_write_b32 a66, v226
 v_mfma_f32_32x32x16_bf16 v[184:199], a[8:11], v[44:47], v[184:199]
 s_waitcnt vmcnt(21)
 s_barrier
 ds_read_b64_tr_b16 a[0:1], v244 offset:0
 ds_read_b64_tr_b16 a[2:3], v244 offset:512
 v_accvgpr_write_b32 a67, v227
 s_add_u32 s69, s65, 8192
 buffer_store_dwordx4 v[224:227], v0, s[16:19], s69 offen offset:0 sc1
 v_cvt_pk_f16_f32 v220, v160, v161
 v_mfma_f32_32x32x16_bf16 v[200:215], a[12:15], v[44:47], v[200:215]
 ds_read_b64_tr_b16 a[4:5], v245 offset:0
 ds_read_b64_tr_b16 a[6:7], v245 offset:512
 v_cvt_pk_f16_f32 v221, v162, v163
 v_pk_fma_f16 v222, v220, v220, s70
 v_pk_fma_f16 v223, v221, v221, s70
 v_pk_mul_f16 v220, v222, v220 neg_lo:[1,0] neg_hi:[1,0]
 s_waitcnt lgkmcnt(4)
 v_mfma_f32_32x32x16_bf16 v[184:199], a[16:19], v[48:51], v[184:199]
 ds_read_b64_tr_b16 a[8:9], v244 offset:2048
 ds_read_b64_tr_b16 a[10:11], v244 offset:2560
 v_pk_mul_f16 v221, v223, v221 neg_lo:[1,0] neg_hi:[1,0]
 v_exp_f16 v222, v220
 v_exp_f16 v223, v221
 v_mfma_f32_32x32x16_bf16 v[200:215], a[20:23], v[48:51], v[200:215]
 ds_read_b64_tr_b16 a[12:13], v245 offset:2048
 ds_read_b64_tr_b16 a[14:15], v245 offset:2560
 buffer_load_dwordx4 v5, s[8:11], s51 offen offset:1536  lds
 v_exp_f16_sdwa v222, v220 dst_sel:WORD_1 dst_unused:UNUSED_PRESERVE src0_sel:WORD_1
 v_exp_f16_sdwa v223, v221 dst_sel:WORD_1 dst_unused:UNUSED_PRESERVE src0_sel:WORD_1
 v_mfma_f32_32x32x16_bf16 v[184:199], a[24:27], v[52:55], v[184:199]
 ds_read_b64_tr_b16 a[16:17], v244 offset:4096
 ds_read_b64_tr_b16 a[18:19], v244 offset:4608
 v_pk_fma_f16 v220, v222, v247, v247
 v_pk_fma_f16 v221, v223, v247, v247
 v_rcp_f16 v216, v220
 v_mfma_f32_32x32x16_bf16 v[200:215], a[28:31], v[52:55], v[200:215]
 ds_read_b64_tr_b16 a[20:21], v245 offset:4096
 ds_read_b64_tr_b16 a[22:23], v245 offset:4608
 v_rcp_f16 v218, v221
 v_rcp_f16_sdwa v217, v220 dst_sel:WORD_0 dst_unused:UNUSED_PAD src0_sel:WORD_1
 s_waitcnt lgkmcnt(4)
 v_mfma_f32_32x32x16_bf16 v[184:199], a[0:3], v[56:59], v[184:199]
 ds_read_b64_tr_b16 a[24:25], v244 offset:6144
 ds_read_b64_tr_b16 a[26:27], v244 offset:6656
 v_rcp_f16_sdwa v219, v221 dst_sel:WORD_0 dst_unused:UNUSED_PAD src0_sel:WORD_1
 v_fma_mix_f32 v216, v160, v216, 0 op_sel_hi:[0,1,0]
 v_mov_b32 v249, 2
 s_waitcnt vmcnt(7)
 s_mov_b64 exec, 1
 buffer_store_dwordx2 v[248:249], off, s[16:19], s67 sc1
 s_mov_b64 exec, -1
 v_mfma_f32_32x32x16_bf16 v[200:215], a[4:7], v[56:59], v[200:215]
 ds_read_b64_tr_b16 a[28:29], v245 offset:6144
 s_add_u32 m0, s64, 48640
 ds_read_b64_tr_b16 a[30:31], v245 offset:6656
 buffer_load_dwordx4 v4, s[8:11], s52 offen offset:512  lds
 v_fma_mix_f32 v218, v162, v218, 0 op_sel_hi:[0,1,0]
 v_fma_mix_f32 v217, v161, v217, 0 op_sel_hi:[0,1,0]
 v_fma_mix_f32 v219, v163, v219, 0 op_sel_hi:[0,1,0]
 v_mfma_f32_32x32x16_bf16 v[184:199], a[8:11], v[60:63], v[184:199]
 ds_read_b64_tr_b16 a[0:1], v244 offset:8192
 ds_read_b64_tr_b16 a[2:3], v244 offset:8704
 ds_read_b128 v[160:163], v246 offset:1088
 v_cvt_pk_bf16_f32 v228, v216, v217
 v_cvt_pk_bf16_f32 v229, v218, v219
 v_accvgpr_write_b32 a68, v228
 v_mfma_f32_32x32x16_bf16 v[200:215], a[12:15], v[60:63], v[200:215]
 ds_read_b64_tr_b16 a[4:5], v245 offset:8192
 ds_read_b64_tr_b16 a[6:7], v245 offset:8704
 v_accvgpr_write_b32 a69, v229
 v_cvt_pk_f16_f32 v220, v164, v165
 v_cvt_pk_f16_f32 v221, v166, v167
 v_pk_fma_f16 v222, v220, v220, s70
 s_bitcmp1_b32 s44, 3
 s_cbranch_scc0 ON_34
 s_add_u32 s3, s35, 591872
 buffer_load_dwordx4 a[236:239], v3, s[24:27], s3 offen
ON_34:
 s_waitcnt lgkmcnt(5)
 v_mfma_f32_32x32x16_bf16 v[184:199], a[16:19], v[64:67], v[184:199]
 ds_read_b64_tr_b16 a[8:9], v244 offset:10240
 ds_read_b64_tr_b16 a[10:11], v244 offset:10752
 v_pk_fma_f16 v223, v221, v221, s70
 v_pk_mul_f16 v220, v222, v220 neg_lo:[1,0] neg_hi:[1,0]
 v_pk_mul_f16 v221, v223, v221 neg_lo:[1,0] neg_hi:[1,0]
 v_mfma_f32_32x32x16_bf16 v[200:215], a[20:23], v[64:67], v[200:215]
 ds_read_b64_tr_b16 a[12:13], v245 offset:10240
 ds_read_b64_tr_b16 a[14:15], v245 offset:10752
 buffer_load_dwordx4 v5, s[8:11], s52 offen offset:1536  lds
 v_exp_f16 v222, v220
 v_exp_f16 v223, v221
 v_mfma_f32_32x32x16_bf16 v[184:199], a[24:27], v[68:71], v[184:199]
 ds_read_b64_tr_b16 a[16:17], v244 offset:12288
 ds_read_b64_tr_b16 a[18:19], v244 offset:12800
 v_exp_f16_sdwa v222, v220 dst_sel:WORD_1 dst_unused:UNUSED_PRESERVE src0_sel:WORD_1
 v_exp_f16_sdwa v223, v221 dst_sel:WORD_1 dst_unused:UNUSED_PRESERVE src0_sel:WORD_1
 v_pk_fma_f16 v220, v222, v247, v247
 v_mfma_f32_32x32x16_bf16 v[200:215], a[28:31], v[68:71], v[200:215]
 ds_read_b64_tr_b16 a[20:21], v245 offset:12288
 ds_read_b64_tr_b16 a[22:23], v245 offset:12800
 v_pk_fma_f16 v221, v223, v247, v247
 v_rcp_f16 v216, v220
 s_waitcnt lgkmcnt(4)
 v_mfma_f32_32x32x16_bf16 v[184:199], a[0:3], v[72:75], v[184:199]
 ds_read_b64_tr_b16 a[24:25], v244 offset:14336
 ds_read_b64_tr_b16 a[26:27], v244 offset:14848
 v_rcp_f16 v218, v221
 v_rcp_f16_sdwa v217, v220 dst_sel:WORD_0 dst_unused:UNUSED_PAD src0_sel:WORD_1
 v_mfma_f32_32x32x16_bf16 v[200:215], a[4:7], v[72:75], v[200:215]
 ds_read_b64_tr_b16 a[28:29], v245 offset:14336
 s_add_u32 m0, s64, 56832
 ds_read_b64_tr_b16 a[30:31], v245 offset:14848
 buffer_load_dwordx4 v4, s[8:11], s53 offen offset:512  lds
 v_rcp_f16_sdwa v219, v221 dst_sel:WORD_0 dst_unused:UNUSED_PAD src0_sel:WORD_1
 v_fma_mix_f32 v216, v164, v216, 0 op_sel_hi:[0,1,0]
 v_fma_mix_f32 v218, v166, v218, 0 op_sel_hi:[0,1,0]
 v_fma_mix_f32 v217, v165, v217, 0 op_sel_hi:[0,1,0]
 v_mfma_f32_32x32x16_bf16 v[184:199], a[8:11], v[76:79], v[184:199]
 ds_read_b64_tr_b16 a[0:1], v244 offset:16384
 ds_read_b64_tr_b16 a[2:3], v244 offset:16896
 v_fma_mix_f32 v219, v167, v219, 0 op_sel_hi:[0,1,0]
 ds_read_b128 v[164:167], v246 offset:1120
 v_cvt_pk_bf16_f32 v230, v216, v217
 v_mfma_f32_32x32x16_bf16 v[200:215], a[12:15], v[76:79], v[200:215]
 ds_read_b64_tr_b16 a[4:5], v245 offset:16384
 ds_read_b64_tr_b16 a[6:7], v245 offset:16896
 v_cvt_pk_bf16_f32 v231, v218, v219
 v_accvgpr_write_b32 a70, v230
 v_accvgpr_write_b32 a71, v231
 buffer_store_dwordx4 v[228:231], v0, s[16:19], s69 offen offset:1024 sc1
 s_waitcnt lgkmcnt(5)
 v_mfma_f32_32x32x16_bf16 v[184:199], a[16:19], v[80:83], v[184:199]
 ds_read_b64_tr_b16 a[8:9], v244 offset:18432
 ds_read_b64_tr_b16 a[10:11], v244 offset:18944
 v_cvt_pk_f16_f32 v220, v168, v169
 v_cvt_pk_f16_f32 v221, v170, v171
 v_pk_fma_f16 v222, v220, v220, s70
 v_mfma_f32_32x32x16_bf16 v[200:215], a[20:23], v[80:83], v[200:215]
 ds_read_b64_tr_b16 a[12:13], v245 offset:18432
 ds_read_b64_tr_b16 a[14:15], v245 offset:18944
 buffer_load_dwordx4 v5, s[8:11], s53 offen offset:1536  lds
 v_pk_fma_f16 v223, v221, v221, s70
 v_pk_mul_f16 v220, v222, v220 neg_lo:[1,0] neg_hi:[1,0]
 v_pk_mul_f16 v221, v223, v221 neg_lo:[1,0] neg_hi:[1,0]
 v_exp_f16 v222, v220
 v_mfma_f32_32x32x16_bf16 v[184:199], a[24:27], v[84:87], v[184:199]
 ds_read_b64_tr_b16 a[16:17], v244 offset:20480
 ds_read_b64_tr_b16 a[18:19], v244 offset:20992
 v_exp_f16 v223, v221
 v_exp_f16_sdwa v222, v220 dst_sel:WORD_1 dst_unused:UNUSED_PRESERVE src0_sel:WORD_1
 v_mfma_f32_32x32x16_bf16 v[200:215], a[28:31], v[84:87], v[200:215]
 ds_read_b64_tr_b16 a[20:21], v245 offset:20480
 ds_read_b64_tr_b16 a[22:23], v245 offset:20992
 v_exp_f16_sdwa v223, v221 dst_sel:WORD_1 dst_unused:UNUSED_PRESERVE src0_sel:WORD_1
 v_pk_fma_f16 v220, v222, v247, v247
 s_waitcnt lgkmcnt(4)
 v_mfma_f32_32x32x16_bf16 v[184:199], a[0:3], v[88:91], v[184:199]
 ds_read_b64_tr_b16 a[24:25], v244 offset:22528
 ds_read_b64_tr_b16 a[26:27], v244 offset:23040
 v_pk_fma_f16 v221, v223, v247, v247
 v_rcp_f16 v216, v220
 v_rcp_f16 v218, v221
 v_mfma_f32_32x32x16_bf16 v[200:215], a[4:7], v[88:91], v[200:215]
 ds_read_b64_tr_b16 a[28:29], v245 offset:22528
 s_add_u32 m0, s64, 65024
 ds_read_b64_tr_b16 a[30:31], v245 offset:23040
 buffer_load_dwordx4 v4, s[8:11], s54 offen offset:512  lds
 v_rcp_f16_sdwa v217, v220 dst_sel:WORD_0 dst_unused:UNUSED_PAD src0_sel:WORD_1
 v_rcp_f16_sdwa v219, v221 dst_sel:WORD_0 dst_unused:UNUSED_PAD src0_sel:WORD_1
 v_mfma_f32_32x32x16_bf16 v[184:199], a[8:11], v[92:95], v[184:199]
 s_barrier
 ds_read_b64_tr_b16 a[0:1], v244 offset:24576
 ds_read_b64_tr_b16 a[2:3], v244 offset:25088
 v_fma_mix_f32 v216, v168, v216, 0 op_sel_hi:[0,1,0]
 v_fma_mix_f32 v218, v170, v218, 0 op_sel_hi:[0,1,0]
 v_fma_mix_f32 v217, v169, v217, 0 op_sel_hi:[0,1,0]
 s_bitcmp1_b32 s44, 3
 s_cbranch_scc0 ON_35
 s_add_u32 s3, s35, 887808
 buffer_load_dwordx4 a[240:243], v3, s[20:23], s3 offen
ON_35:
 v_mfma_f32_32x32x16_bf16 v[200:215], a[12:15], v[92:95], v[200:215]
 ds_read_b64_tr_b16 a[4:5], v245 offset:24576
 ds_read_b64_tr_b16 a[6:7], v245 offset:25088
 v_fma_mix_f32 v219, v171, v219, 0 op_sel_hi:[0,1,0]
 ds_read_b128 v[168:171], v246 offset:1152
 v_cvt_pk_bf16_f32 v232, v216, v217
 s_waitcnt lgkmcnt(5)
 v_mfma_f32_32x32x16_bf16 v[184:199], a[16:19], v[96:99], v[184:199]
 ds_read_b64_tr_b16 a[8:9], v244 offset:26624
 ds_read_b64_tr_b16 a[10:11], v244 offset:27136
 v_cvt_pk_bf16_f32 v233, v218, v219
 v_accvgpr_write_b32 a72, v232
 v_accvgpr_write_b32 a73, v233
 v_cvt_pk_f16_f32 v220, v172, v173
 v_mfma_f32_32x32x16_bf16 v[200:215], a[20:23], v[96:99], v[200:215]
 ds_read_b64_tr_b16 a[12:13], v245 offset:26624
 ds_read_b64_tr_b16 a[14:15], v245 offset:27136
 buffer_load_dwordx4 v5, s[8:11], s54 offen offset:1536  lds
 v_cvt_pk_f16_f32 v221, v174, v175
 v_pk_fma_f16 v222, v220, v220, s70
 v_pk_fma_f16 v223, v221, v221, s70
 v_pk_mul_f16 v220, v222, v220 neg_lo:[1,0] neg_hi:[1,0]
 v_mfma_f32_32x32x16_bf16 v[184:199], a[24:27], v[100:103], v[184:199]
 ds_read_b64_tr_b16 a[16:17], v244 offset:28672
 ds_read_b64_tr_b16 a[18:19], v244 offset:29184
 v_pk_mul_f16 v221, v223, v221 neg_lo:[1,0] neg_hi:[1,0]
 v_exp_f16 v222, v220
 v_exp_f16 v223, v221
 v_mfma_f32_32x32x16_bf16 v[200:215], a[28:31], v[100:103], v[200:215]
 ds_read_b64_tr_b16 a[20:21], v245 offset:28672
 ds_read_b64_tr_b16 a[22:23], v245 offset:29184
 v_exp_f16_sdwa v222, v220 dst_sel:WORD_1 dst_unused:UNUSED_PRESERVE src0_sel:WORD_1
 s_waitcnt lgkmcnt(4)
 v_mfma_f32_32x32x16_bf16 v[184:199], a[0:3], v[104:107], v[184:199]
 ds_read_b64_tr_b16 a[24:25], v244 offset:30720
 ds_read_b64_tr_b16 a[26:27], v244 offset:31232
 v_exp_f16_sdwa v223, v221 dst_sel:WORD_1 dst_unused:UNUSED_PRESERVE src0_sel:WORD_1
 v_pk_fma_f16 v220, v222, v247, v247
 v_pk_fma_f16 v221, v223, v247, v247
 s_bfe_u32 s50, s44, 0x30008
 v_mfma_f32_32x32x16_bf16 v[200:215], a[4:7], v[104:107], v[200:215]
 ds_read_b64_tr_b16 a[28:29], v245 offset:30720
 s_add_u32 m0, s64, 73728
 ds_read_b64_tr_b16 a[30:31], v245 offset:31232
 buffer_load_dwordx4 v6, s[12:15], s56 offen offset:0  lds
 v_rcp_f16 v216, v220
 v_rcp_f16 v218, v221
 s_cmp_ge_u32 s50, 3
 s_cselect_b32 s51, 1, 0
 v_mfma_f32_32x32x16_bf16 v[184:199], a[8:11], v[108:111], v[184:199]
 ds_read_b64_tr_b16 a[0:1], v244 offset:32768
 ds_read_b64_tr_b16 a[2:3], v244 offset:33280
 v_rcp_f16_sdwa v217, v220 dst_sel:WORD_0 dst_unused:UNUSED_PAD src0_sel:WORD_1
 v_rcp_f16_sdwa v219, v221 dst_sel:WORD_0 dst_unused:UNUSED_PAD src0_sel:WORD_1
 v_fma_mix_f32 v216, v172, v216, 0 op_sel_hi:[0,1,0]
 s_lshl_b32 s52, s41, 1
 v_mfma_f32_32x32x16_bf16 v[200:215], a[12:15], v[108:111], v[200:215]
 ds_read_b64_tr_b16 a[4:5], v245 offset:32768
 ds_read_b64_tr_b16 a[6:7], v245 offset:33280
 v_fma_mix_f32 v218, v174, v218, 0 op_sel_hi:[0,1,0]
 v_fma_mix_f32 v217, v173, v217, 0 op_sel_hi:[0,1,0]
 v_fma_mix_f32 v219, v175, v219, 0 op_sel_hi:[0,1,0]
 s_add_u32 s52, s52, s51
 s_mul_i32 s51, s51, 3
 s_waitcnt lgkmcnt(4)
 v_mfma_f32_32x32x16_bf16 v[184:199], a[16:19], v[112:115], v[184:199]
 ds_read_b64_tr_b16 a[8:9], v244 offset:34816
 ds_read_b64_tr_b16 a[10:11], v244 offset:35328
 ds_read_b128 v[172:175], v246 offset:1184
 v_cvt_pk_bf16_f32 v234, v216, v217
 v_cvt_pk_bf16_f32 v235, v218, v219
 v_accvgpr_write_b32 a74, v234
 s_sub_u32 s50, s50, s51
 v_mfma_f32_32x32x16_bf16 v[200:215], a[20:23], v[112:115], v[200:215]
 ds_read_b64_tr_b16 a[12:13], v245 offset:34816
 ds_read_b64_tr_b16 a[14:15], v245 offset:35328
 buffer_load_dwordx4 v7, s[12:15], s56 offen offset:1024  lds
 v_accvgpr_write_b32 a75, v235
 buffer_store_dwordx4 v[232:235], v0, s[16:19], s69 offen offset:2048 sc1
 v_cvt_pk_f16_f32 v220, v176, v177
 v_cvt_pk_f16_f32 v221, v178, v179
 s_mul_i32 s50, s50, 3
 s_mul_i32 s46, s52, 9
 v_mfma_f32_32x32x16_bf16 v[184:199], a[24:27], v[116:119], v[184:199]
 ds_read_b64_tr_b16 a[16:17], v244 offset:36864
 ds_read_b64_tr_b16 a[18:19], v244 offset:37376
 v_pk_fma_f16 v222, v220, v220, s70
 v_pk_fma_f16 v223, v221, v221, s70
 v_pk_mul_f16 v220, v222, v220 neg_lo:[1,0] neg_hi:[1,0]
 v_pk_mul_f16 v221, v223, v221 neg_lo:[1,0] neg_hi:[1,0]
 s_add_u32 s46, s46, s50
 v_mfma_f32_32x32x16_bf16 v[200:215], a[28:31], v[116:119], v[200:215]
 ds_read_b64_tr_b16 a[20:21], v245 offset:36864
 ds_read_b64_tr_b16 a[22:23], v245 offset:37376
 v_exp_f16 v222, v220
 v_exp_f16 v223, v221
 s_lshl_b32 s46, s46, 13
 s_add_u32 s46, s46, s64
 s_waitcnt lgkmcnt(4)
 v_mfma_f32_32x32x16_bf16 v[184:199], a[0:3], v[120:123], v[184:199]
 ds_read_b64_tr_b16 a[24:25], v244 offset:38912
 ds_read_b64_tr_b16 a[26:27], v244 offset:39424
 v_exp_f16_sdwa v222, v220 dst_sel:WORD_1 dst_unused:UNUSED_PRESERVE src0_sel:WORD_1
 v_exp_f16_sdwa v223, v221 dst_sel:WORD_1 dst_unused:UNUSED_PRESERVE src0_sel:WORD_1
 s_bitcmp1_b32 s44, 3
 s_cbranch_scc0 ON_36
 s_add_u32 s3, s35, 887808
 buffer_load_dwordx4 a[244:247], v3, s[24:27], s3 offen
ON_36:
 s_add_u32 s46, s46, 37748736
 v_mfma_f32_32x32x16_bf16 v[200:215], a[4:7], v[120:123], v[200:215]
 ds_read_b64_tr_b16 a[28:29], v245 offset:38912
 s_add_u32 m0, s64, 81920
 ds_read_b64_tr_b16 a[30:31], v245 offset:39424
 buffer_load_dwordx4 v6, s[12:15], s57 offen offset:0  lds
 v_pk_fma_f16 v220, v222, v247, v247
 v_pk_fma_f16 v221, v223, v247, v247
 v_rcp_f16 v216, v220
 s_add_u32 s51, s50, s40
 s_lshl_b32 s51, s51, 5
 v_mfma_f32_32x32x16_bf16 v[184:199], a[8:11], v[124:127], v[184:199]
 ds_read_b64_tr_b16 a[0:1], v244 offset:40960
 ds_read_b64_tr_b16 a[2:3], v244 offset:41472
 v_rcp_f16 v218, v221
 v_rcp_f16_sdwa v217, v220 dst_sel:WORD_0 dst_unused:UNUSED_PAD src0_sel:WORD_1
 s_add_u32 s51, s51, s52
 v_mfma_f32_32x32x16_bf16 v[200:215], a[12:15], v[124:127], v[200:215]
 ds_read_b64_tr_b16 a[4:5], v245 offset:40960
 ds_read_b64_tr_b16 a[6:7], v245 offset:41472
 v_rcp_f16_sdwa v219, v221 dst_sel:WORD_0 dst_unused:UNUSED_PAD src0_sel:WORD_1
 v_fma_mix_f32 v216, v176, v216, 0 op_sel_hi:[0,1,0]
 s_lshl_b32 s47, s51, 3
 s_waitcnt lgkmcnt(4)
 v_mfma_f32_32x32x16_bf16 v[184:199], a[16:19], v[128:131], v[184:199]
 ds_read_b64_tr_b16 a[8:9], v244 offset:43008
 ds_read_b64_tr_b16 a[10:11], v244 offset:43520
 v_fma_mix_f32 v218, v178, v218, 0 op_sel_hi:[0,1,0]
 v_fma_mix_f32 v217, v177, v217, 0 op_sel_hi:[0,1,0]
 v_fma_mix_f32 v219, v179, v219, 0 op_sel_hi:[0,1,0]
 ds_read_b128 v[176:179], v246 offset:1216
 s_add_u32 s47, s47, 42598400
 s_lshl_b32 s48, s51, 7
 v_mfma_f32_32x32x16_bf16 v[200:215], a[20:23], v[128:131], v[200:215]
 ds_read_b64_tr_b16 a[12:13], v245 offset:43008
 ds_read_b64_tr_b16 a[14:15], v245 offset:43520
 buffer_load_dwordx4 v7, s[12:15], s57 offen offset:1024  lds
 v_cvt_pk_bf16_f32 v236, v216, v217
 v_cvt_pk_bf16_f32 v237, v218, v219
 v_accvgpr_write_b32 a76, v236
 s_add_u32 s48, s48, 40108032
 v_mfma_f32_32x32x16_bf16 v[184:199], a[24:27], v[132:135], v[184:199]
 ds_read_b64_tr_b16 a[16:17], v244 offset:45056
 ds_read_b64_tr_b16 a[18:19], v244 offset:45568
 v_accvgpr_write_b32 a77, v237
 v_cvt_pk_f16_f32 v220, v180, v181
 v_cvt_pk_f16_f32 v221, v182, v183
 v_pk_fma_f16 v222, v220, v220, s70
 s_add_u32 s49, s48, 1179648
 v_and_b32 v1, 15, v2
 v_mfma_f32_32x32x16_bf16 v[200:215], a[28:31], v[132:135], v[200:215]
 ds_read_b64_tr_b16 a[20:21], v245 offset:45056
 ds_read_b64_tr_b16 a[22:23], v245 offset:45568
 v_pk_fma_f16 v223, v221, v221, s70
 v_pk_mul_f16 v220, v222, v220 neg_lo:[1,0] neg_hi:[1,0]
 v_pk_mul_f16 v221, v223, v221 neg_lo:[1,0] neg_hi:[1,0]
 v_exp_f16 v222, v220
 s_lshl_b32 s51, s40, 4
 s_waitcnt lgkmcnt(4)
 v_mfma_f32_32x32x16_bf16 v[184:199], a[0:3], v[136:139], v[184:199]
 ds_read_b64_tr_b16 a[24:25], v244 offset:47104
 ds_read_b64_tr_b16 a[26:27], v244 offset:47616
 v_exp_f16 v223, v221
 v_exp_f16_sdwa v222, v220 dst_sel:WORD_1 dst_unused:UNUSED_PRESERVE src0_sel:WORD_1
 v_add_u32 v1, s51, v1
 v_lshrrev_b32 v4, 4, v2
 v_mfma_f32_32x32x16_bf16 v[200:215], a[4:7], v[136:139], v[200:215]
 ds_read_b64_tr_b16 a[28:29], v245 offset:47104
 s_add_u32 m0, s64, 90112
 ds_read_b64_tr_b16 a[30:31], v245 offset:47616
 buffer_load_dwordx4 v6, s[12:15], s58 offen offset:0  lds
 v_exp_f16_sdwa v223, v221 dst_sel:WORD_1 dst_unused:UNUSED_PRESERVE src0_sel:WORD_1
 v_pk_fma_f16 v220, v222, v247, v247
 v_min_u32 v4, 2, v4
 v_mfma_f32_32x32x16_bf16 v[184:199], a[8:11], v[140:143], v[184:199]
 s_barrier
 ds_read_b64_tr_b16 a[0:1], v240 offset:0
 ds_read_b64_tr_b16 a[2:3], v240 offset:512
 v_pk_fma_f16 v221, v223, v247, v247
 v_rcp_f16 v216, v220
 v_rcp_f16 v218, v221
 v_add_u32 v4, s50, v4
 v_sub_u32 v5, 8, v4
 v_mfma_f32_32x32x16_bf16 v[200:215], a[12:15], v[140:143], v[200:215]
 ds_read_b64_tr_b16 a[4:5], v241 offset:0
 ds_read_b64_tr_b16 a[6:7], v241 offset:512
 v_rcp_f16_sdwa v217, v220 dst_sel:WORD_0 dst_unused:UNUSED_PAD src0_sel:WORD_1
 v_rcp_f16_sdwa v219, v221 dst_sel:WORD_0 dst_unused:UNUSED_PAD src0_sel:WORD_1
 v_min_u32 v4, v4, v5
 s_waitcnt lgkmcnt(4)
 v_mfma_f32_32x32x16_bf16 v[184:199], a[16:19], v[144:147], v[184:199]
 ds_read_b64_tr_b16 a[8:9], v240 offset:2048
 ds_read_b64_tr_b16 a[10:11], v240 offset:2560
 v_fma_mix_f32 v216, v180, v216, 0 op_sel_hi:[0,1,0]
 v_fma_mix_f32 v218, v182, v218, 0 op_sel_hi:[0,1,0]
 v_fma_mix_f32 v217, v181, v217, 0 op_sel_hi:[0,1,0]
 v_lshl_add_u32 v1, v4, 6, v1
 v_lshlrev_b32 v1, 3, v1
 v_mfma_f32_32x32x16_bf16 v[200:215], a[20:23], v[144:147], v[200:215]
 ds_read_b64_tr_b16 a[12:13], v241 offset:2048
 ds_read_b64_tr_b16 a[14:15], v241 offset:2560
 buffer_load_dwordx4 v7, s[12:15], s58 offen offset:1024  lds
 v_fma_mix_f32 v219, v183, v219, 0 op_sel_hi:[0,1,0]
 ds_read_b128 v[180:183], v246 offset:1248
 v_cvt_pk_bf16_f32 v238, v216, v217
 v_add_u32 v1, 42602496, v1
 v_mfma_f32_32x32x16_bf16 v[184:199], a[24:27], v[148:151], v[184:199]
 ds_read_b64_tr_b16 a[16:17], v240 offset:4096
 ds_read_b64_tr_b16 a[18:19], v240 offset:4608
 v_cvt_pk_bf16_f32 v239, v218, v219
 v_accvgpr_write_b32 a78, v238
ST1_5:
 s_cbranch_execz STB1_1
 v_accvgpr_write_b32 a79, v239
 buffer_store_dwordx4 v[236:239], v0, s[16:19], s69 offen offset:3072 sc1
 v_mfma_f32_32x32x16_bf16 v[200:215], a[28:31], v[148:151], v[200:215]
 ds_read_b64_tr_b16 a[20:21], v241 offset:4096
 ds_read_b64_tr_b16 a[22:23], v241 offset:4608
 s_waitcnt lgkmcnt(4)
 v_mfma_f32_32x32x16_bf16 v[152:167], a[0:3], v[8:11], v[152:167]
 ds_read_b64_tr_b16 a[24:25], v240 offset:6144
 ds_read_b64_tr_b16 a[26:27], v240 offset:6656
 v_mfma_f32_32x32x16_bf16 v[168:183], a[4:7], v[8:11], v[168:183]
 ds_read_b64_tr_b16 a[28:29], v241 offset:6144
 s_add_u32 m0, s64, 98304
 ds_read_b64_tr_b16 a[30:31], v241 offset:6656
 buffer_load_dwordx4 v6, s[12:15], s55 offen offset:0  lds
 v_cvt_pk_f16_f32 v220, v184, v185
 v_cvt_pk_f16_f32 v221, v186, v187
 v_pk_fma_f16 v222, v220, v220, s70
 v_pk_fma_f16 v223, v221, v221, s70
 v_mfma_f32_32x32x16_bf16 v[152:167], a[8:11], v[12:15], v[152:167]
 ds_read_b64_tr_b16 a[0:1], v240 offset:8192
 ds_read_b64_tr_b16 a[2:3], v240 offset:8704
 v_pk_mul_f16 v220, v222, v220 neg_lo:[1,0] neg_hi:[1,0]
 v_pk_mul_f16 v221, v223, v221 neg_lo:[1,0] neg_hi:[1,0]
 v_exp_f16 v222, v220
 v_mfma_f32_32x32x16_bf16 v[168:183], a[12:15], v[12:15], v[168:183]
 ds_read_b64_tr_b16 a[4:5], v241 offset:8192
 ds_read_b64_tr_b16 a[6:7], v241 offset:8704
 v_exp_f16 v223, v221
 v_exp_f16_sdwa v222, v220 dst_sel:WORD_1 dst_unused:UNUSED_PRESERVE src0_sel:WORD_1
 s_waitcnt lgkmcnt(4)
 v_mfma_f32_32x32x16_bf16 v[152:167], a[16:19], v[16:19], v[152:167]
 ds_read_b64_tr_b16 a[8:9], v240 offset:10240
 ds_read_b64_tr_b16 a[10:11], v240 offset:10752
 v_exp_f16_sdwa v223, v221 dst_sel:WORD_1 dst_unused:UNUSED_PRESERVE src0_sel:WORD_1
 v_pk_fma_f16 v220, v222, v247, v247
 v_mfma_f32_32x32x16_bf16 v[168:183], a[20:23], v[16:19], v[168:183]
 ds_read_b64_tr_b16 a[12:13], v241 offset:10240
 ds_read_b64_tr_b16 a[14:15], v241 offset:10752
 buffer_load_dwordx4 v7, s[12:15], s55 offen offset:1024  lds
 v_pk_fma_f16 v221, v223, v247, v247
 v_rcp_f16 v216, v220
 v_mfma_f32_32x32x16_bf16 v[152:167], a[24:27], v[20:23], v[152:167]
 ds_read_b64_tr_b16 a[16:17], v240 offset:12288
 ds_read_b64_tr_b16 a[18:19], v240 offset:12800
 v_rcp_f16 v218, v221
 v_rcp_f16_sdwa v217, v220 dst_sel:WORD_0 dst_unused:UNUSED_PAD src0_sel:WORD_1
 v_mfma_f32_32x32x16_bf16 v[168:183], a[28:31], v[20:23], v[168:183]
 ds_read_b64_tr_b16 a[20:21], v241 offset:12288
 ds_read_b64_tr_b16 a[22:23], v241 offset:12800
 v_rcp_f16_sdwa v219, v221 dst_sel:WORD_0 dst_unused:UNUSED_PAD src0_sel:WORD_1
 v_fma_mix_f32 v216, v184, v216, 0 op_sel_hi:[0,1,0]
 v_fma_mix_f32 v218, v186, v218, 0 op_sel_hi:[0,1,0]
 s_waitcnt lgkmcnt(4)
 v_mfma_f32_32x32x16_bf16 v[152:167], a[0:3], v[24:27], v[152:167]
 ds_read_b64_tr_b16 a[24:25], v240 offset:14336
 ds_read_b64_tr_b16 a[26:27], v240 offset:14848
 v_fma_mix_f32 v217, v185, v217, 0 op_sel_hi:[0,1,0]
 v_fma_mix_f32 v219, v187, v219, 0 op_sel_hi:[0,1,0]
 v_cvt_pk_bf16_f32 v224, v216, v217
 v_cvt_pk_bf16_f32 v225, v218, v219
 v_mfma_f32_32x32x16_bf16 v[168:183], a[4:7], v[24:27], v[168:183]
 ds_read_b64_tr_b16 a[28:29], v241 offset:14336
 s_add_u32 m0, s64, 106496
 ds_read_b64_tr_b16 a[30:31], v241 offset:14848
 buffer_load_dwordx4 v6, s[12:15], s60 offen offset:0  lds
 v_accvgpr_write_b32 a80, v224
 v_accvgpr_write_b32 a81, v225
 v_cvt_pk_f16_f32 v220, v188, v189
 v_cvt_pk_f16_f32 v221, v190, v191
 v_mfma_f32_32x32x16_bf16 v[152:167], a[8:11], v[28:31], v[152:167]
 ds_read_b64_tr_b16 a[0:1], v240 offset:16384
 ds_read_b64_tr_b16 a[2:3], v240 offset:16896
 v_pk_fma_f16 v222, v220, v220, s70
 v_pk_fma_f16 v223, v221, v221, s70
 v_pk_mul_f16 v220, v222, v220 neg_lo:[1,0] neg_hi:[1,0]
 v_mfma_f32_32x32x16_bf16 v[168:183], a[12:15], v[28:31], v[168:183]
 ds_read_b64_tr_b16 a[4:5], v241 offset:16384
 ds_read_b64_tr_b16 a[6:7], v241 offset:16896
 v_pk_mul_f16 v221, v223, v221 neg_lo:[1,0] neg_hi:[1,0]
 v_exp_f16 v222, v220
 v_exp_f16 v223, v221
 s_waitcnt lgkmcnt(4)
 v_mfma_f32_32x32x16_bf16 v[152:167], a[16:19], v[32:35], v[152:167]
 ds_read_b64_tr_b16 a[8:9], v240 offset:18432
 ds_read_b64_tr_b16 a[10:11], v240 offset:18944
 v_exp_f16_sdwa v222, v220 dst_sel:WORD_1 dst_unused:UNUSED_PRESERVE src0_sel:WORD_1
 v_mfma_f32_32x32x16_bf16 v[168:183], a[20:23], v[32:35], v[168:183]
 ds_read_b64_tr_b16 a[12:13], v241 offset:18432
 ds_read_b64_tr_b16 a[14:15], v241 offset:18944
 buffer_load_dwordx4 v7, s[12:15], s60 offen offset:1024  lds
 v_exp_f16_sdwa v223, v221 dst_sel:WORD_1 dst_unused:UNUSED_PRESERVE src0_sel:WORD_1
 v_pk_fma_f16 v220, v222, v247, v247
 v_pk_fma_f16 v221, v223, v247, v247
 v_mfma_f32_32x32x16_bf16 v[152:167], a[24:27], v[36:39], v[152:167]
 ds_read_b64_tr_b16 a[16:17], v240 offset:20480
 ds_read_b64_tr_b16 a[18:19], v240 offset:20992
 v_rcp_f16 v216, v220
 v_rcp_f16 v218, v221
 v_mfma_f32_32x32x16_bf16 v[168:183], a[28:31], v[36:39], v[168:183]
 ds_read_b64_tr_b16 a[20:21], v241 offset:20480
 ds_read_b64_tr_b16 a[22:23], v241 offset:20992
 v_rcp_f16_sdwa v217, v220 dst_sel:WORD_0 dst_unused:UNUSED_PAD src0_sel:WORD_1
 v_rcp_f16_sdwa v219, v221 dst_sel:WORD_0 dst_unused:UNUSED_PAD src0_sel:WORD_1
 s_waitcnt lgkmcnt(4)
 v_mfma_f32_32x32x16_bf16 v[152:167], a[0:3], v[40:43], v[152:167]
 ds_read_b64_tr_b16 a[24:25], v240 offset:22528
 ds_read_b64_tr_b16 a[26:27], v240 offset:23040
 v_fma_mix_f32 v216, v188, v216, 0 op_sel_hi:[0,1,0]
 v_fma_mix_f32 v218, v190, v218, 0 op_sel_hi:[0,1,0]
 v_fma_mix_f32 v217, v189, v217, 0 op_sel_hi:[0,1,0]
 v_fma_mix_f32 v219, v191, v219, 0 op_sel_hi:[0,1,0]
 v_mfma_f32_32x32x16_bf16 v[168:183], a[4:7], v[40:43], v[168:183]
 ds_read_b64_tr_b16 a[28:29], v241 offset:22528
 s_add_u32 m0, s64, 114688
 ds_read_b64_tr_b16 a[30:31], v241 offset:23040
 buffer_load_dwordx4 v6, s[12:15], s59 offen offset:0  lds
 v_cvt_pk_bf16_f32 v226, v216, v217
 v_cvt_pk_bf16_f32 v227, v218, v219
 v_accvgpr_write_b32 a82, v226
 v_mfma_f32_32x32x16_bf16 v[152:167], a[8:11], v[44:47], v[152:167]
 s_waitcnt vmcnt(21)
 s_barrier
 ds_read_b64_tr_b16 a[0:1], v240 offset:24576
 ds_read_b64_tr_b16 a[2:3], v240 offset:25088
 v_accvgpr_write_b32 a83, v227
 s_add_u32 s69, s65, 12288
 buffer_store_dwordx4 v[224:227], v0, s[16:19], s69 offen offset:0 sc1
 v_cvt_pk_f16_f32 v220, v192, v193
 v_mfma_f32_32x32x16_bf16 v[168:183], a[12:15], v[44:47], v[168:183]
 ds_read_b64_tr_b16 a[4:5], v241 offset:24576
 ds_read_b64_tr_b16 a[6:7], v241 offset:25088
 v_cvt_pk_f16_f32 v221, v194, v195
 v_pk_fma_f16 v222, v220, v220, s70
 v_pk_fma_f16 v223, v221, v221, s70
 v_pk_mul_f16 v220, v222, v220 neg_lo:[1,0] neg_hi:[1,0]
 s_waitcnt lgkmcnt(4)
 v_mfma_f32_32x32x16_bf16 v[152:167], a[16:19], v[48:51], v[152:167]
 ds_read_b64_tr_b16 a[8:9], v240 offset:26624
 ds_read_b64_tr_b16 a[10:11], v240 offset:27136
 v_pk_mul_f16 v221, v223, v221 neg_lo:[1,0] neg_hi:[1,0]
 v_exp_f16 v222, v220
 v_mfma_f32_32x32x16_bf16 v[168:183], a[20:23], v[48:51], v[168:183]
 ds_read_b64_tr_b16 a[12:13], v241 offset:26624
 ds_read_b64_tr_b16 a[14:15], v241 offset:27136
 buffer_load_dwordx4 v7, s[12:15], s59 offen offset:1024  lds
 v_exp_f16 v223, v221
 v_exp_f16_sdwa v222, v220 dst_sel:WORD_1 dst_unused:UNUSED_PRESERVE src0_sel:WORD_1
 v_mfma_f32_32x32x16_bf16 v[152:167], a[24:27], v[52:55], v[152:167]
 ds_read_b64_tr_b16 a[16:17], v240 offset:28672
 ds_read_b64_tr_b16 a[18:19], v240 offset:29184
 v_exp_f16_sdwa v223, v221 dst_sel:WORD_1 dst_unused:UNUSED_PRESERVE src0_sel:WORD_1
 v_pk_fma_f16 v220, v222, v247, v247
 v_pk_fma_f16 v221, v223, v247, v247
 v_mfma_f32_32x32x16_bf16 v[168:183], a[28:31], v[52:55], v[168:183]
 ds_read_b64_tr_b16 a[20:21], v241 offset:28672
 ds_read_b64_tr_b16 a[22:23], v241 offset:29184
 v_rcp_f16 v216, v220
 v_rcp_f16 v218, v221
 s_waitcnt lgkmcnt(4)
 v_mfma_f32_32x32x16_bf16 v[152:167], a[0:3], v[56:59], v[152:167]
 ds_read_b64_tr_b16 a[24:25], v240 offset:30720
 ds_read_b64_tr_b16 a[26:27], v240 offset:31232
 v_rcp_f16_sdwa v217, v220 dst_sel:WORD_0 dst_unused:UNUSED_PAD src0_sel:WORD_1
 v_rcp_f16_sdwa v219, v221 dst_sel:WORD_0 dst_unused:UNUSED_PAD src0_sel:WORD_1
 v_mov_b32 v249, 3
 s_waitcnt vmcnt(7)
 s_mov_b64 exec, 1
 buffer_store_dwordx2 v[248:249], off, s[16:19], s67 sc1
 s_mov_b64 exec, -1
 v_mfma_f32_32x32x16_bf16 v[168:183], a[4:7], v[56:59], v[168:183]
 ds_read_b64_tr_b16 a[28:29], v241 offset:30720
 ds_read_b64_tr_b16 a[30:31], v241 offset:31232
 s_add_u32 m0, s64, 122880
 s_mov_b32 s96, 700416
 v_lshl_add_u64 v[254:255], s[96:97], 0, v[252:253]
 global_load_lds_dwordx4 v[254:255], off
 v_fma_mix_f32 v216, v192, v216, 0 op_sel_hi:[0,1,0]
 v_fma_mix_f32 v218, v194, v218, 0 op_sel_hi:[0,1,0]
 v_fma_mix_f32 v217, v193, v217, 0 op_sel_hi:[0,1,0]
 v_mfma_f32_32x32x16_bf16 v[152:167], a[8:11], v[60:63], v[152:167]
 ds_read_b64_tr_b16 a[0:1], v240 offset:32768
 ds_read_b64_tr_b16 a[2:3], v240 offset:33280
 v_fma_mix_f32 v219, v195, v219, 0 op_sel_hi:[0,1,0]
 v_cvt_pk_bf16_f32 v228, v216, v217
 v_cvt_pk_bf16_f32 v229, v218, v219
 v_accvgpr_write_b32 a84, v228
 buffer_load_dwordx2 v[4:5], v1, s[16:19], 0 offen sc1
 v_mfma_f32_32x32x16_bf16 v[168:183], a[12:15], v[60:63], v[168:183]
 ds_read_b64_tr_b16 a[4:5], v241 offset:32768
 ds_read_b64_tr_b16 a[6:7], v241 offset:33280
 v_accvgpr_write_b32 a85, v229
 v_cvt_pk_f16_f32 v220, v196, v197
 v_cvt_pk_f16_f32 v221, v198, v199
 v_pk_fma_f16 v222, v220, v220, s70
 s_waitcnt lgkmcnt(4)
 v_mfma_f32_32x32x16_bf16 v[152:167], a[16:19], v[64:67], v[152:167]
 ds_read_b64_tr_b16 a[8:9], v240 offset:34816
 ds_read_b64_tr_b16 a[10:11], v240 offset:35328
 v_pk_fma_f16 v223, v221, v221, s70
 v_pk_mul_f16 v220, v222, v220 neg_lo:[1,0] neg_hi:[1,0]
 v_pk_mul_f16 v221, v223, v221 neg_lo:[1,0] neg_hi:[1,0]
 s_buffer_load_dwordx2 s[0:1], s[16:19], s34 glc
 v_mfma_f32_32x32x16_bf16 v[168:183], a[20:23], v[64:67], v[168:183]
 ds_read_b64_tr_b16 a[12:13], v241 offset:34816
 ds_read_b64_tr_b16 a[14:15], v241 offset:35328
 global_load_lds_dwordx4 v[254:255], off offset:1024
 v_exp_f16 v222, v220
 v_exp_f16 v223, v221
 v_mfma_f32_32x32x16_bf16 v[152:167], a[24:27], v[68:71], v[152:167]
 ds_read_b64_tr_b16 a[16:17], v240 offset:36864
 ds_read_b64_tr_b16 a[18:19], v240 offset:37376
 v_exp_f16_sdwa v222, v220 dst_sel:WORD_1 dst_unused:UNUSED_PRESERVE src0_sel:WORD_1
 v_exp_f16_sdwa v223, v221 dst_sel:WORD_1 dst_unused:UNUSED_PRESERVE src0_sel:WORD_1
 v_mfma_f32_32x32x16_bf16 v[168:183], a[28:31], v[68:71], v[168:183]
 ds_read_b64_tr_b16 a[20:21], v241 offset:36864
 ds_read_b64_tr_b16 a[22:23], v241 offset:37376
 v_pk_fma_f16 v220, v222, v247, v247
 v_pk_fma_f16 v221, v223, v247, v247
 v_rcp_f16 v216, v220
 s_waitcnt lgkmcnt(8)
 v_mfma_f32_32x32x16_bf16 v[152:167], a[0:3], v[72:75], v[152:167]
 ds_read_b64_tr_b16 a[24:25], v240 offset:38912
 ds_read_b64_tr_b16 a[26:27], v240 offset:39424
 v_rcp_f16 v218, v221
 v_rcp_f16_sdwa v217, v220 dst_sel:WORD_0 dst_unused:UNUSED_PAD src0_sel:WORD_1
 v_mfma_f32_32x32x16_bf16 v[168:183], a[4:7], v[72:75], v[168:183]
 ds_read_b64_tr_b16 a[28:29], v241 offset:38912
 ds_read_b64_tr_b16 a[30:31], v241 offset:39424
 s_add_u32 m0, s64, 131072
 s_mov_b32 s96, 708608
 v_lshl_add_u64 v[254:255], s[96:97], 0, v[252:253]
 global_load_lds_dwordx4 v[254:255], off
 v_rcp_f16_sdwa v219, v221 dst_sel:WORD_0 dst_unused:UNUSED_PAD src0_sel:WORD_1
 v_fma_mix_f32 v216, v196, v216, 0 op_sel_hi:[0,1,0]
 s_waitcnt lgkmcnt(8)
 v_mfma_f32_32x32x16_bf16 v[152:167], a[8:11], v[76:79], v[152:167]
 ds_read_b64_tr_b16 a[0:1], v240 offset:40960
 ds_read_b64_tr_b16 a[2:3], v240 offset:41472
 v_fma_mix_f32 v218, v198, v218, 0 op_sel_hi:[0,1,0]
 v_fma_mix_f32 v217, v197, v217, 0 op_sel_hi:[0,1,0]
 v_fma_mix_f32 v219, v199, v219, 0 op_sel_hi:[0,1,0]
 v_cvt_pk_bf16_f32 v230, v216, v217
 v_mfma_f32_32x32x16_bf16 v[168:183], a[12:15], v[76:79], v[168:183]
 ds_read_b64_tr_b16 a[4:5], v241 offset:40960
 ds_read_b64_tr_b16 a[6:7], v241 offset:41472
 v_cvt_pk_bf16_f32 v231, v218, v219
 v_accvgpr_write_b32 a86, v230
 v_accvgpr_write_b32 a87, v231
 buffer_store_dwordx4 v[228:231], v0, s[16:19], s69 offen offset:1024 sc1
 s_waitcnt lgkmcnt(8)
 v_mfma_f32_32x32x16_bf16 v[152:167], a[16:19], v[80:83], v[152:167]
 ds_read_b64_tr_b16 a[8:9], v240 offset:43008
 ds_read_b64_tr_b16 a[10:11], v240 offset:43520
 v_cvt_pk_f16_f32 v220, v200, v201
 v_cvt_pk_f16_f32 v221, v202, v203
 v_pk_fma_f16 v222, v220, v220, s70
 v_mfma_f32_32x32x16_bf16 v[168:183], a[20:23], v[80:83], v[168:183]
 ds_read_b64_tr_b16 a[12:13], v241 offset:43008
 ds_read_b64_tr_b16 a[14:15], v241 offset:43520
 global_load_lds_dwordx4 v[254:255], off offset:1024
 v_pk_fma_f16 v223, v221, v221, s70
 v_pk_mul_f16 v220, v222, v220 neg_lo:[1,0] neg_hi:[1,0]
 v_pk_mul_f16 v221, v223, v221 neg_lo:[1,0] neg_hi:[1,0]
 s_waitcnt lgkmcnt(8)
 v_mfma_f32_32x32x16_bf16 v[152:167], a[24:27], v[84:87], v[152:167]
 ds_read_b64_tr_b16 a[16:17], v240 offset:45056
 ds_read_b64_tr_b16 a[18:19], v240 offset:45568
 v_exp_f16 v222, v220
 v_exp_f16 v223, v221
 v_mfma_f32_32x32x16_bf16 v[168:183], a[28:31], v[84:87], v[168:183]
 ds_read_b64_tr_b16 a[20:21], v241 offset:45056
 ds_read_b64_tr_b16 a[22:23], v241 offset:45568
 v_exp_f16_sdwa v222, v220 dst_sel:WORD_1 dst_unused:UNUSED_PRESERVE src0_sel:WORD_1
 v_exp_f16_sdwa v223, v221 dst_sel:WORD_1 dst_unused:UNUSED_PRESERVE src0_sel:WORD_1
 s_waitcnt lgkmcnt(8)
 v_mfma_f32_32x32x16_bf16 v[152:167], a[0:3], v[88:91], v[152:167]
 ds_read_b64_tr_b16 a[24:25], v240 offset:47104
 ds_read_b64_tr_b16 a[26:27], v240 offset:47616
 v_pk_fma_f16 v220, v222, v247, v247
 v_pk_fma_f16 v221, v223, v247, v247
 v_rcp_f16 v216, v220
 v_mfma_f32_32x32x16_bf16 v[168:183], a[4:7], v[88:91], v[168:183]
 ds_read_b64_tr_b16 a[28:29], v241 offset:47104
 ds_read_b64_tr_b16 a[30:31], v241 offset:47616
 s_add_u32 m0, s64, 139264
 s_mov_b32 s96, 716800
 v_lshl_add_u64 v[254:255], s[96:97], 0, v[252:253]
 global_load_lds_dwordx4 v[254:255], off
 v_rcp_f16 v218, v221
 v_rcp_f16_sdwa v217, v220 dst_sel:WORD_0 dst_unused:UNUSED_PAD src0_sel:WORD_1
 s_waitcnt lgkmcnt(8)
 v_mfma_f32_32x32x16_bf16 v[152:167], a[8:11], v[92:95], v[152:167]
 s_barrier
 ds_read_b64_tr_b16 a[0:1], v242 offset:0
 ds_read_b64_tr_b16 a[2:3], v242 offset:512
 v_rcp_f16_sdwa v219, v221 dst_sel:WORD_0 dst_unused:UNUSED_PAD src0_sel:WORD_1
 v_fma_mix_f32 v216, v200, v216, 0 op_sel_hi:[0,1,0]
 v_fma_mix_f32 v218, v202, v218, 0 op_sel_hi:[0,1,0]
 v_mfma_f32_32x32x16_bf16 v[168:183], a[12:15], v[92:95], v[168:183]
 ds_read_b64_tr_b16 a[4:5], v243 offset:0
 ds_read_b64_tr_b16 a[6:7], v243 offset:512
 v_fma_mix_f32 v217, v201, v217, 0 op_sel_hi:[0,1,0]
 v_fma_mix_f32 v219, v203, v219, 0 op_sel_hi:[0,1,0]
 v_cvt_pk_bf16_f32 v232, v216, v217
 s_waitcnt lgkmcnt(8)
 v_mfma_f32_32x32x16_bf16 v[152:167], a[16:19], v[96:99], v[152:167]
 ds_read_b64_tr_b16 a[8:9], v242 offset:2048
 ds_read_b64_tr_b16 a[10:11], v242 offset:2560
 v_cvt_pk_bf16_f32 v233, v218, v219
 v_accvgpr_write_b32 a88, v232
 v_accvgpr_write_b32 a89, v233
 v_cvt_pk_f16_f32 v220, v204, v205
 v_mfma_f32_32x32x16_bf16 v[168:183], a[20:23], v[96:99], v[168:183]
 ds_read_b64_tr_b16 a[12:13], v243 offset:2048
 ds_read_b64_tr_b16 a[14:15], v243 offset:2560
 global_load_lds_dwordx4 v[254:255], off offset:1024
 v_cvt_pk_f16_f32 v221, v206, v207
 v_pk_fma_f16 v222, v220, v220, s70
 v_pk_fma_f16 v223, v221, v221, s70
 v_pk_mul_f16 v220, v222, v220 neg_lo:[1,0] neg_hi:[1,0]
 s_waitcnt lgkmcnt(8)
 v_mfma_f32_32x32x16_bf16 v[152:167], a[24:27], v[100:103], v[152:167]
 ds_read_b64_tr_b16 a[16:17], v242 offset:4096
 ds_read_b64_tr_b16 a[18:19], v242 offset:4608
 v_pk_mul_f16 v221, v223, v221 neg_lo:[1,0] neg_hi:[1,0]
 v_exp_f16 v222, v220
 v_mfma_f32_32x32x16_bf16 v[168:183], a[28:31], v[100:103], v[168:183]
 ds_read_b64_tr_b16 a[20:21], v243 offset:4096
 ds_read_b64_tr_b16 a[22:23], v243 offset:4608
 v_exp_f16 v223, v221
 v_exp_f16_sdwa v222, v220 dst_sel:WORD_1 dst_unused:UNUSED_PRESERVE src0_sel:WORD_1
 s_bitcmp1_b32 s44, 2
 s_cbranch_scc0 ON_37
 s_waitcnt vmcnt(6)
PC_38:
 v_subrev_u32 v5, 1, v5
 v_cmp_ne_u32 vcc, s45, v4
 v_cmp_lt_u32 s[100:101], 60, v5
 s_nop 1
 s_or_b64 vcc, vcc, s[100:101]
 s_cbranch_scc1 PS_39
PK_40:
ON_37:
 s_waitcnt lgkmcnt(8)
 v_mfma_f32_32x32x16_bf16 v[152:167], a[0:3], v[104:107], v[152:167]
 ds_read_b64_tr_b16 a[24:25], v242 offset:6144
 ds_read_b64_tr_b16 a[26:27], v242 offset:6656
 v_exp_f16_sdwa v223, v221 dst_sel:WORD_1 dst_unused:UNUSED_PRESERVE src0_sel:WORD_1
 v_pk_fma_f16 v220, v222, v247, v247
 v_pk_fma_f16 v221, v223, v247, v247
 v_mfma_f32_32x32x16_bf16 v[168:183], a[4:7], v[104:107], v[168:183]
 ds_read_b64_tr_b16 a[28:29], v243 offset:6144
 s_add_u32 m0, s64, 0
 ds_read_b64_tr_b16 a[30:31], v243 offset:6656
 buffer_load_dwordx4 v0, s[16:19], s46 offen offset:0 sc1  lds
 v_rcp_f16 v216, v220
 v_rcp_f16 v218, v221
 s_waitcnt lgkmcnt(8)
 v_mfma_f32_32x32x16_bf16 v[152:167], a[8:11], v[108:111], v[152:167]
 ds_read_b64_tr_b16 a[0:1], v242 offset:8192
 ds_read_b64_tr_b16 a[2:3], v242 offset:8704
 v_rcp_f16_sdwa v217, v220 dst_sel:WORD_0 dst_unused:UNUSED_PAD src0_sel:WORD_1
 v_rcp_f16_sdwa v219, v221 dst_sel:WORD_0 dst_unused:UNUSED_PAD src0_sel:WORD_1
 s_waitcnt lgkmcnt(0)
 s_sub_u32 s1, s1, 2
 s_cmp_lt_u32 s1, 60
 s_cselect_b32 s0, s0, 0
 s_cmp_lg_u32 s0, s45
 s_cbranch_scc1 QC_41
QK_42:
 v_mfma_f32_32x32x16_bf16 v[168:183], a[12:15], v[108:111], v[168:183]
 ds_read_b64_tr_b16 a[4:5], v243 offset:8192
 ds_read_b64_tr_b16 a[6:7], v243 offset:8704
 v_fma_mix_f32 v216, v204, v216, 0 op_sel_hi:[0,1,0]
 v_fma_mix_f32 v218, v206, v218, 0 op_sel_hi:[0,1,0]
 v_fma_mix_f32 v217, v205, v217, 0 op_sel_hi:[0,1,0]
 v_mfma_f32_32x32x16_bf16 v[152:167], a[16:19], v[112:115], v[152:167]
 ds_read_b64_tr_b16 a[8:9], v242 offset:10240
 ds_read_b64_tr_b16 a[10:11], v242 offset:10752
 v_fma_mix_f32 v219, v207, v219, 0 op_sel_hi:[0,1,0]
 v_cvt_pk_bf16_f32 v234, v216, v217
 v_cvt_pk_bf16_f32 v235, v218, v219
 v_accvgpr_write_b32 a90, v234
 v_lshrrev_b32 v3, 5, v2
 v_mfma_f32_32x32x16_bf16 v[168:183], a[20:23], v[112:115], v[168:183]
 ds_read_b64_tr_b16 a[12:13], v243 offset:10240
 ds_read_b64_tr_b16 a[14:15], v243 offset:10752
 buffer_load_dwordx4 v0, s[16:19], s46 offen offset:1024 sc1  lds
 v_accvgpr_write_b32 a91, v235
 buffer_store_dwordx4 v[232:235], v0, s[16:19], s69 offen offset:2048 sc1
 v_cvt_pk_f16_f32 v220, v208, v209
 v_cvt_pk_f16_f32 v221, v210, v211
 s_add_u32 s3, s33, 20480
 buffer_load_dwordx4 a[112:115], v0, s[16:19], s3 offen offset:0 sc1
 v_bfe_u32 v1, v2, 2, 2
 v_mfma_f32_32x32x16_bf16 v[152:167], a[24:27], v[116:119], v[152:167]
 ds_read_b64_tr_b16 a[16:17], v242 offset:12288
 ds_read_b64_tr_b16 a[18:19], v242 offset:12800
 v_pk_fma_f16 v222, v220, v220, s70
 v_pk_fma_f16 v223, v221, v221, s70
 v_pk_mul_f16 v220, v222, v220 neg_lo:[1,0] neg_hi:[1,0]
 v_lshl_add_u32 v3, v3, 2, v1
 v_mfma_f32_32x32x16_bf16 v[168:183], a[28:31], v[116:119], v[168:183]
 ds_read_b64_tr_b16 a[20:21], v243 offset:12288
 ds_read_b64_tr_b16 a[22:23], v243 offset:12800
 v_pk_mul_f16 v221, v223, v221 neg_lo:[1,0] neg_hi:[1,0]
 v_exp_f16 v222, v220
 v_exp_f16 v223, v221
 v_lshlrev_b32 v4, 7, v3
 s_waitcnt lgkmcnt(4)
 v_mfma_f32_32x32x16_bf16 v[152:167], a[0:3], v[120:123], v[152:167]
 ds_read_b64_tr_b16 a[24:25], v242 offset:14336
 ds_read_b64_tr_b16 a[26:27], v242 offset:14848
 v_exp_f16_sdwa v222, v220 dst_sel:WORD_1 dst_unused:UNUSED_PRESERVE src0_sel:WORD_1
 v_lshlrev_b32 v5, 6, v3
 v_mfma_f32_32x32x16_bf16 v[168:183], a[4:7], v[120:123], v[168:183]
 ds_read_b64_tr_b16 a[28:29], v243 offset:14336
 ds_read_b64_tr_b16 a[30:31], v243 offset:14848
 s_add_u32 m0, s64, 8192
 s_add_u32 s68, s46, 8192
 buffer_load_dwordx4 v0, s[16:19], s68 offen sc1  lds
 v_exp_f16_sdwa v223, v221 dst_sel:WORD_1 dst_unused:UNUSED_PRESERVE src0_sel:WORD_1
 v_pk_fma_f16 v220, v222, v247, v247
 v_pk_fma_f16 v221, v223, v247, v247
 v_bfe_u32 v1, v2, 4, 1
 v_mfma_f32_32x32x16_bf16 v[152:167], a[8:11], v[124:127], v[152:167]
 ds_read_b64_tr_b16 a[0:1], v242 offset:16384
 ds_read_b64_tr_b16 a[2:3], v242 offset:16896
 v_rcp_f16 v216, v220
 v_rcp_f16 v218, v221
 s_add_u32 s3, s33, 20480
 buffer_load_dwordx4 a[116:119], v0, s[16:19], s3 offen offset:1024 sc1
 v_lshlrev_b32 v1, 5, v1
 v_mfma_f32_32x32x16_bf16 v[168:183], a[12:15], v[124:127], v[168:183]
 ds_read_b64_tr_b16 a[4:5], v243 offset:16384
 ds_read_b64_tr_b16 a[6:7], v243 offset:16896
 v_rcp_f16_sdwa v217, v220 dst_sel:WORD_0 dst_unused:UNUSED_PAD src0_sel:WORD_1
 v_rcp_f16_sdwa v219, v221 dst_sel:WORD_0 dst_unused:UNUSED_PAD src0_sel:WORD_1
 v_and_b32 v3, 3, v2
 s_waitcnt lgkmcnt(4)
 v_mfma_f32_32x32x16_bf16 v[152:167], a[16:19], v[128:131], v[152:167]
 ds_read_b64_tr_b16 a[8:9], v242 offset:18432
 ds_read_b64_tr_b16 a[10:11], v242 offset:18944
 v_fma_mix_f32 v216, v208, v216, 0 op_sel_hi:[0,1,0]
 v_fma_mix_f32 v218, v210, v218, 0 op_sel_hi:[0,1,0]
 v_fma_mix_f32 v217, v209, v217, 0 op_sel_hi:[0,1,0]
 v_fma_mix_f32 v219, v211, v219, 0 op_sel_hi:[0,1,0]
 v_lshl_add_u32 v1, v3, 3, v1
 v_mfma_f32_32x32x16_bf16 v[168:183], a[20:23], v[128:131], v[168:183]
 ds_read_b64_tr_b16 a[12:13], v243 offset:18432
 ds_read_b64_tr_b16 a[14:15], v243 offset:18944
 buffer_load_dwordx4 v0, s[16:19], s68 offen offset:1024 sc1  lds
 v_cvt_pk_bf16_f32 v236, v216, v217
 v_cvt_pk_bf16_f32 v237, v218, v219
 v_accvgpr_write_b32 a92, v236
 v_mfma_f32_32x32x16_bf16 v[152:167], a[24:27], v[132:135], v[152:167]
 ds_read_b64_tr_b16 a[16:17], v242 offset:20480
 ds_read_b64_tr_b16 a[18:19], v242 offset:20992
 v_accvgpr_write_b32 a93, v237
 v_cvt_pk_f16_f32 v220, v212, v213
 v_cvt_pk_f16_f32 v221, v214, v215
 v_pk_fma_f16 v222, v220, v220, s70
 s_min_u32 s98, s40, 2
 v_mfma_f32_32x32x16_bf16 v[168:183], a[28:31], v[132:135], v[168:183]
 ds_read_b64_tr_b16 a[20:21], v243 offset:20480
 ds_read_b64_tr_b16 a[22:23], v243 offset:20992
 v_pk_fma_f16 v223, v221, v221, s70
 v_pk_mul_f16 v220, v222, v220 neg_lo:[1,0] neg_hi:[1,0]
 v_pk_mul_f16 v221, v223, v221 neg_lo:[1,0] neg_hi:[1,0]
 s_add_u32 s3, s33, 20480
 buffer_load_dwordx4 a[120:123], v0, s[16:19], s3 offen offset:2048 sc1
 s_lshl_b32 s98, s98, 13
 s_waitcnt lgkmcnt(4)
 v_mfma_f32_32x32x16_bf16 v[152:167], a[0:3], v[136:139], v[152:167]
 ds_read_b64_tr_b16 a[24:25], v242 offset:22528
 ds_read_b64_tr_b16 a[26:27], v242 offset:23040
 v_exp_f16 v222, v220
 v_exp_f16 v223, v221
 s_add_u32 s99, s98, 0
 v_mfma_f32_32x32x16_bf16 v[168:183], a[4:7], v[136:139], v[168:183]
 ds_read_b64_tr_b16 a[28:29], v243 offset:22528
 ds_read_b64_tr_b16 a[30:31], v243 offset:23040
 s_add_u32 m0, s64, 16384
 s_add_u32 s68, s46, 16384
 buffer_load_dwordx4 v0, s[16:19], s68 offen sc1  lds
 v_exp_f16_sdwa v222, v220 dst_sel:WORD_1 dst_unused:UNUSED_PRESERVE src0_sel:WORD_1
 v_exp_f16_sdwa v223, v221 dst_sel:WORD_1 dst_unused:UNUSED_PRESERVE src0_sel:WORD_1
 v_add3_u32 v4, v4, v1, s99
 v_mfma_f32_32x32x16_bf16 v[152:167], a[8:11], v[140:143], v[152:167]
 s_barrier
 ds_read_b64_tr_b16 a[0:1], v242 offset:24576
 ds_read_b64_tr_b16 a[2:3], v242 offset:25088
 v_pk_fma_f16 v220, v222, v247, v247
 v_pk_fma_f16 v221, v223, v247, v247
 v_rcp_f16 v216, v220
 s_add_u32 s99, s98, 24576
 v_mfma_f32_32x32x16_bf16 v[168:183], a[12:15], v[140:143], v[168:183]
 ds_read_b64_tr_b16 a[4:5], v243 offset:24576
 ds_read_b64_tr_b16 a[6:7], v243 offset:25088
 v_rcp_f16 v218, v221
 v_rcp_f16_sdwa v217, v220 dst_sel:WORD_0 dst_unused:UNUSED_PAD src0_sel:WORD_1
 v_add3_u32 v5, v5, v1, s99
 s_waitcnt lgkmcnt(4)
 v_mfma_f32_32x32x16_bf16 v[152:167], a[16:19], v[144:147], v[152:167]
 ds_read_b64_tr_b16 a[8:9], v242 offset:26624
 ds_read_b64_tr_b16 a[10:11], v242 offset:27136
 v_rcp_f16_sdwa v219, v221 dst_sel:WORD_0 dst_unused:UNUSED_PAD src0_sel:WORD_1
 v_fma_mix_f32 v216, v212, v216, 0 op_sel_hi:[0,1,0]
 v_fma_mix_f32 v218, v214, v218, 0 op_sel_hi:[0,1,0]
 s_add_u32 s3, s33, 20480
 buffer_load_dwordx4 a[124:127], v0, s[16:19], s3 offen offset:3072 sc1
 v_add_u32 v1, s99, v0
 v_mfma_f32_32x32x16_bf16 v[168:183], a[20:23], v[144:147], v[168:183]
 ds_read_b64_tr_b16 a[12:13], v243 offset:26624
 ds_read_b64_tr_b16 a[14:15], v243 offset:27136
 buffer_load_dwordx4 v0, s[16:19], s68 offen offset:1024 sc1  lds
 v_fma_mix_f32 v217, v213, v217, 0 op_sel_hi:[0,1,0]
 v_fma_mix_f32 v219, v215, v219, 0 op_sel_hi:[0,1,0]
 v_cvt_pk_bf16_f32 v238, v216, v217
 v_add_u32 v3, 122880, v0
 v_mfma_f32_32x32x16_bf16 v[152:167], a[24:27], v[148:151], v[152:167]
 ds_read_b64_tr_b16 a[16:17], v242 offset:28672
 ds_read_b64_tr_b16 a[18:19], v242 offset:29184
 v_cvt_pk_bf16_f32 v239, v218, v219
 v_accvgpr_write_b32 a94, v238
 v_accvgpr_write_b32 a95, v239
 buffer_store_dwordx4 v[236:239], v0, s[16:19], s69 offen offset:3072 sc1
 v_mfma_f32_32x32x16_bf16 v[168:183], a[28:31], v[148:151], v[168:183]
 ds_read_b64_tr_b16 a[20:21], v243 offset:28672
 ds_read_b64_tr_b16 a[22:23], v243 offset:29184
 s_mov_b32 s11, s47
 s_bitcmp1_b32 s44, 3
 s_cbranch_scc1 L_unit
 s_waitcnt lgkmcnt(4)
 v_mfma_f32_32x32x16_bf16 v[104:119], a[0:3], a[48:51], 0
 ds_read_b64_tr_b16 a[24:25], v242 offset:30720
 ds_read_b64_tr_b16 a[26:27], v242 offset:31232
 v_mfma_f32_32x32x16_bf16 v[120:135], a[4:7], a[48:51], 0
 ds_read_b64_tr_b16 a[28:29], v243 offset:30720
 ds_read_b64_tr_b16 a[30:31], v243 offset:31232
 v_mfma_f32_32x32x16_bf16 v[104:119], a[8:11], a[52:55], v[104:119]
 ds_read_b64_tr_b16 a[0:1], v242 offset:32768
 ds_read_b64_tr_b16 a[2:3], v242 offset:33280
 v_mfma_f32_32x32x16_bf16 v[120:135], a[12:15], a[52:55], v[120:135]
 ds_read_b64_tr_b16 a[4:5], v243 offset:32768
 ds_read_b64_tr_b16 a[6:7], v243 offset:33280
 v_cvt_pk_f16_f32 v220, v152, v153
 v_cvt_pk_f16_f32 v221, v154, v155
 v_pk_fma_f16 v222, v220, v220, s70
 v_pk_fma_f16 v223, v221, v221, s70
 v_pk_mul_f16 v220, v222, v220 neg_lo:[1,0] neg_hi:[1,0]
 v_pk_mul_f16 v221, v223, v221 neg_lo:[1,0] neg_hi:[1,0]
 s_waitcnt lgkmcnt(4)
 v_mfma_f32_32x32x16_bf16 v[104:119], a[16:19], a[56:59], v[104:119]
 ds_read_b64_tr_b16 a[8:9], v242 offset:34816
 ds_read_b64_tr_b16 a[10:11], v242 offset:35328
 v_exp_f16 v222, v220
 v_exp_f16 v223, v221
 v_exp_f16_sdwa v222, v220 dst_sel:WORD_1 dst_unused:UNUSED_PRESERVE src0_sel:WORD_1
 v_mfma_f32_32x32x16_bf16 v[120:135], a[20:23], a[56:59], v[120:135]
 ds_read_b64_tr_b16 a[12:13], v243 offset:34816
 ds_read_b64_tr_b16 a[14:15], v243 offset:35328
ST1_6:
 s_cbranch_execz STB1_1
 v_exp_f16_sdwa v223, v221 dst_sel:WORD_1 dst_unused:UNUSED_PRESERVE src0_sel:WORD_1
 v_pk_fma_f16 v220, v222, v247, v247
 v_pk_fma_f16 v221, v223, v247, v247
 v_rcp_f16 v216, v220
 v_rcp_f16 v218, v221
 v_mfma_f32_32x32x16_bf16 v[104:119], a[24:27], a[60:63], v[104:119]
 ds_read_b64_tr_b16 a[16:17], v242 offset:36864
 ds_read_b64_tr_b16 a[18:19], v242 offset:37376
 v_rcp_f16_sdwa v217, v220 dst_sel:WORD_0 dst_unused:UNUSED_PAD src0_sel:WORD_1
 v_rcp_f16_sdwa v219, v221 dst_sel:WORD_0 dst_unused:UNUSED_PAD src0_sel:WORD_1
 v_fma_mix_f32 v216, v152, v216, 0 op_sel_hi:[0,1,0]
 v_mfma_f32_32x32x16_bf16 v[120:135], a[28:31], a[60:63], v[120:135]
 ds_read_b64_tr_b16 a[20:21], v243 offset:36864
 ds_read_b64_tr_b16 a[22:23], v243 offset:37376
 v_fma_mix_f32 v218, v154, v218, 0 op_sel_hi:[0,1,0]
 v_fma_mix_f32 v217, v153, v217, 0 op_sel_hi:[0,1,0]
 v_fma_mix_f32 v219, v155, v219, 0 op_sel_hi:[0,1,0]
 v_cvt_pk_bf16_f32 v224, v216, v217
 v_cvt_pk_bf16_f32 v225, v218, v219
 v_accvgpr_write_b32 a96, v224
 v_accvgpr_write_b32 a97, v225
 s_waitcnt lgkmcnt(4)
 v_mfma_f32_32x32x16_bf16 v[104:119], a[0:3], a[64:67], v[104:119]
 ds_read_b64_tr_b16 a[24:25], v242 offset:38912
 ds_read_b64_tr_b16 a[26:27], v242 offset:39424
 v_cvt_pk_f16_f32 v220, v156, v157
 v_cvt_pk_f16_f32 v221, v158, v159
 v_pk_fma_f16 v222, v220, v220, s70
 v_pk_fma_f16 v223, v221, v221, s70
 v_pk_mul_f16 v220, v222, v220 neg_lo:[1,0] neg_hi:[1,0]
 v_pk_mul_f16 v221, v223, v221 neg_lo:[1,0] neg_hi:[1,0]
 v_mfma_f32_32x32x16_bf16 v[120:135], a[4:7], a[64:67], v[120:135]
 ds_read_b64_tr_b16 a[28:29], v243 offset:38912
 ds_read_b64_tr_b16 a[30:31], v243 offset:39424
 v_exp_f16 v222, v220
 v_exp_f16 v223, v221
 v_exp_f16_sdwa v222, v220 dst_sel:WORD_1 dst_unused:UNUSED_PRESERVE src0_sel:WORD_1
 v_mfma_f32_32x32x16_bf16 v[104:119], a[8:11], a[68:71], v[104:119]
 ds_read_b64_tr_b16 a[0:1], v242 offset:40960
 ds_read_b64_tr_b16 a[2:3], v242 offset:41472
 v_exp_f16_sdwa v223, v221 dst_sel:WORD_1 dst_unused:UNUSED_PRESERVE src0_sel:WORD_1
 v_pk_fma_f16 v220, v222, v247, v247
 v_pk_fma_f16 v221, v223, v247, v247
 v_rcp_f16 v216, v220
 v_mfma_f32_32x32x16_bf16 v[120:135], a[12:15], a[68:71], v[120:135]
 ds_read_b64_tr_b16 a[4:5], v243 offset:40960
 ds_read_b64_tr_b16 a[6:7], v243 offset:41472
 v_rcp_f16 v218, v221
 v_rcp_f16_sdwa v217, v220 dst_sel:WORD_0 dst_unused:UNUSED_PAD src0_sel:WORD_1
 v_rcp_f16_sdwa v219, v221 dst_sel:WORD_0 dst_unused:UNUSED_PAD src0_sel:WORD_1
 v_fma_mix_f32 v216, v156, v216, 0 op_sel_hi:[0,1,0]
 s_waitcnt lgkmcnt(4)
 v_mfma_f32_32x32x16_bf16 v[104:119], a[16:19], a[72:75], v[104:119]
 ds_read_b64_tr_b16 a[8:9], v242 offset:43008
 ds_read_b64_tr_b16 a[10:11], v242 offset:43520
 v_fma_mix_f32 v218, v158, v218, 0 op_sel_hi:[0,1,0]
 v_fma_mix_f32 v217, v157, v217, 0 op_sel_hi:[0,1,0]
 v_fma_mix_f32 v219, v159, v219, 0 op_sel_hi:[0,1,0]
 v_cvt_pk_bf16_f32 v226, v216, v217
 v_cvt_pk_bf16_f32 v227, v218, v219
 v_accvgpr_write_b32 a98, v226
 v_accvgpr_write_b32 a99, v227
 v_mfma_f32_32x32x16_bf16 v[120:135], a[20:23], a[72:75], v[120:135]
 ds_read_b64_tr_b16 a[12:13], v243 offset:43008
 ds_read_b64_tr_b16 a[14:15], v243 offset:43520
 s_add_u32 s69, s65, 16384
 buffer_store_dwordx4 v[224:227], v0, s[16:19], s69 offen offset:0 sc1
 v_cvt_pk_f16_f32 v220, v160, v161
 v_cvt_pk_f16_f32 v221, v162, v163
 v_pk_fma_f16 v222, v220, v220, s70
 v_pk_fma_f16 v223, v221, v221, s70
 v_mfma_f32_32x32x16_bf16 v[104:119], a[24:27], a[76:79], v[104:119]
 ds_read_b64_tr_b16 a[16:17], v242 offset:45056
 ds_read_b64_tr_b16 a[18:19], v242 offset:45568
 v_pk_mul_f16 v220, v222, v220 neg_lo:[1,0] neg_hi:[1,0]
 v_pk_mul_f16 v221, v223, v221 neg_lo:[1,0] neg_hi:[1,0]
 v_exp_f16 v222, v220
 v_exp_f16 v223, v221
 v_mfma_f32_32x32x16_bf16 v[120:135], a[28:31], a[76:79], v[120:135]
 ds_read_b64_tr_b16 a[20:21], v243 offset:45056
 ds_read_b64_tr_b16 a[22:23], v243 offset:45568
 v_exp_f16_sdwa v222, v220 dst_sel:WORD_1 dst_unused:UNUSED_PRESERVE src0_sel:WORD_1
 v_exp_f16_sdwa v223, v221 dst_sel:WORD_1 dst_unused:UNUSED_PRESERVE src0_sel:WORD_1
 v_pk_fma_f16 v220, v222, v247, v247
 v_pk_fma_f16 v221, v223, v247, v247
 s_waitcnt lgkmcnt(4)
 v_mfma_f32_32x32x16_bf16 v[104:119], a[0:3], a[80:83], v[104:119]
 ds_read_b64_tr_b16 a[24:25], v242 offset:47104
 ds_read_b64_tr_b16 a[26:27], v242 offset:47616
 v_rcp_f16 v216, v220
 v_rcp_f16 v218, v221
 v_rcp_f16_sdwa v217, v220 dst_sel:WORD_0 dst_unused:UNUSED_PAD src0_sel:WORD_1
 v_rcp_f16_sdwa v219, v221 dst_sel:WORD_0 dst_unused:UNUSED_PAD src0_sel:WORD_1
 v_mfma_f32_32x32x16_bf16 v[120:135], a[4:7], a[80:83], v[120:135]
 ds_read_b64_tr_b16 a[28:29], v243 offset:47104
 ds_read_b64_tr_b16 a[30:31], v243 offset:47616
 v_fma_mix_f32 v216, v160, v216, 0 op_sel_hi:[0,1,0]
 v_fma_mix_f32 v218, v162, v218, 0 op_sel_hi:[0,1,0]
 v_fma_mix_f32 v217, v161, v217, 0 op_sel_hi:[0,1,0]
 v_fma_mix_f32 v219, v163, v219, 0 op_sel_hi:[0,1,0]
 v_cvt_pk_bf16_f32 v228, v216, v217
 v_mfma_f32_32x32x16_bf16 v[104:119], a[8:11], a[84:87], v[104:119]
 s_waitcnt vmcnt(2)
 s_barrier
 ds_read_b64_tr_b16 a[0:1], v244 offset:0
 ds_read_b64_tr_b16 a[2:3], v244 offset:512
 v_cvt_pk_bf16_f32 v229, v218, v219
 v_accvgpr_write_b32 a100, v228
 v_accvgpr_write_b32 a101, v229
 v_cvt_pk_f16_f32 v220, v164, v165
 v_cvt_pk_f16_f32 v221, v166, v167
 v_pk_fma_f16 v222, v220, v220, s70
 v_pk_fma_f16 v223, v221, v221, s70
 v_mfma_f32_32x32x16_bf16 v[120:135], a[12:15], a[84:87], v[120:135]
 ds_read_b64_tr_b16 a[4:5], v245 offset:0
 ds_read_b64_tr_b16 a[6:7], v245 offset:512
 v_pk_mul_f16 v220, v222, v220 neg_lo:[1,0] neg_hi:[1,0]
 v_pk_mul_f16 v221, v223, v221 neg_lo:[1,0] neg_hi:[1,0]
 v_exp_f16 v222, v220
 v_exp_f16 v223, v221
 s_waitcnt lgkmcnt(4)
 v_mfma_f32_32x32x16_bf16 v[104:119], a[16:19], a[88:91], v[104:119]
 ds_read_b64_tr_b16 a[8:9], v244 offset:2048
 ds_read_b64_tr_b16 a[10:11], v244 offset:2560
 v_exp_f16_sdwa v222, v220 dst_sel:WORD_1 dst_unused:UNUSED_PRESERVE src0_sel:WORD_1
 v_exp_f16_sdwa v223, v221 dst_sel:WORD_1 dst_unused:UNUSED_PRESERVE src0_sel:WORD_1
 v_pk_fma_f16 v220, v222, v247, v247
 v_pk_fma_f16 v221, v223, v247, v247
 v_mfma_f32_32x32x16_bf16 v[120:135], a[20:23], a[88:91], v[120:135]
 ds_read_b64_tr_b16 a[12:13], v245 offset:2048
 ds_read_b64_tr_b16 a[14:15], v245 offset:2560
 v_rcp_f16 v216, v220
 v_rcp_f16 v218, v221
 v_rcp_f16_sdwa v217, v220 dst_sel:WORD_0 dst_unused:UNUSED_PAD src0_sel:WORD_1
 v_mfma_f32_32x32x16_bf16 v[104:119], a[24:27], a[92:95], v[104:119]
 ds_read_b64_tr_b16 a[16:17], v244 offset:4096
 ds_read_b64_tr_b16 a[18:19], v244 offset:4608
 v_rcp_f16_sdwa v219, v221 dst_sel:WORD_0 dst_unused:UNUSED_PAD src0_sel:WORD_1
 v_fma_mix_f32 v216, v164, v216, 0 op_sel_hi:[0,1,0]
 v_fma_mix_f32 v218, v166, v218, 0 op_sel_hi:[0,1,0]
 v_fma_mix_f32 v217, v165, v217, 0 op_sel_hi:[0,1,0]
 v_fma_mix_f32 v219, v167, v219, 0 op_sel_hi:[0,1,0]
 v_cvt_pk_bf16_f32 v230, v216, v217
 v_mfma_f32_32x32x16_bf16 v[120:135], a[28:31], a[92:95], v[120:135]
 ds_read_b64_tr_b16 a[20:21], v245 offset:4096
 ds_read_b64_tr_b16 a[22:23], v245 offset:4608
 v_cvt_pk_bf16_f32 v231, v218, v219
 v_accvgpr_write_b32 a102, v230
 v_accvgpr_write_b32 a103, v231
 buffer_store_dwordx4 v[228:231], v0, s[16:19], s69 offen offset:1024 sc1
 v_cvt_pk_f16_f32 v220, v168, v169
 v_cvt_pk_f16_f32 v221, v170, v171
 v_pk_fma_f16 v222, v220, v220, s70
 s_waitcnt lgkmcnt(4)
 v_mfma_f32_32x32x16_bf16 v[104:119], a[0:3], a[32:35], v[104:119]
 ds_read_b64_tr_b16 a[24:25], v244 offset:6144
 ds_read_b64_tr_b16 a[26:27], v244 offset:6656
 v_pk_fma_f16 v223, v221, v221, s70
 v_pk_mul_f16 v220, v222, v220 neg_lo:[1,0] neg_hi:[1,0]
 v_pk_mul_f16 v221, v223, v221 neg_lo:[1,0] neg_hi:[1,0]
 v_exp_f16 v222, v220
 v_exp_f16 v223, v221
 v_mfma_f32_32x32x16_bf16 v[120:135], a[4:7], a[32:35], v[120:135]
 ds_read_b64_tr_b16 a[28:29], v245 offset:6144
 s_add_u32 m0, s64, 49152
 ds_read_b64_tr_b16 a[30:31], v245 offset:6656
 buffer_load_dwordx4 v6, s[12:15], s61 offen offset:0  lds
 v_exp_f16_sdwa v222, v220 dst_sel:WORD_1 dst_unused:UNUSED_PRESERVE src0_sel:WORD_1
 v_exp_f16_sdwa v223, v221 dst_sel:WORD_1 dst_unused:UNUSED_PRESERVE src0_sel:WORD_1
 v_pk_fma_f16 v220, v222, v247, v247
 v_mfma_f32_32x32x16_bf16 v[104:119], a[8:11], a[36:39], v[104:119]
 ds_read_b64_tr_b16 a[0:1], v244 offset:8192
 ds_read_b64_tr_b16 a[2:3], v244 offset:8704
 v_pk_fma_f16 v221, v223, v247, v247
 v_rcp_f16 v216, v220
 v_rcp_f16 v218, v221
 v_rcp_f16_sdwa v217, v220 dst_sel:WORD_0 dst_unused:UNUSED_PAD src0_sel:WORD_1
 v_mov_b32 v249, 4
 s_waitcnt vmcnt(3)
 s_mov_b64 exec, 1
 buffer_store_dwordx2 v[248:249], off, s[16:19], s67 sc1
 s_mov_b64 exec, -1
 v_mfma_f32_32x32x16_bf16 v[120:135], a[12:15], a[36:39], v[120:135]
 ds_read_b64_tr_b16 a[4:5], v245 offset:8192
 ds_read_b64_tr_b16 a[6:7], v245 offset:8704
 v_rcp_f16_sdwa v219, v221 dst_sel:WORD_0 dst_unused:UNUSED_PAD src0_sel:WORD_1
 v_fma_mix_f32 v216, v168, v216, 0 op_sel_hi:[0,1,0]
 v_fma_mix_f32 v218, v170, v218, 0 op_sel_hi:[0,1,0]
 v_fma_mix_f32 v217, v169, v217, 0 op_sel_hi:[0,1,0]
 v_fma_mix_f32 v219, v171, v219, 0 op_sel_hi:[0,1,0]
 s_waitcnt lgkmcnt(4)
 v_mfma_f32_32x32x16_bf16 v[104:119], a[16:19], a[40:43], v[104:119]
 ds_read_b64_tr_b16 a[8:9], v244 offset:10240
 ds_read_b64_tr_b16 a[10:11], v244 offset:10752
 v_cvt_pk_bf16_f32 v232, v216, v217
 v_cvt_pk_bf16_f32 v233, v218, v219
 v_accvgpr_write_b32 a104, v232
 v_accvgpr_write_b32 a105, v233
 v_cvt_pk_f16_f32 v220, v172, v173
 v_cvt_pk_f16_f32 v221, v174, v175
 v_pk_fma_f16 v222, v220, v220, s70
 v_mfma_f32_32x32x16_bf16 v[120:135], a[20:23], a[40:43], v[120:135]
 ds_read_b64_tr_b16 a[12:13], v245 offset:10240
 ds_read_b64_tr_b16 a[14:15], v245 offset:10752
 buffer_load_dwordx4 v7, s[12:15], s61 offen offset:1024  lds
 v_pk_fma_f16 v223, v221, v221, s70
 v_pk_mul_f16 v220, v222, v220 neg_lo:[1,0] neg_hi:[1,0]
 v_pk_mul_f16 v221, v223, v221 neg_lo:[1,0] neg_hi:[1,0]
 v_exp_f16 v222, v220
 v_mfma_f32_32x32x16_bf16 v[104:119], a[24:27], a[44:47], v[104:119]
 ds_read_b64_tr_b16 a[16:17], v244 offset:12288
 ds_read_b64_tr_b16 a[18:19], v244 offset:12800
 v_exp_f16 v223, v221
 v_exp_f16_sdwa v222, v220 dst_sel:WORD_1 dst_unused:UNUSED_PRESERVE src0_sel:WORD_1
 v_exp_f16_sdwa v223, v221 dst_sel:WORD_1 dst_unused:UNUSED_PRESERVE src0_sel:WORD_1
 v_pk_fma_f16 v220, v222, v247, v247
 s_buffer_load_dwordx2 s[0:1], s[16:19], s34 glc
 v_mfma_f32_32x32x16_bf16 v[120:135], a[28:31], a[44:47], v[120:135]
 ds_read_b64_tr_b16 a[20:21], v245 offset:12288
 ds_read_b64_tr_b16 a[22:23], v245 offset:12800
 v_pk_fma_f16 v221, v223, v247, v247
 v_rcp_f16 v216, v220
 v_rcp_f16 v218, v221
 v_rcp_f16_sdwa v217, v220 dst_sel:WORD_0 dst_unused:UNUSED_PAD src0_sel:WORD_1
 s_waitcnt lgkmcnt(8)
 v_mfma_f32_32x32x16_bf16 v[104:119], a[0:3], a[112:115], v[104:119]
 ds_read_b64_tr_b16 a[24:25], v244 offset:14336
 ds_read_b64_tr_b16 a[26:27], v244 offset:14848
 v_rcp_f16_sdwa v219, v221 dst_sel:WORD_0 dst_unused:UNUSED_PAD src0_sel:WORD_1
 v_fma_mix_f32 v216, v172, v216, 0 op_sel_hi:[0,1,0]
 v_fma_mix_f32 v218, v174, v218, 0 op_sel_hi:[0,1,0]
 v_fma_mix_f32 v217, v173, v217, 0 op_sel_hi:[0,1,0]
 v_fma_mix_f32 v219, v175, v219, 0 op_sel_hi:[0,1,0]
 v_mfma_f32_32x32x16_bf16 v[120:135], a[4:7], a[112:115], v[120:135]
 ds_read_b64_tr_b16 a[28:29], v245 offset:14336
 s_add_u32 m0, s64, 57216
 ds_read_b64_tr_b16 a[30:31], v245 offset:14848
 buffer_load_dwordx4 v6, s[12:15], s56 offen offset:128  lds
 v_cvt_pk_bf16_f32 v234, v216, v217
 v_cvt_pk_bf16_f32 v235, v218, v219
 v_accvgpr_write_b32 a106, v234
 v_accvgpr_write_b32 a107, v235
 buffer_store_dwordx4 v[232:235], v0, s[16:19], s69 offen offset:2048 sc1
 v_cvt_pk_f16_f32 v220, v176, v177
 s_waitcnt lgkmcnt(8)
 v_mfma_f32_32x32x16_bf16 v[104:119], a[8:11], a[116:119], v[104:119]
 ds_read_b64_tr_b16 a[0:1], v244 offset:16384
 ds_read_b64_tr_b16 a[2:3], v244 offset:16896
 v_cvt_pk_f16_f32 v221, v178, v179
 v_pk_fma_f16 v222, v220, v220, s70
 v_pk_fma_f16 v223, v221, v221, s70
 v_pk_mul_f16 v220, v222, v220 neg_lo:[1,0] neg_hi:[1,0]
 v_pk_mul_f16 v221, v223, v221 neg_lo:[1,0] neg_hi:[1,0]
 v_exp_f16 v222, v220
 v_mfma_f32_32x32x16_bf16 v[120:135], a[12:15], a[116:119], v[120:135]
 ds_read_b64_tr_b16 a[4:5], v245 offset:16384
 ds_read_b64_tr_b16 a[6:7], v245 offset:16896
 v_exp_f16 v223, v221
 v_exp_f16_sdwa v222, v220 dst_sel:WORD_1 dst_unused:UNUSED_PRESERVE src0_sel:WORD_1
 v_exp_f16_sdwa v223, v221 dst_sel:WORD_1 dst_unused:UNUSED_PRESERVE src0_sel:WORD_1
 s_waitcnt lgkmcnt(8)
 v_mfma_f32_32x32x16_bf16 v[104:119], a[16:19], a[120:123], v[104:119]
 ds_read_b64_tr_b16 a[8:9], v244 offset:18432
 ds_read_b64_tr_b16 a[10:11], v244 offset:18944
 v_pk_fma_f16 v220, v222, v247, v247
 v_pk_fma_f16 v221, v223, v247, v247
 v_rcp_f16 v216, v220
 v_rcp_f16 v218, v221
 v_mfma_f32_32x32x16_bf16 v[120:135], a[20:23], a[120:123], v[120:135]
 ds_read_b64_tr_b16 a[12:13], v245 offset:18432
 ds_read_b64_tr_b16 a[14:15], v245 offset:18944
 buffer_load_dwordx4 v7, s[12:15], s56 offen offset:1152  lds
 v_rcp_f16_sdwa v217, v220 dst_sel:WORD_0 dst_unused:UNUSED_PAD src0_sel:WORD_1
 v_rcp_f16_sdwa v219, v221 dst_sel:WORD_0 dst_unused:UNUSED_PAD src0_sel:WORD_1
 v_fma_mix_f32 v216, v176, v216, 0 op_sel_hi:[0,1,0]
 v_fma_mix_f32 v218, v178, v218, 0 op_sel_hi:[0,1,0]
 v_fma_mix_f32 v217, v177, v217, 0 op_sel_hi:[0,1,0]
 s_waitcnt lgkmcnt(8)
 v_mfma_f32_32x32x16_bf16 v[104:119], a[24:27], a[124:127], v[104:119]
 ds_read_b64_tr_b16 a[16:17], v244 offset:20480
 ds_read_b64_tr_b16 a[18:19], v244 offset:20992
 v_fma_mix_f32 v219, v179, v219, 0 op_sel_hi:[0,1,0]
 v_cvt_pk_bf16_f32 v236, v216, v217
 v_cvt_pk_bf16_f32 v237, v218, v219
 v_accvgpr_write_b32 a108, v236
 v_accvgpr_write_b32 a109, v237
 v_cvt_pk_f16_f32 v220, v180, v181
 v_mfma_f32_32x32x16_bf16 v[120:135], a[28:31], a[124:127], v[120:135]
 ds_read_b64_tr_b16 a[20:21], v245 offset:20480
 ds_read_b64_tr_b16 a[22:23], v245 offset:20992
 v_cvt_pk_f16_f32 v221, v182, v183
 v_pk_fma_f16 v222, v220, v220, s70
 v_pk_fma_f16 v223, v221, v221, s70
 v_pk_mul_f16 v220, v222, v220 neg_lo:[1,0] neg_hi:[1,0]
 v_pk_mul_f16 v221, v223, v221 neg_lo:[1,0] neg_hi:[1,0]
 v_exp_f16 v222, v220
 s_waitcnt lgkmcnt(8)
 v_mfma_f32_32x32x16_bf16 v[104:119], a[0:3], a[96:99], v[104:119]
 ds_read_b64_tr_b16 a[24:25], v244 offset:22528
 ds_read_b64_tr_b16 a[26:27], v244 offset:23040
 v_exp_f16 v223, v221
 v_exp_f16_sdwa v222, v220 dst_sel:WORD_1 dst_unused:UNUSED_PRESERVE src0_sel:WORD_1
 v_exp_f16_sdwa v223, v221 dst_sel:WORD_1 dst_unused:UNUSED_PRESERVE src0_sel:WORD_1
 v_mfma_f32_32x32x16_bf16 v[120:135], a[4:7], a[96:99], v[120:135]
 ds_read_b64_tr_b16 a[28:29], v245 offset:22528
 s_add_u32 m0, s64, 65536
 ds_read_b64_tr_b16 a[30:31], v245 offset:23040
 buffer_load_dwordx4 v6, s[12:15], s62 offen offset:0  lds
 v_pk_fma_f16 v220, v222, v247, v247
 v_pk_fma_f16 v221, v223, v247, v247
 v_rcp_f16 v216, v220
 v_rcp_f16 v218, v221
 s_waitcnt lgkmcnt(8)
 v_mfma_f32_32x32x16_bf16 v[104:119], a[8:11], a[100:103], v[104:119]
 v_rcp_f16_sdwa v217, v220 dst_sel:WORD_0 dst_unused:UNUSED_PAD src0_sel:WORD_1
 v_rcp_f16_sdwa v219, v221 dst_sel:WORD_0 dst_unused:UNUSED_PAD src0_sel:WORD_1
 v_fma_mix_f32 v216, v180, v216, 0 op_sel_hi:[0,1,0]
 v_fma_mix_f32 v218, v182, v218, 0 op_sel_hi:[0,1,0]
 v_fma_mix_f32 v217, v181, v217, 0 op_sel_hi:[0,1,0]
 v_mfma_f32_32x32x16_bf16 v[120:135], a[12:15], a[100:103], v[120:135]
 v_fma_mix_f32 v219, v183, v219, 0 op_sel_hi:[0,1,0]
 v_cvt_pk_bf16_f32 v238, v216, v217
 v_cvt_pk_bf16_f32 v239, v218, v219
 v_accvgpr_write_b32 a110, v238
 v_accvgpr_write_b32 a111, v239
 buffer_store_dwordx4 v[236:239], v0, s[16:19], s69 offen offset:3072 sc1
 s_waitcnt lgkmcnt(4)
 v_mfma_f32_32x32x16_bf16 v[104:119], a[16:19], a[104:107], v[104:119]
 v_mfma_f32_32x32x16_bf16 v[120:135], a[20:23], a[104:107], v[120:135]
 buffer_load_dwordx4 v7, s[12:15], s62 offen offset:1024  lds
 s_waitcnt lgkmcnt(0)
 v_mfma_f32_32x32x16_bf16 v[104:119], a[24:27], a[108:111], v[104:119]
 v_mfma_f32_32x32x16_bf16 v[120:135], a[28:31], a[108:111], v[120:135]
 s_barrier
 v_subrev_u32 v8, 55296, v6
 v_subrev_u32 v9, 55296, v7
 v_subrev_u32 v10, 36864, v6
 v_subrev_u32 v11, 36864, v7
 v_subrev_u32 v12, 18432, v6
 v_subrev_u32 v13, 18432, v7
 s_lshl_b32 s52, s41, 2
 s_lshr_b32 s38, s42, 2
 s_add_u32 s52, s52, s38
 s_add_u32 m0, s64, 73600
 s_nop 0
 buffer_load_dwordx4 v6, s[12:15], s57 offen offset:128  lds
 buffer_load_dwordx4 v7, s[12:15], s57 offen offset:1152  lds
 s_add_u32 m0, s64, 81792
 s_nop 0
 buffer_load_dwordx4 v6, s[12:15], s58 offen offset:128  lds
 buffer_load_dwordx4 v7, s[12:15], s58 offen offset:1152  lds
 s_bitcmp1_b32 s44, 2
 s_cbranch_scc0 ON_43
 s_mov_b32 m0, 73728
 s_add_u32 s68, s57, 128
 buffer_load_dwordx4 v8, s[12:15], s68 offen lds
 buffer_load_dwordx4 v9, s[12:15], s68 offen offset:1024 lds
 s_mov_b32 m0, 75776
 s_add_u32 s68, s57, 128
 buffer_load_dwordx4 v10, s[12:15], s68 offen lds
 buffer_load_dwordx4 v11, s[12:15], s68 offen offset:1024 lds
 s_mov_b32 m0, 77824
 s_add_u32 s68, s57, 128
 buffer_load_dwordx4 v12, s[12:15], s68 offen lds
 buffer_load_dwordx4 v13, s[12:15], s68 offen offset:1024 lds
 s_mov_b32 m0, 81920
 s_add_u32 s68, s58, 128
 buffer_load_dwordx4 v8, s[12:15], s68 offen lds
 buffer_load_dwordx4 v9, s[12:15], s68 offen offset:1024 lds
 s_mov_b32 m0, 83968
 s_add_u32 s68, s58, 128
 buffer_load_dwordx4 v10, s[12:15], s68 offen lds
 buffer_load_dwordx4 v11, s[12:15], s68 offen offset:1024 lds
 s_mov_b32 m0, 86016
 s_add_u32 s68, s58, 128
 buffer_load_dwordx4 v12, s[12:15], s68 offen lds
 buffer_load_dwordx4 v13, s[12:15], s68 offen offset:1024 lds
ON_43:
 s_waitcnt lgkmcnt(0)
 s_sub_u32 s1, s1, 3
 s_cmp_lt_u32 s1, 60
 s_cselect_b32 s0, s0, 0
 s_cmp_lg_u32 s0, s45
 s_cbranch_scc1 QC_44
QK_45:
 s_add_u32 s3, s33, 24576
 buffer_load_dwordx4 a[128:131], v0, s[16:19], s3 offen offset:0 sc1
 s_add_u32 s3, s33, 24576
 buffer_load_dwordx4 a[132:135], v0, s[16:19], s3 offen offset:1024 sc1
 s_add_u32 s3, s33, 24576
 buffer_load_dwordx4 a[136:139], v0, s[16:19], s3 offen offset:2048 sc1
 s_add_u32 s3, s33, 24576
 buffer_load_dwordx4 a[140:143], v0, s[16:19], s3 offen offset:3072 sc1
 s_barrier
 s_add_u32 m0, s64, 89984
 s_nop 0
 buffer_load_dwordx4 v6, s[12:15], s59 offen offset:128  lds
 buffer_load_dwordx4 v7, s[12:15], s59 offen offset:1152  lds
 s_add_u32 m0, s64, 98304
 s_nop 0
 buffer_load_dwordx4 v6, s[12:15], s63 offen offset:0  lds
 buffer_load_dwordx4 v7, s[12:15], s63 offen offset:1024  lds
 s_add_u32 m0, s64, 106368
 s_nop 0
 buffer_load_dwordx4 v6, s[12:15], s55 offen offset:128  lds
 buffer_load_dwordx4 v7, s[12:15], s55 offen offset:1152  lds
 s_add_u32 m0, s64, 114560
 s_nop 0
 buffer_load_dwordx4 v6, s[12:15], s60 offen offset:128  lds
 buffer_load_dwordx4 v7, s[12:15], s60 offen offset:1152  lds
 s_bitcmp1_b32 s44, 2
 s_cbranch_scc0 ON_46
 s_mov_b32 m0, 90112
 s_add_u32 s68, s59, 128
 buffer_load_dwordx4 v8, s[12:15], s68 offen lds
 buffer_load_dwordx4 v9, s[12:15], s68 offen offset:1024 lds
 s_mov_b32 m0, 92160
 s_add_u32 s68, s59, 128
 buffer_load_dwordx4 v10, s[12:15], s68 offen lds
 buffer_load_dwordx4 v11, s[12:15], s68 offen offset:1024 lds
 s_mov_b32 m0, 94208
 s_add_u32 s68, s59, 128
 buffer_load_dwordx4 v12, s[12:15], s68 offen lds
 buffer_load_dwordx4 v13, s[12:15], s68 offen offset:1024 lds
 s_mov_b32 m0, 98304
 s_add_u32 s68, s63, 0
 buffer_load_dwordx4 v8, s[12:15], s68 offen lds
 buffer_load_dwordx4 v9, s[12:15], s68 offen offset:1024 lds
 s_mov_b32 m0, 100352
 s_add_u32 s68, s63, 0
 buffer_load_dwordx4 v10, s[12:15], s68 offen lds
 buffer_load_dwordx4 v11, s[12:15], s68 offen offset:1024 lds
 s_mov_b32 m0, 102400
 s_add_u32 s68, s63, 0
 buffer_load_dwordx4 v12, s[12:15], s68 offen lds
 buffer_load_dwordx4 v13, s[12:15], s68 offen offset:1024 lds
 s_mov_b32 m0, 106496
 s_add_u32 s68, s55, 128
 buffer_load_dwordx4 v8, s[12:15], s68 offen lds
 buffer_load_dwordx4 v9, s[12:15], s68 offen offset:1024 lds
 s_mov_b32 m0, 108544
 s_add_u32 s68, s55, 128
 buffer_load_dwordx4 v10, s[12:15], s68 offen lds
 buffer_load_dwordx4 v11, s[12:15], s68 offen offset:1024 lds
 s_mov_b32 m0, 110592
 s_add_u32 s68, s55, 128
 buffer_load_dwordx4 v12, s[12:15], s68 offen lds
 buffer_load_dwordx4 v13, s[12:15], s68 offen offset:1024 lds
 s_mov_b32 m0, 114688
 s_add_u32 s68, s60, 128
 buffer_load_dwordx4 v8, s[12:15], s68 offen lds
 buffer_load_dwordx4 v9, s[12:15], s68 offen offset:1024 lds
 s_mov_b32 m0, 116736
 s_add_u32 s68, s60, 128
 buffer_load_dwordx4 v10, s[12:15], s68 offen lds
 buffer_load_dwordx4 v11, s[12:15], s68 offen offset:1024 lds
 s_mov_b32 m0, 118784
 s_add_u32 s68, s60, 128
 buffer_load_dwordx4 v12, s[12:15], s68 offen lds
 buffer_load_dwordx4 v13, s[12:15], s68 offen offset:1024 lds
ON_46:
 s_add_u32 m0, s64, 122752
 s_nop 0
 buffer_load_dwordx4 v6, s[12:15], s61 offen offset:128  lds
 buffer_load_dwordx4 v7, s[12:15], s61 offen offset:1152  lds
 s_add_u32 m0, s64, 130944
 s_nop 0
 buffer_load_dwordx4 v6, s[12:15], s62 offen offset:128  lds
 buffer_load_dwordx4 v7, s[12:15], s62 offen offset:1152  lds
 s_add_u32 m0, s64, 139136
 s_nop 0
 buffer_load_dwordx4 v6, s[12:15], s63 offen offset:128  lds
 buffer_load_dwordx4 v7, s[12:15], s63 offen offset:1152  lds
 s_bitcmp1_b32 s44, 2
 s_cbranch_scc0 ON_47
 s_mov_b32 m0, 122880
 s_add_u32 s68, s61, 128
 buffer_load_dwordx4 v8, s[12:15], s68 offen lds
 buffer_load_dwordx4 v9, s[12:15], s68 offen offset:1024 lds
 s_mov_b32 m0, 124928
 s_add_u32 s68, s61, 128
 buffer_load_dwordx4 v10, s[12:15], s68 offen lds
 buffer_load_dwordx4 v11, s[12:15], s68 offen offset:1024 lds
 s_mov_b32 m0, 126976
 s_add_u32 s68, s61, 128
 buffer_load_dwordx4 v12, s[12:15], s68 offen lds
 buffer_load_dwordx4 v13, s[12:15], s68 offen offset:1024 lds
 s_mov_b32 m0, 131072
 s_add_u32 s68, s62, 128
 buffer_load_dwordx4 v8, s[12:15], s68 offen lds
 buffer_load_dwordx4 v9, s[12:15], s68 offen offset:1024 lds
 s_mov_b32 m0, 133120
 s_add_u32 s68, s62, 128
 buffer_load_dwordx4 v10, s[12:15], s68 offen lds
 buffer_load_dwordx4 v11, s[12:15], s68 offen offset:1024 lds
 s_mov_b32 m0, 135168
 s_add_u32 s68, s62, 128
 buffer_load_dwordx4 v12, s[12:15], s68 offen lds
 buffer_load_dwordx4 v13, s[12:15], s68 offen offset:1024 lds
 s_mov_b32 m0, 139264
 s_add_u32 s68, s63, 128
 buffer_load_dwordx4 v8, s[12:15], s68 offen lds
 buffer_load_dwordx4 v9, s[12:15], s68 offen offset:1024 lds
 s_mov_b32 m0, 141312
 s_add_u32 s68, s63, 128
 buffer_load_dwordx4 v10, s[12:15], s68 offen lds
 buffer_load_dwordx4 v11, s[12:15], s68 offen offset:1024 lds
 s_mov_b32 m0, 143360
 s_add_u32 s68, s63, 128
 buffer_load_dwordx4 v12, s[12:15], s68 offen lds
 buffer_load_dwordx4 v13, s[12:15], s68 offen offset:1024 lds
ON_47:
 s_waitcnt lgkmcnt(0)
 s_buffer_load_dwordx2 s[0:1], s[16:19], s34 glc
 s_and_b32 s98, s42, 3
 s_min_u32 s98, s98, 2
 s_mul_i32 s96, s98, 110592
 s_add_u32 s96, s96, 368640
 v_lshl_add_u64 v[252:253], s[96:97], 0, v[252:253]
 s_waitcnt vmcnt(0)
 s_barrier
 ds_read_b64_tr_b16 a[0:1], v242 offset:0
 ds_read_b64_tr_b16 a[2:3], v242 offset:512
 ds_read_b64_tr_b16 a[4:5], v243 offset:0
 ds_read_b64_tr_b16 a[6:7], v243 offset:512
 ds_read_b64_tr_b16 a[8:9], v242 offset:2048
 ds_read_b64_tr_b16 a[10:11], v242 offset:2560
 ds_read_b64_tr_b16 a[12:13], v243 offset:2048
 ds_read_b64_tr_b16 a[14:15], v243 offset:2560
 ds_read_b64_tr_b16 a[16:17], v242 offset:4096
 ds_read_b64_tr_b16 a[18:19], v242 offset:4608
 ds_read_b64_tr_b16 a[20:21], v243 offset:4096
 ds_read_b64_tr_b16 a[22:23], v243 offset:4608
 s_waitcnt lgkmcnt(0)
 s_sub_u32 s1, s1, 4
 s_cmp_lt_u32 s1, 60
 s_cselect_b32 s0, s0, 0
 s_cmp_lg_u32 s0, s45
 s_cbranch_scc1 QC_53
QK_54:
 s_add_u32 s3, s33, 28672
 buffer_load_dwordx4 a[144:147], v0, s[16:19], s3 offen offset:0 sc1
 s_add_u32 s3, s33, 28672
 buffer_load_dwordx4 a[148:151], v0, s[16:19], s3 offen offset:1024 sc1
 s_add_u32 s3, s33, 28672
 buffer_load_dwordx4 a[152:155], v0, s[16:19], s3 offen offset:2048 sc1
 s_add_u32 s3, s33, 28672
 buffer_load_dwordx4 a[156:159], v0, s[16:19], s3 offen offset:3072 sc1
 v_mfma_f32_32x32x16_bf16 v[104:119], a[0:3], a[128:131], v[104:119]
 ds_read_b64_tr_b16 a[24:25], v242 offset:6144
 ds_read_b64_tr_b16 a[26:27], v242 offset:6656
 v_mfma_f32_32x32x16_bf16 v[120:135], a[4:7], a[128:131], v[120:135]
 ds_read_b64_tr_b16 a[28:29], v243 offset:6144
 ds_read_b64_tr_b16 a[30:31], v243 offset:6656
 s_add_u32 m0, s64, 0
 s_add_u32 s68, s56, 256
 buffer_load_dwordx4 v6, s[12:15], s68 offen  lds
 v_mfma_f32_32x32x16_bf16 v[104:119], a[8:11], a[132:135], v[104:119]
 ds_read_b64_tr_b16 a[0:1], v242 offset:8192
 ds_read_b64_tr_b16 a[2:3], v242 offset:8704
 v_mfma_f32_32x32x16_bf16 v[120:135], a[12:15], a[132:135], v[120:135]
 ds_read_b64_tr_b16 a[4:5], v243 offset:8192
ST1_7:
 s_cbranch_execz STB1_1
 ds_read_b64_tr_b16 a[6:7], v243 offset:8704
 s_waitcnt lgkmcnt(4)
 v_mfma_f32_32x32x16_bf16 v[104:119], a[16:19], a[136:139], v[104:119]
 ds_read_b64_tr_b16 a[8:9], v242 offset:10240
 ds_read_b64_tr_b16 a[10:11], v242 offset:10752
 v_mfma_f32_32x32x16_bf16 v[120:135], a[20:23], a[136:139], v[120:135]
 ds_read_b64_tr_b16 a[12:13], v243 offset:10240
 ds_read_b64_tr_b16 a[14:15], v243 offset:10752
 buffer_load_dwordx4 v7, s[12:15], s68 offen offset:1024  lds
 v_mfma_f32_32x32x16_bf16 v[104:119], a[24:27], a[140:143], v[104:119]
 ds_read_b64_tr_b16 a[16:17], v242 offset:12288
 ds_read_b64_tr_b16 a[18:19], v242 offset:12800
 s_buffer_load_dwordx2 s[0:1], s[16:19], s34 glc
 v_mfma_f32_32x32x16_bf16 v[120:135], a[28:31], a[140:143], v[120:135]
 ds_read_b64_tr_b16 a[20:21], v243 offset:12288
 ds_read_b64_tr_b16 a[22:23], v243 offset:12800
 s_waitcnt lgkmcnt(8)
 v_mfma_f32_32x32x16_bf16 v[72:87], a[0:3], a[48:51], 0
 ds_read_b64_tr_b16 a[24:25], v242 offset:14336
 ds_read_b64_tr_b16 a[26:27], v242 offset:14848
 v_mfma_f32_32x32x16_bf16 v[88:103], a[4:7], a[48:51], 0
 ds_read_b64_tr_b16 a[28:29], v243 offset:14336
 s_add_u32 m0, s64, 7936
 ds_read_b64_tr_b16 a[30:31], v243 offset:14848
 buffer_load_dwordx4 v6, s[12:15], s57 offen offset:256  lds
 s_waitcnt lgkmcnt(8)
 v_mfma_f32_32x32x16_bf16 v[72:87], a[8:11], a[52:55], v[72:87]
 ds_read_b64_tr_b16 a[0:1], v242 offset:16384
 ds_read_b64_tr_b16 a[2:3], v242 offset:16896
 v_mfma_f32_32x32x16_bf16 v[88:103], a[12:15], a[52:55], v[88:103]
 ds_read_b64_tr_b16 a[4:5], v243 offset:16384
 ds_read_b64_tr_b16 a[6:7], v243 offset:16896
 s_waitcnt lgkmcnt(8)
 v_mfma_f32_32x32x16_bf16 v[72:87], a[16:19], a[56:59], v[72:87]
 ds_read_b64_tr_b16 a[8:9], v242 offset:18432
 ds_read_b64_tr_b16 a[10:11], v242 offset:18944
 v_mfma_f32_32x32x16_bf16 v[88:103], a[20:23], a[56:59], v[88:103]
 ds_read_b64_tr_b16 a[12:13], v243 offset:18432
 ds_read_b64_tr_b16 a[14:15], v243 offset:18944
 buffer_load_dwordx4 v7, s[12:15], s57 offen offset:1280  lds
 s_waitcnt lgkmcnt(8)
 v_mfma_f32_32x32x16_bf16 v[72:87], a[24:27], a[60:63], v[72:87]
 ds_read_b64_tr_b16 a[16:17], v242 offset:20480
 ds_read_b64_tr_b16 a[18:19], v242 offset:20992
 v_mfma_f32_32x32x16_bf16 v[88:103], a[28:31], a[60:63], v[88:103]
 ds_read_b64_tr_b16 a[20:21], v243 offset:20480
 ds_read_b64_tr_b16 a[22:23], v243 offset:20992
 s_waitcnt vmcnt(4)
 s_waitcnt lgkmcnt(8)
 v_mfma_f32_32x32x16_bf16 v[104:119], a[0:3], a[144:147], v[104:119]
 ds_read_b64_tr_b16 a[24:25], v242 offset:22528
 ds_read_b64_tr_b16 a[26:27], v242 offset:23040
 v_mfma_f32_32x32x16_bf16 v[120:135], a[4:7], a[144:147], v[120:135]
 ds_read_b64_tr_b16 a[28:29], v243 offset:22528
 s_add_u32 m0, s64, 16128
 ds_read_b64_tr_b16 a[30:31], v243 offset:23040
 buffer_load_dwordx4 v6, s[12:15], s58 offen offset:256  lds
 s_waitcnt lgkmcnt(8)
 v_mfma_f32_32x32x16_bf16 v[104:119], a[8:11], a[148:151], v[104:119]
 s_barrier
 ds_read_b64_tr_b16 a[0:1], v242 offset:24576
 ds_read_b64_tr_b16 a[2:3], v242 offset:25088
 v_mfma_f32_32x32x16_bf16 v[120:135], a[12:15], a[148:151], v[120:135]
 ds_read_b64_tr_b16 a[4:5], v243 offset:24576
 ds_read_b64_tr_b16 a[6:7], v243 offset:25088
 s_waitcnt lgkmcnt(8)
 v_mfma_f32_32x32x16_bf16 v[104:119], a[16:19], a[152:155], v[104:119]
 ds_read_b64_tr_b16 a[8:9], v242 offset:26624
 ds_read_b64_tr_b16 a[10:11], v242 offset:27136
 v_mfma_f32_32x32x16_bf16 v[120:135], a[20:23], a[152:155], v[120:135]
 ds_read_b64_tr_b16 a[12:13], v243 offset:26624
 ds_read_b64_tr_b16 a[14:15], v243 offset:27136
 buffer_load_dwordx4 v7, s[12:15], s58 offen offset:1280  lds
 s_waitcnt lgkmcnt(8)
 v_mfma_f32_32x32x16_bf16 v[104:119], a[24:27], a[156:159], v[104:119]
 ds_read_b64_tr_b16 a[16:17], v242 offset:28672
 ds_read_b64_tr_b16 a[18:19], v242 offset:29184
 v_mfma_f32_32x32x16_bf16 v[120:135], a[28:31], a[156:159], v[120:135]
 ds_read_b64_tr_b16 a[20:21], v243 offset:28672
 ds_read_b64_tr_b16 a[22:23], v243 offset:29184
 s_branch L_s7u
L_unit:
ST1_8:
 s_cbranch_execz STB1_2
 s_waitcnt lgkmcnt(8)
 v_mfma_f32_32x32x16_bf16 v[104:119], a[0:3], a[48:51], 0
 ds_read_b64_tr_b16 a[24:25], v242 offset:30720
 ds_read_b64_tr_b16 a[26:27], v242 offset:31232
 v_mfma_f32_32x32x16_bf16 v[120:135], a[4:7], a[48:51], 0
 ds_read_b64_tr_b16 a[28:29], v243 offset:30720
 ds_read_b64_tr_b16 a[30:31], v243 offset:31232
 s_waitcnt lgkmcnt(8)
 v_mfma_f32_32x32x16_bf16 v[104:119], a[8:11], a[52:55], v[104:119]
 ds_read_b64_tr_b16 a[0:1], v242 offset:32768
 ds_read_b64_tr_b16 a[2:3], v242 offset:33280
 v_mfma_f32_32x32x16_bf16 v[120:135], a[12:15], a[52:55], v[120:135]
 ds_read_b64_tr_b16 a[4:5], v243 offset:32768
 ds_read_b64_tr_b16 a[6:7], v243 offset:33280
 v_cvt_pk_f16_f32 v220, v152, v153
 v_cvt_pk_f16_f32 v221, v154, v155
 v_pk_fma_f16 v222, v220, v220, s70
 v_pk_fma_f16 v223, v221, v221, s70
 v_pk_mul_f16 v220, v222, v220 neg_lo:[1,0] neg_hi:[1,0]
 v_pk_mul_f16 v221, v223, v221 neg_lo:[1,0] neg_hi:[1,0]
 v_exp_f16 v222, v220
 s_waitcnt lgkmcnt(8)
 v_mfma_f32_32x32x16_bf16 v[104:119], a[16:19], a[56:59], v[104:119]
 ds_read_b64_tr_b16 a[8:9], v242 offset:34816
 ds_read_b64_tr_b16 a[10:11], v242 offset:35328
 v_exp_f16 v223, v221
 v_exp_f16_sdwa v222, v220 dst_sel:WORD_1 dst_unused:UNUSED_PRESERVE src0_sel:WORD_1
 v_exp_f16_sdwa v223, v221 dst_sel:WORD_1 dst_unused:UNUSED_PRESERVE src0_sel:WORD_1
 v_pk_fma_f16 v220, v222, v247, v247
 v_mfma_f32_32x32x16_bf16 v[120:135], a[20:23], a[56:59], v[120:135]
 ds_read_b64_tr_b16 a[12:13], v243 offset:34816
 ds_read_b64_tr_b16 a[14:15], v243 offset:35328
 v_pk_fma_f16 v221, v223, v247, v247
 v_rcp_f16 v216, v220
 v_rcp_f16 v218, v221
 v_rcp_f16_sdwa v217, v220 dst_sel:WORD_0 dst_unused:UNUSED_PAD src0_sel:WORD_1
 v_rcp_f16_sdwa v219, v221 dst_sel:WORD_0 dst_unused:UNUSED_PAD src0_sel:WORD_1
 s_waitcnt lgkmcnt(8)
 v_mfma_f32_32x32x16_bf16 v[104:119], a[24:27], a[60:63], v[104:119]
 ds_read_b64_tr_b16 a[16:17], v242 offset:36864
 ds_read_b64_tr_b16 a[18:19], v242 offset:37376
 v_fma_mix_f32 v216, v152, v216, 0 op_sel_hi:[0,1,0]
 v_fma_mix_f32 v218, v154, v218, 0 op_sel_hi:[0,1,0]
 v_fma_mix_f32 v217, v153, v217, 0 op_sel_hi:[0,1,0]
 v_fma_mix_f32 v219, v155, v219, 0 op_sel_hi:[0,1,0]
 v_cvt_pk_bf16_f32 v224, v216, v217
 v_cvt_pk_bf16_f32 v225, v218, v219
 v_accvgpr_write_b32 a96, v224
 v_mfma_f32_32x32x16_bf16 v[120:135], a[28:31], a[60:63], v[120:135]
 ds_read_b64_tr_b16 a[20:21], v243 offset:36864
 ds_read_b64_tr_b16 a[22:23], v243 offset:37376
 v_accvgpr_write_b32 a97, v225
 v_cvt_pk_f16_f32 v220, v156, v157
 v_cvt_pk_f16_f32 v221, v158, v159
 v_pk_fma_f16 v222, v220, v220, s70
 v_pk_fma_f16 v223, v221, v221, s70
 v_pk_mul_f16 v220, v222, v220 neg_lo:[1,0] neg_hi:[1,0]
 v_pk_mul_f16 v221, v223, v221 neg_lo:[1,0] neg_hi:[1,0]
 s_waitcnt lgkmcnt(8)
 v_mfma_f32_32x32x16_bf16 v[104:119], a[0:3], a[64:67], v[104:119]
 ds_read_b64_tr_b16 a[24:25], v242 offset:38912
 ds_read_b64_tr_b16 a[26:27], v242 offset:39424
 v_exp_f16 v222, v220
 v_exp_f16 v223, v221
 v_exp_f16_sdwa v222, v220 dst_sel:WORD_1 dst_unused:UNUSED_PRESERVE src0_sel:WORD_1
 v_exp_f16_sdwa v223, v221 dst_sel:WORD_1 dst_unused:UNUSED_PRESERVE src0_sel:WORD_1
 v_mfma_f32_32x32x16_bf16 v[120:135], a[4:7], a[64:67], v[120:135]
 ds_read_b64_tr_b16 a[28:29], v243 offset:38912
 ds_read_b64_tr_b16 a[30:31], v243 offset:39424
 v_pk_fma_f16 v220, v222, v247, v247
 v_pk_fma_f16 v221, v223, v247, v247
 v_rcp_f16 v216, v220
 v_rcp_f16 v218, v221
 v_rcp_f16_sdwa v217, v220 dst_sel:WORD_0 dst_unused:UNUSED_PAD src0_sel:WORD_1
 s_waitcnt lgkmcnt(8)
 v_mfma_f32_32x32x16_bf16 v[104:119], a[8:11], a[68:71], v[104:119]
 ds_read_b64_tr_b16 a[0:1], v242 offset:40960
 ds_read_b64_tr_b16 a[2:3], v242 offset:41472
 v_rcp_f16_sdwa v219, v221 dst_sel:WORD_0 dst_unused:UNUSED_PAD src0_sel:WORD_1
 v_fma_mix_f32 v216, v156, v216, 0 op_sel_hi:[0,1,0]
 v_fma_mix_f32 v218, v158, v218, 0 op_sel_hi:[0,1,0]
 v_fma_mix_f32 v217, v157, v217, 0 op_sel_hi:[0,1,0]
 v_fma_mix_f32 v219, v159, v219, 0 op_sel_hi:[0,1,0]
 v_cvt_pk_bf16_f32 v226, v216, v217
 v_mfma_f32_32x32x16_bf16 v[120:135], a[12:15], a[68:71], v[120:135]
 ds_read_b64_tr_b16 a[4:5], v243 offset:40960
 ds_read_b64_tr_b16 a[6:7], v243 offset:41472
 v_cvt_pk_bf16_f32 v227, v218, v219
 v_accvgpr_write_b32 a98, v226
 v_accvgpr_write_b32 a99, v227
 s_add_u32 s69, s65, 16384
 buffer_store_dwordx4 v[224:227], v0, s[16:19], s69 offen offset:0 sc1
 v_cvt_pk_f16_f32 v220, v160, v161
 v_cvt_pk_f16_f32 v221, v162, v163
 v_pk_fma_f16 v222, v220, v220, s70
 s_waitcnt lgkmcnt(8)
 v_mfma_f32_32x32x16_bf16 v[104:119], a[16:19], a[72:75], v[104:119]
 ds_read_b64_tr_b16 a[8:9], v242 offset:43008
 ds_read_b64_tr_b16 a[10:11], v242 offset:43520
 v_pk_fma_f16 v223, v221, v221, s70
 v_pk_mul_f16 v220, v222, v220 neg_lo:[1,0] neg_hi:[1,0]
 v_pk_mul_f16 v221, v223, v221 neg_lo:[1,0] neg_hi:[1,0]
 v_exp_f16 v222, v220
 v_exp_f16 v223, v221
 v_mfma_f32_32x32x16_bf16 v[120:135], a[20:23], a[72:75], v[120:135]
 ds_read_b64_tr_b16 a[12:13], v243 offset:43008
 ds_read_b64_tr_b16 a[14:15], v243 offset:43520
 v_exp_f16_sdwa v222, v220 dst_sel:WORD_1 dst_unused:UNUSED_PRESERVE src0_sel:WORD_1
 v_exp_f16_sdwa v223, v221 dst_sel:WORD_1 dst_unused:UNUSED_PRESERVE src0_sel:WORD_1
 v_pk_fma_f16 v220, v222, v247, v247
 v_pk_fma_f16 v221, v223, v247, v247
 v_rcp_f16 v216, v220
 s_waitcnt lgkmcnt(8)
 v_mfma_f32_32x32x16_bf16 v[104:119], a[24:27], a[76:79], v[104:119]
 ds_read_b64_tr_b16 a[16:17], v242 offset:45056
 ds_read_b64_tr_b16 a[18:19], v242 offset:45568
 v_rcp_f16 v218, v221
 v_rcp_f16_sdwa v217, v220 dst_sel:WORD_0 dst_unused:UNUSED_PAD src0_sel:WORD_1
 v_rcp_f16_sdwa v219, v221 dst_sel:WORD_0 dst_unused:UNUSED_PAD src0_sel:WORD_1
 v_fma_mix_f32 v216, v160, v216, 0 op_sel_hi:[0,1,0]
 v_fma_mix_f32 v218, v162, v218, 0 op_sel_hi:[0,1,0]
 v_mfma_f32_32x32x16_bf16 v[120:135], a[28:31], a[76:79], v[120:135]
 ds_read_b64_tr_b16 a[20:21], v243 offset:45056
 ds_read_b64_tr_b16 a[22:23], v243 offset:45568
 v_fma_mix_f32 v217, v161, v217, 0 op_sel_hi:[0,1,0]
 v_fma_mix_f32 v219, v163, v219, 0 op_sel_hi:[0,1,0]
 v_cvt_pk_bf16_f32 v228, v216, v217
 v_cvt_pk_bf16_f32 v229, v218, v219
 v_accvgpr_write_b32 a100, v228
 v_accvgpr_write_b32 a101, v229
 v_cvt_pk_f16_f32 v220, v164, v165
 v_cvt_pk_f16_f32 v221, v166, v167
 s_waitcnt lgkmcnt(8)
 v_mfma_f32_32x32x16_bf16 v[104:119], a[0:3], a[80:83], v[104:119]
 ds_read_b64_tr_b16 a[24:25], v242 offset:47104
 ds_read_b64_tr_b16 a[26:27], v242 offset:47616
 v_pk_fma_f16 v222, v220, v220, s70
 v_pk_fma_f16 v223, v221, v221, s70
 v_pk_mul_f16 v220, v222, v220 neg_lo:[1,0] neg_hi:[1,0]
 v_pk_mul_f16 v221, v223, v221 neg_lo:[1,0] neg_hi:[1,0]
 v_exp_f16 v222, v220
 v_exp_f16 v223, v221
 v_mfma_f32_32x32x16_bf16 v[120:135], a[4:7], a[80:83], v[120:135]
 ds_read_b64_tr_b16 a[28:29], v243 offset:47104
 ds_read_b64_tr_b16 a[30:31], v243 offset:47616
 v_exp_f16_sdwa v222, v220 dst_sel:WORD_1 dst_unused:UNUSED_PRESERVE src0_sel:WORD_1
 v_exp_f16_sdwa v223, v221 dst_sel:WORD_1 dst_unused:UNUSED_PRESERVE src0_sel:WORD_1
 v_pk_fma_f16 v220, v222, v247, v247
 v_pk_fma_f16 v221, v223, v247, v247
 v_rcp_f16 v216, v220
 s_waitcnt lgkmcnt(8)
 v_mfma_f32_32x32x16_bf16 v[104:119], a[8:11], a[84:87], v[104:119]
 s_waitcnt vmcnt(2)
 s_barrier
 ds_read_b64_tr_b16 a[0:1], v244 offset:0
 ds_read_b64_tr_b16 a[2:3], v244 offset:512
 v_rcp_f16 v218, v221
 v_rcp_f16_sdwa v217, v220 dst_sel:WORD_0 dst_unused:UNUSED_PAD src0_sel:WORD_1
 v_rcp_f16_sdwa v219, v221 dst_sel:WORD_0 dst_unused:UNUSED_PAD src0_sel:WORD_1
 v_fma_mix_f32 v216, v164, v216, 0 op_sel_hi:[0,1,0]
 v_mfma_f32_32x32x16_bf16 v[120:135], a[12:15], a[84:87], v[120:135]
 ds_read_b64_tr_b16 a[4:5], v245 offset:0
 ds_read_b64_tr_b16 a[6:7], v245 offset:512
 v_fma_mix_f32 v218, v166, v218, 0 op_sel_hi:[0,1,0]
 v_fma_mix_f32 v217, v165, v217, 0 op_sel_hi:[0,1,0]
 v_fma_mix_f32 v219, v167, v219, 0 op_sel_hi:[0,1,0]
 v_cvt_pk_bf16_f32 v230, v216, v217
 v_cvt_pk_bf16_f32 v231, v218, v219
 v_accvgpr_write_b32 a102, v230
 v_accvgpr_write_b32 a103, v231
 buffer_store_dwordx4 v[228:231], v0, s[16:19], s69 offen offset:1024 sc1
 s_waitcnt lgkmcnt(8)
 v_mfma_f32_32x32x16_bf16 v[104:119], a[16:19], a[88:91], v[104:119]
 ds_read_b64_tr_b16 a[8:9], v244 offset:2048
 ds_read_b64_tr_b16 a[10:11], v244 offset:2560
 v_cvt_pk_f16_f32 v220, v168, v169
 v_cvt_pk_f16_f32 v221, v170, v171
 v_pk_fma_f16 v222, v220, v220, s70
 v_pk_fma_f16 v223, v221, v221, s70
 v_pk_mul_f16 v220, v222, v220 neg_lo:[1,0] neg_hi:[1,0]
 v_pk_mul_f16 v221, v223, v221 neg_lo:[1,0] neg_hi:[1,0]
 v_exp_f16 v222, v220
 v_mfma_f32_32x32x16_bf16 v[120:135], a[20:23], a[88:91], v[120:135]
 ds_read_b64_tr_b16 a[12:13], v245 offset:2048
 ds_read_b64_tr_b16 a[14:15], v245 offset:2560
 v_exp_f16 v223, v221
 v_exp_f16_sdwa v222, v220 dst_sel:WORD_1 dst_unused:UNUSED_PRESERVE src0_sel:WORD_1
 v_exp_f16_sdwa v223, v221 dst_sel:WORD_1 dst_unused:UNUSED_PRESERVE src0_sel:WORD_1
 v_pk_fma_f16 v220, v222, v247, v247
 s_waitcnt lgkmcnt(8)
 v_mfma_f32_32x32x16_bf16 v[104:119], a[24:27], a[92:95], v[104:119]
 ds_read_b64_tr_b16 a[16:17], v244 offset:4096
 ds_read_b64_tr_b16 a[18:19], v244 offset:4608
 v_pk_fma_f16 v221, v223, v247, v247
 v_rcp_f16 v216, v220
 v_rcp_f16 v218, v221
 v_rcp_f16_sdwa v217, v220 dst_sel:WORD_0 dst_unused:UNUSED_PAD src0_sel:WORD_1
 v_mfma_f32_32x32x16_bf16 v[120:135], a[28:31], a[92:95], v[120:135]
 ds_read_b64_tr_b16 a[20:21], v245 offset:4096
 ds_read_b64_tr_b16 a[22:23], v245 offset:4608
 v_rcp_f16_sdwa v219, v221 dst_sel:WORD_0 dst_unused:UNUSED_PAD src0_sel:WORD_1
 v_fma_mix_f32 v216, v168, v216, 0 op_sel_hi:[0,1,0]
 v_fma_mix_f32 v218, v170, v218, 0 op_sel_hi:[0,1,0]
 v_fma_mix_f32 v217, v169, v217, 0 op_sel_hi:[0,1,0]
 v_fma_mix_f32 v219, v171, v219, 0 op_sel_hi:[0,1,0]
 v_cvt_pk_bf16_f32 v232, v216, v217
 v_cvt_pk_bf16_f32 v233, v218, v219
 ds_write_b128 v1, a[216:219] offset:0
 s_waitcnt lgkmcnt(9)
 v_mfma_f32_32x32x16_bf16 v[104:119], a[0:3], a[32:35], v[104:119]
 ds_read_b64_tr_b16 a[24:25], v244 offset:6144
 ds_read_b64_tr_b16 a[26:27], v244 offset:6656
 v_accvgpr_write_b32 a104, v232
 v_accvgpr_write_b32 a105, v233
 v_cvt_pk_f16_f32 v220, v172, v173
 v_cvt_pk_f16_f32 v221, v174, v175
 v_pk_fma_f16 v222, v220, v220, s70
 v_pk_fma_f16 v223, v221, v221, s70
 v_pk_mul_f16 v220, v222, v220 neg_lo:[1,0] neg_hi:[1,0]
 v_pk_mul_f16 v221, v223, v221 neg_lo:[1,0] neg_hi:[1,0]
 v_mfma_f32_32x32x16_bf16 v[120:135], a[4:7], a[32:35], v[120:135]
 ds_read_b64_tr_b16 a[28:29], v245 offset:6144
 s_add_u32 m0, s64, 49152
 ds_read_b64_tr_b16 a[30:31], v245 offset:6656
 buffer_load_dwordx4 v6, s[12:15], s61 offen offset:0  lds
 v_exp_f16 v222, v220
 v_exp_f16 v223, v221
 v_exp_f16_sdwa v222, v220 dst_sel:WORD_1 dst_unused:UNUSED_PRESERVE src0_sel:WORD_1
 v_exp_f16_sdwa v223, v221 dst_sel:WORD_1 dst_unused:UNUSED_PRESERVE src0_sel:WORD_1
 ds_write_b128 v1, a[220:223] offset:1024
 s_waitcnt lgkmcnt(10)
 v_mfma_f32_32x32x16_bf16 v[104:119], a[8:11], a[36:39], v[104:119]
 ds_read_b64_tr_b16 a[0:1], v244 offset:8192
 ds_read_b64_tr_b16 a[2:3], v244 offset:8704
 v_pk_fma_f16 v220, v222, v247, v247
 v_pk_fma_f16 v221, v223, v247, v247
 v_rcp_f16 v216, v220
 v_rcp_f16 v218, v221
 v_rcp_f16_sdwa v217, v220 dst_sel:WORD_0 dst_unused:UNUSED_PAD src0_sel:WORD_1
 ds_write_b128 v1, a[224:227] offset:2048
 v_mov_b32 v249, 4
 s_waitcnt vmcnt(3)
 s_mov_b64 exec, 1
 buffer_store_dwordx2 v[248:249], off, s[16:19], s67 sc1
 s_mov_b64 exec, -1
 v_mfma_f32_32x32x16_bf16 v[120:135], a[12:15], a[36:39], v[120:135]
 ds_read_b64_tr_b16 a[4:5], v245 offset:8192
 ds_read_b64_tr_b16 a[6:7], v245 offset:8704
 v_rcp_f16_sdwa v219, v221 dst_sel:WORD_0 dst_unused:UNUSED_PAD src0_sel:WORD_1
 v_fma_mix_f32 v216, v172, v216, 0 op_sel_hi:[0,1,0]
 v_fma_mix_f32 v218, v174, v218, 0 op_sel_hi:[0,1,0]
 v_fma_mix_f32 v217, v173, v217, 0 op_sel_hi:[0,1,0]
 v_fma_mix_f32 v219, v175, v219, 0 op_sel_hi:[0,1,0]
 v_cvt_pk_bf16_f32 v234, v216, v217
 ds_write_b128 v1, a[228:231] offset:3072
 s_waitcnt lgkmcnt(12)
 v_mfma_f32_32x32x16_bf16 v[104:119], a[16:19], a[40:43], v[104:119]
 ds_read_b64_tr_b16 a[8:9], v244 offset:10240
 ds_read_b64_tr_b16 a[10:11], v244 offset:10752
 v_cvt_pk_bf16_f32 v235, v218, v219
 v_accvgpr_write_b32 a106, v234
 v_accvgpr_write_b32 a107, v235
 buffer_store_dwordx4 v[232:235], v0, s[16:19], s69 offen offset:2048 sc1
 v_cvt_pk_f16_f32 v220, v176, v177
 v_cvt_pk_f16_f32 v221, v178, v179
 v_pk_fma_f16 v222, v220, v220, s70
 v_pk_fma_f16 v223, v221, v221, s70
 ds_write_b128 v1, a[232:235] offset:4096
 v_mfma_f32_32x32x16_bf16 v[120:135], a[20:23], a[40:43], v[120:135]
 ds_read_b64_tr_b16 a[12:13], v245 offset:10240
 ds_read_b64_tr_b16 a[14:15], v245 offset:10752
 buffer_load_dwordx4 v7, s[12:15], s61 offen offset:1024  lds
 v_pk_mul_f16 v220, v222, v220 neg_lo:[1,0] neg_hi:[1,0]
 v_pk_mul_f16 v221, v223, v221 neg_lo:[1,0] neg_hi:[1,0]
 v_exp_f16 v222, v220
 v_exp_f16 v223, v221
 v_exp_f16_sdwa v222, v220 dst_sel:WORD_1 dst_unused:UNUSED_PRESERVE src0_sel:WORD_1
 ds_write_b128 v1, a[236:239] offset:5120
 s_waitcnt lgkmcnt(13)
 v_mfma_f32_32x32x16_bf16 v[104:119], a[24:27], a[44:47], v[104:119]
 ds_read_b64_tr_b16 a[16:17], v244 offset:12288
 ds_read_b64_tr_b16 a[18:19], v244 offset:12800
 v_exp_f16_sdwa v223, v221 dst_sel:WORD_1 dst_unused:UNUSED_PRESERVE src0_sel:WORD_1
 v_pk_fma_f16 v220, v222, v247, v247
 v_pk_fma_f16 v221, v223, v247, v247
 v_rcp_f16 v216, v220
 ds_write_b128 v1, a[240:243] offset:6144
 s_buffer_load_dwordx2 s[0:1], s[16:19], s34 glc
 v_mfma_f32_32x32x16_bf16 v[120:135], a[28:31], a[44:47], v[120:135]
 ds_read_b64_tr_b16 a[20:21], v245 offset:12288
 ds_read_b64_tr_b16 a[22:23], v245 offset:12800
 v_rcp_f16 v218, v221
 v_rcp_f16_sdwa v217, v220 dst_sel:WORD_0 dst_unused:UNUSED_PAD src0_sel:WORD_1
 v_rcp_f16_sdwa v219, v221 dst_sel:WORD_0 dst_unused:UNUSED_PAD src0_sel:WORD_1
 v_fma_mix_f32 v216, v176, v216, 0 op_sel_hi:[0,1,0]
 v_fma_mix_f32 v218, v178, v218, 0 op_sel_hi:[0,1,0]
 v_fma_mix_f32 v217, v177, v217, 0 op_sel_hi:[0,1,0]
 ds_write_b128 v1, a[244:247] offset:7168
 s_waitcnt lgkmcnt(13)
 v_mfma_f32_32x32x16_bf16 v[104:119], a[0:3], a[112:115], v[104:119]
 ds_read_b64_tr_b16 a[24:25], v244 offset:14336
 ds_read_b64_tr_b16 a[26:27], v244 offset:14848
 v_fma_mix_f32 v219, v179, v219, 0 op_sel_hi:[0,1,0]
 v_cvt_pk_bf16_f32 v236, v216, v217
 v_cvt_pk_bf16_f32 v237, v218, v219
 v_accvgpr_write_b32 a108, v236
 v_accvgpr_write_b32 a109, v237
 v_cvt_pk_f16_f32 v220, v180, v181
 v_cvt_pk_f16_f32 v221, v182, v183
 s_bitcmp1_b32 s44, 6
 s_cbranch_scc0 ON_48
 v_lshrrev_b32 v254, 4, v2
 v_lshlrev_b32 v254, 11, v254
 v_and_b32 v255, 15, v2
 v_lshl_add_u32 v254, v255, 6, v254
 v_add_u32 v254, 32768, v254
 ds_write_b16 v254, a253 offset:62
 ds_write_b16 v254, a254 offset:1086
ON_48:
 v_mfma_f32_32x32x16_bf16 v[120:135], a[4:7], a[112:115], v[120:135]
 ds_read_b64_tr_b16 a[28:29], v245 offset:14336
 s_add_u32 m0, s64, 57216
 ds_read_b64_tr_b16 a[30:31], v245 offset:14848
 buffer_load_dwordx4 v6, s[12:15], s56 offen offset:128  lds
 v_pk_fma_f16 v222, v220, v220, s70
 v_pk_fma_f16 v223, v221, v221, s70
 v_pk_mul_f16 v220, v222, v220 neg_lo:[1,0] neg_hi:[1,0]
 v_pk_mul_f16 v221, v223, v221 neg_lo:[1,0] neg_hi:[1,0]
 v_exp_f16 v222, v220
 v_exp_f16 v223, v221
 ds_read_b64_tr_b16 v[40:41], v5 offset:0
 ds_read_b64_tr_b16 v[42:43], v5 offset:512
 ds_read_b64_tr_b16 v[44:45], v5 offset:2048
 s_waitcnt lgkmcnt(14)
 v_mfma_f32_32x32x16_bf16 v[104:119], a[8:11], a[116:119], v[104:119]
 ds_read_b64_tr_b16 a[0:1], v244 offset:16384
 ds_read_b64_tr_b16 a[2:3], v244 offset:16896
 v_exp_f16_sdwa v222, v220 dst_sel:WORD_1 dst_unused:UNUSED_PRESERVE src0_sel:WORD_1
 v_exp_f16_sdwa v223, v221 dst_sel:WORD_1 dst_unused:UNUSED_PRESERVE src0_sel:WORD_1
 v_pk_fma_f16 v220, v222, v247, v247
 v_pk_fma_f16 v221, v223, v247, v247
 v_rcp_f16 v216, v220
 ds_read_b64_tr_b16 v[46:47], v5 offset:2560
 ds_read_b64_tr_b16 v[48:49], v5 offset:4096
 ds_read_b64_tr_b16 v[50:51], v5 offset:4608
 v_mfma_f32_32x32x16_bf16 v[120:135], a[12:15], a[116:119], v[120:135]
 ds_read_b64_tr_b16 a[4:5], v245 offset:16384
 ds_read_b64_tr_b16 a[6:7], v245 offset:16896
 v_rcp_f16 v218, v221
 v_rcp_f16_sdwa v217, v220 dst_sel:WORD_0 dst_unused:UNUSED_PAD src0_sel:WORD_1
 v_rcp_f16_sdwa v219, v221 dst_sel:WORD_0 dst_unused:UNUSED_PAD src0_sel:WORD_1
 v_fma_mix_f32 v216, v180, v216, 0 op_sel_hi:[0,1,0]
 ds_read_b64_tr_b16 v[52:53], v5 offset:6144
 ds_read_b64_tr_b16 v[54:55], v5 offset:6656
 ds_read_b64_tr_b16 v[8:9], v4 offset:0
 ds_read_b64_tr_b16 v[10:11], v4 offset:1024
 s_waitcnt lgkmcnt(15)
 v_mfma_f32_32x32x16_bf16 v[104:119], a[16:19], a[120:123], v[104:119]
 ds_read_b64_tr_b16 a[8:9], v244 offset:18432
 ds_read_b64_tr_b16 a[10:11], v244 offset:18944
 v_fma_mix_f32 v218, v182, v218, 0 op_sel_hi:[0,1,0]
 v_fma_mix_f32 v217, v181, v217, 0 op_sel_hi:[0,1,0]
 v_fma_mix_f32 v219, v183, v219, 0 op_sel_hi:[0,1,0]
 v_cvt_pk_bf16_f32 v238, v216, v217
 v_cvt_pk_bf16_f32 v239, v218, v219
 v_accvgpr_write_b32 a110, v238
 v_accvgpr_write_b32 a111, v239
 buffer_store_dwordx4 v[236:239], v0, s[16:19], s69 offen offset:3072 sc1
 ds_read_b64_tr_b16 v[56:57], v5 offset:1024
 ds_read_b64_tr_b16 v[58:59], v5 offset:1536
 ds_read_b64_tr_b16 v[60:61], v5 offset:3072
 ds_read_b64_tr_b16 v[24:25], v4 offset:64
 ds_read_b64_tr_b16 v[26:27], v4 offset:1088
 v_mfma_f32_32x32x16_bf16 v[120:135], a[20:23], a[120:123], v[120:135]
 ds_read_b64_tr_b16 a[12:13], v245 offset:18432
 ds_read_b64_tr_b16 a[14:15], v245 offset:18944
 buffer_load_dwordx4 v7, s[12:15], s56 offen offset:1152  lds
 ds_read_b64_tr_b16 v[62:63], v5 offset:3584
 ds_read_b64_tr_b16 v[64:65], v5 offset:5120
 ds_read_b128 a[176:179], v3 offset:0
 ds_read_b128 a[208:211], v3 offset:8192
 s_waitcnt lgkmcnt(15)
 v_mfma_f32_32x32x16_bf16 v[104:119], a[24:27], a[124:127], v[104:119]
 ds_read_b64_tr_b16 a[16:17], v244 offset:20480
 ds_read_b64_tr_b16 a[18:19], v244 offset:20992
 ds_read_b64_tr_b16 v[66:67], v5 offset:5632
 ds_read_b64_tr_b16 v[68:69], v5 offset:7168
 ds_read_b64_tr_b16 v[70:71], v5 offset:7680
 ds_read_b128 a[240:243], v3 offset:16384
 ds_read_b64_tr_b16 v[12:13], v4 offset:2048
 ds_read_b64_tr_b16 v[14:15], v4 offset:3072
 v_mfma_f32_32x32x16_bf16 v[120:135], a[28:31], a[124:127], v[120:135]
 ds_read_b64_tr_b16 a[20:21], v245 offset:20480
 ds_read_b64_tr_b16 a[22:23], v245 offset:20992
 ds_read_b64_tr_b16 v[28:29], v4 offset:2112
 ds_read_b64_tr_b16 v[30:31], v4 offset:3136
 v_mfma_f32_32x32x16_bf16 v[104:119], a[0:3], a[96:99], v[104:119]
 ds_read_b64_tr_b16 a[24:25], v244 offset:22528
 ds_read_b64_tr_b16 a[26:27], v244 offset:23040
 ds_read_b128 a[180:183], v3 offset:1024
 ds_read_b128 a[212:215], v3 offset:9216
 v_mfma_f32_32x32x16_bf16 v[120:135], a[4:7], a[96:99], v[120:135]
 ds_read_b64_tr_b16 a[28:29], v245 offset:22528
 s_add_u32 m0, s64, 65536
 ds_read_b64_tr_b16 a[30:31], v245 offset:23040
 buffer_load_dwordx4 v6, s[12:15], s62 offen offset:0  lds
 ds_read_b128 a[244:247], v3 offset:17408
 ds_read_b64_tr_b16 v[16:17], v4 offset:4096
 s_waitcnt lgkmcnt(15)
 v_mfma_f32_32x32x16_bf16 v[104:119], a[8:11], a[100:103], v[104:119]
 ds_read_b64_tr_b16 v[18:19], v4 offset:5120
 ds_read_b64_tr_b16 v[32:33], v4 offset:4160
 v_mfma_f32_32x32x16_bf16 v[120:135], a[12:15], a[100:103], v[120:135]
 ds_read_b64_tr_b16 v[34:35], v4 offset:5184
 ds_read_b128 a[184:187], v3 offset:2048
 s_waitcnt lgkmcnt(14)
 v_mfma_f32_32x32x16_bf16 v[104:119], a[16:19], a[104:107], v[104:119]
 ds_read_b128 a[216:219], v3 offset:10240
 ds_read_b128 a[248:251], v3 offset:18432
 ds_read_b64_tr_b16 v[20:21], v4 offset:6144
 v_mfma_f32_32x32x16_bf16 v[120:135], a[20:23], a[104:107], v[120:135]
 buffer_load_dwordx4 v7, s[12:15], s62 offen offset:1024  lds
 ds_read_b64_tr_b16 v[22:23], v4 offset:7168
 ds_read_b64_tr_b16 v[36:37], v4 offset:6208
 s_waitcnt lgkmcnt(11)
 v_mfma_f32_32x32x16_bf16 v[104:119], a[24:27], a[108:111], v[104:119]
 ds_read_b64_tr_b16 v[38:39], v4 offset:7232
 ds_read_b128 a[188:191], v3 offset:3072
 v_mfma_f32_32x32x16_bf16 v[120:135], a[28:31], a[108:111], v[120:135]
 ds_read_b128 a[220:223], v3 offset:11264
 ds_read_b128 a[252:255], v3 offset:19456
 s_waitcnt lgkmcnt(0)
 s_barrier
 v_mfma_f32_32x32x16_bf16 v[72:87], a[176:179], v[8:11], 0
 ds_read_b128 a[192:195], v3 offset:4096
 v_mfma_f32_32x32x16_bf16 v[88:103], a[176:179], v[24:27], 0
 ds_read_b128 a[224:227], v3 offset:12288
 v_mfma_f32_32x32x16_bf16 v[72:87], a[208:211], v[24:27], v[72:87]
 ds_read_b128 v[200:203], v3 offset:20480
 v_mfma_f32_32x32x16_bf16 v[88:103], a[240:243], v[8:11], v[88:103]
 s_waitcnt lgkmcnt(0)
 s_sub_u32 s1, s1, 3
 s_cmp_lt_u32 s1, 60
 s_cselect_b32 s0, s0, 0
 s_cmp_lg_u32 s0, s45
 s_cbranch_scc1 QC_49
QK_50:
 v_mfma_f32_32x32x16_bf16 v[72:87], a[180:183], v[12:15], v[72:87]
 ds_read_b128 a[196:199], v3 offset:5120
 v_mfma_f32_32x32x16_bf16 v[88:103], a[180:183], v[28:31], v[88:103]
 ds_read_b128 a[228:231], v3 offset:13312
 v_mfma_f32_32x32x16_bf16 v[72:87], a[212:215], v[28:31], v[72:87]
 s_add_u32 s3, s33, 24576
 buffer_load_dwordx4 a[128:131], v0, s[16:19], s3 offen offset:0 sc1
 v_mfma_f32_32x32x16_bf16 v[88:103], a[244:247], v[12:15], v[88:103]
 ds_read_b128 v[204:207], v3 offset:21504
 v_mfma_f32_32x32x16_bf16 v[72:87], a[184:187], v[16:19], v[72:87]
 ds_read_b128 a[200:203], v3 offset:6144
 v_mfma_f32_32x32x16_bf16 v[88:103], a[184:187], v[32:35], v[88:103]
 ds_read_b128 a[232:235], v3 offset:14336
 v_mfma_f32_32x32x16_bf16 v[72:87], a[216:219], v[32:35], v[72:87]
 s_add_u32 s3, s33, 24576
 buffer_load_dwordx4 a[132:135], v0, s[16:19], s3 offen offset:1024 sc1
 v_mfma_f32_32x32x16_bf16 v[88:103], a[248:251], v[16:19], v[88:103]
 ds_read_b128 v[208:211], v3 offset:22528
 v_mfma_f32_32x32x16_bf16 v[72:87], a[188:191], v[20:23], v[72:87]
 ds_read_b128 a[204:207], v3 offset:7168
 v_mfma_f32_32x32x16_bf16 v[88:103], a[188:191], v[36:39], v[88:103]
 s_add_u32 s3, s33, 24576
 buffer_load_dwordx4 a[136:139], v0, s[16:19], s3 offen offset:2048 sc1
 v_mfma_f32_32x32x16_bf16 v[72:87], a[220:223], v[36:39], v[72:87]
 ds_read_b128 a[236:239], v3 offset:15360
 v_mfma_f32_32x32x16_bf16 v[88:103], a[252:255], v[20:23], v[88:103]
 ds_read_b128 v[212:215], v3 offset:23552
 s_add_u32 s3, s33, 24576
ST1_9:
 s_cbranch_execz STB1_2
 buffer_load_dwordx4 a[140:143], v0, s[16:19], s3 offen offset:3072 sc1
 s_waitcnt lgkmcnt(0)
 s_barrier
 v_mfma_f32_32x32x16_bf16 v[136:151], a[192:195], v[8:11], 0
 v_and_b32 v1, 15, v2
 v_lshlrev_b32 v1, 7, v1
 v_bfe_u32 v3, v2, 4, 1
 v_mfma_f32_32x32x16_bf16 v[152:167], a[192:195], v[24:27], 0
 v_lshl_add_u32 v1, v3, 13, v1
 v_lshrrev_b32 v3, 5, v2
 v_lshlrev_b32 v3, 2, v3
 v_and_b32 v4, 7, v2
 v_mfma_f32_32x32x16_bf16 v[136:151], a[224:227], v[24:27], v[136:151]
 v_xor_b32 v3, v3, v4
 v_lshl_add_u32 v1, v3, 4, v1
 s_add_u32 s98, s64, 24576
 v_add_u32 v1, s98, v1
 v_mfma_f32_32x32x16_bf16 v[152:167], v[200:203], v[8:11], v[152:167]
 v_lshlrev_b32 v216, 16, v40
 v_and_b32 v217, 0xffff0000, v40
 v_lshlrev_b32 v218, 16, v56
 v_and_b32 v219, 0xffff0000, v56
 v_mul_f32 v220, v88, v218
 v_mul_f32 v222, v88, v216
 v_mul_f32 v221, v89, v219
 v_mul_f32 v223, v89, v217
 v_mfma_f32_32x32x16_bf16 v[136:151], a[196:199], v[12:15], v[136:151]
 v_fma_f32 v220, v72, v216, -v220
 v_fma_f32 v222, v72, v218, v222
 v_fma_f32 v221, v73, v217, -v221
 v_fma_f32 v223, v73, v219, v223
 v_cvt_pk_bf16_f32 v192, v220, v221
 v_cvt_pk_bf16_f32 v184, v222, v223
 v_lshlrev_b32 v216, 16, v41
 v_and_b32 v217, 0xffff0000, v41
 v_lshlrev_b32 v218, 16, v57
 v_mfma_f32_32x32x16_bf16 v[152:167], a[196:199], v[28:31], v[152:167]
 v_and_b32 v219, 0xffff0000, v57
 v_mul_f32 v220, v90, v218
 v_mul_f32 v222, v90, v216
 v_mul_f32 v221, v91, v219
 v_mul_f32 v223, v91, v217
 v_fma_f32 v220, v74, v216, -v220
 v_fma_f32 v222, v74, v218, v222
 v_fma_f32 v221, v75, v217, -v221
 v_mfma_f32_32x32x16_bf16 v[136:151], a[228:231], v[28:31], v[136:151]
 v_fma_f32 v223, v75, v219, v223
 v_cvt_pk_bf16_f32 v193, v220, v221
 v_cvt_pk_bf16_f32 v185, v222, v223
 v_lshlrev_b32 v216, 16, v42
 v_and_b32 v217, 0xffff0000, v42
 v_lshlrev_b32 v218, 16, v58
 v_and_b32 v219, 0xffff0000, v58
 v_mul_f32 v220, v92, v218
 v_mul_f32 v222, v92, v216
 v_mfma_f32_32x32x16_bf16 v[152:167], v[204:207], v[12:15], v[152:167]
 v_mul_f32 v221, v93, v219
 v_mul_f32 v223, v93, v217
 v_fma_f32 v220, v76, v216, -v220
 v_fma_f32 v222, v76, v218, v222
 v_fma_f32 v221, v77, v217, -v221
 v_fma_f32 v223, v77, v219, v223
 v_cvt_pk_bf16_f32 v194, v220, v221
 v_cvt_pk_bf16_f32 v186, v222, v223
 v_lshlrev_b32 v216, 16, v43
 v_mfma_f32_32x32x16_bf16 v[136:151], a[200:203], v[16:19], v[136:151]
 v_and_b32 v217, 0xffff0000, v43
 v_lshlrev_b32 v218, 16, v59
 v_and_b32 v219, 0xffff0000, v59
 v_mul_f32 v220, v94, v218
 v_mul_f32 v222, v94, v216
 v_mul_f32 v221, v95, v219
 v_mul_f32 v223, v95, v217
 v_fma_f32 v220, v78, v216, -v220
 v_mfma_f32_32x32x16_bf16 v[152:167], a[200:203], v[32:35], v[152:167]
 v_fma_f32 v222, v78, v218, v222
 v_fma_f32 v221, v79, v217, -v221
 v_fma_f32 v223, v79, v219, v223
 v_cvt_pk_bf16_f32 v195, v220, v221
 v_cvt_pk_bf16_f32 v187, v222, v223
 v_lshlrev_b32 v216, 16, v44
 v_and_b32 v217, 0xffff0000, v44
 v_lshlrev_b32 v218, 16, v60
 v_and_b32 v219, 0xffff0000, v60
 v_mfma_f32_32x32x16_bf16 v[136:151], a[232:235], v[32:35], v[136:151]
 v_mul_f32 v220, v96, v218
 v_mul_f32 v222, v96, v216
 v_mul_f32 v221, v97, v219
 v_mul_f32 v223, v97, v217
 v_fma_f32 v220, v80, v216, -v220
 v_fma_f32 v222, v80, v218, v222
 v_fma_f32 v221, v81, v217, -v221
 v_fma_f32 v223, v81, v219, v223
 v_mfma_f32_32x32x16_bf16 v[152:167], v[208:211], v[16:19], v[152:167]
 v_cvt_pk_bf16_f32 v196, v220, v221
 v_cvt_pk_bf16_f32 v188, v222, v223
 v_lshlrev_b32 v216, 16, v45
 v_and_b32 v217, 0xffff0000, v45
 v_lshlrev_b32 v218, 16, v61
 v_and_b32 v219, 0xffff0000, v61
 v_mul_f32 v220, v98, v218
 v_mul_f32 v222, v98, v216
 v_mul_f32 v221, v99, v219
 v_mfma_f32_32x32x16_bf16 v[136:151], a[204:207], v[20:23], v[136:151]
 v_mul_f32 v223, v99, v217
 v_fma_f32 v220, v82, v216, -v220
 v_fma_f32 v222, v82, v218, v222
 v_fma_f32 v221, v83, v217, -v221
 v_fma_f32 v223, v83, v219, v223
 v_cvt_pk_bf16_f32 v197, v220, v221
 v_cvt_pk_bf16_f32 v189, v222, v223
 v_lshlrev_b32 v216, 16, v46
 v_and_b32 v217, 0xffff0000, v46
 v_mfma_f32_32x32x16_bf16 v[152:167], a[204:207], v[36:39], v[152:167]
 v_lshlrev_b32 v218, 16, v62
 v_and_b32 v219, 0xffff0000, v62
 v_mul_f32 v220, v100, v218
 v_mul_f32 v222, v100, v216
 v_mul_f32 v221, v101, v219
 v_mul_f32 v223, v101, v217
 v_fma_f32 v220, v84, v216, -v220
 v_fma_f32 v222, v84, v218, v222
 v_mfma_f32_32x32x16_bf16 v[136:151], a[236:239], v[36:39], v[136:151]
 v_fma_f32 v221, v85, v217, -v221
 v_fma_f32 v223, v85, v219, v223
 v_cvt_pk_bf16_f32 v198, v220, v221
 v_cvt_pk_bf16_f32 v190, v222, v223
 v_lshlrev_b32 v216, 16, v47
 v_and_b32 v217, 0xffff0000, v47
 v_lshlrev_b32 v218, 16, v63
 v_and_b32 v219, 0xffff0000, v63
 v_mul_f32 v220, v102, v218
 v_mfma_f32_32x32x16_bf16 v[152:167], v[212:215], v[20:23], v[152:167]
 v_mul_f32 v222, v102, v216
 v_mul_f32 v221, v103, v219
 v_mul_f32 v223, v103, v217
 v_fma_f32 v220, v86, v216, -v220
 v_fma_f32 v222, v86, v218, v222
 v_fma_f32 v221, v87, v217, -v221
 v_fma_f32 v223, v87, v219, v223
 v_cvt_pk_bf16_f32 v199, v220, v221
 v_cvt_pk_bf16_f32 v191, v222, v223
 s_nop 1
 v_mfma_f32_32x32x16_bf16 v[72:87], v[192:195], a[176:179], 0
 v_lshrrev_b32 v3, 3, v2
 v_mul_u32_u24 v254, 36864, v3
 v_lshl_add_u32 v4, v4, 4, v254
 v_mfma_f32_32x32x16_bf16 v[88:103], v[184:187], a[176:179], 0
 v_lshlrev_b32 v3, 4, v3
 v_xor_b32 v3, v3, v0
 v_add_u32 v3, s98, v3
 s_and_b32 s98, s42, 3
 v_mfma_f32_32x32x16_bf16 v[72:87], v[184:187], a[240:243], v[72:87]
 s_min_u32 s98, s98, 2
 s_mul_i32 s96, s98, 110592
 s_add_u32 s96, s96, 368640
 v_lshl_add_u64 v[252:253], s[96:97], 0, v[252:253]
 v_mfma_f32_32x32x16_bf16 v[88:103], v[192:195], a[208:211], v[88:103]
 v_lshlrev_b32 v216, 16, v48
 v_and_b32 v217, 0xffff0000, v48
 v_lshlrev_b32 v218, 16, v64
 v_and_b32 v219, 0xffff0000, v64
 v_mul_f32 v220, v152, v218
 v_mul_f32 v222, v152, v216
 v_mul_f32 v221, v153, v219
 v_mul_f32 v223, v153, v217
 v_mfma_f32_32x32x16_bf16 v[72:87], v[196:199], a[180:183], v[72:87]
 v_fma_f32 v220, v136, v216, -v220
 v_fma_f32 v222, v136, v218, v222
 v_fma_f32 v221, v137, v217, -v221
 v_fma_f32 v223, v137, v219, v223
 v_cvt_pk_bf16_f32 v8, v220, v221
 v_cvt_pk_bf16_f32 v16, v222, v223
 v_lshlrev_b32 v216, 16, v49
 v_and_b32 v217, 0xffff0000, v49
 v_lshlrev_b32 v218, 16, v65
 v_mfma_f32_32x32x16_bf16 v[88:103], v[188:191], a[180:183], v[88:103]
 v_and_b32 v219, 0xffff0000, v65
 v_mul_f32 v220, v154, v218
 v_mul_f32 v222, v154, v216
 v_mul_f32 v221, v155, v219
 v_mul_f32 v223, v155, v217
 v_fma_f32 v220, v138, v216, -v220
 v_fma_f32 v222, v138, v218, v222
 v_fma_f32 v221, v139, v217, -v221
 v_fma_f32 v223, v139, v219, v223
 v_mfma_f32_32x32x16_bf16 v[72:87], v[188:191], a[244:247], v[72:87]
 v_cvt_pk_bf16_f32 v9, v220, v221
 v_cvt_pk_bf16_f32 v17, v222, v223
 v_lshlrev_b32 v216, 16, v50
 v_and_b32 v217, 0xffff0000, v50
 s_buffer_load_dwordx2 s[0:1], s[16:19], s34 glc
 v_lshlrev_b32 v218, 16, v66
 v_and_b32 v219, 0xffff0000, v66
 v_mul_f32 v220, v156, v218
 v_mfma_f32_32x32x16_bf16 v[88:103], v[196:199], a[212:215], v[88:103]
 v_mul_f32 v222, v156, v216
 v_mul_f32 v221, v157, v219
 v_mul_f32 v223, v157, v217
 v_fma_f32 v220, v140, v216, -v220
 v_fma_f32 v222, v140, v218, v222
 v_fma_f32 v221, v141, v217, -v221
 v_fma_f32 v223, v141, v219, v223
 v_cvt_pk_bf16_f32 v10, v220, v221
 v_cvt_pk_bf16_f32 v18, v222, v223
 v_mfma_f32_32x32x16_bf16 v[168:183], v[192:195], a[192:195], 0
 v_lshlrev_b32 v216, 16, v51
 v_and_b32 v217, 0xffff0000, v51
 v_lshlrev_b32 v218, 16, v67
 v_and_b32 v219, 0xffff0000, v67
 v_mul_f32 v220, v158, v218
 v_mul_f32 v222, v158, v216
 v_mul_f32 v221, v159, v219
 v_mul_f32 v223, v159, v217
 v_fma_f32 v220, v142, v216, -v220
 v_mfma_f32_32x32x16_bf16 v[24:39], v[184:187], a[192:195], 0
 v_fma_f32 v222, v142, v218, v222
 v_fma_f32 v221, v143, v217, -v221
 v_fma_f32 v223, v143, v219, v223
 v_cvt_pk_bf16_f32 v11, v220, v221
 v_cvt_pk_bf16_f32 v19, v222, v223
 v_lshlrev_b32 v216, 16, v52
 v_and_b32 v217, 0xffff0000, v52
 v_lshlrev_b32 v218, 16, v68
 v_mfma_f32_32x32x16_bf16 v[168:183], v[184:187], v[200:203], v[168:183]
 v_and_b32 v219, 0xffff0000, v68
 v_mul_f32 v220, v160, v218
 v_mul_f32 v222, v160, v216
 v_mul_f32 v221, v161, v219
 v_mul_f32 v223, v161, v217
 v_fma_f32 v220, v144, v216, -v220
 v_fma_f32 v222, v144, v218, v222
 v_fma_f32 v221, v145, v217, -v221
 v_fma_f32 v223, v145, v219, v223
 v_mfma_f32_32x32x16_bf16 v[24:39], v[192:195], a[224:227], v[24:39]
 v_cvt_pk_bf16_f32 v12, v220, v221
 v_cvt_pk_bf16_f32 v20, v222, v223
 v_lshlrev_b32 v216, 16, v53
 v_and_b32 v217, 0xffff0000, v53
 v_lshlrev_b32 v218, 16, v69
 v_and_b32 v219, 0xffff0000, v69
 v_mul_f32 v220, v162, v218
 v_mul_f32 v222, v162, v216
 v_mul_f32 v221, v163, v219
 v_mfma_f32_32x32x16_bf16 v[168:183], v[196:199], a[196:199], v[168:183]
 v_mul_f32 v223, v163, v217
 v_fma_f32 v220, v146, v216, -v220
 v_fma_f32 v222, v146, v218, v222
 v_fma_f32 v221, v147, v217, -v221
 v_fma_f32 v223, v147, v219, v223
 v_cvt_pk_bf16_f32 v13, v220, v221
 v_cvt_pk_bf16_f32 v21, v222, v223
 v_lshlrev_b32 v216, 16, v54
 v_mfma_f32_32x32x16_bf16 v[24:39], v[188:191], a[196:199], v[24:39]
 v_and_b32 v217, 0xffff0000, v54
 v_lshlrev_b32 v218, 16, v70
 v_and_b32 v219, 0xffff0000, v70
 v_mul_f32 v220, v164, v218
 v_mul_f32 v222, v164, v216
 v_mul_f32 v221, v165, v219
 v_mul_f32 v223, v165, v217
 v_fma_f32 v220, v148, v216, -v220
 v_fma_f32 v222, v148, v218, v222
 v_mfma_f32_32x32x16_bf16 v[168:183], v[188:191], v[204:207], v[168:183]
 v_fma_f32 v221, v149, v217, -v221
 v_fma_f32 v223, v149, v219, v223
 v_cvt_pk_bf16_f32 v14, v220, v221
 v_cvt_pk_bf16_f32 v22, v222, v223
 v_lshlrev_b32 v216, 16, v55
 v_and_b32 v217, 0xffff0000, v55
 v_lshlrev_b32 v218, 16, v71
 v_and_b32 v219, 0xffff0000, v71
 v_mul_f32 v220, v166, v218
 v_mfma_f32_32x32x16_bf16 v[24:39], v[196:199], a[228:231], v[24:39]
 v_mul_f32 v222, v166, v216
 v_mul_f32 v221, v167, v219
 v_mul_f32 v223, v167, v217
 v_fma_f32 v220, v150, v216, -v220
 v_fma_f32 v222, v150, v218, v222
 v_fma_f32 v221, v151, v217, -v221
 v_fma_f32 v223, v151, v219, v223
 v_cvt_pk_bf16_f32 v15, v220, v221
 v_cvt_pk_bf16_f32 v23, v222, v223
 s_nop 1
 v_mfma_f32_32x32x16_bf16 v[72:87], v[8:11], a[184:187], v[72:87]
 v_mfma_f32_32x32x16_bf16 v[88:103], v[16:19], a[184:187], v[88:103]
 s_waitcnt lgkmcnt(0)
 s_sub_u32 s1, s1, 4
 s_cmp_lt_u32 s1, 60
 s_cselect_b32 s0, s0, 0
 s_cmp_lg_u32 s0, s45
 s_cbranch_scc1 QC_51
QK_52:
 v_mfma_f32_32x32x16_bf16 v[72:87], v[16:19], a[248:251], v[72:87]
 v_mfma_f32_32x32x16_bf16 v[88:103], v[8:11], a[216:219], v[88:103]
 s_add_u32 s3, s33, 28672
 buffer_load_dwordx4 a[144:147], v0, s[16:19], s3 offen offset:0 sc1
 v_mfma_f32_32x32x16_bf16 v[72:87], v[12:15], a[188:191], v[72:87]
 s_add_u32 s3, s33, 28672
 buffer_load_dwordx4 a[148:151], v0, s[16:19], s3 offen offset:1024 sc1
 v_mfma_f32_32x32x16_bf16 v[88:103], v[20:23], a[188:191], v[88:103]
 v_mfma_f32_32x32x16_bf16 v[72:87], v[20:23], a[252:255], v[72:87]
 s_add_u32 s3, s33, 28672
 buffer_load_dwordx4 a[152:155], v0, s[16:19], s3 offen offset:2048 sc1
 v_mfma_f32_32x32x16_bf16 v[88:103], v[12:15], a[220:223], v[88:103]
 v_mfma_f32_32x32x16_bf16 v[168:183], v[8:11], a[200:203], v[168:183]
 s_add_u32 s3, s33, 28672
 buffer_load_dwordx4 a[156:159], v0, s[16:19], s3 offen offset:3072 sc1
 v_mfma_f32_32x32x16_bf16 v[24:39], v[16:19], a[200:203], v[24:39]
 s_waitcnt vmcnt(8)
 s_barrier
 ds_read_b64_tr_b16 a[0:1], v242 offset:0
 ds_read_b64_tr_b16 a[2:3], v242 offset:512
 ds_read_b64_tr_b16 a[4:5], v243 offset:0
 ds_read_b64_tr_b16 a[6:7], v243 offset:512
 ds_read_b64_tr_b16 a[8:9], v242 offset:2048
 ds_read_b64_tr_b16 a[10:11], v242 offset:2560
 ds_read_b64_tr_b16 a[12:13], v243 offset:2048
 ds_read_b64_tr_b16 a[14:15], v243 offset:2560
 ds_read_b64_tr_b16 a[16:17], v242 offset:4096
 ds_read_b64_tr_b16 a[18:19], v242 offset:4608
 ds_read_b64_tr_b16 a[20:21], v243 offset:4096
 ds_read_b64_tr_b16 a[22:23], v243 offset:4608
 v_mfma_f32_32x32x16_bf16 v[168:183], v[16:19], v[208:211], v[168:183]
 v_cvt_pk_bf16_f32 v40, v72, v74
 v_cvt_pk_bf16_f32 v41, v76, v78
 v_cvt_pk_bf16_f32 v42, v80, v82
 v_cvt_pk_bf16_f32 v43, v84, v86
 v_mfma_f32_32x32x16_bf16 v[24:39], v[8:11], a[232:235], v[24:39]
 ds_write_b128 v1, v[40:43]
 v_cvt_pk_bf16_f32 v44, v73, v75
 v_cvt_pk_bf16_f32 v45, v77, v79
 v_cvt_pk_bf16_f32 v46, v81, v83
 v_cvt_pk_bf16_f32 v47, v85, v87
 v_mfma_f32_32x32x16_bf16 v[168:183], v[12:15], a[204:207], v[168:183]
 v_xor_b32 v254, 16, v1
 ds_write_b128 v254, v[44:47]
 v_cvt_pk_bf16_f32 v48, v88, v90
 v_cvt_pk_bf16_f32 v49, v92, v94
 v_mfma_f32_32x32x16_bf16 v[24:39], v[20:23], a[204:207], v[24:39]
 v_cvt_pk_bf16_f32 v50, v96, v98
 v_cvt_pk_bf16_f32 v51, v100, v102
 v_xor_b32 v254, 32, v1
 ds_write_b128 v254, v[48:51]
 v_cvt_pk_bf16_f32 v52, v89, v91
 v_mfma_f32_32x32x16_bf16 v[168:183], v[20:23], v[212:215], v[168:183]
 v_cvt_pk_bf16_f32 v53, v93, v95
 v_cvt_pk_bf16_f32 v54, v97, v99
 v_cvt_pk_bf16_f32 v55, v101, v103
 v_xor_b32 v254, 48, v1
 v_mfma_f32_32x32x16_bf16 v[24:39], v[12:15], a[236:239], v[24:39]
 ds_write_b128 v254, v[52:55]
 ds_read_b128 v[40:43], v3 offset:0
 ds_read_b128 v[44:47], v3 offset:1024
 ds_read_b128 v[48:51], v3 offset:8192
 ds_read_b128 v[52:55], v3 offset:9216
 s_waitcnt vmcnt(4)
 s_waitcnt lgkmcnt(12)
 v_mfma_f32_32x32x16_bf16 v[104:119], a[0:3], a[128:131], v[104:119]
 ds_read_b64_tr_b16 a[24:25], v242 offset:6144
 ds_read_b64_tr_b16 a[26:27], v242 offset:6656
 v_mfma_f32_32x32x16_bf16 v[120:135], a[4:7], a[128:131], v[120:135]
 ds_read_b64_tr_b16 a[28:29], v243 offset:6144
 ds_read_b64_tr_b16 a[30:31], v243 offset:6656
 s_add_u32 m0, s64, 0
 s_add_u32 s68, s56, 256
 buffer_load_dwordx4 v6, s[12:15], s68 offen  lds
 s_waitcnt lgkmcnt(7)
 buffer_store_dwordx4 v[40:43], v4, s[16:19], s48 offen sc1
 s_add_u32 s48, s48, 294912
 v_mfma_f32_32x32x16_bf16 v[104:119], a[8:11], a[132:135], v[104:119]
 ds_read_b64_tr_b16 a[0:1], v242 offset:8192
 ds_read_b64_tr_b16 a[2:3], v242 offset:8704
 v_cvt_pk_bf16_f32 v56, v168, v170
 v_cvt_pk_bf16_f32 v57, v172, v174
 v_cvt_pk_bf16_f32 v58, v176, v178
 v_mfma_f32_32x32x16_bf16 v[120:135], a[12:15], a[132:135], v[120:135]
 ds_read_b64_tr_b16 a[4:5], v243 offset:8192
 ds_read_b64_tr_b16 a[6:7], v243 offset:8704
 v_cvt_pk_bf16_f32 v59, v180, v182
 ds_write_b128 v1, v[56:59]
 v_cvt_pk_bf16_f32 v60, v169, v171
 v_cvt_pk_bf16_f32 v61, v173, v175
 s_waitcnt lgkmcnt(5)
 v_mfma_f32_32x32x16_bf16 v[104:119], a[16:19], a[136:139], v[104:119]
 ds_read_b64_tr_b16 a[8:9], v242 offset:10240
 ds_read_b64_tr_b16 a[10:11], v242 offset:10752
 v_cvt_pk_bf16_f32 v62, v177, v179
 v_cvt_pk_bf16_f32 v63, v181, v183
 v_xor_b32 v254, 16, v1
 buffer_store_dwordx4 v[44:47], v4, s[16:19], s48 offen sc1
 s_add_u32 s48, s48, 294912
 v_mfma_f32_32x32x16_bf16 v[120:135], a[20:23], a[136:139], v[120:135]
 ds_read_b64_tr_b16 a[12:13], v243 offset:10240
 ds_read_b64_tr_b16 a[14:15], v243 offset:10752
 buffer_load_dwordx4 v7, s[12:15], s68 offen offset:1024  lds
 ds_write_b128 v254, v[60:63]
 v_cvt_pk_bf16_f32 v64, v24, v26
 v_cvt_pk_bf16_f32 v65, v28, v30
 v_cvt_pk_bf16_f32 v66, v32, v34
 v_mfma_f32_32x32x16_bf16 v[104:119], a[24:27], a[140:143], v[104:119]
 ds_read_b64_tr_b16 a[16:17], v242 offset:12288
 ds_read_b64_tr_b16 a[18:19], v242 offset:12800
 v_cvt_pk_bf16_f32 v67, v36, v38
 v_xor_b32 v254, 32, v1
 ds_write_b128 v254, v[64:67]
 buffer_store_dwordx4 v[48:51], v4, s[16:19], s48 offen sc1
 s_add_u32 s48, s48, 294912
 s_buffer_load_dwordx2 s[0:1], s[16:19], s34 glc
 v_mfma_f32_32x32x16_bf16 v[120:135], a[28:31], a[140:143], v[120:135]
 ds_read_b64_tr_b16 a[20:21], v243 offset:12288
 ds_read_b64_tr_b16 a[22:23], v243 offset:12800
 v_cvt_pk_bf16_f32 v68, v25, v27
 v_cvt_pk_bf16_f32 v69, v29, v31
 v_cvt_pk_bf16_f32 v70, v33, v35
 s_waitcnt lgkmcnt(11)
 v_mfma_f32_32x32x16_bf16 v[72:87], a[0:3], a[48:51], 0
 ds_read_b64_tr_b16 a[24:25], v242 offset:14336
 ds_read_b64_tr_b16 a[26:27], v242 offset:14848
 v_cvt_pk_bf16_f32 v71, v37, v39
 v_xor_b32 v254, 48, v1
 ds_write_b128 v254, v[68:71]
 ds_read_b128 v[56:59], v3 offset:0
 v_mfma_f32_32x32x16_bf16 v[88:103], a[4:7], a[48:51], 0
 ds_read_b64_tr_b16 a[28:29], v243 offset:14336
 s_add_u32 m0, s64, 7936
 ds_read_b64_tr_b16 a[30:31], v243 offset:14848
 buffer_load_dwordx4 v6, s[12:15], s57 offen offset:256  lds
 ds_read_b128 v[60:63], v3 offset:1024
 ds_read_b128 v[64:67], v3 offset:8192
 ds_read_b128 v[68:71], v3 offset:9216
 buffer_store_dwordx4 v[52:55], v4, s[16:19], s48 offen sc1
 s_add_u32 s48, s48, 294912
 s_waitcnt lgkmcnt(15)
 v_mfma_f32_32x32x16_bf16 v[72:87], a[8:11], a[52:55], v[72:87]
 ds_read_b64_tr_b16 a[0:1], v242 offset:16384
 ds_read_b64_tr_b16 a[2:3], v242 offset:16896
 v_mfma_f32_32x32x16_bf16 v[88:103], a[12:15], a[52:55], v[88:103]
 ds_read_b64_tr_b16 a[4:5], v243 offset:16384
 ds_read_b64_tr_b16 a[6:7], v243 offset:16896
 s_waitcnt lgkmcnt(13)
 v_mfma_f32_32x32x16_bf16 v[72:87], a[16:19], a[56:59], v[72:87]
 ds_read_b64_tr_b16 a[8:9], v242 offset:18432
 ds_read_b64_tr_b16 a[10:11], v242 offset:18944
 s_waitcnt lgkmcnt(11)
 buffer_store_dwordx4 v[56:59], v4, s[16:19], s49 offen sc1
 s_add_u32 s49, s49, 294912
 v_mfma_f32_32x32x16_bf16 v[88:103], a[20:23], a[56:59], v[88:103]
 ds_read_b64_tr_b16 a[12:13], v243 offset:18432
 ds_read_b64_tr_b16 a[14:15], v243 offset:18944
 buffer_load_dwordx4 v7, s[12:15], s57 offen offset:1280  lds
 s_waitcnt lgkmcnt(11)
 v_mfma_f32_32x32x16_bf16 v[72:87], a[24:27], a[60:63], v[72:87]
 ds_read_b64_tr_b16 a[16:17], v242 offset:20480
 ds_read_b64_tr_b16 a[18:19], v242 offset:20992
 v_mfma_f32_32x32x16_bf16 v[88:103], a[28:31], a[60:63], v[88:103]
 ds_read_b64_tr_b16 a[20:21], v243 offset:20480
 ds_read_b64_tr_b16 a[22:23], v243 offset:20992
 s_waitcnt lgkmcnt(14)
 buffer_store_dwordx4 v[60:63], v4, s[16:19], s49 offen sc1
 s_add_u32 s49, s49, 294912
 s_waitcnt vmcnt(10)
 s_waitcnt lgkmcnt(8)
 v_mfma_f32_32x32x16_bf16 v[104:119], a[0:3], a[144:147], v[104:119]
 ds_read_b64_tr_b16 a[24:25], v242 offset:22528
 ds_read_b64_tr_b16 a[26:27], v242 offset:23040
 v_mfma_f32_32x32x16_bf16 v[120:135], a[4:7], a[144:147], v[120:135]
 ds_read_b64_tr_b16 a[28:29], v243 offset:22528
 s_add_u32 m0, s64, 16128
 ds_read_b64_tr_b16 a[30:31], v243 offset:23040
 buffer_load_dwordx4 v6, s[12:15], s58 offen offset:256  lds
 s_waitcnt lgkmcnt(8)
 v_mfma_f32_32x32x16_bf16 v[104:119], a[8:11], a[148:151], v[104:119]
 s_barrier
 ds_read_b64_tr_b16 a[0:1], v242 offset:24576
 ds_read_b64_tr_b16 a[2:3], v242 offset:25088
 buffer_store_dwordx4 v[64:67], v4, s[16:19], s49 offen sc1
 s_add_u32 s49, s49, 294912
 v_mfma_f32_32x32x16_bf16 v[120:135], a[12:15], a[148:151], v[120:135]
 ds_read_b64_tr_b16 a[4:5], v243 offset:24576
 ds_read_b64_tr_b16 a[6:7], v243 offset:25088
 s_waitcnt lgkmcnt(8)
 v_mfma_f32_32x32x16_bf16 v[104:119], a[16:19], a[152:155], v[104:119]
 ds_read_b64_tr_b16 a[8:9], v242 offset:26624
 ds_read_b64_tr_b16 a[10:11], v242 offset:27136
 v_mfma_f32_32x32x16_bf16 v[120:135], a[20:23], a[152:155], v[120:135]
 ds_read_b64_tr_b16 a[12:13], v243 offset:26624
 ds_read_b64_tr_b16 a[14:15], v243 offset:27136
 buffer_load_dwordx4 v7, s[12:15], s58 offen offset:1280  lds
 buffer_store_dwordx4 v[68:71], v4, s[16:19], s49 offen sc1
 s_add_u32 s49, s49, 294912
 s_waitcnt lgkmcnt(8)
 v_mfma_f32_32x32x16_bf16 v[104:119], a[24:27], a[156:159], v[104:119]
 ds_read_b64_tr_b16 a[16:17], v242 offset:28672
 ds_read_b64_tr_b16 a[18:19], v242 offset:29184
 v_mfma_f32_32x32x16_bf16 v[120:135], a[28:31], a[156:159], v[120:135]
 ds_read_b64_tr_b16 a[20:21], v243 offset:28672
 ds_read_b64_tr_b16 a[22:23], v243 offset:29184
L_s7u:
 s_waitcnt lgkmcnt(8)
 v_mfma_f32_32x32x16_bf16 v[72:87], a[0:3], a[64:67], v[72:87]
 ds_read_b64_tr_b16 a[24:25], v242 offset:30720
 ds_read_b64_tr_b16 a[26:27], v242 offset:31232
 s_waitcnt lgkmcnt(0)
 s_sub_u32 s1, s1, 5
 s_cmp_lt_u32 s1, 60
 s_cselect_b32 s0, s0, 0
 s_cmp_lg_u32 s0, s45
 s_cbranch_scc1 QC_55
QK_56:
 v_mfma_f32_32x32x16_bf16 v[88:103], a[4:7], a[64:67], v[88:103]
 ds_read_b64_tr_b16 a[28:29], v243 offset:30720
 s_add_u32 m0, s64, 24320
 ds_read_b64_tr_b16 a[30:31], v243 offset:31232
 buffer_load_dwordx4 v6, s[12:15], s59 offen offset:256  lds
 s_add_u32 s3, s33, 32768
 buffer_load_dwordx4 a[160:163], v0, s[16:19], s3 offen offset:0 sc1
 v_mfma_f32_32x32x16_bf16 v[72:87], a[8:11], a[68:71], v[72:87]
 ds_read_b64_tr_b16 a[0:1], v242 offset:32768
 ds_read_b64_tr_b16 a[2:3], v242 offset:33280
 s_min_u32 s3, s40, 2
 s_lshl_b32 s3, s3, 12
 s_add_u32 s3, s3, 149504
 v_and_b32 v5, 31, v2
 v_lshl_add_u32 v5, v5, 6, s3
 v_mfma_f32_32x32x16_bf16 v[88:103], a[12:15], a[68:71], v[88:103]
 ds_read_b64_tr_b16 a[4:5], v243 offset:32768
 ds_read_b64_tr_b16 a[6:7], v243 offset:33280
 s_add_u32 s3, s33, 32768
 buffer_load_dwordx4 a[164:167], v0, s[16:19], s3 offen offset:1024 sc1
 s_waitcnt lgkmcnt(4)
 v_mfma_f32_32x32x16_bf16 v[72:87], a[16:19], a[72:75], v[72:87]
 ds_read_b64_tr_b16 a[8:9], v242 offset:34816
 ds_read_b64_tr_b16 a[10:11], v242 offset:35328
 v_bfe_u32 v1, v2, 2, 2
 v_mfma_f32_32x32x16_bf16 v[88:103], a[20:23], a[72:75], v[88:103]
 ds_read_b64_tr_b16 a[12:13], v243 offset:34816
 ds_read_b64_tr_b16 a[14:15], v243 offset:35328
 buffer_load_dwordx4 v7, s[12:15], s59 offen offset:1280  lds
 s_add_u32 s3, s33, 32768
 buffer_load_dwordx4 a[168:171], v0, s[16:19], s3 offen offset:2048 sc1
 v_lshl_add_u32 v5, v1, 4, v5
 v_lshrrev_b32 v1, 5, v2
 v_mfma_f32_32x32x16_bf16 v[72:87], a[24:27], a[76:79], v[72:87]
 ds_read_b64_tr_b16 a[16:17], v242 offset:36864
 ds_read_b64_tr_b16 a[18:19], v242 offset:37376
 v_lshl_add_u32 v5, v1, 3, v5
 v_mfma_f32_32x32x16_bf16 v[88:103], a[28:31], a[76:79], v[88:103]
 ds_read_b64_tr_b16 a[20:21], v243 offset:36864
 ds_read_b64_tr_b16 a[22:23], v243 offset:37376
 s_add_u32 s3, s33, 32768
 buffer_load_dwordx4 a[172:175], v0, s[16:19], s3 offen offset:3072 sc1
 ds_read_b64 a[232:233], v5 offset:0
 ds_read_b64 a[240:241], v5 offset:2048
 s_waitcnt lgkmcnt(6)
 v_mfma_f32_32x32x16_bf16 v[72:87], a[0:3], a[80:83], v[72:87]
 ds_read_b64_tr_b16 a[24:25], v242 offset:38912
 ds_read_b64_tr_b16 a[26:27], v242 offset:39424
 v_xor_b32 v1, 16, v5
 v_mfma_f32_32x32x16_bf16 v[88:103], a[4:7], a[80:83], v[88:103]
 ds_read_b64_tr_b16 a[28:29], v243 offset:38912
 s_add_u32 m0, s64, 32512
 ds_read_b64_tr_b16 a[30:31], v243 offset:39424
 buffer_load_dwordx4 v6, s[12:15], s55 offen offset:256  lds
 ds_read_b64 a[234:235], v1 offset:0
 ds_read_b64 a[242:243], v1 offset:2048
 s_getpc_b64 s[100:101]
CT_57:
 s_lshr_b32 s3, s2, 3
 s_lshl_b32 s3, s3, 2
 s_add_u32 s3, s3, s40
 s_lshl_b32 s3, s3, 8
 v_lshlrev_b32 v254, 7, v2
 v_add_u32 v254, s3, v254
 v_min_u32 v254, L_tailend-L_s9-4, v254
 s_sub_u32 s100, s100, CT_57-L_main
 s_subb_u32 s101, s101, 0
 v_add_u32 v254, L_s9-L_main, v254
 v_mov_b32 v255, 0
 v_lshl_add_u64 v[254:255], s[100:101], 0, v[254:255]
 s_mov_b64 exec, 3
 global_load_dword a252, v[254:255], off
 s_mov_b64 exec, -1
 v_mfma_f32_32x32x16_bf16 v[72:87], a[8:11], a[84:87], v[72:87]
 ds_read_b64_tr_b16 a[0:1], v242 offset:40960
 ds_read_b64_tr_b16 a[2:3], v242 offset:41472
 v_xor_b32 v1, 32, v5
 s_lshl_b32 s52, s41, 2
 s_lshr_b32 s38, s42, 2
 s_add_u32 s52, s52, s38
 v_and_b32 v216, 31, v2
 v_mfma_f32_32x32x16_bf16 v[88:103], a[12:15], a[84:87], v[88:103]
 ds_read_b64_tr_b16 a[4:5], v243 offset:40960
 ds_read_b64_tr_b16 a[6:7], v243 offset:41472
 ds_read_b64 a[236:237], v1 offset:0
 ds_read_b64 a[244:245], v1 offset:2048
 v_lshrrev_b32 v217, 5, v2
 v_lshlrev_b32 v207, 2, v217
 v_sub_u32 v207, v216, v207
 v_lshlrev_b32 v216, 6, v216
 s_waitcnt lgkmcnt(8)
 v_mfma_f32_32x32x16_bf16 v[72:87], a[16:19], a[88:91], v[72:87]
 ds_read_b64_tr_b16 a[8:9], v242 offset:43008
 ds_read_b64_tr_b16 a[10:11], v242 offset:43520
 v_xor_b32 v1, 48, v5
 v_add_u32 v216, s52, v216
ST1_10:
 s_cbranch_execz STB1_2
 s_lshr_b32 s38, s40, 1
 s_and_b32 s39, s40, 1
 s_lshl_b32 s8, s38, 4
 v_mfma_f32_32x32x16_bf16 v[88:103], a[20:23], a[88:91], v[88:103]
 ds_read_b64_tr_b16 a[12:13], v243 offset:43008
 ds_read_b64_tr_b16 a[14:15], v243 offset:43520
 buffer_load_dwordx4 v7, s[12:15], s55 offen offset:1280  lds
 ds_read_b64 a[238:239], v1 offset:0
 ds_read_b64 a[246:247], v1 offset:2048
 s_lshl_b32 s9, s39, 2
 s_add_u32 s8, s8, s9
 v_lshl_add_u32 v217, v217, 3, s8
 v_mul_u32_u24 v217, v217, v216
 v_mfma_f32_32x32x16_bf16 v[72:87], a[24:27], a[92:95], v[72:87]
 ds_read_b64_tr_b16 a[16:17], v242 offset:45056
 ds_read_b64_tr_b16 a[18:19], v242 offset:45568
 s_add_u32 s8, s8, s9
 v_subrev_u32 v207, s8, v207
 s_lshl_b32 s38, s38, 10
 s_lshl_b32 s39, s39, 3
 v_mfma_f32_32x32x16_bf16 v[88:103], a[28:31], a[92:95], v[88:103]
 ds_read_b64_tr_b16 a[20:21], v243 offset:45056
 ds_read_b64_tr_b16 a[22:23], v243 offset:45568
 s_add_u32 s38, s38, s39
 s_add_u32 s38, s38, 149504
 v_add_u32 v206, s38, v0
 v_mad_u32_u24 v208, v216, 0, v217
 s_waitcnt lgkmcnt(6)
 v_mfma_f32_32x32x16_bf16 v[72:87], a[0:3], a[96:99], v[72:87]
 ds_read_b64_tr_b16 a[24:25], v242 offset:47104
 ds_read_b64_tr_b16 a[26:27], v242 offset:47616
 v_mad_u32_u24 v209, v216, 1, v217
 v_mad_u32_u24 v210, v216, 2, v217
 v_mad_u32_u24 v211, v216, 3, v217
 v_and_b32 v208, 0x7ff, v208
 v_mfma_f32_32x32x16_bf16 v[88:103], a[4:7], a[96:99], v[88:103]
 ds_read_b64_tr_b16 a[28:29], v243 offset:47104
 s_add_u32 m0, s64, 40704
 ds_read_b64_tr_b16 a[30:31], v243 offset:47616
 buffer_load_dwordx4 v6, s[12:15], s60 offen offset:256  lds
 v_and_b32 v209, 0x7ff, v209
 v_and_b32 v210, 0x7ff, v210
 v_and_b32 v211, 0x7ff, v211
 v_cvt_f32_u32 v208, v208
 v_mfma_f32_32x32x16_bf16 v[72:87], a[8:11], a[100:103], v[72:87]
 s_barrier
 ds_read_b64_tr_b16 a[0:1], v244 offset:0
 ds_read_b64_tr_b16 a[2:3], v244 offset:512
 v_cvt_f32_u32 v209, v209
 v_cvt_f32_u32 v210, v210
 v_cvt_f32_u32 v211, v211
 v_mul_f32 v208, 0x3a000000, v208
 v_mfma_f32_32x32x16_bf16 v[88:103], a[12:15], a[100:103], v[88:103]
 ds_read_b64_tr_b16 a[4:5], v245 offset:0
 ds_read_b64_tr_b16 a[6:7], v245 offset:512
 v_mul_f32 v209, 0x3a000000, v209
 v_mul_f32 v210, 0x3a000000, v210
 v_mul_f32 v211, 0x3a000000, v211
 v_cos_f32 v212, v208
 s_waitcnt lgkmcnt(4)
 v_mfma_f32_32x32x16_bf16 v[72:87], a[16:19], a[104:107], v[72:87]
 ds_read_b64_tr_b16 a[8:9], v244 offset:2048
 ds_read_b64_tr_b16 a[10:11], v244 offset:2560
 v_cos_f32 v213, v209
 v_cos_f32 v214, v210
 v_cos_f32 v215, v211
 v_sin_f32 v208, v208
 v_mfma_f32_32x32x16_bf16 v[88:103], a[20:23], a[104:107], v[88:103]
 ds_read_b64_tr_b16 a[12:13], v245 offset:2048
 ds_read_b64_tr_b16 a[14:15], v245 offset:2560
 buffer_load_dwordx4 v7, s[12:15], s60 offen offset:1280  lds
 v_sin_f32 v209, v209
 v_sin_f32 v210, v210
 v_sin_f32 v211, v211
 v_mul_f32 v212, 0x3672b9d6, v212
 v_mfma_f32_32x32x16_bf16 v[72:87], a[24:27], a[108:111], v[72:87]
 ds_read_b64_tr_b16 a[16:17], v244 offset:4096
 ds_read_b64_tr_b16 a[18:19], v244 offset:4608
 v_mul_f32 v213, 0x3672b9d6, v213
 v_mul_f32 v214, 0x3672b9d6, v214
 v_mul_f32 v215, 0x3672b9d6, v215
 v_mul_f32 v208, 0x3672b9d6, v208
 v_mfma_f32_32x32x16_bf16 v[88:103], a[28:31], a[108:111], v[88:103]
 ds_read_b64_tr_b16 a[20:21], v245 offset:4096
 ds_read_b64_tr_b16 a[22:23], v245 offset:4608
 v_mul_f32 v209, 0x3672b9d6, v209
 v_mul_f32 v210, 0x3672b9d6, v210
 v_mul_f32 v211, 0x3672b9d6, v211
 v_cvt_pk_bf16_f32 v216, v212, v213
 s_waitcnt vmcnt(5)
 s_waitcnt lgkmcnt(4)
 v_mfma_f32_32x32x16_bf16 v[104:119], a[0:3], a[160:163], v[104:119]
 ds_read_b64_tr_b16 a[24:25], v244 offset:6144
 ds_read_b64_tr_b16 a[26:27], v244 offset:6656
 v_cvt_pk_bf16_f32 v217, v214, v215
 v_cvt_pk_bf16_f32 v218, v208, v209
 v_cvt_pk_bf16_f32 v219, v210, v211
 v_xor_b32 v220, 0x80008000, v218
 v_mfma_f32_32x32x16_bf16 v[120:135], a[4:7], a[160:163], v[120:135]
 ds_read_b64_tr_b16 a[28:29], v245 offset:6144
 s_add_u32 m0, s64, 48896
 ds_read_b64_tr_b16 a[30:31], v245 offset:6656
 buffer_load_dwordx4 v6, s[12:15], s61 offen offset:256  lds
 v_xor_b32 v221, 0x80008000, v219
 v_and_b32 v208, 1, v207
 v_lshlrev_b32 v208, 4, v208
 v_mov_b32 v209, 0x3f80
 v_mfma_f32_32x32x16_bf16 v[104:119], a[8:11], a[164:167], v[104:119]
 ds_read_b64_tr_b16 a[0:1], v244 offset:8192
 ds_read_b64_tr_b16 a[2:3], v244 offset:8704
 v_lshlrev_b32 v208, v208, v209
 v_and_b32 v207, -2, v207
 v_cmp_eq_u32 vcc, 0, v207
 s_nop 1
 v_cndmask_b32 v222, 0, v208, vcc
 v_mfma_f32_32x32x16_bf16 v[120:135], a[12:15], a[164:167], v[120:135]
 ds_read_b64_tr_b16 a[4:5], v245 offset:8192
 ds_read_b64_tr_b16 a[6:7], v245 offset:8704
 v_cmp_eq_u32 vcc, 2, v207
 s_nop 1
 v_cndmask_b32 v223, 0, v208, vcc
 s_waitcnt lgkmcnt(4)
 v_mfma_f32_32x32x16_bf16 v[104:119], a[16:19], a[168:171], v[104:119]
 ds_read_b64_tr_b16 a[8:9], v244 offset:10240
 ds_read_b64_tr_b16 a[10:11], v244 offset:10752
 ds_write_b64 v206, v[216:217] offset:0
 v_mfma_f32_32x32x16_bf16 v[120:135], a[20:23], a[168:171], v[120:135]
 ds_read_b64_tr_b16 a[12:13], v245 offset:10240
 ds_read_b64_tr_b16 a[14:15], v245 offset:10752
 buffer_load_dwordx4 v7, s[12:15], s61 offen offset:1280  lds
 s_bitcmp1_b32 s44, 3
 s_cbranch_scc0 ON_58
 v_mov_b32 v249, 1
 s_mov_b64 exec, 1
 buffer_store_dwordx2 v[248:249], off, s[16:19], s11 sc1
 s_mov_b64 exec, -1
ON_58:
 v_mfma_f32_32x32x16_bf16 v[104:119], a[24:27], a[172:175], v[104:119]
 ds_read_b64_tr_b16 a[16:17], v244 offset:12288
 ds_read_b64_tr_b16 a[18:19], v244 offset:12800
 ds_write_b64 v206, v[218:219] offset:2048
 v_mfma_f32_32x32x16_bf16 v[120:135], a[28:31], a[172:175], v[120:135]
 ds_read_b64_tr_b16 a[20:21], v245 offset:12288
 ds_read_b64_tr_b16 a[22:23], v245 offset:12800
 s_waitcnt lgkmcnt(5)
 v_mfma_f32_32x32x16_bf16 v[72:87], a[0:3], a[32:35], v[72:87]
 ds_read_b64_tr_b16 a[24:25], v244 offset:14336
 ds_read_b64_tr_b16 a[26:27], v244 offset:14848
 ds_write_b64 v206, v[220:221] offset:4096
 v_mfma_f32_32x32x16_bf16 v[88:103], a[4:7], a[32:35], v[88:103]
 ds_read_b64_tr_b16 a[28:29], v245 offset:14336
 s_add_u32 m0, s64, 57088
 ds_read_b64_tr_b16 a[30:31], v245 offset:14848
 buffer_load_dwordx4 v6, s[12:15], s62 offen offset:256  lds
 v_mfma_f32_32x32x16_bf16 v[72:87], a[8:11], a[36:39], v[72:87]
 ds_read_b64_tr_b16 a[0:1], v244 offset:16384
 ds_read_b64_tr_b16 a[2:3], v244 offset:16896
 ds_write_b64 v206, v[222:223] offset:6144
 v_mfma_f32_32x32x16_bf16 v[88:103], a[12:15], a[36:39], v[88:103]
 ds_read_b64_tr_b16 a[4:5], v245 offset:16384
 ds_read_b64_tr_b16 a[6:7], v245 offset:16896
 s_add_u32 s69, s66, 0
 s_waitcnt lgkmcnt(5)
 v_mfma_f32_32x32x16_bf16 v[72:87], a[16:19], a[40:43], v[72:87]
 ds_read_b64_tr_b16 a[8:9], v244 offset:18432
 ds_read_b64_tr_b16 a[10:11], v244 offset:18944
 v_cvt_pk_bf16_f32 v224, v104, v105
 s_lshl_b32 s67, s43, 1
 s_and_b32 s39, s42, 1
 v_mfma_f32_32x32x16_bf16 v[88:103], a[20:23], a[40:43], v[88:103]
 ds_read_b64_tr_b16 a[12:13], v245 offset:18432
 ds_read_b64_tr_b16 a[14:15], v245 offset:18944
 buffer_load_dwordx4 v7, s[12:15], s62 offen offset:1280  lds
 v_cvt_pk_bf16_f32 v225, v106, v107
 s_add_u32 s67, s67, s39
 s_mul_i32 s67, s67, 128
 s_lshr_b32 s39, s42, 1
 v_mfma_f32_32x32x16_bf16 v[72:87], a[24:27], a[44:47], v[72:87]
 ds_read_b64_tr_b16 a[16:17], v244 offset:20480
 ds_read_b64_tr_b16 a[18:19], v244 offset:20992
 v_cvt_pk_bf16_f32 v226, v108, v109
 s_mul_i32 s39, s39, 4
 s_add_u32 s67, s67, s39
 v_mfma_f32_32x32x16_bf16 v[88:103], a[28:31], a[44:47], v[88:103]
 ds_read_b64_tr_b16 a[20:21], v245 offset:20480
 ds_read_b64_tr_b16 a[22:23], v245 offset:20992
 s_add_u32 s67, s67, 42610688
 s_lshl_b32 s52, s41, 2
 s_waitcnt lgkmcnt(4)
 v_mfma_f32_32x32x16_bf16 v[72:87], a[0:3], a[112:115], v[72:87]
 ds_read_b64_tr_b16 a[24:25], v244 offset:22528
 ds_read_b64_tr_b16 a[26:27], v244 offset:23040
 v_cvt_pk_bf16_f32 v227, v110, v111
 s_lshr_b32 s38, s42, 2
 s_add_u32 s52, s52, s38
 s_and_b32 s65, s42, 3
 v_mfma_f32_32x32x16_bf16 v[88:103], a[4:7], a[112:115], v[88:103]
 ds_read_b64_tr_b16 a[28:29], v245 offset:22528
 s_add_u32 m0, s64, 65280
 ds_read_b64_tr_b16 a[30:31], v245 offset:23040
 buffer_load_dwordx4 v6, s[12:15], s63 offen offset:256  lds
 buffer_store_dwordx4 v[224:227], v0, s[16:19], s69 offen offset:0 sc1
 s_min_u32 s65, s65, 2
 s_mul_i32 s38, s40, 3
 v_mfma_f32_32x32x16_bf16 v[72:87], a[8:11], a[116:119], v[72:87]
 s_barrier
 ds_read_b64_tr_b16 a[0:1], v244 offset:24576
 ds_read_b64_tr_b16 a[2:3], v244 offset:25088
 v_cvt_pk_bf16_f32 v228, v112, v113
 s_add_u32 s65, s65, s38
 s_min_u32 s65, s65, 8
 v_mfma_f32_32x32x16_bf16 v[88:103], a[12:15], a[116:119], v[88:103]
 ds_read_b64_tr_b16 a[4:5], v245 offset:24576
 ds_read_b64_tr_b16 a[6:7], v245 offset:25088
 v_cvt_pk_bf16_f32 v229, v114, v115
 s_mul_i32 s39, s65, 3
 s_lshr_b32 s46, 0x6ff69fe, s39
 s_and_b32 s46, s46, 7
 s_waitcnt lgkmcnt(4)
 v_mfma_f32_32x32x16_bf16 v[72:87], a[16:19], a[120:123], v[72:87]
 ds_read_b64_tr_b16 a[8:9], v244 offset:26624
 ds_read_b64_tr_b16 a[10:11], v244 offset:27136
 v_cvt_pk_bf16_f32 v230, v116, v117
 s_lshr_b32 s47, 0x496cb64, s39
 s_and_b32 s47, s47, 7
 v_mfma_f32_32x32x16_bf16 v[88:103], a[20:23], a[120:123], v[88:103]
 ds_read_b64_tr_b16 a[12:13], v245 offset:26624
 ds_read_b64_tr_b16 a[14:15], v245 offset:27136
 buffer_load_dwordx4 v7, s[12:15], s63 offen offset:1280  lds
 v_cvt_pk_bf16_f32 v231, v118, v119
 s_lshr_b32 s38, 0x2912122, s39
 s_and_b32 s38, s38, 7
 v_mfma_f32_32x32x16_bf16 v[72:87], a[24:27], a[124:127], v[72:87]
 ds_read_b64_tr_b16 a[16:17], v244 offset:28672
 ds_read_b64_tr_b16 a[18:19], v244 offset:29184
 buffer_store_dwordx4 v[228:231], v0, s[16:19], s69 offen offset:1024 sc1
 s_lshl_b32 s53, 1, s38
 s_lshr_b32 s38, 0x1249249, s39
 s_and_b32 s38, s38, 7
 v_mfma_f32_32x32x16_bf16 v[88:103], a[28:31], a[124:127], v[88:103]
 ds_read_b64_tr_b16 a[20:21], v245 offset:28672
 ds_read_b64_tr_b16 a[22:23], v245 offset:29184
 s_bitset1_b32 s53, s38
 s_bitcmp1_b32 s44, 5
 s_cselect_b32 s53, s53, 0
 s_waitcnt lgkmcnt(4)
 v_mfma_f32_32x32x16_bf16 v[72:87], a[0:3], a[128:131], v[72:87]
 ds_read_b64_tr_b16 a[24:25], v244 offset:30720
 ds_read_b64_tr_b16 a[26:27], v244 offset:31232
 s_add_u32 s69, s66, 16384
 s_mul_i32 s39, s52, 256
 v_mfma_f32_32x32x16_bf16 v[88:103], a[4:7], a[128:131], v[88:103]
 ds_read_b64_tr_b16 a[28:29], v245 offset:30720
 s_add_u32 m0, s64, 73344
 ds_read_b64_tr_b16 a[30:31], v245 offset:31232
 buffer_load_dwordx4 v6, s[12:15], s56 offen offset:384  lds
 v_cvt_pk_bf16_f32 v232, v120, v121
 s_add_u32 s39, s39, 42610816
 s_cmp_eq_u32 s65, 8
 s_cselect_b32 s38, 0, 128
 v_mfma_f32_32x32x16_bf16 v[72:87], a[8:11], a[132:135], v[72:87]
 ds_read_b64_tr_b16 a[0:1], v244 offset:32768
 ds_read_b64_tr_b16 a[2:3], v244 offset:33280
 v_cvt_pk_bf16_f32 v233, v122, v123
 s_sub_u32 s38, s39, s38
 s_mul_i32 s50, s52, 18
 v_mfma_f32_32x32x16_bf16 v[88:103], a[12:15], a[132:135], v[88:103]
 ds_read_b64_tr_b16 a[4:5], v245 offset:32768
 ds_read_b64_tr_b16 a[6:7], v245 offset:33280
 v_cvt_pk_bf16_f32 v234, v124, v125
 s_add_u32 s50, s50, s65
 s_lshl_b32 s50, s50, 14
 s_add_u32 s50, s50, 18874368
 s_waitcnt lgkmcnt(4)
 v_mfma_f32_32x32x16_bf16 v[72:87], a[16:19], a[136:139], v[72:87]
 ds_read_b64_tr_b16 a[8:9], v244 offset:34816
 ds_read_b64_tr_b16 a[10:11], v244 offset:35328
 v_cvt_pk_bf16_f32 v235, v126, v127
 s_lshl_b32 s4, s65, 6
 v_mfma_f32_32x32x16_bf16 v[88:103], a[20:23], a[136:139], v[88:103]
 ds_read_b64_tr_b16 a[12:13], v245 offset:34816
 ds_read_b64_tr_b16 a[14:15], v245 offset:35328
 buffer_load_dwordx4 v7, s[12:15], s56 offen offset:1408  lds
 buffer_store_dwordx4 v[232:235], v0, s[16:19], s69 offen offset:0 sc1
 v_mfma_f32_32x32x16_bf16 v[72:87], a[24:27], a[140:143], v[72:87]
 ds_read_b64_tr_b16 a[16:17], v244 offset:36864
 ds_read_b64_tr_b16 a[18:19], v244 offset:37376
 v_cvt_pk_bf16_f32 v236, v128, v129
 s_bitcmp1_b32 0xf, s65
 s_cselect_b32 s48, s39, s38
 s_cselect_b32 s49, s38, s39
 s_cselect_b32 s36, -1.0, 1.0
 s_cselect_b32 s37, 1.0, -1.0
 s_cselect_b32 s38, 147456, 0
 s_cselect_b32 s39, 576, 0
 v_mfma_f32_32x32x16_bf16 v[88:103], a[28:31], a[140:143], v[88:103]
 ds_read_b64_tr_b16 a[20:21], v245 offset:36864
 ds_read_b64_tr_b16 a[22:23], v245 offset:37376
 s_add_u32 s51, s50, 147456
 s_waitcnt lgkmcnt(4)
 v_mfma_f32_32x32x16_bf16 v[72:87], a[0:3], a[144:147], v[72:87]
 ds_read_b64_tr_b16 a[24:25], v244 offset:38912
 ds_read_b64_tr_b16 a[26:27], v244 offset:39424
 v_cvt_pk_bf16_f32 v237, v130, v131
 s_sub_u32 s51, s51, s38
 s_add_u32 s50, s50, s38
 v_mfma_f32_32x32x16_bf16 v[88:103], a[4:7], a[144:147], v[88:103]
 ds_read_b64_tr_b16 a[28:29], v245 offset:38912
 s_add_u32 m0, s64, 81536
 ds_read_b64_tr_b16 a[30:31], v245 offset:39424
 buffer_load_dwordx4 v6, s[12:15], s57 offen offset:384  lds
 v_cvt_pk_bf16_f32 v238, v132, v133
 s_add_u32 s5, s4, 576
 s_sub_u32 s5, s5, s39
 s_add_u32 s4, s4, s39
 v_mfma_f32_32x32x16_bf16 v[72:87], a[8:11], a[148:151], v[72:87]
 ds_read_b64_tr_b16 a[0:1], v244 offset:40960
 ds_read_b64_tr_b16 a[2:3], v244 offset:41472
 v_cvt_pk_bf16_f32 v239, v134, v135
 s_add_u32 s6, s4, 1179648
 s_add_u32 s7, s5, 1179648
 v_mfma_f32_32x32x16_bf16 v[88:103], a[12:15], a[148:151], v[88:103]
 ds_read_b64_tr_b16 a[4:5], v245 offset:40960
 ds_read_b64_tr_b16 a[6:7], v245 offset:41472
 buffer_store_dwordx4 v[236:239], v0, s[16:19], s69 offen offset:1024 sc1
 s_sub_u32 s38, s46, 4
 s_mul_i32 s38, s38, 16384
 s_waitcnt lgkmcnt(4)
 v_mfma_f32_32x32x16_bf16 v[72:87], a[16:19], a[152:155], v[72:87]
 ds_read_b64_tr_b16 a[8:9], v244 offset:43008
 ds_read_b64_tr_b16 a[10:11], v244 offset:43520
 s_add_u32 s48, s48, s38
 s_sub_u32 s38, s47, 4
 s_mul_i32 s38, s38, 16384
 v_mfma_f32_32x32x16_bf16 v[88:103], a[20:23], a[152:155], v[88:103]
 ds_read_b64_tr_b16 a[12:13], v245 offset:43008
 ds_read_b64_tr_b16 a[14:15], v245 offset:43520
 buffer_load_dwordx4 v7, s[12:15], s57 offen offset:1408  lds
 s_add_u32 s49, s49, s38
 s_add_u32 s46, s46, s45
 v_mfma_f32_32x32x16_bf16 v[72:87], a[24:27], a[156:159], v[72:87]
 ds_read_b64_tr_b16 a[16:17], v244 offset:45056
 ds_read_b64_tr_b16 a[18:19], v244 offset:45568
 s_add_u32 s47, s47, s45
 v_and_b32 v4, 7, v2
 v_mfma_f32_32x32x16_bf16 v[88:103], a[28:31], a[156:159], v[88:103]
 ds_read_b64_tr_b16 a[20:21], v245 offset:45056
 ds_read_b64_tr_b16 a[22:23], v245 offset:45568
 v_lshlrev_b32 v4, 2, v4
 v_lshrrev_b32 v5, 2, v2
 s_mov_b32 s38, 73728
 s_waitcnt lgkmcnt(4)
 v_mfma_f32_32x32x16_bf16 v[72:87], a[0:3], a[160:163], v[72:87]
 ds_read_b64_tr_b16 a[24:25], v244 offset:47104
 ds_read_b64_tr_b16 a[26:27], v244 offset:47616
 v_mul_lo_u32 v5, v5, s38
 v_and_b32 v206, 3, v2
 v_mfma_f32_32x32x16_bf16 v[88:103], a[4:7], a[160:163], v[88:103]
 ds_read_b64_tr_b16 a[28:29], v245 offset:47104
 s_add_u32 m0, s64, 89728
 ds_read_b64_tr_b16 a[30:31], v245 offset:47616
 buffer_load_dwordx4 v6, s[12:15], s58 offen offset:384  lds
 v_lshl_add_u32 v5, v206, 4, v5
 s_mul_i32 s38, s52, 1152
 v_mfma_f32_32x32x16_bf16 v[72:87], a[8:11], a[164:167], v[72:87]
 s_barrier
 ds_read_b64_tr_b16 a[0:1], v240 offset:0
 ds_read_b64_tr_b16 a[2:3], v240 offset:512
 v_add_u32 v5, s38, v5
 s_mul_i32 s54, s52, 36864
 s_mul_i32 s38, s40, 12288
 v_mfma_f32_32x32x16_bf16 v[88:103], a[12:15], a[164:167], v[88:103]
 ds_read_b64_tr_b16 a[4:5], v241 offset:0
 ds_read_b64_tr_b16 a[6:7], v241 offset:512
 s_add_u32 s54, s54, s38
 s_add_u32 s54, s54, 40108032
 s_waitcnt lgkmcnt(4)
 v_mfma_f32_32x32x16_bf16 v[72:87], a[16:19], a[168:171], v[72:87]
 ds_read_b64_tr_b16 a[8:9], v240 offset:2048
 ds_read_b64_tr_b16 a[10:11], v240 offset:2560
 s_add_u32 s10, s66, 32768
 v_mfma_f32_32x32x16_bf16 v[88:103], a[20:23], a[168:171], v[88:103]
 ds_read_b64_tr_b16 a[12:13], v241 offset:2048
 ds_read_b64_tr_b16 a[14:15], v241 offset:2560
 buffer_load_dwordx4 v7, s[12:15], s58 offen offset:1408  lds
 v_mfma_f32_32x32x16_bf16 v[72:87], a[24:27], a[172:175], v[72:87]
 ds_read_b64_tr_b16 a[16:17], v240 offset:4096
 ds_read_b64_tr_b16 a[18:19], v240 offset:4608
 v_mfma_f32_32x32x16_bf16 v[88:103], a[28:31], a[172:175], v[88:103]
 ds_read_b64_tr_b16 a[20:21], v241 offset:4096
 ds_read_b64_tr_b16 a[22:23], v241 offset:4608
L_s9:
 s_mov_b64 exec, 0
 s_cmp_eq_u32 s40, 1
 s_cbranch_scc1 ST3_1
 s_cmp_eq_u32 s40, 2
 s_cbranch_scc1 ST3_2
 s_cmp_eq_u32 s40, 3
 s_cbranch_scc1 ST3_3
 s_branch ST3_0
STB3_0:
 s_mov_b64 exec, -1
 s_waitcnt lgkmcnt(4)
 v_mfma_f32_32x32x16_bf16 v[104:119], a[0:3], a[48:51], 0
 ds_read_b64_tr_b16 a[24:25], v240 offset:6144
 ds_read_b64_tr_b16 a[26:27], v240 offset:6656
 v_mfma_f32_32x32x16_bf16 v[120:135], a[4:7], a[48:51], 0
 ds_read_b64_tr_b16 a[28:29], v241 offset:6144
 s_add_u32 m0, s64, 97920
 ds_read_b64_tr_b16 a[30:31], v241 offset:6656
 buffer_load_dwordx4 v6, s[12:15], s59 offen offset:384  lds
 v_mfma_f32_32x32x16_bf16 v[104:119], a[8:11], a[52:55], v[104:119]
 ds_read_b64_tr_b16 a[0:1], v240 offset:8192
 ds_read_b64_tr_b16 a[2:3], v240 offset:8704
 v_mfma_f32_32x32x16_bf16 v[120:135], a[12:15], a[52:55], v[120:135]
 ds_read_b64_tr_b16 a[4:5], v241 offset:8192
 ds_read_b64_tr_b16 a[6:7], v241 offset:8704
 s_add_u32 s69, s10, 0
 s_waitcnt lgkmcnt(4)
 v_mfma_f32_32x32x16_bf16 v[104:119], a[16:19], a[56:59], v[104:119]
 ds_read_b64_tr_b16 a[8:9], v240 offset:10240
 ds_read_b64_tr_b16 a[10:11], v240 offset:10752
 v_cvt_pk_bf16_f32 v224, v72, v73
 v_mfma_f32_32x32x16_bf16 v[120:135], a[20:23], a[56:59], v[120:135]
 ds_read_b64_tr_b16 a[12:13], v241 offset:10240
 ds_read_b64_tr_b16 a[14:15], v241 offset:10752
 buffer_load_dwordx4 v7, s[12:15], s59 offen offset:1408  lds
 v_mfma_f32_32x32x16_bf16 v[104:119], a[24:27], a[60:63], v[104:119]
 ds_read_b64_tr_b16 a[16:17], v240 offset:12288
 ds_read_b64_tr_b16 a[18:19], v240 offset:12800
 v_cvt_pk_bf16_f32 v225, v74, v75
 v_mfma_f32_32x32x16_bf16 v[120:135], a[28:31], a[60:63], v[120:135]
 ds_read_b64_tr_b16 a[20:21], v241 offset:12288
 ds_read_b64_tr_b16 a[22:23], v241 offset:12800
 v_cvt_pk_bf16_f32 v226, v76, v77
 s_waitcnt lgkmcnt(4)
 v_mfma_f32_32x32x16_bf16 v[104:119], a[0:3], a[64:67], v[104:119]
 ds_read_b64_tr_b16 a[24:25], v240 offset:14336
 ds_read_b64_tr_b16 a[26:27], v240 offset:14848
 v_cvt_pk_bf16_f32 v227, v78, v79
 v_mfma_f32_32x32x16_bf16 v[120:135], a[4:7], a[64:67], v[120:135]
 ds_read_b64_tr_b16 a[28:29], v241 offset:14336
 s_add_u32 m0, s64, 106112
 ds_read_b64_tr_b16 a[30:31], v241 offset:14848
 buffer_load_dwordx4 v6, s[12:15], s55 offen offset:384  lds
 buffer_store_dwordx4 v[224:227], v0, s[16:19], s69 offen offset:0 sc1
 v_mfma_f32_32x32x16_bf16 v[104:119], a[8:11], a[68:71], v[104:119]
 ds_read_b64_tr_b16 a[0:1], v240 offset:16384
 ds_read_b64_tr_b16 a[2:3], v240 offset:16896
 v_cvt_pk_bf16_f32 v228, v80, v81
 v_mfma_f32_32x32x16_bf16 v[120:135], a[12:15], a[68:71], v[120:135]
 ds_read_b64_tr_b16 a[4:5], v241 offset:16384
 ds_read_b64_tr_b16 a[6:7], v241 offset:16896
 s_waitcnt lgkmcnt(4)
 v_mfma_f32_32x32x16_bf16 v[104:119], a[16:19], a[72:75], v[104:119]
 ds_read_b64_tr_b16 a[8:9], v240 offset:18432
 ds_read_b64_tr_b16 a[10:11], v240 offset:18944
 v_cvt_pk_bf16_f32 v229, v82, v83
 v_mfma_f32_32x32x16_bf16 v[120:135], a[20:23], a[72:75], v[120:135]
 ds_read_b64_tr_b16 a[12:13], v241 offset:18432
 ds_read_b64_tr_b16 a[14:15], v241 offset:18944
 buffer_load_dwordx4 v7, s[12:15], s55 offen offset:1408  lds
 v_cvt_pk_bf16_f32 v230, v84, v85
 v_mfma_f32_32x32x16_bf16 v[104:119], a[24:27], a[76:79], v[104:119]
 ds_read_b64_tr_b16 a[16:17], v240 offset:20480
 ds_read_b64_tr_b16 a[18:19], v240 offset:20992
 v_cvt_pk_bf16_f32 v231, v86, v87
 v_add_u32 v249, 4, v248
 s_add_u32 s3, s67, 0
 s_waitcnt vmcnt(8)
 s_mov_b64 exec, 1
 buffer_store_dword v249, off, s[16:19], s3 sc1
 s_mov_b64 exec, -1
 v_mfma_f32_32x32x16_bf16 v[120:135], a[28:31], a[76:79], v[120:135]
 ds_read_b64_tr_b16 a[20:21], v241 offset:20480
 ds_read_b64_tr_b16 a[22:23], v241 offset:20992
 buffer_store_dwordx4 v[228:231], v0, s[16:19], s69 offen offset:1024 sc1
 s_waitcnt lgkmcnt(4)
 v_mfma_f32_32x32x16_bf16 v[104:119], a[0:3], a[80:83], v[104:119]
 ds_read_b64_tr_b16 a[24:25], v240 offset:22528
 ds_read_b64_tr_b16 a[26:27], v240 offset:23040
 v_mfma_f32_32x32x16_bf16 v[120:135], a[4:7], a[80:83], v[120:135]
 ds_read_b64_tr_b16 a[28:29], v241 offset:22528
 s_add_u32 m0, s64, 114304
 ds_read_b64_tr_b16 a[30:31], v241 offset:23040
 buffer_load_dwordx4 v6, s[12:15], s60 offen offset:384  lds
 s_add_u32 s69, s10, 16384
 v_mfma_f32_32x32x16_bf16 v[104:119], a[8:11], a[84:87], v[104:119]
 s_barrier
 ds_read_b64_tr_b16 a[0:1], v240 offset:24576
 ds_read_b64_tr_b16 a[2:3], v240 offset:25088
 v_cvt_pk_bf16_f32 v232, v88, v89
 v_mfma_f32_32x32x16_bf16 v[120:135], a[12:15], a[84:87], v[120:135]
 ds_read_b64_tr_b16 a[4:5], v241 offset:24576
 ds_read_b64_tr_b16 a[6:7], v241 offset:25088
 v_cvt_pk_bf16_f32 v233, v90, v91
 s_waitcnt lgkmcnt(4)
 v_mfma_f32_32x32x16_bf16 v[104:119], a[16:19], a[88:91], v[104:119]
 ds_read_b64_tr_b16 a[8:9], v240 offset:26624
 ds_read_b64_tr_b16 a[10:11], v240 offset:27136
 v_cvt_pk_bf16_f32 v234, v92, v93
 v_mfma_f32_32x32x16_bf16 v[120:135], a[20:23], a[88:91], v[120:135]
 ds_read_b64_tr_b16 a[12:13], v241 offset:26624
 ds_read_b64_tr_b16 a[14:15], v241 offset:27136
 buffer_load_dwordx4 v7, s[12:15], s60 offen offset:1408  lds
 v_mfma_f32_32x32x16_bf16 v[104:119], a[24:27], a[92:95], v[104:119]
 ds_read_b64_tr_b16 a[16:17], v240 offset:28672
 ds_read_b64_tr_b16 a[18:19], v240 offset:29184
 v_cvt_pk_bf16_f32 v235, v94, v95
 v_mfma_f32_32x32x16_bf16 v[120:135], a[28:31], a[92:95], v[120:135]
 ds_read_b64_tr_b16 a[20:21], v241 offset:28672
 ds_read_b64_tr_b16 a[22:23], v241 offset:29184
 buffer_store_dwordx4 v[232:235], v0, s[16:19], s69 offen offset:0 sc1
 s_waitcnt lgkmcnt(4)
 v_mfma_f32_32x32x16_bf16 v[104:119], a[0:3], a[96:99], v[104:119]
 ds_read_b64_tr_b16 a[24:25], v240 offset:30720
 ds_read_b64_tr_b16 a[26:27], v240 offset:31232
 v_cvt_pk_bf16_f32 v236, v96, v97
 v_mfma_f32_32x32x16_bf16 v[120:135], a[4:7], a[96:99], v[120:135]
 ds_read_b64_tr_b16 a[28:29], v241 offset:30720
 s_add_u32 m0, s64, 122496
 ds_read_b64_tr_b16 a[30:31], v241 offset:31232
 buffer_load_dwordx4 v6, s[12:15], s61 offen offset:384  lds
 v_cvt_pk_bf16_f32 v237, v98, v99
 v_mfma_f32_32x32x16_bf16 v[104:119], a[8:11], a[100:103], v[104:119]
 ds_read_b64_tr_b16 a[0:1], v240 offset:32768
 ds_read_b64_tr_b16 a[2:3], v240 offset:33280
 v_cvt_pk_bf16_f32 v238, v100, v101
 v_mfma_f32_32x32x16_bf16 v[120:135], a[12:15], a[100:103], v[120:135]
 ds_read_b64_tr_b16 a[4:5], v241 offset:32768
 ds_read_b64_tr_b16 a[6:7], v241 offset:33280
 s_waitcnt lgkmcnt(4)
 v_mfma_f32_32x32x16_bf16 v[104:119], a[16:19], a[104:107], v[104:119]
 ds_read_b64_tr_b16 a[8:9], v240 offset:34816
 ds_read_b64_tr_b16 a[10:11], v240 offset:35328
 v_cvt_pk_bf16_f32 v239, v102, v103
 v_mfma_f32_32x32x16_bf16 v[120:135], a[20:23], a[104:107], v[120:135]
 ds_read_b64_tr_b16 a[12:13], v241 offset:34816
 ds_read_b64_tr_b16 a[14:15], v241 offset:35328
 buffer_load_dwordx4 v7, s[12:15], s61 offen offset:1408  lds
 buffer_store_dwordx4 v[236:239], v0, s[16:19], s69 offen offset:1024 sc1
 v_mfma_f32_32x32x16_bf16 v[104:119], a[24:27], a[108:111], v[104:119]
 ds_read_b64_tr_b16 a[16:17], v240 offset:36864
 ds_read_b64_tr_b16 a[18:19], v240 offset:37376
 v_lshrrev_b32 v246, 5, v2
 v_mfma_f32_32x32x16_bf16 v[120:135], a[28:31], a[108:111], v[120:135]
 ds_read_b64_tr_b16 a[20:21], v241 offset:36864
 ds_read_b64_tr_b16 a[22:23], v241 offset:37376
 v_lshlrev_b32 v246, 3, v246
 s_waitcnt lgkmcnt(4)
 v_mfma_f32_32x32x16_bf16 v[104:119], a[0:3], a[32:35], v[104:119]
 ds_read_b64_tr_b16 a[24:25], v240 offset:38912
 ds_read_b64_tr_b16 a[26:27], v240 offset:39424
 v_add_u32 v1, s4, v246
 v_add_u32 v1, 161792, v1
 v_mfma_f32_32x32x16_bf16 v[120:135], a[4:7], a[32:35], v[120:135]
 ds_read_b64_tr_b16 a[28:29], v241 offset:38912
 s_add_u32 m0, s64, 130688
 ds_read_b64_tr_b16 a[30:31], v241 offset:39424
 buffer_load_dwordx4 v6, s[12:15], s62 offen offset:384  lds
 v_mfma_f32_32x32x16_bf16 v[104:119], a[8:11], a[36:39], v[104:119]
 ds_read_b64_tr_b16 a[0:1], v240 offset:40960
 ds_read_b64_tr_b16 a[2:3], v240 offset:41472
 ds_read_b64 a[208:209], v1 offset:0
 v_mfma_f32_32x32x16_bf16 v[120:135], a[12:15], a[36:39], v[120:135]
 ds_read_b64_tr_b16 a[4:5], v241 offset:40960
 ds_read_b64_tr_b16 a[6:7], v241 offset:41472
 ds_read_b64 a[210:211], v1 offset:16
 s_waitcnt lgkmcnt(6)
 v_mfma_f32_32x32x16_bf16 v[104:119], a[16:19], a[40:43], v[104:119]
 ds_read_b64_tr_b16 a[8:9], v240 offset:43008
 ds_read_b64_tr_b16 a[10:11], v240 offset:43520
 ds_read_b64 a[212:213], v1 offset:32
 v_mfma_f32_32x32x16_bf16 v[120:135], a[20:23], a[40:43], v[120:135]
 ds_read_b64_tr_b16 a[12:13], v241 offset:43008
 ds_read_b64_tr_b16 a[14:15], v241 offset:43520
 buffer_load_dwordx4 v7, s[12:15], s62 offen offset:1408  lds
 ds_read_b64 a[214:215], v1 offset:48
 v_mfma_f32_32x32x16_bf16 v[104:119], a[24:27], a[44:47], v[104:119]
 ds_read_b64_tr_b16 a[16:17], v240 offset:45056
 ds_read_b64_tr_b16 a[18:19], v240 offset:45568
 v_add_u32 v1, s5, v246
 v_add_u32 v1, 161792, v1
 v_mfma_f32_32x32x16_bf16 v[120:135], a[28:31], a[44:47], v[120:135]
ST3_0:
 s_cbranch_execz ST3_4
 ds_read_b64_tr_b16 a[20:21], v241 offset:45056
 ds_read_b64_tr_b16 a[22:23], v241 offset:45568
 ds_read_b64 a[216:217], v1 offset:0
 s_waitcnt lgkmcnt(6)
 v_mfma_f32_32x32x16_bf16 v[104:119], a[0:3], a[112:115], v[104:119]
 ds_read_b64_tr_b16 a[24:25], v240 offset:47104
 ds_read_b64_tr_b16 a[26:27], v240 offset:47616
 v_mfma_f32_32x32x16_bf16 v[120:135], a[4:7], a[112:115], v[120:135]
 ds_read_b64_tr_b16 a[28:29], v241 offset:47104
 s_add_u32 m0, s64, 138880
 ds_read_b64_tr_b16 a[30:31], v241 offset:47616
 buffer_load_dwordx4 v6, s[12:15], s63 offen offset:384  lds
 ds_read_b64 a[218:219], v1 offset:16
 v_mfma_f32_32x32x16_bf16 v[104:119], a[8:11], a[116:119], v[104:119]
 s_barrier
 ds_read_b64_tr_b16 a[0:1], v242 offset:0
 ds_read_b64_tr_b16 a[2:3], v242 offset:512
 ds_read_b64 a[220:221], v1 offset:32
 v_mfma_f32_32x32x16_bf16 v[120:135], a[12:15], a[116:119], v[120:135]
 ds_read_b64_tr_b16 a[4:5], v243 offset:0
 ds_read_b64_tr_b16 a[6:7], v243 offset:512
 ds_read_b64 a[222:223], v1 offset:48
 s_waitcnt lgkmcnt(7)
 v_mfma_f32_32x32x16_bf16 v[104:119], a[16:19], a[120:123], v[104:119]
 ds_read_b64_tr_b16 a[8:9], v242 offset:2048
 ds_read_b64_tr_b16 a[10:11], v242 offset:2560
 v_mfma_f32_32x32x16_bf16 v[120:135], a[20:23], a[120:123], v[120:135]
 ds_read_b64_tr_b16 a[12:13], v243 offset:2048
 ds_read_b64_tr_b16 a[14:15], v243 offset:2560
 buffer_load_dwordx4 v7, s[12:15], s63 offen offset:1408  lds
 s_min_u32 s98, s40, 2
 s_mul_i32 s98, s98, 768
 s_add_u32 s98, s98, 42598400
 v_lshlrev_b32 v204, 3, v2
 v_add_u32 v204, s98, v204
 v_add_u32 v205, 256, v204
 buffer_load_dwordx2 v[200:201], v204, s[16:19], 0 offen sc1
 buffer_load_dwordx2 v[202:203], v205, s[16:19], 0 offen sc1
 v_mfma_f32_32x32x16_bf16 v[104:119], a[24:27], a[124:127], v[104:119]
 ds_read_b64_tr_b16 a[16:17], v242 offset:4096
 ds_read_b64_tr_b16 a[18:19], v242 offset:4608
 v_mfma_f32_32x32x16_bf16 v[120:135], a[28:31], a[124:127], v[120:135]
 ds_read_b64_tr_b16 a[20:21], v243 offset:4096
 ds_read_b64_tr_b16 a[22:23], v243 offset:4608
 s_waitcnt lgkmcnt(4)
 v_mfma_f32_32x32x16_bf16 v[104:119], a[0:3], a[128:131], v[104:119]
 ds_read_b64_tr_b16 a[24:25], v242 offset:6144
 ds_read_b64_tr_b16 a[26:27], v242 offset:6656
 v_mfma_f32_32x32x16_bf16 v[120:135], a[4:7], a[128:131], v[120:135]
 ds_read_b64_tr_b16 a[28:29], v243 offset:6144
 ds_read_b64_tr_b16 a[30:31], v243 offset:6656
 s_add_u32 m0, s64, 0
 s_mov_b32 s96, 0
 v_lshl_add_u64 v[254:255], s[96:97], 0, v[252:253]
 global_load_lds_dwordx4 v[254:255], off
 v_mfma_f32_32x32x16_bf16 v[104:119], a[8:11], a[132:135], v[104:119]
 ds_read_b64_tr_b16 a[0:1], v242 offset:8192
 ds_read_b64_tr_b16 a[2:3], v242 offset:8704
 s_buffer_load_dwordx8 s[20:27], s[16:19], s49 glc
 v_mfma_f32_32x32x16_bf16 v[120:135], a[12:15], a[132:135], v[120:135]
 ds_read_b64_tr_b16 a[4:5], v243 offset:8192
 ds_read_b64_tr_b16 a[6:7], v243 offset:8704
 s_waitcnt lgkmcnt(8)
 v_mfma_f32_32x32x16_bf16 v[104:119], a[16:19], a[136:139], v[104:119]
 ds_read_b64_tr_b16 a[8:9], v242 offset:10240
 ds_read_b64_tr_b16 a[10:11], v242 offset:10752
 v_mfma_f32_32x32x16_bf16 v[120:135], a[20:23], a[136:139], v[120:135]
 ds_read_b64_tr_b16 a[12:13], v243 offset:10240
 ds_read_b64_tr_b16 a[14:15], v243 offset:10752
 global_load_lds_dwordx4 v[254:255], off offset:1024
 s_waitcnt lgkmcnt(8)
 v_mfma_f32_32x32x16_bf16 v[104:119], a[24:27], a[140:143], v[104:119]
 ds_read_b64_tr_b16 a[16:17], v242 offset:12288
 ds_read_b64_tr_b16 a[18:19], v242 offset:12800
 v_add_u32 v249, 5, v248
 s_add_u32 s3, s67, 16384
 s_waitcnt vmcnt(8)
 s_mov_b64 exec, 1
 buffer_store_dword v249, off, s[16:19], s3 sc1
 s_mov_b64 exec, -1
 v_mfma_f32_32x32x16_bf16 v[120:135], a[28:31], a[140:143], v[120:135]
 ds_read_b64_tr_b16 a[20:21], v243 offset:12288
 ds_read_b64_tr_b16 a[22:23], v243 offset:12800
 s_waitcnt lgkmcnt(8)
 v_mfma_f32_32x32x16_bf16 v[104:119], a[0:3], a[144:147], v[104:119]
 ds_read_b64_tr_b16 a[24:25], v242 offset:14336
 ds_read_b64_tr_b16 a[26:27], v242 offset:14848
 v_mfma_f32_32x32x16_bf16 v[120:135], a[4:7], a[144:147], v[120:135]
 ds_read_b64_tr_b16 a[28:29], v243 offset:14336
 ds_read_b64_tr_b16 a[30:31], v243 offset:14848
 s_add_u32 m0, s64, 8192
 s_mov_b32 s96, 8192
 v_lshl_add_u64 v[254:255], s[96:97], 0, v[252:253]
 global_load_lds_dwordx4 v[254:255], off
 s_waitcnt lgkmcnt(8)
 v_mfma_f32_32x32x16_bf16 v[104:119], a[8:11], a[148:151], v[104:119]
 ds_read_b64_tr_b16 a[0:1], v242 offset:16384
 ds_read_b64_tr_b16 a[2:3], v242 offset:16896
 v_mfma_f32_32x32x16_bf16 v[120:135], a[12:15], a[148:151], v[120:135]
 ds_read_b64_tr_b16 a[4:5], v243 offset:16384
 ds_read_b64_tr_b16 a[6:7], v243 offset:16896
 s_waitcnt lgkmcnt(8)
 v_mfma_f32_32x32x16_bf16 v[104:119], a[16:19], a[152:155], v[104:119]
 ds_read_b64_tr_b16 a[8:9], v242 offset:18432
 ds_read_b64_tr_b16 a[10:11], v242 offset:18944
 v_mfma_f32_32x32x16_bf16 v[120:135], a[20:23], a[152:155], v[120:135]
 ds_read_b64_tr_b16 a[12:13], v243 offset:18432
 ds_read_b64_tr_b16 a[14:15], v243 offset:18944
 global_load_lds_dwordx4 v[254:255], off offset:1024
 s_waitcnt lgkmcnt(8)
 v_mfma_f32_32x32x16_bf16 v[104:119], a[24:27], a[156:159], v[104:119]
 ds_read_b64_tr_b16 a[16:17], v242 offset:20480
 ds_read_b64_tr_b16 a[18:19], v242 offset:20992
 v_mfma_f32_32x32x16_bf16 v[120:135], a[28:31], a[156:159], v[120:135]
 ds_read_b64_tr_b16 a[20:21], v243 offset:20480
 ds_read_b64_tr_b16 a[22:23], v243 offset:20992
 s_waitcnt lgkmcnt(8)
 v_mfma_f32_32x32x16_bf16 v[104:119], a[0:3], a[160:163], v[104:119]
 ds_read_b64_tr_b16 a[24:25], v242 offset:22528
 ds_read_b64_tr_b16 a[26:27], v242 offset:23040
 s_waitcnt lgkmcnt(0)
 v_mfma_f32_32x32x16_bf16 v[120:135], a[4:7], a[160:163], v[120:135]
 ds_read_b64_tr_b16 a[28:29], v243 offset:22528
 ds_read_b64_tr_b16 a[30:31], v243 offset:23040
 s_add_u32 m0, s64, 16384
 s_mov_b32 s96, 16384
 v_lshl_add_u64 v[254:255], s[96:97], 0, v[252:253]
 global_load_lds_dwordx4 v[254:255], off
 s_sub_u32 s20, s20, s47
 s_sub_u32 s21, s21, s47
 s_sub_u32 s22, s22, s47
 v_mfma_f32_32x32x16_bf16 v[104:119], a[8:11], a[164:167], v[104:119]
 s_barrier
 ds_read_b64_tr_b16 a[0:1], v242 offset:24576
 ds_read_b64_tr_b16 a[2:3], v242 offset:25088
 s_sub_u32 s23, s23, s47
 s_sub_u32 s24, s24, s47
 s_sub_u32 s25, s25, s47
 v_mfma_f32_32x32x16_bf16 v[120:135], a[12:15], a[164:167], v[120:135]
 ds_read_b64_tr_b16 a[4:5], v243 offset:24576
 ds_read_b64_tr_b16 a[6:7], v243 offset:25088
 s_sub_u32 s26, s26, s47
 s_sub_u32 s27, s27, s47
 s_max_u32 s20, s20, s21
 s_waitcnt lgkmcnt(4)
 v_mfma_f32_32x32x16_bf16 v[104:119], a[16:19], a[168:171], v[104:119]
 ds_read_b64_tr_b16 a[8:9], v242 offset:26624
 ds_read_b64_tr_b16 a[10:11], v242 offset:27136
 s_max_u32 s22, s22, s23
 s_max_u32 s24, s24, s25
 s_max_u32 s26, s26, s27
 v_mfma_f32_32x32x16_bf16 v[120:135], a[20:23], a[168:171], v[120:135]
 ds_read_b64_tr_b16 a[12:13], v243 offset:26624
 ds_read_b64_tr_b16 a[14:15], v243 offset:27136
 global_load_lds_dwordx4 v[254:255], off offset:1024
 s_max_u32 s20, s20, s22
 s_max_u32 s24, s24, s26
 s_max_u32 s20, s20, s24
 v_mfma_f32_32x32x16_bf16 v[104:119], a[24:27], a[172:175], v[104:119]
 ds_read_b64_tr_b16 a[16:17], v242 offset:28672
 ds_read_b64_tr_b16 a[18:19], v242 offset:29184
 s_cmp_gt_u32 s20, 8
 s_cselect_b32 s20, 0, 2
 s_and_b32 s20, s20, s53
 v_mfma_f32_32x32x16_bf16 v[120:135], a[28:31], a[172:175], v[120:135]
 ds_read_b64_tr_b16 a[20:21], v243 offset:28672
 ds_read_b64_tr_b16 a[22:23], v243 offset:29184
 s_mul_i32 s20, s20, 2561
 s_bitset0_b32 s53, 10
 s_xor_b32 s53, s53, s20
 s_bitcmp1_b32 s44, 5
 s_cbranch_scc0 ON_77
 s_waitcnt vmcnt(8)
PC_78:
 v_subrev_u32 v201, 1, v201
 v_cmp_ne_u32 vcc, s45, v200
 v_cmp_lt_u32 s[100:101], 60, v201
 s_nop 1
 s_or_b64 vcc, vcc, s[100:101]
 s_cbranch_scc1 PS_79
PK_80:
 s_waitcnt vmcnt(7)
PC_81:
 v_subrev_u32 v203, 1, v203
 v_cmp_ne_u32 vcc, s45, v202
 v_cmp_lt_u32 s[100:101], 60, v203
 s_nop 1
 s_or_b64 vcc, vcc, s[100:101]
 s_cbranch_scc1 PS_82
PK_83:
ON_77:
 s_bitcmp1_b32 s44, 5
 s_cselect_b32 s11, 0, 1
 s_and_b32 s98, s53, 1024
 s_cbranch_scc1 TW_84
 s_waitcnt lgkmcnt(4)
 v_mfma_f32_32x32x16_bf16 v[72:87], a[0:3], a[48:51], 0
 ds_read_b64_tr_b16 a[24:25], v242 offset:30720
 ds_read_b64_tr_b16 a[26:27], v242 offset:31232
 v_mfma_f32_32x32x16_bf16 v[88:103], a[4:7], a[48:51], 0
 ds_read_b64_tr_b16 a[28:29], v243 offset:30720
 ds_read_b64_tr_b16 a[30:31], v243 offset:31232
 s_cmp_lg_u32 s11, 0
 s_cbranch_scc1 DA_86
 s_add_u32 m0, s64, 24576
 s_nop 0
 buffer_load_dwordx4 v0, s[16:19], s54 offen offset:0 sc1 lds
 buffer_load_dwordx4 v0, s[16:19], s54 offen offset:1024 sc1 lds
DB_87:
 v_mfma_f32_32x32x16_bf16 v[72:87], a[8:11], a[52:55], v[72:87]
 ds_read_b64_tr_b16 a[0:1], v242 offset:32768
 ds_read_b64_tr_b16 a[2:3], v242 offset:33280
 v_mfma_f32_32x32x16_bf16 v[88:103], a[12:15], a[52:55], v[88:103]
 ds_read_b64_tr_b16 a[4:5], v243 offset:32768
 ds_read_b64_tr_b16 a[6:7], v243 offset:33280
 s_add_u32 s69, s66, 65536
 s_waitcnt lgkmcnt(4)
 v_mfma_f32_32x32x16_bf16 v[72:87], a[16:19], a[56:59], v[72:87]
 ds_read_b64_tr_b16 a[8:9], v242 offset:34816
 ds_read_b64_tr_b16 a[10:11], v242 offset:35328
 v_add_u32 v206, 149504, v0
 v_mfma_f32_32x32x16_bf16 v[88:103], a[20:23], a[56:59], v[88:103]
 ds_read_b64_tr_b16 a[12:13], v243 offset:34816
 ds_read_b64_tr_b16 a[14:15], v243 offset:35328
 v_cvt_pk_bf16_f32 v224, v104, v105
 v_mfma_f32_32x32x16_bf16 v[72:87], a[24:27], a[60:63], v[72:87]
 ds_read_b64_tr_b16 a[16:17], v242 offset:36864
 ds_read_b64_tr_b16 a[18:19], v242 offset:37376
 ds_read_b128 a[176:179], v206 offset:0
 v_mfma_f32_32x32x16_bf16 v[88:103], a[28:31], a[60:63], v[88:103]
 ds_read_b64_tr_b16 a[20:21], v243 offset:36864
 ds_read_b64_tr_b16 a[22:23], v243 offset:37376
 v_cvt_pk_bf16_f32 v225, v106, v107
 s_waitcnt lgkmcnt(5)
 v_mfma_f32_32x32x16_bf16 v[72:87], a[0:3], a[64:67], v[72:87]
 ds_read_b64_tr_b16 a[24:25], v242 offset:38912
 ds_read_b64_tr_b16 a[26:27], v242 offset:39424
 ds_read_b128 a[180:183], v206 offset:1024
 v_mfma_f32_32x32x16_bf16 v[88:103], a[4:7], a[64:67], v[88:103]
 ds_read_b64_tr_b16 a[28:29], v243 offset:38912
 ds_read_b64_tr_b16 a[30:31], v243 offset:39424
 s_cmp_lg_u32 s11, 0
 s_cbranch_scc1 DA_88
 s_add_u32 m0, s64, 32768
 s_add_u32 s68, s54, 2048
 buffer_load_dwordx4 v0, s[16:19], s68 offen sc1 lds
 buffer_load_dwordx4 v0, s[16:19], s68 offen offset:1024 sc1 lds
DB_89:
 v_cvt_pk_bf16_f32 v226, v108, v109
 v_mfma_f32_32x32x16_bf16 v[72:87], a[8:11], a[68:71], v[72:87]
 ds_read_b64_tr_b16 a[0:1], v242 offset:40960
 ds_read_b64_tr_b16 a[2:3], v242 offset:41472
 v_cvt_pk_bf16_f32 v227, v110, v111
 ds_read_b128 a[184:187], v206 offset:2048
 v_mfma_f32_32x32x16_bf16 v[88:103], a[12:15], a[68:71], v[88:103]
 ds_read_b64_tr_b16 a[4:5], v243 offset:40960
 ds_read_b64_tr_b16 a[6:7], v243 offset:41472
 ds_read_b128 a[188:191], v206 offset:3072
 s_waitcnt lgkmcnt(6)
 v_mfma_f32_32x32x16_bf16 v[72:87], a[16:19], a[72:75], v[72:87]
 ds_read_b64_tr_b16 a[8:9], v242 offset:43008
 ds_read_b64_tr_b16 a[10:11], v242 offset:43520
 buffer_store_dwordx4 v[224:227], v0, s[16:19], s69 offen offset:0 sc1
 v_mfma_f32_32x32x16_bf16 v[88:103], a[20:23], a[72:75], v[88:103]
 ds_read_b64_tr_b16 a[12:13], v243 offset:43008
 ds_read_b64_tr_b16 a[14:15], v243 offset:43520
 ds_read_b128 a[192:195], v206 offset:4096
 v_mfma_f32_32x32x16_bf16 v[72:87], a[24:27], a[76:79], v[72:87]
 ds_read_b64_tr_b16 a[16:17], v242 offset:45056
 ds_read_b64_tr_b16 a[18:19], v242 offset:45568
 v_cvt_pk_bf16_f32 v228, v112, v113
 v_mfma_f32_32x32x16_bf16 v[88:103], a[28:31], a[76:79], v[88:103]
 ds_read_b64_tr_b16 a[20:21], v243 offset:45056
 ds_read_b64_tr_b16 a[22:23], v243 offset:45568
 v_cvt_pk_bf16_f32 v229, v114, v115
 ds_read_b128 a[196:199], v206 offset:5120
 s_waitcnt lgkmcnt(6)
 v_mfma_f32_32x32x16_bf16 v[72:87], a[0:3], a[80:83], v[72:87]
 ds_read_b64_tr_b16 a[24:25], v242 offset:47104
 ds_read_b64_tr_b16 a[26:27], v242 offset:47616
 v_mfma_f32_32x32x16_bf16 v[88:103], a[4:7], a[80:83], v[88:103]
 ds_read_b64_tr_b16 a[28:29], v243 offset:47104
 ds_read_b64_tr_b16 a[30:31], v243 offset:47616
 s_cmp_lg_u32 s11, 0
 s_cbranch_scc1 DA_90
 s_add_u32 m0, s64, 40960
 s_add_u32 s68, s54, 4096
 buffer_load_dwordx4 v0, s[16:19], s68 offen sc1 lds
 buffer_load_dwordx4 v0, s[16:19], s68 offen offset:1024 sc1 lds
DB_91:
 v_cvt_pk_bf16_f32 v230, v116, v117
 ds_read_b128 a[200:203], v206 offset:6144
 v_mfma_f32_32x32x16_bf16 v[72:87], a[8:11], a[84:87], v[72:87]
 s_barrier
 ds_read_b64_tr_b16 a[0:1], v244 offset:0
 ds_read_b64_tr_b16 a[2:3], v244 offset:512
 v_mfma_f32_32x32x16_bf16 v[88:103], a[12:15], a[84:87], v[88:103]
 ds_read_b64_tr_b16 a[4:5], v245 offset:0
 ds_read_b64_tr_b16 a[6:7], v245 offset:512
 v_cvt_pk_bf16_f32 v231, v118, v119
 ds_read_b128 a[204:207], v206 offset:7168
 s_waitcnt lgkmcnt(6)
 v_mfma_f32_32x32x16_bf16 v[72:87], a[16:19], a[88:91], v[72:87]
 ds_read_b64_tr_b16 a[8:9], v244 offset:2048
 ds_read_b64_tr_b16 a[10:11], v244 offset:2560
 v_mfma_f32_32x32x16_bf16 v[88:103], a[20:23], a[88:91], v[88:103]
 ds_read_b64_tr_b16 a[12:13], v245 offset:2048
 ds_read_b64_tr_b16 a[14:15], v245 offset:2560
 buffer_store_dwordx4 v[228:231], v0, s[16:19], s69 offen offset:1024 sc1
 v_mfma_f32_32x32x16_bf16 v[72:87], a[24:27], a[92:95], v[72:87]
 ds_read_b64_tr_b16 a[16:17], v244 offset:4096
 ds_read_b64_tr_b16 a[18:19], v244 offset:4608
 v_mfma_f32_32x32x16_bf16 v[88:103], a[28:31], a[92:95], v[88:103]
 ds_read_b64_tr_b16 a[20:21], v245 offset:4096
 ds_read_b64_tr_b16 a[22:23], v245 offset:4608
 s_waitcnt lgkmcnt(4)
 v_mfma_f32_32x32x16_bf16 v[72:87], a[0:3], a[96:99], v[72:87]
 ds_read_b64_tr_b16 a[24:25], v244 offset:6144
 ds_read_b64_tr_b16 a[26:27], v244 offset:6656
 s_add_u32 s69, s66, 81920
 v_mfma_f32_32x32x16_bf16 v[88:103], a[4:7], a[96:99], v[88:103]
 ds_read_b64_tr_b16 a[28:29], v245 offset:6144
 ds_read_b64_tr_b16 a[30:31], v245 offset:6656
 s_cmp_lg_u32 s11, 0
 s_cbranch_scc1 DA_92
 s_add_u32 m0, s64, 49152
 s_add_u32 s68, s54, 6144
 buffer_load_dwordx4 v0, s[16:19], s68 offen sc1 lds
 buffer_load_dwordx4 v0, s[16:19], s68 offen offset:1024 sc1 lds
DB_93:
 v_cvt_pk_bf16_f32 v232, v120, v121
 v_mfma_f32_32x32x16_bf16 v[72:87], a[8:11], a[100:103], v[72:87]
 ds_read_b64_tr_b16 a[0:1], v244 offset:8192
 ds_read_b64_tr_b16 a[2:3], v244 offset:8704
 v_cvt_pk_bf16_f32 v233, v122, v123
 s_buffer_load_dwordx8 s[20:27], s[16:19], s49 glc
 v_mfma_f32_32x32x16_bf16 v[88:103], a[12:15], a[100:103], v[88:103]
 ds_read_b64_tr_b16 a[4:5], v245 offset:8192
 ds_read_b64_tr_b16 a[6:7], v245 offset:8704
 v_cvt_pk_bf16_f32 v234, v124, v125
 s_waitcnt lgkmcnt(8)
 v_mfma_f32_32x32x16_bf16 v[72:87], a[16:19], a[104:107], v[72:87]
 ds_read_b64_tr_b16 a[8:9], v244 offset:10240
 ds_read_b64_tr_b16 a[10:11], v244 offset:10752
 v_cvt_pk_bf16_f32 v235, v126, v127
 v_mfma_f32_32x32x16_bf16 v[88:103], a[20:23], a[104:107], v[88:103]
 ds_read_b64_tr_b16 a[12:13], v245 offset:10240
 ds_read_b64_tr_b16 a[14:15], v245 offset:10752
 buffer_store_dwordx4 v[232:235], v0, s[16:19], s69 offen offset:0 sc1
 s_waitcnt lgkmcnt(8)
 v_mfma_f32_32x32x16_bf16 v[72:87], a[24:27], a[108:111], v[72:87]
 ds_read_b64_tr_b16 a[16:17], v244 offset:12288
 ds_read_b64_tr_b16 a[18:19], v244 offset:12800
 v_mfma_f32_32x32x16_bf16 v[88:103], a[28:31], a[108:111], v[88:103]
 ds_read_b64_tr_b16 a[20:21], v245 offset:12288
 ds_read_b64_tr_b16 a[22:23], v245 offset:12800
 v_cvt_pk_bf16_f32 v236, v128, v129
 s_waitcnt lgkmcnt(8)
 v_mfma_f32_32x32x16_bf16 v[72:87], a[0:3], a[32:35], v[72:87]
 ds_read_b64_tr_b16 a[24:25], v244 offset:14336
 ds_read_b64_tr_b16 a[26:27], v244 offset:14848
 v_cvt_pk_bf16_f32 v237, v130, v131
 s_add_u32 s38, s64, 24576
 v_mfma_f32_32x32x16_bf16 v[88:103], a[4:7], a[32:35], v[88:103]
 ds_read_b64_tr_b16 a[28:29], v245 offset:14336
 ds_read_b64_tr_b16 a[30:31], v245 offset:14848
 s_cmp_lg_u32 s11, 0
 s_cbranch_scc1 DA_94
 s_add_u32 m0, s64, 57344
 s_add_u32 s68, s54, 8192
 buffer_load_dwordx4 v0, s[16:19], s68 offen sc1 lds
 buffer_load_dwordx4 v0, s[16:19], s68 offen offset:1024 sc1 lds
DB_95:
 v_cvt_pk_bf16_f32 v238, v132, v133
 v_lshrrev_b32 v6, 5, v2
 v_bfe_u32 v7, v2, 2, 2
 s_waitcnt lgkmcnt(8)
 v_mfma_f32_32x32x16_bf16 v[72:87], a[8:11], a[36:39], v[72:87]
 ds_read_b64_tr_b16 a[0:1], v244 offset:16384
 ds_read_b64_tr_b16 a[2:3], v244 offset:16896
 v_cvt_pk_bf16_f32 v239, v134, v135
 v_lshl_add_u32 v6, v6, 3, v7
 v_mfma_f32_32x32x16_bf16 v[88:103], a[12:15], a[36:39], v[88:103]
 ds_read_b64_tr_b16 a[4:5], v245 offset:16384
 ds_read_b64_tr_b16 a[6:7], v245 offset:16896
 buffer_store_dwordx4 v[236:239], v0, s[16:19], s69 offen offset:1024 sc1
 v_lshlrev_b32 v6, 7, v6
 s_waitcnt lgkmcnt(8)
 v_mfma_f32_32x32x16_bf16 v[72:87], a[16:19], a[40:43], v[72:87]
 ds_read_b64_tr_b16 a[8:9], v244 offset:18432
 ds_read_b64_tr_b16 a[10:11], v244 offset:18944
 v_bfe_u32 v7, v2, 1, 1
 v_lshl_add_u32 v6, v7, 6, v6
 v_mfma_f32_32x32x16_bf16 v[88:103], a[20:23], a[40:43], v[88:103]
 ds_read_b64_tr_b16 a[12:13], v245 offset:18432
 ds_read_b64_tr_b16 a[14:15], v245 offset:18944
 v_bfe_u32 v7, v2, 4, 1
 s_waitcnt lgkmcnt(8)
 v_mfma_f32_32x32x16_bf16 v[72:87], a[24:27], a[44:47], v[72:87]
 ds_read_b64_tr_b16 a[16:17], v244 offset:20480
 ds_read_b64_tr_b16 a[18:19], v244 offset:20992
 v_lshl_add_u32 v6, v7, 4, v6
 v_mfma_f32_32x32x16_bf16 v[88:103], a[28:31], a[44:47], v[88:103]
 ds_read_b64_tr_b16 a[20:21], v245 offset:20480
 ds_read_b64_tr_b16 a[22:23], v245 offset:20992
 v_and_b32 v7, 1, v2
 v_lshl_add_u32 v6, v7, 3, v6
 s_waitcnt lgkmcnt(8)
 v_mfma_f32_32x32x16_bf16 v[72:87], a[0:3], a[112:115], v[72:87]
 ds_read_b64_tr_b16 a[24:25], v244 offset:22528
 ds_read_b64_tr_b16 a[26:27], v244 offset:23040
 v_add_u32 v6, s38, v6
 s_waitcnt lgkmcnt(0)
 v_mfma_f32_32x32x16_bf16 v[88:103], a[4:7], a[112:115], v[88:103]
 ds_read_b64_tr_b16 a[28:29], v245 offset:22528
 ds_read_b64_tr_b16 a[30:31], v245 offset:23040
 s_cmp_lg_u32 s11, 0
 s_cbranch_scc1 DA_96
 s_add_u32 m0, s64, 65536
 s_add_u32 s68, s54, 10240
 buffer_load_dwordx4 v0, s[16:19], s68 offen sc1 lds
 buffer_load_dwordx4 v0, s[16:19], s68 offen offset:1024 sc1 lds
DB_97:
 v_add_u32 v7, s38, v0
 s_sub_u32 s20, s20, s47
 s_sub_u32 s21, s21, s47
 s_sub_u32 s22, s22, s47
 s_sub_u32 s23, s23, s47
 v_mfma_f32_32x32x16_bf16 v[72:87], a[8:11], a[116:119], v[72:87]
 s_waitcnt vmcnt(25)
 s_barrier
 ds_read_b64_tr_b16 a[0:1], v244 offset:24576
 ds_read_b64_tr_b16 a[2:3], v244 offset:25088
 s_lshl_b32 s38, s40, 12
 v_add_u32 v3, s38, v0
 s_sub_u32 s24, s24, s47
 s_sub_u32 s25, s25, s47
 s_sub_u32 s26, s26, s47
 v_mfma_f32_32x32x16_bf16 v[88:103], a[12:15], a[116:119], v[88:103]
 ds_read_b64_tr_b16 a[4:5], v245 offset:24576
 ds_read_b64_tr_b16 a[6:7], v245 offset:25088
 v_add_u32 v1, 73728, v3
 s_sub_u32 s27, s27, s47
 s_max_u32 s20, s20, s21
 s_max_u32 s22, s22, s23
 s_max_u32 s24, s24, s25
 s_waitcnt lgkmcnt(4)
 v_mfma_f32_32x32x16_bf16 v[72:87], a[16:19], a[120:123], v[72:87]
 ds_read_b64_tr_b16 a[8:9], v244 offset:26624
 ds_read_b64_tr_b16 a[10:11], v244 offset:27136
 s_lshl_b32 s38, s40, 14
 s_max_u32 s26, s26, s27
 s_max_u32 s20, s20, s22
 s_max_u32 s24, s24, s26
 v_mfma_f32_32x32x16_bf16 v[88:103], a[20:23], a[120:123], v[88:103]
 ds_read_b64_tr_b16 a[12:13], v245 offset:26624
 ds_read_b64_tr_b16 a[14:15], v245 offset:27136
 s_add_u32 s38, s38, 30720
 v_add_u32 v247, s38, v0
 s_max_u32 s20, s20, s24
 s_bitcmp1_b32 s53, 1
 s_cselect_b32 s20, s20, 0
 s_cmp_gt_u32 s20, 8
 s_cbranch_scc1 BC_98
BK_99:
 s_mov_b32 s20, 0
 v_mfma_f32_32x32x16_bf16 v[72:87], a[24:27], a[124:127], v[72:87]
 ds_read_b64_tr_b16 a[16:17], v244 offset:28672
 ds_read_b64_tr_b16 a[18:19], v244 offset:29184
 s_mov_b32 s39, 0xbfb8aa3b
 s_cmp_gt_u32 s20, 8
 s_cselect_b32 s20, 0, 2
 v_mfma_f32_32x32x16_bf16 v[88:103], a[28:31], a[124:127], v[88:103]
 ds_read_b64_tr_b16 a[20:21], v245 offset:28672
 ds_read_b64_tr_b16 a[22:23], v245 offset:29184
 s_and_b32 s20, s20, s53
 s_mul_i32 s20, s20, 2561
 s_bitset0_b32 s53, 10
 s_xor_b32 s53, s53, s20
 s_branch TX_85
TW_84:
ST3_1:
 s_cbranch_execz ST3_5
 s_waitcnt lgkmcnt(4)
 v_mfma_f32_32x32x16_bf16 v[72:87], a[0:3], a[48:51], 0
 ds_read_b64_tr_b16 a[24:25], v242 offset:30720
 ds_read_b64_tr_b16 a[26:27], v242 offset:31232
 v_mfma_f32_32x32x16_bf16 v[88:103], a[4:7], a[48:51], 0
 ds_read_b64_tr_b16 a[28:29], v243 offset:30720
 ds_read_b64_tr_b16 a[30:31], v243 offset:31232
 s_cmp_lg_u32 s11, 0
 s_cbranch_scc1 DA_100
 s_add_u32 m0, s64, 24576
 s_nop 0
 buffer_load_dwordx4 v0, s[16:19], s54 offen offset:0 sc1 lds
 buffer_load_dwordx4 v0, s[16:19], s54 offen offset:1024 sc1 lds
DB_101:
 s_add_u32 s3, s51, 0
 buffer_load_dwordx4 v[8:11], v0, s[16:19], s3 offen offset:0 sc1
 v_mfma_f32_32x32x16_bf16 v[72:87], a[8:11], a[52:55], v[72:87]
 ds_read_b64_tr_b16 a[0:1], v242 offset:32768
 ds_read_b64_tr_b16 a[2:3], v242 offset:33280
 v_mfma_f32_32x32x16_bf16 v[88:103], a[12:15], a[52:55], v[88:103]
 ds_read_b64_tr_b16 a[4:5], v243 offset:32768
 ds_read_b64_tr_b16 a[6:7], v243 offset:33280
 s_add_u32 s69, s66, 65536
 s_add_u32 s3, s51, 0
 buffer_load_dwordx4 v[12:15], v0, s[16:19], s3 offen offset:1024 sc1
 s_waitcnt lgkmcnt(4)
 v_mfma_f32_32x32x16_bf16 v[72:87], a[16:19], a[56:59], v[72:87]
 ds_read_b64_tr_b16 a[8:9], v242 offset:34816
 ds_read_b64_tr_b16 a[10:11], v242 offset:35328
 v_add_u32 v206, 149504, v0
 v_mfma_f32_32x32x16_bf16 v[88:103], a[20:23], a[56:59], v[88:103]
 ds_read_b64_tr_b16 a[12:13], v243 offset:34816
 ds_read_b64_tr_b16 a[14:15], v243 offset:35328
 v_cvt_pk_bf16_f32 v224, v104, v105
 v_mfma_f32_32x32x16_bf16 v[72:87], a[24:27], a[60:63], v[72:87]
 ds_read_b64_tr_b16 a[16:17], v242 offset:36864
 ds_read_b64_tr_b16 a[18:19], v242 offset:37376
 ds_read_b128 a[176:179], v206 offset:0
 s_add_u32 s3, s51, 0
 buffer_load_dwordx4 v[16:19], v0, s[16:19], s3 offen offset:2048 sc1
 v_mfma_f32_32x32x16_bf16 v[88:103], a[28:31], a[60:63], v[88:103]
 ds_read_b64_tr_b16 a[20:21], v243 offset:36864
 ds_read_b64_tr_b16 a[22:23], v243 offset:37376
 v_cvt_pk_bf16_f32 v225, v106, v107
 s_waitcnt lgkmcnt(5)
 v_mfma_f32_32x32x16_bf16 v[72:87], a[0:3], a[64:67], v[72:87]
 ds_read_b64_tr_b16 a[24:25], v242 offset:38912
 ds_read_b64_tr_b16 a[26:27], v242 offset:39424
 ds_read_b128 a[180:183], v206 offset:1024
 s_add_u32 s3, s51, 0
 buffer_load_dwordx4 v[20:23], v0, s[16:19], s3 offen offset:3072 sc1
 v_mfma_f32_32x32x16_bf16 v[88:103], a[4:7], a[64:67], v[88:103]
 ds_read_b64_tr_b16 a[28:29], v243 offset:38912
 ds_read_b64_tr_b16 a[30:31], v243 offset:39424
 s_cmp_lg_u32 s11, 0
 s_cbranch_scc1 DA_102
 s_add_u32 m0, s64, 32768
 s_add_u32 s68, s54, 2048
 buffer_load_dwordx4 v0, s[16:19], s68 offen sc1 lds
 buffer_load_dwordx4 v0, s[16:19], s68 offen offset:1024 sc1 lds
DB_103:
 v_cvt_pk_bf16_f32 v226, v108, v109
 v_mfma_f32_32x32x16_bf16 v[72:87], a[8:11], a[68:71], v[72:87]
 ds_read_b64_tr_b16 a[0:1], v242 offset:40960
 ds_read_b64_tr_b16 a[2:3], v242 offset:41472
 v_cvt_pk_bf16_f32 v227, v110, v111
 ds_read_b128 a[184:187], v206 offset:2048
 s_add_u32 s3, s51, 4096
 buffer_load_dwordx4 v[24:27], v0, s[16:19], s3 offen offset:0 sc1
 v_mfma_f32_32x32x16_bf16 v[88:103], a[12:15], a[68:71], v[88:103]
 ds_read_b64_tr_b16 a[4:5], v243 offset:40960
 ds_read_b64_tr_b16 a[6:7], v243 offset:41472
 ds_read_b128 a[188:191], v206 offset:3072
 s_waitcnt lgkmcnt(6)
 v_mfma_f32_32x32x16_bf16 v[72:87], a[16:19], a[72:75], v[72:87]
 ds_read_b64_tr_b16 a[8:9], v242 offset:43008
 ds_read_b64_tr_b16 a[10:11], v242 offset:43520
 buffer_store_dwordx4 v[224:227], v0, s[16:19], s69 offen offset:0 sc1
 v_mfma_f32_32x32x16_bf16 v[88:103], a[20:23], a[72:75], v[88:103]
 ds_read_b64_tr_b16 a[12:13], v243 offset:43008
 ds_read_b64_tr_b16 a[14:15], v243 offset:43520
 ds_read_b128 a[192:195], v206 offset:4096
 s_add_u32 s3, s51, 4096
 buffer_load_dwordx4 v[28:31], v0, s[16:19], s3 offen offset:1024 sc1
 v_mfma_f32_32x32x16_bf16 v[72:87], a[24:27], a[76:79], v[72:87]
 ds_read_b64_tr_b16 a[16:17], v242 offset:45056
 ds_read_b64_tr_b16 a[18:19], v242 offset:45568
 v_cvt_pk_bf16_f32 v228, v112, v113
 v_mfma_f32_32x32x16_bf16 v[88:103], a[28:31], a[76:79], v[88:103]
 ds_read_b64_tr_b16 a[20:21], v243 offset:45056
 ds_read_b64_tr_b16 a[22:23], v243 offset:45568
 v_cvt_pk_bf16_f32 v229, v114, v115
 ds_read_b128 a[196:199], v206 offset:5120
 s_add_u32 s3, s51, 4096
 buffer_load_dwordx4 v[32:35], v0, s[16:19], s3 offen offset:2048 sc1
 s_waitcnt lgkmcnt(6)
 v_mfma_f32_32x32x16_bf16 v[72:87], a[0:3], a[80:83], v[72:87]
 ds_read_b64_tr_b16 a[24:25], v242 offset:47104
 ds_read_b64_tr_b16 a[26:27], v242 offset:47616
 v_mfma_f32_32x32x16_bf16 v[88:103], a[4:7], a[80:83], v[88:103]
 ds_read_b64_tr_b16 a[28:29], v243 offset:47104
 ds_read_b64_tr_b16 a[30:31], v243 offset:47616
 s_cmp_lg_u32 s11, 0
 s_cbranch_scc1 DA_104
 s_add_u32 m0, s64, 40960
 s_add_u32 s68, s54, 4096
 buffer_load_dwordx4 v0, s[16:19], s68 offen sc1 lds
 buffer_load_dwordx4 v0, s[16:19], s68 offen offset:1024 sc1 lds
DB_105:
 v_cvt_pk_bf16_f32 v230, v116, v117
 ds_read_b128 a[200:203], v206 offset:6144
 v_mfma_f32_32x32x16_bf16 v[72:87], a[8:11], a[84:87], v[72:87]
 s_barrier
 ds_read_b64_tr_b16 a[0:1], v244 offset:0
 ds_read_b64_tr_b16 a[2:3], v244 offset:512
 s_add_u32 s3, s51, 4096
 buffer_load_dwordx4 v[36:39], v0, s[16:19], s3 offen offset:3072 sc1
 v_mfma_f32_32x32x16_bf16 v[88:103], a[12:15], a[84:87], v[88:103]
ST3_2:
 s_cbranch_execz ST3_6
 ds_read_b64_tr_b16 a[4:5], v245 offset:0
 ds_read_b64_tr_b16 a[6:7], v245 offset:512
 v_cvt_pk_bf16_f32 v231, v118, v119
 ds_read_b128 a[204:207], v206 offset:7168
 s_waitcnt lgkmcnt(6)
 v_mfma_f32_32x32x16_bf16 v[72:87], a[16:19], a[88:91], v[72:87]
 ds_read_b64_tr_b16 a[8:9], v244 offset:2048
 ds_read_b64_tr_b16 a[10:11], v244 offset:2560
 s_add_u32 s3, s51, 8192
 buffer_load_dwordx4 v[40:43], v0, s[16:19], s3 offen offset:0 sc1
 v_mfma_f32_32x32x16_bf16 v[88:103], a[20:23], a[88:91], v[88:103]
 ds_read_b64_tr_b16 a[12:13], v245 offset:2048
 ds_read_b64_tr_b16 a[14:15], v245 offset:2560
 buffer_store_dwordx4 v[228:231], v0, s[16:19], s69 offen offset:1024 sc1
 v_mfma_f32_32x32x16_bf16 v[72:87], a[24:27], a[92:95], v[72:87]
 ds_read_b64_tr_b16 a[16:17], v244 offset:4096
 ds_read_b64_tr_b16 a[18:19], v244 offset:4608
 v_mfma_f32_32x32x16_bf16 v[88:103], a[28:31], a[92:95], v[88:103]
 ds_read_b64_tr_b16 a[20:21], v245 offset:4096
 ds_read_b64_tr_b16 a[22:23], v245 offset:4608
 s_waitcnt lgkmcnt(4)
 v_mfma_f32_32x32x16_bf16 v[72:87], a[0:3], a[96:99], v[72:87]
 ds_read_b64_tr_b16 a[24:25], v244 offset:6144
 ds_read_b64_tr_b16 a[26:27], v244 offset:6656
 s_add_u32 s69, s66, 81920
 v_mfma_f32_32x32x16_bf16 v[88:103], a[4:7], a[96:99], v[88:103]
 ds_read_b64_tr_b16 a[28:29], v245 offset:6144
 ds_read_b64_tr_b16 a[30:31], v245 offset:6656
 s_cmp_lg_u32 s11, 0
 s_cbranch_scc1 DA_106
 s_add_u32 m0, s64, 49152
 s_add_u32 s68, s54, 6144
 buffer_load_dwordx4 v0, s[16:19], s68 offen sc1 lds
 buffer_load_dwordx4 v0, s[16:19], s68 offen offset:1024 sc1 lds
DB_107:
 v_cvt_pk_bf16_f32 v232, v120, v121
 s_add_u32 s3, s51, 8192
 buffer_load_dwordx4 v[44:47], v0, s[16:19], s3 offen offset:1024 sc1
 v_mfma_f32_32x32x16_bf16 v[72:87], a[8:11], a[100:103], v[72:87]
 ds_read_b64_tr_b16 a[0:1], v244 offset:8192
 ds_read_b64_tr_b16 a[2:3], v244 offset:8704
 v_cvt_pk_bf16_f32 v233, v122, v123
 s_buffer_load_dwordx8 s[20:27], s[16:19], s49 glc
 v_mfma_f32_32x32x16_bf16 v[88:103], a[12:15], a[100:103], v[88:103]
 ds_read_b64_tr_b16 a[4:5], v245 offset:8192
 ds_read_b64_tr_b16 a[6:7], v245 offset:8704
 v_cvt_pk_bf16_f32 v234, v124, v125
 s_waitcnt lgkmcnt(8)
 v_mfma_f32_32x32x16_bf16 v[72:87], a[16:19], a[104:107], v[72:87]
 ds_read_b64_tr_b16 a[8:9], v244 offset:10240
 ds_read_b64_tr_b16 a[10:11], v244 offset:10752
 v_cvt_pk_bf16_f32 v235, v126, v127
 s_add_u32 s3, s51, 8192
 buffer_load_dwordx4 v[48:51], v0, s[16:19], s3 offen offset:2048 sc1
 v_mfma_f32_32x32x16_bf16 v[88:103], a[20:23], a[104:107], v[88:103]
 ds_read_b64_tr_b16 a[12:13], v245 offset:10240
 ds_read_b64_tr_b16 a[14:15], v245 offset:10752
 buffer_store_dwordx4 v[232:235], v0, s[16:19], s69 offen offset:0 sc1
 s_waitcnt lgkmcnt(8)
 v_mfma_f32_32x32x16_bf16 v[72:87], a[24:27], a[108:111], v[72:87]
 ds_read_b64_tr_b16 a[16:17], v244 offset:12288
 ds_read_b64_tr_b16 a[18:19], v244 offset:12800
 v_mfma_f32_32x32x16_bf16 v[88:103], a[28:31], a[108:111], v[88:103]
 ds_read_b64_tr_b16 a[20:21], v245 offset:12288
 ds_read_b64_tr_b16 a[22:23], v245 offset:12800
 v_cvt_pk_bf16_f32 v236, v128, v129
 s_add_u32 s3, s51, 8192
 buffer_load_dwordx4 v[52:55], v0, s[16:19], s3 offen offset:3072 sc1
 s_waitcnt lgkmcnt(8)
 v_mfma_f32_32x32x16_bf16 v[72:87], a[0:3], a[32:35], v[72:87]
 ds_read_b64_tr_b16 a[24:25], v244 offset:14336
 ds_read_b64_tr_b16 a[26:27], v244 offset:14848
 v_cvt_pk_bf16_f32 v237, v130, v131
 s_add_u32 s38, s64, 24576
 v_mfma_f32_32x32x16_bf16 v[88:103], a[4:7], a[32:35], v[88:103]
 ds_read_b64_tr_b16 a[28:29], v245 offset:14336
 ds_read_b64_tr_b16 a[30:31], v245 offset:14848
 s_cmp_lg_u32 s11, 0
 s_cbranch_scc1 DA_108
 s_add_u32 m0, s64, 57344
 s_add_u32 s68, s54, 8192
 buffer_load_dwordx4 v0, s[16:19], s68 offen sc1 lds
 buffer_load_dwordx4 v0, s[16:19], s68 offen offset:1024 sc1 lds
DB_109:
 v_cvt_pk_bf16_f32 v238, v132, v133
 v_lshrrev_b32 v6, 5, v2
 v_bfe_u32 v7, v2, 2, 2
 s_waitcnt lgkmcnt(8)
 v_mfma_f32_32x32x16_bf16 v[72:87], a[8:11], a[36:39], v[72:87]
 ds_read_b64_tr_b16 a[0:1], v244 offset:16384
 ds_read_b64_tr_b16 a[2:3], v244 offset:16896
 v_cvt_pk_bf16_f32 v239, v134, v135
 v_lshl_add_u32 v6, v6, 3, v7
 s_add_u32 s3, s51, 12288
 buffer_load_dwordx4 v[56:59], v0, s[16:19], s3 offen offset:0 sc1
 v_mfma_f32_32x32x16_bf16 v[88:103], a[12:15], a[36:39], v[88:103]
 ds_read_b64_tr_b16 a[4:5], v245 offset:16384
 ds_read_b64_tr_b16 a[6:7], v245 offset:16896
 buffer_store_dwordx4 v[236:239], v0, s[16:19], s69 offen offset:1024 sc1
 v_lshlrev_b32 v6, 7, v6
 s_waitcnt lgkmcnt(8)
 v_mfma_f32_32x32x16_bf16 v[72:87], a[16:19], a[40:43], v[72:87]
 ds_read_b64_tr_b16 a[8:9], v244 offset:18432
 ds_read_b64_tr_b16 a[10:11], v244 offset:18944
 v_bfe_u32 v7, v2, 1, 1
 v_lshl_add_u32 v6, v7, 6, v6
 v_mfma_f32_32x32x16_bf16 v[88:103], a[20:23], a[40:43], v[88:103]
 ds_read_b64_tr_b16 a[12:13], v245 offset:18432
 ds_read_b64_tr_b16 a[14:15], v245 offset:18944
 v_bfe_u32 v7, v2, 4, 1
 s_waitcnt lgkmcnt(8)
 v_mfma_f32_32x32x16_bf16 v[72:87], a[24:27], a[44:47], v[72:87]
 ds_read_b64_tr_b16 a[16:17], v244 offset:20480
 ds_read_b64_tr_b16 a[18:19], v244 offset:20992
 v_lshl_add_u32 v6, v7, 4, v6
 s_add_u32 s3, s51, 12288
 buffer_load_dwordx4 v[60:63], v0, s[16:19], s3 offen offset:1024 sc1
 v_mfma_f32_32x32x16_bf16 v[88:103], a[28:31], a[44:47], v[88:103]
 ds_read_b64_tr_b16 a[20:21], v245 offset:20480
 ds_read_b64_tr_b16 a[22:23], v245 offset:20992
 v_and_b32 v7, 1, v2
 v_lshl_add_u32 v6, v7, 3, v6
 s_waitcnt lgkmcnt(8)
 v_mfma_f32_32x32x16_bf16 v[72:87], a[0:3], a[112:115], v[72:87]
 ds_read_b64_tr_b16 a[24:25], v244 offset:22528
 ds_read_b64_tr_b16 a[26:27], v244 offset:23040
 v_add_u32 v6, s38, v6
 s_waitcnt lgkmcnt(0)
 v_mfma_f32_32x32x16_bf16 v[88:103], a[4:7], a[112:115], v[88:103]
 ds_read_b64_tr_b16 a[28:29], v245 offset:22528
 ds_read_b64_tr_b16 a[30:31], v245 offset:23040
 s_cmp_lg_u32 s11, 0
 s_cbranch_scc1 DA_110
 s_add_u32 m0, s64, 65536
 s_add_u32 s68, s54, 10240
 buffer_load_dwordx4 v0, s[16:19], s68 offen sc1 lds
 buffer_load_dwordx4 v0, s[16:19], s68 offen offset:1024 sc1 lds
DB_111:
 v_add_u32 v7, s38, v0
 s_sub_u32 s20, s20, s47
 s_sub_u32 s21, s21, s47
 s_sub_u32 s22, s22, s47
 s_sub_u32 s23, s23, s47
 s_add_u32 s3, s51, 12288
 buffer_load_dwordx4 v[64:67], v0, s[16:19], s3 offen offset:2048 sc1
 v_mfma_f32_32x32x16_bf16 v[72:87], a[8:11], a[116:119], v[72:87]
 s_waitcnt vmcnt(40)
 s_barrier
 ds_read_b64_tr_b16 a[0:1], v244 offset:24576
 ds_read_b64_tr_b16 a[2:3], v244 offset:25088
 s_lshl_b32 s38, s40, 12
 v_add_u32 v3, s38, v0
 s_sub_u32 s24, s24, s47
 s_sub_u32 s25, s25, s47
 s_sub_u32 s26, s26, s47
 v_mfma_f32_32x32x16_bf16 v[88:103], a[12:15], a[116:119], v[88:103]
 ds_read_b64_tr_b16 a[4:5], v245 offset:24576
 ds_read_b64_tr_b16 a[6:7], v245 offset:25088
 v_add_u32 v1, 73728, v3
 s_sub_u32 s27, s27, s47
 s_max_u32 s20, s20, s21
 s_max_u32 s22, s22, s23
 s_max_u32 s24, s24, s25
 s_waitcnt lgkmcnt(4)
 v_mfma_f32_32x32x16_bf16 v[72:87], a[16:19], a[120:123], v[72:87]
 ds_read_b64_tr_b16 a[8:9], v244 offset:26624
 ds_read_b64_tr_b16 a[10:11], v244 offset:27136
 s_lshl_b32 s38, s40, 14
 s_max_u32 s26, s26, s27
 s_max_u32 s20, s20, s22
 s_max_u32 s24, s24, s26
 s_add_u32 s3, s51, 12288
 buffer_load_dwordx4 v[68:71], v0, s[16:19], s3 offen offset:3072 sc1
 v_mfma_f32_32x32x16_bf16 v[88:103], a[20:23], a[120:123], v[88:103]
 ds_read_b64_tr_b16 a[12:13], v245 offset:26624
 ds_read_b64_tr_b16 a[14:15], v245 offset:27136
 s_add_u32 s38, s38, 30720
 v_add_u32 v247, s38, v0
 s_max_u32 s20, s20, s24
 s_bitcmp1_b32 s53, 1
 s_cselect_b32 s20, s20, 0
 s_cmp_gt_u32 s20, 8
 s_cbranch_scc1 BC_112
BK_113:
 s_mov_b32 s20, 0
 v_mfma_f32_32x32x16_bf16 v[72:87], a[24:27], a[124:127], v[72:87]
 ds_read_b64_tr_b16 a[16:17], v244 offset:28672
 ds_read_b64_tr_b16 a[18:19], v244 offset:29184
 s_mov_b32 s39, 0xbfb8aa3b
 s_cmp_gt_u32 s20, 8
 s_cselect_b32 s20, 0, 2
 v_mfma_f32_32x32x16_bf16 v[88:103], a[28:31], a[124:127], v[88:103]
 ds_read_b64_tr_b16 a[20:21], v245 offset:28672
 ds_read_b64_tr_b16 a[22:23], v245 offset:29184
 s_and_b32 s20, s20, s53
 s_mul_i32 s20, s20, 2561
 s_bitset0_b32 s53, 10
 s_xor_b32 s53, s53, s20
TX_85:
 s_and_b32 s98, s53, 1024
 s_cbranch_scc1 TW_114
 s_waitcnt lgkmcnt(4)
 v_mfma_f32_32x32x16_bf16 v[72:87], a[0:3], a[128:131], v[72:87]
 ds_read_b64_tr_b16 a[24:25], v244 offset:30720
 ds_read_b64_tr_b16 a[26:27], v244 offset:31232
 v_mfma_f32_32x32x16_bf16 v[88:103], a[4:7], a[128:131], v[88:103]
 ds_read_b64_tr_b16 a[28:29], v245 offset:30720
 ds_read_b64_tr_b16 a[30:31], v245 offset:31232
 s_add_u32 m0, s64, 73728
 s_mov_b32 s96, 36864
 v_lshl_add_u64 v[254:255], s[96:97], 0, v[252:253]
 global_load_lds_dwordx4 v[254:255], off
 v_mfma_f32_32x32x16_bf16 v[72:87], a[8:11], a[132:135], v[72:87]
 ds_read_b64_tr_b16 a[0:1], v244 offset:32768
 ds_read_b64_tr_b16 a[2:3], v244 offset:33280
 v_mfma_f32_32x32x16_bf16 v[88:103], a[12:15], a[132:135], v[88:103]
 ds_read_b64_tr_b16 a[4:5], v245 offset:32768
 ds_read_b64_tr_b16 a[6:7], v245 offset:33280
 s_barrier
 s_waitcnt lgkmcnt(4)
 v_mfma_f32_32x32x16_bf16 v[72:87], a[16:19], a[136:139], v[72:87]
 ds_read_b64_tr_b16 a[8:9], v244 offset:34816
 ds_read_b64_tr_b16 a[10:11], v244 offset:35328
 v_mfma_f32_32x32x16_bf16 v[88:103], a[20:23], a[136:139], v[88:103]
 ds_read_b64_tr_b16 a[12:13], v245 offset:34816
 ds_read_b64_tr_b16 a[14:15], v245 offset:35328
 global_load_lds_dwordx4 v[254:255], off offset:1024
 v_mfma_f32_32x32x16_bf16 v[72:87], a[24:27], a[140:143], v[72:87]
 ds_read_b64_tr_b16 a[16:17], v244 offset:36864
 ds_read_b64_tr_b16 a[18:19], v244 offset:37376
 v_mfma_f32_32x32x16_bf16 v[88:103], a[28:31], a[140:143], v[88:103]
 ds_read_b64_tr_b16 a[20:21], v245 offset:36864
 ds_read_b64_tr_b16 a[22:23], v245 offset:37376
 s_waitcnt lgkmcnt(4)
 v_mfma_f32_32x32x16_bf16 v[72:87], a[0:3], a[144:147], v[72:87]
 ds_read_b64_tr_b16 a[24:25], v244 offset:38912
 ds_read_b64_tr_b16 a[26:27], v244 offset:39424
 v_mfma_f32_32x32x16_bf16 v[88:103], a[4:7], a[144:147], v[88:103]
 ds_read_b64_tr_b16 a[28:29], v245 offset:38912
 ds_read_b64_tr_b16 a[30:31], v245 offset:39424
 s_add_u32 m0, s64, 81920
 s_mov_b32 s96, 45056
 v_lshl_add_u64 v[254:255], s[96:97], 0, v[252:253]
 global_load_lds_dwordx4 v[254:255], off
 v_mfma_f32_32x32x16_bf16 v[72:87], a[8:11], a[148:151], v[72:87]
 ds_read_b64_tr_b16 a[0:1], v244 offset:40960
 ds_read_b64_tr_b16 a[2:3], v244 offset:41472
 s_buffer_load_dwordx8 s[56:63], s[16:19], s48 glc
 v_mfma_f32_32x32x16_bf16 v[88:103], a[12:15], a[148:151], v[88:103]
 ds_read_b64_tr_b16 a[4:5], v245 offset:40960
 ds_read_b64_tr_b16 a[6:7], v245 offset:41472
 global_load_lds_dwordx4 v[254:255], off offset:1024
 s_waitcnt lgkmcnt(8)
 v_mfma_f32_32x32x16_bf16 v[72:87], a[16:19], a[152:155], v[72:87]
 ds_read_b64_tr_b16 a[8:9], v244 offset:43008
 ds_read_b64_tr_b16 a[10:11], v244 offset:43520
 s_waitcnt vmcnt(4)
 ds_read_b64_tr_b16 a[32:33], v6 offset:0
 v_add_u32 v249, 6, v248
 s_add_u32 s3, s67, 32768
 s_mov_b64 exec, 1
 buffer_store_dword v249, off, s[16:19], s3 sc1
 s_mov_b64 exec, -1
 v_mfma_f32_32x32x16_bf16 v[88:103], a[20:23], a[152:155], v[88:103]
 ds_read_b64_tr_b16 a[12:13], v245 offset:43008
 ds_read_b64_tr_b16 a[14:15], v245 offset:43520
 s_add_u32 m0, s64, 98304
 s_mov_b32 s96, 61440
 v_lshl_add_u64 v[254:255], s[96:97], 0, v[252:253]
 global_load_lds_dwordx4 v[254:255], off
 ds_read_b64_tr_b16 a[34:35], v6 offset:512
 ds_read_b64_tr_b16 a[40:41], v6 offset:32
 s_waitcnt lgkmcnt(11)
 v_mfma_f32_32x32x16_bf16 v[72:87], a[24:27], a[156:159], v[72:87]
 ds_read_b64_tr_b16 a[16:17], v244 offset:45056
 ds_read_b64_tr_b16 a[18:19], v244 offset:45568
 ds_read_b64_tr_b16 a[42:43], v6 offset:544
 ds_read_b64_tr_b16 a[36:37], v6 offset:8192
 v_mfma_f32_32x32x16_bf16 v[88:103], a[28:31], a[156:159], v[88:103]
 ds_read_b64_tr_b16 a[20:21], v245 offset:45056
 ds_read_b64_tr_b16 a[22:23], v245 offset:45568
 global_load_lds_dwordx4 v[254:255], off offset:1024
 ds_read_b64_tr_b16 a[38:39], v6 offset:8704
 ds_read_b64_tr_b16 a[44:45], v6 offset:8224
 s_waitcnt lgkmcnt(15)
 v_mfma_f32_32x32x16_bf16 v[72:87], a[0:3], a[160:163], v[72:87]
 ds_read_b64_tr_b16 a[24:25], v244 offset:47104
 ds_read_b64_tr_b16 a[26:27], v244 offset:47616
 s_add_u32 m0, s64, 106496
 s_mov_b32 s96, 69632
 v_lshl_add_u64 v[254:255], s[96:97], 0, v[252:253]
 global_load_lds_dwordx4 v[254:255], off
 ds_read_b64_tr_b16 a[46:47], v6 offset:8736
 ds_read_b64_tr_b16 a[48:49], v6 offset:16384
 v_mfma_f32_32x32x16_bf16 v[88:103], a[4:7], a[160:163], v[88:103]
 ds_read_b64_tr_b16 a[28:29], v245 offset:47104
 ds_read_b64_tr_b16 a[30:31], v245 offset:47616
 global_load_lds_dwordx4 v[254:255], off offset:1024
 ds_read_b64_tr_b16 a[50:51], v6 offset:16896
 ds_read_b64_tr_b16 a[56:57], v6 offset:16416
 ds_read_b64_tr_b16 a[58:59], v6 offset:16928
 s_waitcnt lgkmcnt(15)
 v_mfma_f32_32x32x16_bf16 v[72:87], a[8:11], a[164:167], v[72:87]
 s_add_u32 m0, s64, 90112
 s_mov_b32 s96, 53248
 v_lshl_add_u64 v[254:255], s[96:97], 0, v[252:253]
 global_load_lds_dwordx4 v[254:255], off
 ds_read_b64_tr_b16 a[52:53], v6 offset:24576
 ds_read_b64_tr_b16 a[54:55], v6 offset:25088
 v_mfma_f32_32x32x16_bf16 v[88:103], a[12:15], a[164:167], v[88:103]
 global_load_lds_dwordx4 v[254:255], off offset:1024
 ds_read_b64_tr_b16 a[60:61], v6 offset:24608
 ds_read_b64_tr_b16 a[62:63], v6 offset:25120
 s_waitcnt lgkmcnt(15)
 v_mfma_f32_32x32x16_bf16 v[72:87], a[16:19], a[168:171], v[72:87]
 s_add_u32 m0, s64, 114688
 s_mov_b32 s96, 77824
 v_lshl_add_u64 v[254:255], s[96:97], 0, v[252:253]
 global_load_lds_dwordx4 v[254:255], off
 ds_read_b64_tr_b16 a[64:65], v6 offset:32768
 ds_read_b64_tr_b16 a[66:67], v6 offset:33280
 v_mfma_f32_32x32x16_bf16 v[88:103], a[20:23], a[168:171], v[88:103]
 global_load_lds_dwordx4 v[254:255], off offset:1024
 ds_read_b64_tr_b16 a[72:73], v6 offset:32800
 ds_read_b64_tr_b16 a[74:75], v6 offset:33312
 s_waitcnt lgkmcnt(11)
 v_mfma_f32_32x32x16_bf16 v[72:87], a[24:27], a[172:175], v[72:87]
 ds_read_b64_tr_b16 a[68:69], v6 offset:40960
 ds_read_b64_tr_b16 a[70:71], v6 offset:41472
 s_barrier
 v_mfma_f32_32x32x16_bf16 v[88:103], a[28:31], a[172:175], v[88:103]
 ds_read_b64_tr_b16 a[76:77], v6 offset:40992
 ds_read_b64_tr_b16 a[78:79], v6 offset:41504
 s_branch TX_115
TW_114:
ST3_3:
 s_cbranch_execz STB3_0
 s_waitcnt lgkmcnt(8)
 v_mfma_f32_32x32x16_bf16 v[72:87], a[0:3], a[128:131], v[72:87]
 ds_read_b64_tr_b16 a[24:25], v244 offset:30720
 ds_read_b64_tr_b16 a[26:27], v244 offset:31232
 s_add_u32 s3, s51, 0
 buffer_load_dwordx4 v[8:11], v0, s[16:19], s3 offen offset:0 sc1
 v_mfma_f32_32x32x16_bf16 v[88:103], a[4:7], a[128:131], v[88:103]
 ds_read_b64_tr_b16 a[28:29], v245 offset:30720
 ds_read_b64_tr_b16 a[30:31], v245 offset:31232
 s_add_u32 m0, s64, 73728
 s_mov_b32 s96, 36864
 v_lshl_add_u64 v[254:255], s[96:97], 0, v[252:253]
 global_load_lds_dwordx4 v[254:255], off
 s_add_u32 s3, s51, 0
 buffer_load_dwordx4 v[12:15], v0, s[16:19], s3 offen offset:1024 sc1
 s_waitcnt lgkmcnt(8)
 v_mfma_f32_32x32x16_bf16 v[72:87], a[8:11], a[132:135], v[72:87]
 ds_read_b64_tr_b16 a[0:1], v244 offset:32768
 ds_read_b64_tr_b16 a[2:3], v244 offset:33280
 s_add_u32 s3, s51, 0
 buffer_load_dwordx4 v[16:19], v0, s[16:19], s3 offen offset:2048 sc1
 v_mfma_f32_32x32x16_bf16 v[88:103], a[12:15], a[132:135], v[88:103]
 ds_read_b64_tr_b16 a[4:5], v245 offset:32768
 ds_read_b64_tr_b16 a[6:7], v245 offset:33280
 s_add_u32 s3, s51, 0
 buffer_load_dwordx4 v[20:23], v0, s[16:19], s3 offen offset:3072 sc1
 s_barrier
 s_waitcnt lgkmcnt(8)
 v_mfma_f32_32x32x16_bf16 v[72:87], a[16:19], a[136:139], v[72:87]
 ds_read_b64_tr_b16 a[8:9], v244 offset:34816
 ds_read_b64_tr_b16 a[10:11], v244 offset:35328
 s_add_u32 s3, s51, 4096
 buffer_load_dwordx4 v[24:27], v0, s[16:19], s3 offen offset:0 sc1
 v_mfma_f32_32x32x16_bf16 v[88:103], a[20:23], a[136:139], v[88:103]
 ds_read_b64_tr_b16 a[12:13], v245 offset:34816
 ds_read_b64_tr_b16 a[14:15], v245 offset:35328
 global_load_lds_dwordx4 v[254:255], off offset:1024
 s_add_u32 s3, s51, 4096
 buffer_load_dwordx4 v[28:31], v0, s[16:19], s3 offen offset:1024 sc1
 s_waitcnt lgkmcnt(8)
 v_mfma_f32_32x32x16_bf16 v[72:87], a[24:27], a[140:143], v[72:87]
 ds_read_b64_tr_b16 a[16:17], v244 offset:36864
 ds_read_b64_tr_b16 a[18:19], v244 offset:37376
 s_add_u32 s3, s51, 4096
 buffer_load_dwordx4 v[32:35], v0, s[16:19], s3 offen offset:2048 sc1
 v_mfma_f32_32x32x16_bf16 v[88:103], a[28:31], a[140:143], v[88:103]
 ds_read_b64_tr_b16 a[20:21], v245 offset:36864
 ds_read_b64_tr_b16 a[22:23], v245 offset:37376
 s_add_u32 s3, s51, 4096
 buffer_load_dwordx4 v[36:39], v0, s[16:19], s3 offen offset:3072 sc1
 s_waitcnt lgkmcnt(8)
 v_mfma_f32_32x32x16_bf16 v[72:87], a[0:3], a[144:147], v[72:87]
 ds_read_b64_tr_b16 a[24:25], v244 offset:38912
 ds_read_b64_tr_b16 a[26:27], v244 offset:39424
 s_add_u32 s3, s51, 8192
 buffer_load_dwordx4 v[40:43], v0, s[16:19], s3 offen offset:0 sc1
 v_mfma_f32_32x32x16_bf16 v[88:103], a[4:7], a[144:147], v[88:103]
 ds_read_b64_tr_b16 a[28:29], v245 offset:38912
 ds_read_b64_tr_b16 a[30:31], v245 offset:39424
 s_add_u32 m0, s64, 81920
 s_mov_b32 s96, 45056
 v_lshl_add_u64 v[254:255], s[96:97], 0, v[252:253]
 global_load_lds_dwordx4 v[254:255], off
 s_add_u32 s3, s51, 8192
 buffer_load_dwordx4 v[44:47], v0, s[16:19], s3 offen offset:1024 sc1
 s_waitcnt lgkmcnt(8)
 v_mfma_f32_32x32x16_bf16 v[72:87], a[8:11], a[148:151], v[72:87]
 ds_read_b64_tr_b16 a[0:1], v244 offset:40960
 ds_read_b64_tr_b16 a[2:3], v244 offset:41472
 s_add_u32 s3, s51, 8192
 buffer_load_dwordx4 v[48:51], v0, s[16:19], s3 offen offset:2048 sc1
 s_buffer_load_dwordx8 s[56:63], s[16:19], s48 glc
 v_mfma_f32_32x32x16_bf16 v[88:103], a[12:15], a[148:151], v[88:103]
 ds_read_b64_tr_b16 a[4:5], v245 offset:40960
 ds_read_b64_tr_b16 a[6:7], v245 offset:41472
 global_load_lds_dwordx4 v[254:255], off offset:1024
 s_add_u32 s3, s51, 8192
 buffer_load_dwordx4 v[52:55], v0, s[16:19], s3 offen offset:3072 sc1
 s_waitcnt lgkmcnt(8)
 v_mfma_f32_32x32x16_bf16 v[72:87], a[16:19], a[152:155], v[72:87]
 ds_read_b64_tr_b16 a[8:9], v244 offset:43008
 ds_read_b64_tr_b16 a[10:11], v244 offset:43520
 s_waitcnt vmcnt(16)
 ds_read_b64_tr_b16 a[32:33], v6 offset:0
 s_add_u32 s3, s51, 12288
 buffer_load_dwordx4 v[56:59], v0, s[16:19], s3 offen offset:0 sc1
 v_add_u32 v249, 6, v248
 s_add_u32 s3, s67, 32768
 s_mov_b64 exec, 1
 buffer_store_dword v249, off, s[16:19], s3 sc1
 s_mov_b64 exec, -1
 v_mfma_f32_32x32x16_bf16 v[88:103], a[20:23], a[152:155], v[88:103]
 ds_read_b64_tr_b16 a[12:13], v245 offset:43008
 ds_read_b64_tr_b16 a[14:15], v245 offset:43520
 s_add_u32 m0, s64, 98304
 s_mov_b32 s96, 61440
 v_lshl_add_u64 v[254:255], s[96:97], 0, v[252:253]
 global_load_lds_dwordx4 v[254:255], off
 ds_read_b64_tr_b16 a[34:35], v6 offset:512
 ds_read_b64_tr_b16 a[40:41], v6 offset:32
 s_add_u32 s3, s51, 12288
 buffer_load_dwordx4 v[60:63], v0, s[16:19], s3 offen offset:1024 sc1
 s_waitcnt lgkmcnt(11)
 v_mfma_f32_32x32x16_bf16 v[72:87], a[24:27], a[156:159], v[72:87]
 ds_read_b64_tr_b16 a[16:17], v244 offset:45056
 ds_read_b64_tr_b16 a[18:19], v244 offset:45568
 ds_read_b64_tr_b16 a[42:43], v6 offset:544
 ds_read_b64_tr_b16 a[36:37], v6 offset:8192
 s_add_u32 s3, s51, 12288
 buffer_load_dwordx4 v[64:67], v0, s[16:19], s3 offen offset:2048 sc1
 v_mfma_f32_32x32x16_bf16 v[88:103], a[28:31], a[156:159], v[88:103]
 ds_read_b64_tr_b16 a[20:21], v245 offset:45056
 ds_read_b64_tr_b16 a[22:23], v245 offset:45568
 global_load_lds_dwordx4 v[254:255], off offset:1024
 ds_read_b64_tr_b16 a[38:39], v6 offset:8704
 ds_read_b64_tr_b16 a[44:45], v6 offset:8224
 s_add_u32 s3, s51, 12288
 buffer_load_dwordx4 v[68:71], v0, s[16:19], s3 offen offset:3072 sc1
 s_waitcnt lgkmcnt(15)
 v_mfma_f32_32x32x16_bf16 v[72:87], a[0:3], a[160:163], v[72:87]
 ds_read_b64_tr_b16 a[24:25], v244 offset:47104
 ds_read_b64_tr_b16 a[26:27], v244 offset:47616
 s_add_u32 m0, s64, 106496
 s_mov_b32 s96, 69632
 v_lshl_add_u64 v[254:255], s[96:97], 0, v[252:253]
 global_load_lds_dwordx4 v[254:255], off
 ds_read_b64_tr_b16 a[46:47], v6 offset:8736
 ds_read_b64_tr_b16 a[48:49], v6 offset:16384
 v_mfma_f32_32x32x16_bf16 v[88:103], a[4:7], a[160:163], v[88:103]
 ds_read_b64_tr_b16 a[28:29], v245 offset:47104
 ds_read_b64_tr_b16 a[30:31], v245 offset:47616
 global_load_lds_dwordx4 v[254:255], off offset:1024
 ds_read_b64_tr_b16 a[50:51], v6 offset:16896
 ds_read_b64_tr_b16 a[56:57], v6 offset:16416
 ds_read_b64_tr_b16 a[58:59], v6 offset:16928
 s_waitcnt lgkmcnt(15)
 v_mfma_f32_32x32x16_bf16 v[72:87], a[8:11], a[164:167], v[72:87]
 s_add_u32 m0, s64, 90112
 s_mov_b32 s96, 53248
 v_lshl_add_u64 v[254:255], s[96:97], 0, v[252:253]
 global_load_lds_dwordx4 v[254:255], off
 ds_read_b64_tr_b16 a[52:53], v6 offset:24576
 ds_read_b64_tr_b16 a[54:55], v6 offset:25088
 v_mfma_f32_32x32x16_bf16 v[88:103], a[12:15], a[164:167], v[88:103]
 global_load_lds_dwordx4 v[254:255], off offset:1024
 ds_read_b64_tr_b16 a[60:61], v6 offset:24608
 ds_read_b64_tr_b16 a[62:63], v6 offset:25120
 s_waitcnt lgkmcnt(15)
 v_mfma_f32_32x32x16_bf16 v[72:87], a[16:19], a[168:171], v[72:87]
 s_add_u32 m0, s64, 114688
 s_mov_b32 s96, 77824
 v_lshl_add_u64 v[254:255], s[96:97], 0, v[252:253]
 global_load_lds_dwordx4 v[254:255], off
 ds_read_b64_tr_b16 a[64:65], v6 offset:32768
 ds_read_b64_tr_b16 a[66:67], v6 offset:33280
 v_mfma_f32_32x32x16_bf16 v[88:103], a[20:23], a[168:171], v[88:103]
 global_load_lds_dwordx4 v[254:255], off offset:1024
 ds_read_b64_tr_b16 a[72:73], v6 offset:32800
 ds_read_b64_tr_b16 a[74:75], v6 offset:33312
 s_waitcnt lgkmcnt(11)
 v_mfma_f32_32x32x16_bf16 v[72:87], a[24:27], a[172:175], v[72:87]
 ds_read_b64_tr_b16 a[68:69], v6 offset:40960
 ds_read_b64_tr_b16 a[70:71], v6 offset:41472
 s_barrier
 v_mfma_f32_32x32x16_bf16 v[88:103], a[28:31], a[172:175], v[88:103]
 ds_read_b64_tr_b16 a[76:77], v6 offset:40992
 ds_read_b64_tr_b16 a[78:79], v6 offset:41504
TX_115:
 s_bitcmp1_b32 s44, 5
 s_cbranch_scc0 L_nfw
 s_nop 1
 v_mfma_f32_32x32x16_bf16 v[104:119], a[32:35], a[176:179], 0
 v_mfma_f32_32x32x16_bf16 v[120:135], a[40:43], a[176:179], 0
 s_nop 2
 v_mfma_f32_32x32x16_bf16 v[104:119], a[40:43], a[192:195], v[104:119]
 v_cvt_pk_bf16_f32 v72, v72, v73
 v_cvt_pk_bf16_f32 v73, v74, v75
 v_cvt_pk_bf16_f32 v74, v76, v77
 v_cvt_pk_bf16_f32 v75, v78, v79
 s_add_u32 s3, s66, 98304
 buffer_store_dwordx4 v[72:75], v0, s[16:19], s3 offen offset:0 sc1
 v_cvt_pk_bf16_f32 v80, v80, v81
 v_mfma_f32_32x32x16_bf16 v[120:135], a[32:35], a[184:187], v[120:135]
 v_cvt_pk_bf16_f32 v81, v82, v83
 v_cvt_pk_bf16_f32 v82, v84, v85
 v_cvt_pk_bf16_f32 v83, v86, v87
 s_add_u32 s3, s66, 98304
 buffer_store_dwordx4 v[80:83], v0, s[16:19], s3 offen offset:1024 sc1
 v_cvt_pk_bf16_f32 v88, v88, v89
 v_cvt_pk_bf16_f32 v89, v90, v91
 v_cvt_pk_bf16_f32 v90, v92, v93
 v_mfma_f32_32x32x16_bf16 v[104:119], a[36:39], a[180:183], v[104:119]
 v_cvt_pk_bf16_f32 v91, v94, v95
 s_add_u32 s3, s66, 114688
 buffer_store_dwordx4 v[88:91], v0, s[16:19], s3 offen offset:0 sc1
 v_cvt_pk_bf16_f32 v96, v96, v97
 v_cvt_pk_bf16_f32 v97, v98, v99
 v_cvt_pk_bf16_f32 v98, v100, v101
 v_cvt_pk_bf16_f32 v99, v102, v103
 s_add_u32 s3, s66, 114688
 buffer_store_dwordx4 v[96:99], v0, s[16:19], s3 offen offset:1024 sc1
 v_mfma_f32_32x32x16_bf16 v[120:135], a[44:47], a[180:183], v[120:135]
 s_waitcnt lgkmcnt(0)
 s_sub_u32 s56, s56, s46
 s_sub_u32 s57, s57, s46
 s_sub_u32 s58, s58, s46
 s_sub_u32 s59, s59, s46
 s_sub_u32 s60, s60, s46
 v_mfma_f32_32x32x16_bf16 v[104:119], a[44:47], a[196:199], v[104:119]
 s_sub_u32 s61, s61, s46
 s_sub_u32 s62, s62, s46
 s_sub_u32 s63, s63, s46
 s_max_u32 s56, s56, s57
 s_max_u32 s58, s58, s59
 s_max_u32 s60, s60, s61
 s_max_u32 s62, s62, s63
 v_mfma_f32_32x32x16_bf16 v[120:135], a[36:39], a[188:191], v[120:135]
 s_max_u32 s56, s56, s58
 s_max_u32 s60, s60, s62
 s_max_u32 s56, s56, s60
 s_cmp_gt_u32 s56, 8
 s_cselect_b32 s98, 0, 5
 s_and_b32 s98, s98, s53
 s_cselect_b32 s99, 16384, 0
 s_xor_b32 s53, s53, s98
 s_or_b32 s53, s53, s99
PL_117:
 s_buffer_load_dwordx8 s[20:27], s[16:19], s48 glc
 v_mfma_f32_32x32x16_bf16 v[208:223], a[48:51], a[176:179], 0
 v_mfma_f32_32x32x16_bf16 v[224:239], a[56:59], a[176:179], 0
 s_and_b32 s98, s53, 16384
 s_cbranch_scc0 CB_118
 s_add_u32 s3, s50, 0
 buffer_load_dwordx4 v[136:139], v0, s[16:19], s3 offen offset:0 sc1
 buffer_load_dwordx4 v[140:143], v0, s[16:19], s3 offen offset:1024 sc1
 buffer_load_dwordx4 v[144:147], v0, s[16:19], s3 offen offset:2048 sc1
 buffer_load_dwordx4 v[148:151], v0, s[16:19], s3 offen offset:3072 sc1
CB_118:
 s_nop 5
 v_mfma_f32_32x32x16_bf16 v[208:223], a[56:59], a[192:195], v[208:223]
 v_cvt_pk_bf16_f32 v104, v104, v105
 v_cvt_pk_bf16_f32 v105, v106, v107
 v_cvt_pk_bf16_f32 v106, v108, v109
 v_mfma_f32_32x32x16_bf16 v[224:239], a[48:51], a[184:187], v[224:239]
 v_cvt_pk_bf16_f32 v107, v110, v111
ST3_4:
 s_cbranch_execz STB3_0
 ds_write_b128 v7, v[104:107] offset:0
 v_cvt_pk_bf16_f32 v112, v112, v113
 v_cvt_pk_bf16_f32 v113, v114, v115
 v_mfma_f32_32x32x16_bf16 v[208:223], a[52:55], a[180:183], v[208:223]
 v_cvt_pk_bf16_f32 v114, v116, v117
 v_cvt_pk_bf16_f32 v115, v118, v119
 ds_write_b128 v7, v[112:115] offset:8192
 v_mfma_f32_32x32x16_bf16 v[224:239], a[60:63], a[180:183], v[224:239]
 s_and_b32 s98, s53, 16384
 s_cbranch_scc0 CB_119
 s_add_u32 s3, s50, 4096
 buffer_load_dwordx4 v[152:155], v0, s[16:19], s3 offen offset:0 sc1
 buffer_load_dwordx4 v[156:159], v0, s[16:19], s3 offen offset:1024 sc1
 buffer_load_dwordx4 v[160:163], v0, s[16:19], s3 offen offset:2048 sc1
 buffer_load_dwordx4 v[164:167], v0, s[16:19], s3 offen offset:3072 sc1
CB_119:
 v_cvt_pk_bf16_f32 v120, v120, v121
 v_cvt_pk_bf16_f32 v121, v122, v123
 v_cvt_pk_bf16_f32 v122, v124, v125
 v_mfma_f32_32x32x16_bf16 v[208:223], a[60:63], a[196:199], v[208:223]
 v_cvt_pk_bf16_f32 v123, v126, v127
 ds_write_b128 v7, v[120:123] offset:1024
 v_cvt_pk_bf16_f32 v128, v128, v129
 v_mfma_f32_32x32x16_bf16 v[224:239], a[52:55], a[188:191], v[224:239]
 v_cvt_pk_bf16_f32 v129, v130, v131
 v_cvt_pk_bf16_f32 v130, v132, v133
 v_cvt_pk_bf16_f32 v131, v134, v135
 ds_write_b128 v7, v[128:131] offset:9216
 v_mfma_f32_32x32x16_bf16 v[72:87], a[64:67], a[176:179], 0
 v_mfma_f32_32x32x16_bf16 v[88:103], a[72:75], a[176:179], 0
 s_and_b32 s98, s53, 16384
 s_cbranch_scc0 CB_120
 s_add_u32 s3, s50, 8192
 buffer_load_dwordx4 v[168:171], v0, s[16:19], s3 offen offset:0 sc1
 buffer_load_dwordx4 v[172:175], v0, s[16:19], s3 offen offset:1024 sc1
 buffer_load_dwordx4 v[176:179], v0, s[16:19], s3 offen offset:2048 sc1
 buffer_load_dwordx4 v[180:183], v0, s[16:19], s3 offen offset:3072 sc1
CB_120:
 s_nop 5
 v_mfma_f32_32x32x16_bf16 v[72:87], a[72:75], a[192:195], v[72:87]
 v_cvt_pk_bf16_f32 v208, v208, v209
 v_cvt_pk_bf16_f32 v209, v210, v211
 v_cvt_pk_bf16_f32 v210, v212, v213
 v_mfma_f32_32x32x16_bf16 v[88:103], a[64:67], a[184:187], v[88:103]
 v_cvt_pk_bf16_f32 v211, v214, v215
 ds_write_b128 v7, v[208:211] offset:16384
 v_cvt_pk_bf16_f32 v216, v216, v217
 v_cvt_pk_bf16_f32 v217, v218, v219
 v_mfma_f32_32x32x16_bf16 v[72:87], a[68:71], a[180:183], v[72:87]
 v_cvt_pk_bf16_f32 v218, v220, v221
 v_cvt_pk_bf16_f32 v219, v222, v223
 ds_write_b128 v7, v[216:219] offset:24576
 v_mfma_f32_32x32x16_bf16 v[88:103], a[76:79], a[180:183], v[88:103]
 s_and_b32 s98, s53, 16384
 s_cbranch_scc0 CB_121
 s_add_u32 s3, s50, 12288
 buffer_load_dwordx4 v[184:187], v0, s[16:19], s3 offen offset:0 sc1
 buffer_load_dwordx4 v[188:191], v0, s[16:19], s3 offen offset:1024 sc1
 buffer_load_dwordx4 v[192:195], v0, s[16:19], s3 offen offset:2048 sc1
 buffer_load_dwordx4 v[196:199], v0, s[16:19], s3 offen offset:3072 sc1
CB_121:
 v_cvt_pk_bf16_f32 v224, v224, v225
 v_cvt_pk_bf16_f32 v225, v226, v227
 v_cvt_pk_bf16_f32 v226, v228, v229
 v_mfma_f32_32x32x16_bf16 v[72:87], a[76:79], a[196:199], v[72:87]
 v_cvt_pk_bf16_f32 v227, v230, v231
 ds_write_b128 v7, v[224:227] offset:17408
 v_cvt_pk_bf16_f32 v232, v232, v233
 v_mfma_f32_32x32x16_bf16 v[88:103], a[68:71], a[188:191], v[88:103]
 v_cvt_pk_bf16_f32 v233, v234, v235
 v_cvt_pk_bf16_f32 v234, v236, v237
 v_cvt_pk_bf16_f32 v235, v238, v239
 ds_write_b128 v7, v[232:235] offset:25600
 s_bitcmp1_b32 s53, 14
 s_cbranch_scc1 MW_122
 s_waitcnt vmcnt(0)
MW_122:
 s_waitcnt vmcnt(16)
 v_add_u32 v249, 7, v248
 s_add_u32 s3, s67, 49152
 s_mov_b64 exec, 1
 buffer_store_dword v249, off, s[16:19], s3 sc1
 s_mov_b64 exec, -1
 s_and_b32 s98, s53, 21
 s_cselect_b32 s98, 64, 0
 s_or_b32 s53, s53, s98
 v_mfma_f32_32x32x16_bf16 v[104:119], a[200:203], a[216:219], 0
 v_mfma_f32_32x32x16_bf16 v[104:119], a[204:207], a[220:223], v[104:119]
 s_nop 2
 v_mfma_f32_32x32x16_bf16 v[104:119], a[200:203], v[8:11], v[104:119]
 v_cvt_pk_bf16_f32 v72, v72, v73
 v_cvt_pk_bf16_f32 v73, v74, v75
 v_cvt_pk_bf16_f32 v74, v76, v77
 v_mfma_f32_32x32x16_bf16 v[104:119], a[204:207], v[12:15], v[104:119]
 v_cvt_pk_bf16_f32 v75, v78, v79
 ds_write_b128 v7, v[72:75] offset:32768
 v_cvt_pk_bf16_f32 v80, v80, v81
 v_mfma_f32_32x32x16_bf16 v[104:119], a[200:203], v[16:19], v[104:119]
 v_cvt_pk_bf16_f32 v81, v82, v83
 v_cvt_pk_bf16_f32 v82, v84, v85
 v_cvt_pk_bf16_f32 v83, v86, v87
 v_mfma_f32_32x32x16_bf16 v[104:119], a[204:207], v[20:23], v[104:119]
 ds_write_b128 v7, v[80:83] offset:40960
 v_cvt_pk_bf16_f32 v88, v88, v89
 v_cvt_pk_bf16_f32 v89, v90, v91
 v_mfma_f32_32x32x16_bf16 v[104:119], a[200:203], v[24:27], v[104:119]
 v_cvt_pk_bf16_f32 v90, v92, v93
 v_cvt_pk_bf16_f32 v91, v94, v95
 ds_write_b128 v7, v[88:91] offset:33792
 v_mfma_f32_32x32x16_bf16 v[104:119], a[204:207], v[28:31], v[104:119]
 v_cvt_pk_bf16_f32 v96, v96, v97
 v_cvt_pk_bf16_f32 v97, v98, v99
 v_cvt_pk_bf16_f32 v98, v100, v101
 v_mfma_f32_32x32x16_bf16 v[104:119], a[200:203], v[32:35], v[104:119]
 v_cvt_pk_bf16_f32 v99, v102, v103
 ds_write_b128 v7, v[96:99] offset:41984
 v_add_u32 v7, 24576, v0
 v_mfma_f32_32x32x16_bf16 v[104:119], a[204:207], v[36:39], v[104:119]
 s_mul_i32 s38, s40, 5120
 s_add_u32 s38, s38, 147456
 v_and_b32 v204, 31, v2
 v_mfma_f32_32x32x16_bf16 v[104:119], a[200:203], v[40:43], v[104:119]
 v_mul_u32_u24 v204, 80, v204
 v_add3_u32 v204, v204, v246, s38
 v_lshrrev_b32 v205, 2, v2
 v_mfma_f32_32x32x16_bf16 v[104:119], a[204:207], v[44:47], v[104:119]
 v_mul_u32_u24 v205, 80, v205
 v_and_b32 v206, 3, v2
 v_lshlrev_b32 v206, 4, v206
 v_add3_u32 v205, v205, v206, s38
 s_waitcnt lgkmcnt(0)
 s_barrier
 v_mfma_f32_32x32x16_bf16 v[104:119], a[200:203], v[48:51], v[104:119]
 ds_read_b128 a[16:19], v7 offset:0
 ds_read_b128 a[0:3], v3 offset:0
 ds_read_b128 a[20:23], v7 offset:1024
 ds_read_b128 a[4:7], v3 offset:1024
 v_mfma_f32_32x32x16_bf16 v[104:119], a[204:207], v[52:55], v[104:119]
 ds_read_b128 a[24:27], v7 offset:8192
 ds_read_b128 a[8:11], v3 offset:2048
 s_sub_u32 s20, s20, s46
 v_mfma_f32_32x32x16_bf16 v[104:119], a[200:203], v[56:59], v[104:119]
 s_sub_u32 s21, s21, s46
 s_sub_u32 s22, s22, s46
 v_mfma_f32_32x32x16_bf16 v[104:119], a[204:207], v[60:63], v[104:119]
 s_sub_u32 s23, s23, s46
 s_sub_u32 s24, s24, s46
 v_mfma_f32_32x32x16_bf16 v[104:119], a[200:203], v[64:67], v[104:119]
 s_sub_u32 s25, s25, s46
 s_sub_u32 s26, s26, s46
 s_sub_u32 s27, s27, s46
 v_mfma_f32_32x32x16_bf16 v[104:119], a[204:207], v[68:71], v[104:119]
 s_max_u32 s20, s20, s21
 s_max_u32 s22, s22, s23
 v_mfma_f32_32x32x16_bf16 v[120:135], a[200:203], a[240:243], 0
 s_max_u32 s24, s24, s25
 s_max_u32 s26, s26, s27
 v_mfma_f32_32x32x16_bf16 v[120:135], a[204:207], a[244:247], v[120:135]
 s_max_u32 s20, s20, s22
 s_max_u32 s24, s24, s26
 v_mfma_f32_32x32x16_bf16 v[8:23], a[200:203], a[232:235], 0
 s_max_u32 s20, s20, s24
 s_cmp_gt_u32 s20, 8
 s_cselect_b32 s98, 0, 64
 v_mfma_f32_32x32x16_bf16 v[8:23], a[204:207], a[236:239], v[8:23]
 s_and_b32 s98, s98, s53
 s_mul_i32 s98, s98, 133
 s_xor_b32 s53, s53, s98
 ds_read_b128 a[28:31], v7 offset:9216
 ds_read_b128 a[12:15], v3 offset:3072
 s_waitcnt lgkmcnt(4)
 v_mfma_f32_32x32x16_bf16 v[88:103], a[0:3], a[16:19], 0
 s_and_b32 s98, s53, 8192
 s_cbranch_scc0 CB_123
 s_add_u32 s3, s50, 0
 buffer_load_dwordx4 v[136:139], v0, s[16:19], s3 offen offset:0 sc1
 buffer_load_dwordx4 v[140:143], v0, s[16:19], s3 offen offset:1024 sc1
 buffer_load_dwordx4 v[144:147], v0, s[16:19], s3 offen offset:2048 sc1
 buffer_load_dwordx4 v[148:151], v0, s[16:19], s3 offen offset:3072 sc1
CB_123:
 ds_read_b128 a[16:19], v7 offset:16384
 ds_read_b128 a[0:3], v3 offset:12288
 v_mfma_f32_32x32x16_bf16 v[88:103], a[4:7], a[20:23], v[88:103]
 v_mul_f32 v240, s39, v104
 v_mul_f32 v241, s39, v105
 ds_read_b128 a[20:23], v7 offset:17408
 ds_read_b128 a[4:7], v3 offset:13312
 s_waitcnt lgkmcnt(4)
 v_mfma_f32_32x32x16_bf16 v[72:87], a[8:11], a[24:27], 0
 v_mul_f32 v242, s39, v106
 v_mul_f32 v243, s39, v107
 ds_read_b128 a[24:27], v7 offset:24576
 ds_read_b128 a[8:11], v3 offset:14336
 v_mfma_f32_32x32x16_bf16 v[72:87], a[12:15], a[28:31], v[72:87]
 s_and_b32 s98, s53, 8192
 s_cbranch_scc0 CB_124
 s_add_u32 s3, s50, 4096
 buffer_load_dwordx4 v[152:155], v0, s[16:19], s3 offen offset:0 sc1
 buffer_load_dwordx4 v[156:159], v0, s[16:19], s3 offen offset:1024 sc1
 buffer_load_dwordx4 v[160:163], v0, s[16:19], s3 offen offset:2048 sc1
 buffer_load_dwordx4 v[164:167], v0, s[16:19], s3 offen offset:3072 sc1
CB_124:
 v_exp_f32 v240, v240
 v_exp_f32 v241, v241
 v_exp_f32 v242, v242
 ds_read_b128 a[28:31], v7 offset:25600
 ds_read_b128 a[12:15], v3 offset:15360
 s_waitcnt lgkmcnt(4)
 v_mfma_f32_32x32x16_bf16 v[88:103], a[0:3], a[16:19], v[88:103]
 v_exp_f32 v243, v243
 v_add_f32 v240, 1.0, v240
 ds_read_b128 a[16:19], v7 offset:32768
 ds_read_b128 a[0:3], v247 offset:0
 v_mfma_f32_32x32x16_bf16 v[88:103], a[4:7], a[20:23], v[88:103]
 v_add_f32 v241, 1.0, v241
 v_add_f32 v242, 1.0, v242
 ds_read_b128 a[20:23], v7 offset:33792
 ds_read_b128 a[4:7], v247 offset:1024
 s_waitcnt lgkmcnt(4)
 v_mfma_f32_32x32x16_bf16 v[72:87], a[8:11], a[24:27], v[72:87]
 s_and_b32 s98, s53, 8192
 s_cbranch_scc0 CB_125
 s_add_u32 s3, s50, 8192
 buffer_load_dwordx4 v[168:171], v0, s[16:19], s3 offen offset:0 sc1
 buffer_load_dwordx4 v[172:175], v0, s[16:19], s3 offen offset:1024 sc1
 buffer_load_dwordx4 v[176:179], v0, s[16:19], s3 offen offset:2048 sc1
 buffer_load_dwordx4 v[180:183], v0, s[16:19], s3 offen offset:3072 sc1
CB_125:
 v_add_f32 v243, 1.0, v243
 v_rcp_f32 v240, v240
 v_rcp_f32 v241, v241
 ds_read_b128 a[24:27], v7 offset:40960
 ds_read_b128 a[8:11], v247 offset:8192
 v_mfma_f32_32x32x16_bf16 v[72:87], a[12:15], a[28:31], v[72:87]
 v_rcp_f32 v242, v242
 v_rcp_f32 v243, v243
 ds_read_b128 a[28:31], v7 offset:41984
 ds_read_b128 a[12:15], v247 offset:9216
 s_waitcnt lgkmcnt(4)
 v_mfma_f32_32x32x16_bf16 v[88:103], a[0:3], a[16:19], v[88:103]
 v_mul_f32 v104, v240, v104
 v_mul_f32 v105, v241, v105
 ds_read_b128 a[16:19], v7 offset:2048
 ds_read_b128 a[0:3], v1 offset:0
 v_mfma_f32_32x32x16_bf16 v[88:103], a[4:7], a[20:23], v[88:103]
 s_and_b32 s98, s53, 8192
 s_cbranch_scc0 CB_126
 s_add_u32 s3, s50, 12288
 buffer_load_dwordx4 v[184:187], v0, s[16:19], s3 offen offset:0 sc1
 buffer_load_dwordx4 v[188:191], v0, s[16:19], s3 offen offset:1024 sc1
 buffer_load_dwordx4 v[192:195], v0, s[16:19], s3 offen offset:2048 sc1
 buffer_load_dwordx4 v[196:199], v0, s[16:19], s3 offen offset:3072 sc1
CB_126:
 v_mul_f32 v106, v242, v106
 v_mul_f32 v107, v243, v107
 v_mul_f32 v240, s39, v108
 ds_read_b128 a[20:23], v7 offset:3072
 ds_read_b128 a[4:7], v1 offset:1024
 s_waitcnt lgkmcnt(4)
 v_mfma_f32_32x32x16_bf16 v[72:87], a[8:11], a[24:27], v[72:87]
 s_buffer_load_dwordx8 s[20:27], s[16:19], s48 glc
 v_mul_f32 v241, s39, v109
 v_mul_f32 v242, s39, v110
 ds_read_b128 a[24:27], v7 offset:10240
 ds_read_b128 a[8:11], v1 offset:2048
 v_mfma_f32_32x32x16_bf16 v[72:87], a[12:15], a[28:31], v[72:87]
 v_mul_f32 v243, s39, v111
 v_exp_f32 v240, v240
 ds_read_b128 a[28:31], v7 offset:11264
 ds_read_b128 a[12:15], v1 offset:3072
 s_waitcnt lgkmcnt(4)
 v_mfma_f32_32x32x16_bf16 v[88:103], a[0:3], a[16:19], v[88:103]
 v_exp_f32 v241, v241
 v_exp_f32 v242, v242
 v_exp_f32 v243, v243
 ds_read_b128 a[16:19], v7 offset:18432
 ds_read_b128 a[0:3], v1 offset:12288
 v_mfma_f32_32x32x16_bf16 v[88:103], a[4:7], a[20:23], v[88:103]
 v_add_f32 v240, 1.0, v240
 v_add_f32 v241, 1.0, v241
 ds_read_b128 a[20:23], v7 offset:19456
 ds_read_b128 a[4:7], v1 offset:13312
 s_waitcnt lgkmcnt(4)
 v_mfma_f32_32x32x16_bf16 v[72:87], a[8:11], a[24:27], v[72:87]
 v_add_f32 v242, 1.0, v242
 v_add_f32 v243, 1.0, v243
 ds_read_b128 a[24:27], v7 offset:26624
 ds_read_b128 a[8:11], v1 offset:14336
 v_mfma_f32_32x32x16_bf16 v[72:87], a[12:15], a[28:31], v[72:87]
 v_rcp_f32 v240, v240
 v_rcp_f32 v241, v241
 v_rcp_f32 v242, v242
 ds_read_b128 a[28:31], v7 offset:27648
 ds_read_b128 a[12:15], v1 offset:15360
 s_waitcnt lgkmcnt(4)
 v_mfma_f32_32x32x16_bf16 v[88:103], a[0:3], a[16:19], v[88:103]
 v_rcp_f32 v243, v243
 v_mul_f32 v108, v240, v108
 ds_read_b128 a[16:19], v7 offset:34816
 ds_read_b128 a[0:3], v1 offset:24576
 v_mfma_f32_32x32x16_bf16 v[88:103], a[4:7], a[20:23], v[88:103]
 v_mul_f32 v109, v241, v109
 v_mul_f32 v110, v242, v110
 v_mul_f32 v111, v243, v111
 ds_read_b128 a[20:23], v7 offset:35840
 ds_read_b128 a[4:7], v1 offset:25600
 s_waitcnt lgkmcnt(4)
 v_mfma_f32_32x32x16_bf16 v[72:87], a[8:11], a[24:27], v[72:87]
 v_mul_f32 v240, s39, v112
 v_mul_f32 v241, s39, v113
 ds_read_b128 a[24:27], v7 offset:43008
 ds_read_b128 a[8:11], v1 offset:26624
 v_mfma_f32_32x32x16_bf16 v[72:87], a[12:15], a[28:31], v[72:87]
 v_mul_f32 v242, s39, v114
 v_mul_f32 v243, s39, v115
 ds_read_b128 a[28:31], v7 offset:44032
 ds_read_b128 a[12:15], v1 offset:27648
 s_waitcnt lgkmcnt(4)
 v_mfma_f32_32x32x16_bf16 v[72:87], a[0:3], a[16:19], v[72:87]
 v_exp_f32 v240, v240
 v_exp_f32 v241, v241
 v_exp_f32 v242, v242
 ds_read_b128 a[16:19], v7 offset:4096
 ds_read_b128 a[0:3], v1 offset:36864
 v_mfma_f32_32x32x16_bf16 v[72:87], a[4:7], a[20:23], v[72:87]
 v_exp_f32 v243, v243
 v_add_f32 v240, 1.0, v240
 ds_read_b128 a[20:23], v7 offset:5120
 ds_read_b128 a[4:7], v1 offset:37888
 s_waitcnt lgkmcnt(4)
 v_mfma_f32_32x32x16_bf16 v[88:103], a[8:11], a[24:27], v[88:103]
 v_add_f32 v241, 1.0, v241
 v_add_f32 v242, 1.0, v242
 ds_read_b128 a[24:27], v7 offset:12288
 ds_read_b128 a[8:11], v1 offset:38912
 v_mfma_f32_32x32x16_bf16 v[88:103], a[12:15], a[28:31], v[88:103]
 v_add_f32 v243, 1.0, v243
 v_rcp_f32 v240, v240
 v_rcp_f32 v241, v241
 ds_read_b128 a[28:31], v7 offset:13312
 ds_read_b128 a[12:15], v1 offset:39936
 s_waitcnt lgkmcnt(4)
 v_mfma_f32_32x32x16_bf16 v[72:87], a[0:3], a[16:19], v[72:87]
 v_rcp_f32 v242, v242
 v_rcp_f32 v243, v243
 s_barrier
 ds_read_b128 a[16:19], v7 offset:20480
 ds_read_b128 a[0:3], v1 offset:49152
 v_mfma_f32_32x32x16_bf16 v[72:87], a[4:7], a[20:23], v[72:87]
 s_and_b32 s98, s53, 64
 s_cbranch_scc0 CB_127
 s_waitcnt lgkmcnt(0)
 s_sub_u32 s20, s20, s46
 s_sub_u32 s21, s21, s46
 s_sub_u32 s22, s22, s46
 s_sub_u32 s23, s23, s46
 s_sub_u32 s24, s24, s46
 s_sub_u32 s25, s25, s46
 s_sub_u32 s26, s26, s46
 s_sub_u32 s27, s27, s46
 s_max_u32 s20, s20, s21
 s_max_u32 s22, s22, s23
 s_max_u32 s24, s24, s25
 s_max_u32 s26, s26, s27
 s_max_u32 s20, s20, s22
 s_max_u32 s24, s24, s26
 s_max_u32 s20, s20, s24
 s_cmp_gt_u32 s20, 8
 s_buffer_load_dwordx8 s[20:27], s[16:19], s48 glc
 s_cbranch_scc1 T0_128
 s_add_u32 s3, s50, 0
 buffer_load_dwordx4 v[136:139], v0, s[16:19], s3 offen offset:0 sc1
 buffer_load_dwordx4 v[140:143], v0, s[16:19], s3 offen offset:1024 sc1
 buffer_load_dwordx4 v[144:147], v0, s[16:19], s3 offen offset:2048 sc1
 buffer_load_dwordx4 v[148:151], v0, s[16:19], s3 offen offset:3072 sc1
 s_add_u32 s3, s50, 4096
 buffer_load_dwordx4 v[152:155], v0, s[16:19], s3 offen offset:0 sc1
 buffer_load_dwordx4 v[156:159], v0, s[16:19], s3 offen offset:1024 sc1
 buffer_load_dwordx4 v[160:163], v0, s[16:19], s3 offen offset:2048 sc1
 buffer_load_dwordx4 v[164:167], v0, s[16:19], s3 offen offset:3072 sc1
 s_add_u32 s3, s50, 8192
 buffer_load_dwordx4 v[168:171], v0, s[16:19], s3 offen offset:0 sc1
 buffer_load_dwordx4 v[172:175], v0, s[16:19], s3 offen offset:1024 sc1
 buffer_load_dwordx4 v[176:179], v0, s[16:19], s3 offen offset:2048 sc1
 buffer_load_dwordx4 v[180:183], v0, s[16:19], s3 offen offset:3072 sc1
 s_add_u32 s3, s50, 12288
 buffer_load_dwordx4 v[184:187], v0, s[16:19], s3 offen offset:0 sc1
 buffer_load_dwordx4 v[188:191], v0, s[16:19], s3 offen offset:1024 sc1
 buffer_load_dwordx4 v[192:195], v0, s[16:19], s3 offen offset:2048 sc1
 buffer_load_dwordx4 v[196:199], v0, s[16:19], s3 offen offset:3072 sc1
 s_xor_b32 s53, s53, 320
T0_128:
CB_127:
 v_mul_f32 v112, v240, v112
 v_mul_f32 v113, v241, v113
 ds_read_b128 a[20:23], v7 offset:21504
 ds_read_b128 a[4:7], v1 offset:50176
 s_waitcnt lgkmcnt(4)
 v_mfma_f32_32x32x16_bf16 v[88:103], a[8:11], a[24:27], v[88:103]
 v_mul_f32 v114, v242, v114
 v_mul_f32 v115, v243, v115
 v_mul_f32 v240, s39, v116
 ds_read_b128 a[24:27], v7 offset:28672
 ds_read_b128 a[8:11], v1 offset:51200
 v_mfma_f32_32x32x16_bf16 v[88:103], a[12:15], a[28:31], v[88:103]
 v_mul_f32 v241, s39, v117
 v_mul_f32 v242, s39, v118
 ds_read_b128 a[28:31], v7 offset:29696
 ds_read_b128 a[12:15], v1 offset:52224
 s_waitcnt lgkmcnt(4)
 v_mfma_f32_32x32x16_bf16 v[72:87], a[0:3], a[16:19], v[72:87]
 v_mul_f32 v243, s39, v119
 v_exp_f32 v240, v240
 ds_read_b128 a[16:19], v7 offset:36864
 ds_read_b128 a[0:3], v1 offset:61440
 v_mfma_f32_32x32x16_bf16 v[72:87], a[4:7], a[20:23], v[72:87]
 v_exp_f32 v241, v241
 v_exp_f32 v242, v242
 v_exp_f32 v243, v243
 ds_read_b128 a[20:23], v7 offset:37888
 ds_read_b128 a[4:7], v1 offset:62464
 s_waitcnt lgkmcnt(4)
 v_mfma_f32_32x32x16_bf16 v[88:103], a[8:11], a[24:27], v[88:103]
 v_add_f32 v240, 1.0, v240
 v_add_f32 v241, 1.0, v241
 ds_read_b128 a[24:27], v7 offset:45056
 ds_read_b128 a[8:11], v1 offset:63488
 v_mfma_f32_32x32x16_bf16 v[88:103], a[12:15], a[28:31], v[88:103]
 v_add_f32 v242, 1.0, v242
 v_add_f32 v243, 1.0, v243
 ds_read_b128 a[28:31], v7 offset:46080
 ds_read_b128 a[12:15], v1 offset:64512
 s_waitcnt lgkmcnt(4)
 v_mfma_f32_32x32x16_bf16 v[72:87], a[0:3], a[16:19], v[72:87]
 v_rcp_f32 v240, v240
 v_rcp_f32 v241, v241
 v_rcp_f32 v242, v242
 v_mfma_f32_32x32x16_bf16 v[72:87], a[4:7], a[20:23], v[72:87]
 v_rcp_f32 v243, v243
 v_mul_f32 v116, v240, v116
 s_waitcnt lgkmcnt(0)
 v_mfma_f32_32x32x16_bf16 v[88:103], a[8:11], a[24:27], v[88:103]
 v_mul_f32 v117, v241, v117
 v_mul_f32 v118, v242, v118
 v_mul_f32 v119, v243, v119
 v_mfma_f32_32x32x16_bf16 v[88:103], a[12:15], a[28:31], v[88:103]
 s_and_b32 s98, s53, 64
 s_cbranch_scc1 FF_129
 s_waitcnt vmcnt(0)
 v_mfma_f32_32x32x16_bf16 v[208:223], a[200:203], a[208:211], 0
 v_mfma_f32_32x32x16_bf16 v[208:223], a[200:203], v[136:139], v[208:223]
 s_nop 5
 v_mfma_f32_32x32x16_bf16 v[208:223], a[200:203], v[144:147], v[208:223]
 v_fma_f32 v248, v88, s37, v72
 v_fma_f32 v249, v89, s37, v73
 v_fma_f32 v250, v90, s37, v74
 v_fma_f32 v251, v91, s37, v75
 v_fma_f32 v248, v248, v104, v120
 v_fma_f32 v249, v249, v105, v121
 v_mfma_f32_32x32x16_bf16 v[208:223], a[200:203], v[152:155], v[208:223]
 v_fma_f32 v250, v250, v106, v122
 v_fma_f32 v251, v251, v107, v123
 v_cvt_pk_bf16_f32 v232, v248, v249
 v_cvt_pk_bf16_f32 v233, v250, v251
 ds_write_b64 v204, v[232:233] offset:2560
 v_fma_f32 v248, v92, s37, v76
 v_fma_f32 v249, v93, s37, v77
 v_mfma_f32_32x32x16_bf16 v[208:223], a[200:203], v[160:163], v[208:223]
 v_fma_f32 v250, v94, s37, v78
 v_fma_f32 v251, v95, s37, v79
 v_fma_f32 v248, v248, v108, v124
 v_fma_f32 v249, v249, v109, v125
 v_fma_f32 v250, v250, v110, v126
 v_fma_f32 v251, v251, v111, v127
 v_mfma_f32_32x32x16_bf16 v[208:223], a[200:203], v[168:171], v[208:223]
 v_cvt_pk_bf16_f32 v234, v248, v249
 v_cvt_pk_bf16_f32 v235, v250, v251
 ds_write_b64 v204, v[234:235] offset:2576
 v_fma_f32 v248, v96, s37, v80
 v_fma_f32 v249, v97, s37, v81
 v_fma_f32 v250, v98, s37, v82
 v_fma_f32 v251, v99, s37, v83
 v_mfma_f32_32x32x16_bf16 v[208:223], a[200:203], v[176:179], v[208:223]
 v_fma_f32 v248, v248, v112, v128
 v_fma_f32 v249, v249, v113, v129
 v_fma_f32 v250, v250, v114, v130
 v_fma_f32 v251, v251, v115, v131
 v_cvt_pk_bf16_f32 v236, v248, v249
 v_cvt_pk_bf16_f32 v237, v250, v251
 v_mfma_f32_32x32x16_bf16 v[208:223], a[200:203], v[184:187], v[208:223]
 ds_write_b64 v204, v[236:237] offset:2592
 v_fma_f32 v248, v100, s37, v84
 v_fma_f32 v249, v101, s37, v85
 v_fma_f32 v250, v102, s37, v86
 v_fma_f32 v251, v103, s37, v87
 v_fma_f32 v248, v248, v116, v132
 v_fma_f32 v249, v249, v117, v133
 v_mfma_f32_32x32x16_bf16 v[208:223], a[200:203], v[192:195], v[208:223]
 v_fma_f32 v250, v250, v118, v134
 v_fma_f32 v251, v251, v119, v135
 v_cvt_pk_bf16_f32 v238, v248, v249
 v_cvt_pk_bf16_f32 v239, v250, v251
 ds_write_b64 v204, v[238:239] offset:2608
 ds_read_b128 v[232:235], v205 offset:2560
 ds_read_b128 v[236:239], v205 offset:3840
 v_mfma_f32_32x32x16_bf16 v[40:55], a[204:207], a[212:215], 0
 v_fma_f32 v24, v88, s36, v72
 v_fma_f32 v25, v89, s36, v73
 v_fma_f32 v26, v90, s36, v74
 v_fma_f32 v27, v91, s36, v75
 v_fma_f32 v28, v92, s36, v76
 v_fma_f32 v29, v93, s36, v77
 v_mfma_f32_32x32x16_bf16 v[40:55], a[204:207], v[140:143], v[40:55]
 v_fma_f32 v30, v94, s36, v78
 v_fma_f32 v31, v95, s36, v79
 v_fma_f32 v32, v96, s36, v80
 v_fma_f32 v33, v97, s36, v81
 v_fma_f32 v34, v98, s36, v82
 v_fma_f32 v35, v99, s36, v83
 v_mfma_f32_32x32x16_bf16 v[40:55], a[204:207], v[148:151], v[40:55]
 v_fma_f32 v36, v100, s36, v84
 v_fma_f32 v37, v101, s36, v85
 v_fma_f32 v38, v102, s36, v86
 v_fma_f32 v39, v103, s36, v87
 s_waitcnt lgkmcnt(1)
 buffer_store_dwordx4 v[232:235], v5, s[28:31], s5 offen sc1
 s_waitcnt lgkmcnt(0)
 buffer_store_dwordx4 v[236:239], v5, s[28:31], s7 offen sc1
 s_branch L_last
FF_129:
 s_and_b32 s98, s53, 64
 s_cbranch_scc0 CB_130
 s_waitcnt lgkmcnt(0)
 s_sub_u32 s20, s20, s46
 s_sub_u32 s21, s21, s46
 s_sub_u32 s22, s22, s46
 s_sub_u32 s23, s23, s46
 s_sub_u32 s24, s24, s46
 s_sub_u32 s25, s25, s46
 s_sub_u32 s26, s26, s46
 s_sub_u32 s27, s27, s46
 s_max_u32 s20, s20, s21
 s_max_u32 s22, s22, s23
 s_max_u32 s24, s24, s25
 s_max_u32 s26, s26, s27
 s_max_u32 s20, s20, s22
 s_max_u32 s24, s24, s26
 s_max_u32 s20, s20, s24
 s_cmp_gt_u32 s20, 8
 s_buffer_load_dwordx8 s[20:27], s[16:19], s48 glc
 s_cbranch_scc1 T0_131
 s_add_u32 s3, s50, 0
 buffer_load_dwordx4 v[136:139], v0, s[16:19], s3 offen offset:0 sc1
 buffer_load_dwordx4 v[140:143], v0, s[16:19], s3 offen offset:1024 sc1
 buffer_load_dwordx4 v[144:147], v0, s[16:19], s3 offen offset:2048 sc1
 buffer_load_dwordx4 v[148:151], v0, s[16:19], s3 offen offset:3072 sc1
 s_add_u32 s3, s50, 4096
 buffer_load_dwordx4 v[152:155], v0, s[16:19], s3 offen offset:0 sc1
 buffer_load_dwordx4 v[156:159], v0, s[16:19], s3 offen offset:1024 sc1
 buffer_load_dwordx4 v[160:163], v0, s[16:19], s3 offen offset:2048 sc1
 buffer_load_dwordx4 v[164:167], v0, s[16:19], s3 offen offset:3072 sc1
 s_add_u32 s3, s50, 8192
 buffer_load_dwordx4 v[168:171], v0, s[16:19], s3 offen offset:0 sc1
 buffer_load_dwordx4 v[172:175], v0, s[16:19], s3 offen offset:1024 sc1
 buffer_load_dwordx4 v[176:179], v0, s[16:19], s3 offen offset:2048 sc1
 buffer_load_dwordx4 v[180:183], v0, s[16:19], s3 offen offset:3072 sc1
 s_add_u32 s3, s50, 12288
 buffer_load_dwordx4 v[184:187], v0, s[16:19], s3 offen offset:0 sc1
 buffer_load_dwordx4 v[188:191], v0, s[16:19], s3 offen offset:1024 sc1
 buffer_load_dwordx4 v[192:195], v0, s[16:19], s3 offen offset:2048 sc1
 buffer_load_dwordx4 v[196:199], v0, s[16:19], s3 offen offset:3072 sc1
 s_xor_b32 s53, s53, 320
T0_131:
CB_130:
 s_nop 7
 v_fma_f32 v248, v88, s37, v72
 v_fma_f32 v249, v89, s37, v73
 v_fma_f32 v250, v90, s37, v74
 v_fma_f32 v251, v91, s37, v75
 v_fma_f32 v248, v248, v104, v120
 v_fma_f32 v249, v249, v105, v121
 v_fma_f32 v250, v250, v106, v122
 v_fma_f32 v251, v251, v107, v123
 v_cvt_pk_bf16_f32 v232, v248, v249
 v_cvt_pk_bf16_f32 v233, v250, v251
 ds_write_b64 v204, v[232:233] offset:2560
 v_fma_f32 v248, v92, s37, v76
 v_fma_f32 v249, v93, s37, v77
 v_fma_f32 v250, v94, s37, v78
 v_fma_f32 v251, v95, s37, v79
 v_fma_f32 v248, v248, v108, v124
 v_fma_f32 v249, v249, v109, v125
 v_fma_f32 v250, v250, v110, v126
 v_fma_f32 v251, v251, v111, v127
 v_cvt_pk_bf16_f32 v234, v248, v249
 v_cvt_pk_bf16_f32 v235, v250, v251
 ds_write_b64 v204, v[234:235] offset:2576
 v_fma_f32 v248, v96, s37, v80
 v_fma_f32 v249, v97, s37, v81
 v_fma_f32 v250, v98, s37, v82
 v_fma_f32 v251, v99, s37, v83
 v_fma_f32 v248, v248, v112, v128
 v_fma_f32 v249, v249, v113, v129
 v_fma_f32 v250, v250, v114, v130
 v_fma_f32 v251, v251, v115, v131
 v_cvt_pk_bf16_f32 v236, v248, v249
 v_cvt_pk_bf16_f32 v237, v250, v251
 ds_write_b64 v204, v[236:237] offset:2592
 v_fma_f32 v248, v100, s37, v84
 v_fma_f32 v249, v101, s37, v85
 v_fma_f32 v250, v102, s37, v86
 v_fma_f32 v251, v103, s37, v87
 v_fma_f32 v248, v248, v116, v132
 v_fma_f32 v249, v249, v117, v133
 v_fma_f32 v250, v250, v118, v134
 v_fma_f32 v251, v251, v119, v135
 v_cvt_pk_bf16_f32 v238, v248, v249
 v_cvt_pk_bf16_f32 v239, v250, v251
 ds_write_b64 v204, v[238:239] offset:2608
 ds_read_b128 v[232:235], v205 offset:2560
 ds_read_b128 v[236:239], v205 offset:3840
ST3_5:
 s_cbranch_execz STB3_0
 v_fma_f32 v24, v88, s36, v72
 v_fma_f32 v25, v89, s36, v73
 v_fma_f32 v26, v90, s36, v74
 v_fma_f32 v27, v91, s36, v75
 v_fma_f32 v28, v92, s36, v76
 v_fma_f32 v29, v93, s36, v77
 v_fma_f32 v30, v94, s36, v78
 v_fma_f32 v31, v95, s36, v79
 v_fma_f32 v32, v96, s36, v80
 v_fma_f32 v33, v97, s36, v81
 v_fma_f32 v34, v98, s36, v82
 v_fma_f32 v35, v99, s36, v83
 v_fma_f32 v36, v100, s36, v84
 v_fma_f32 v37, v101, s36, v85
 v_fma_f32 v38, v102, s36, v86
 v_fma_f32 v39, v103, s36, v87
 s_waitcnt lgkmcnt(1)
 buffer_store_dwordx4 v[232:235], v5, s[28:31], s5 offen sc1
 s_waitcnt lgkmcnt(0)
 buffer_store_dwordx4 v[236:239], v5, s[28:31], s7 offen sc1
L_w0:
 s_and_b32 s98, s53, 64
 s_cbranch_scc0 CB_132
 s_mov_b32 s99, 6
MS_133:
 s_waitcnt lgkmcnt(0)
 s_sub_u32 s20, s20, s46
 s_sub_u32 s21, s21, s46
 s_sub_u32 s22, s22, s46
 s_sub_u32 s23, s23, s46
 s_sub_u32 s24, s24, s46
 s_sub_u32 s25, s25, s46
 s_sub_u32 s26, s26, s46
 s_sub_u32 s27, s27, s46
 s_max_u32 s20, s20, s21
 s_max_u32 s22, s22, s23
 s_max_u32 s24, s24, s25
 s_max_u32 s26, s26, s27
 s_max_u32 s20, s20, s22
 s_max_u32 s24, s24, s26
 s_max_u32 s20, s20, s24
 s_cmp_gt_u32 s20, 8
 s_cbranch_scc0 MT_134
 s_buffer_load_dwordx8 s[20:27], s[16:19], s48 glc
 s_sub_u32 s99, s99, 1
 s_cbranch_scc0 MS_133
 s_waitcnt lgkmcnt(0)
 s_sub_u32 s20, s20, s46
 s_sub_u32 s21, s21, s46
 s_sub_u32 s22, s22, s46
 s_sub_u32 s23, s23, s46
 s_sub_u32 s24, s24, s46
 s_sub_u32 s25, s25, s46
 s_sub_u32 s26, s26, s46
 s_sub_u32 s27, s27, s46
 s_max_u32 s20, s20, s21
 s_max_u32 s22, s22, s23
 s_max_u32 s24, s24, s25
 s_max_u32 s26, s26, s27
 s_max_u32 s20, s20, s22
 s_max_u32 s24, s24, s26
 s_max_u32 s20, s20, s24
 s_cmp_gt_u32 s20, 8
 s_cbranch_scc1 EC_135
EK_136:
MT_134:
 s_add_u32 s3, s50, 0
 buffer_load_dwordx4 v[136:139], v0, s[16:19], s3 offen offset:0 sc1
 buffer_load_dwordx4 v[140:143], v0, s[16:19], s3 offen offset:1024 sc1
 buffer_load_dwordx4 v[144:147], v0, s[16:19], s3 offen offset:2048 sc1
 buffer_load_dwordx4 v[148:151], v0, s[16:19], s3 offen offset:3072 sc1
 s_add_u32 s3, s50, 4096
 buffer_load_dwordx4 v[152:155], v0, s[16:19], s3 offen offset:0 sc1
 buffer_load_dwordx4 v[156:159], v0, s[16:19], s3 offen offset:1024 sc1
 buffer_load_dwordx4 v[160:163], v0, s[16:19], s3 offen offset:2048 sc1
 buffer_load_dwordx4 v[164:167], v0, s[16:19], s3 offen offset:3072 sc1
 s_add_u32 s3, s50, 8192
 buffer_load_dwordx4 v[168:171], v0, s[16:19], s3 offen offset:0 sc1
 buffer_load_dwordx4 v[172:175], v0, s[16:19], s3 offen offset:1024 sc1
 buffer_load_dwordx4 v[176:179], v0, s[16:19], s3 offen offset:2048 sc1
 buffer_load_dwordx4 v[180:183], v0, s[16:19], s3 offen offset:3072 sc1
 s_add_u32 s3, s50, 12288
 buffer_load_dwordx4 v[184:187], v0, s[16:19], s3 offen offset:0 sc1
 buffer_load_dwordx4 v[188:191], v0, s[16:19], s3 offen offset:1024 sc1
 buffer_load_dwordx4 v[192:195], v0, s[16:19], s3 offen offset:2048 sc1
 buffer_load_dwordx4 v[196:199], v0, s[16:19], s3 offen offset:3072 sc1
CB_132:
 s_waitcnt vmcnt(0)
 v_mfma_f32_32x32x16_bf16 v[208:223], a[200:203], a[208:211], 0
 v_mfma_f32_32x32x16_bf16 v[208:223], a[200:203], v[136:139], v[208:223]
 v_mfma_f32_32x32x16_bf16 v[208:223], a[200:203], v[144:147], v[208:223]
 v_mfma_f32_32x32x16_bf16 v[208:223], a[200:203], v[152:155], v[208:223]
 v_mfma_f32_32x32x16_bf16 v[208:223], a[200:203], v[160:163], v[208:223]
 v_mfma_f32_32x32x16_bf16 v[208:223], a[200:203], v[168:171], v[208:223]
 v_mfma_f32_32x32x16_bf16 v[208:223], a[200:203], v[176:179], v[208:223]
 v_mfma_f32_32x32x16_bf16 v[208:223], a[200:203], v[184:187], v[208:223]
 v_mfma_f32_32x32x16_bf16 v[208:223], a[200:203], v[192:195], v[208:223]
 v_mfma_f32_32x32x16_bf16 v[40:55], a[204:207], a[212:215], 0
 v_mfma_f32_32x32x16_bf16 v[40:55], a[204:207], v[140:143], v[40:55]
 s_nop 7
 v_mfma_f32_32x32x16_bf16 v[40:55], a[204:207], v[148:151], v[40:55]
L_last:
 v_mfma_f32_32x32x16_bf16 v[40:55], a[204:207], v[156:159], v[40:55]
 v_mul_f32 v240, s39, v208
 v_mul_f32 v241, s39, v209
 v_mul_f32 v242, s39, v210
 v_mul_f32 v243, s39, v211
 v_exp_f32 v240, v240
 v_exp_f32 v241, v241
 v_exp_f32 v242, v242
 v_exp_f32 v243, v243
 v_add_f32 v240, 1.0, v240
 v_mfma_f32_32x32x16_bf16 v[40:55], a[204:207], v[164:167], v[40:55]
 v_add_f32 v241, 1.0, v241
 v_add_f32 v242, 1.0, v242
 v_add_f32 v243, 1.0, v243
 v_rcp_f32 v240, v240
 v_rcp_f32 v241, v241
 v_rcp_f32 v242, v242
 v_rcp_f32 v243, v243
 v_mul_f32 v208, v24, v208
 v_mul_f32 v209, v25, v209
 v_mfma_f32_32x32x16_bf16 v[40:55], a[204:207], v[172:175], v[40:55]
 v_mul_f32 v210, v26, v210
 v_mul_f32 v211, v27, v211
 v_fma_f32 v240, v240, v208, v8
 v_fma_f32 v241, v241, v209, v9
 v_fma_f32 v242, v242, v210, v10
 v_fma_f32 v243, v243, v211, v11
 v_cvt_pk_bf16_f32 v224, v240, v241
 v_cvt_pk_bf16_f32 v225, v242, v243
 ds_write_b64 v204, v[224:225] offset:0
 v_mfma_f32_32x32x16_bf16 v[40:55], a[204:207], v[180:183], v[40:55]
 v_mul_f32 v240, s39, v212
 v_mul_f32 v241, s39, v213
 v_mul_f32 v242, s39, v214
 v_mul_f32 v243, s39, v215
 v_exp_f32 v240, v240
 v_exp_f32 v241, v241
 v_exp_f32 v242, v242
 v_exp_f32 v243, v243
 v_add_f32 v240, 1.0, v240
 v_mfma_f32_32x32x16_bf16 v[40:55], a[204:207], v[188:191], v[40:55]
 v_add_f32 v241, 1.0, v241
 v_add_f32 v242, 1.0, v242
 v_add_f32 v243, 1.0, v243
 v_rcp_f32 v240, v240
 v_rcp_f32 v241, v241
 v_rcp_f32 v242, v242
 v_rcp_f32 v243, v243
 v_mul_f32 v212, v28, v212
 v_mul_f32 v213, v29, v213
 v_mfma_f32_32x32x16_bf16 v[40:55], a[204:207], v[196:199], v[40:55]
 v_mul_f32 v214, v30, v214
 v_mul_f32 v215, v31, v215
 v_fma_f32 v240, v240, v212, v12
 v_fma_f32 v241, v241, v213, v13
 v_fma_f32 v242, v242, v214, v14
 v_fma_f32 v243, v243, v215, v15
 v_cvt_pk_bf16_f32 v226, v240, v241
 v_cvt_pk_bf16_f32 v227, v242, v243
 ds_write_b64 v204, v[226:227] offset:16
 s_nop 3
 v_mul_f32 v240, s39, v48
 v_mul_f32 v241, s39, v49
 v_mul_f32 v242, s39, v50
 v_mul_f32 v243, s39, v51
 v_exp_f32 v240, v240
 v_exp_f32 v241, v241
 v_exp_f32 v242, v242
 v_exp_f32 v243, v243
 v_add_f32 v240, 1.0, v240
 v_add_f32 v241, 1.0, v241
 v_add_f32 v242, 1.0, v242
 v_add_f32 v243, 1.0, v243
 v_rcp_f32 v240, v240
 v_rcp_f32 v241, v241
 v_rcp_f32 v242, v242
 v_rcp_f32 v243, v243
 v_mul_f32 v48, v32, v48
 v_mul_f32 v49, v33, v49
 v_mul_f32 v50, v34, v50
 v_mul_f32 v51, v35, v51
 v_fma_f32 v240, v240, v48, v16
 v_fma_f32 v241, v241, v49, v17
 v_fma_f32 v242, v242, v50, v18
 v_fma_f32 v243, v243, v51, v19
 v_cvt_pk_bf16_f32 v228, v240, v241
 v_cvt_pk_bf16_f32 v229, v242, v243
 ds_write_b64 v204, v[228:229] offset:32
 v_mul_f32 v240, s39, v52
 v_mul_f32 v241, s39, v53
 v_mul_f32 v242, s39, v54
 v_mul_f32 v243, s39, v55
 v_exp_f32 v240, v240
 v_exp_f32 v241, v241
 v_exp_f32 v242, v242
 v_exp_f32 v243, v243
 v_add_f32 v240, 1.0, v240
 v_add_f32 v241, 1.0, v241
 v_add_f32 v242, 1.0, v242
 v_add_f32 v243, 1.0, v243
 v_rcp_f32 v240, v240
 v_rcp_f32 v241, v241
 v_rcp_f32 v242, v242
 v_rcp_f32 v243, v243
 v_mul_f32 v52, v36, v52
 v_mul_f32 v53, v37, v53
 v_mul_f32 v54, v38, v54
 v_mul_f32 v55, v39, v55
 v_fma_f32 v240, v240, v52, v20
 v_fma_f32 v241, v241, v53, v21
 v_fma_f32 v242, v242, v54, v22
 v_fma_f32 v243, v243, v55, v23
 v_cvt_pk_bf16_f32 v230, v240, v241
 v_cvt_pk_bf16_f32 v231, v242, v243
 ds_write_b64 v204, v[230:231] offset:48
 ds_read_b128 v[224:227], v205 offset:0
 ds_read_b128 v[228:231], v205 offset:1280
 s_waitcnt lgkmcnt(1)
 buffer_store_dwordx4 v[224:227], v5, s[28:31], s4 offen sc1
 s_waitcnt lgkmcnt(0)
 buffer_store_dwordx4 v[228:231], v5, s[28:31], s6 offen sc1
L_fin:
L_end:
 s_endpgm
L_hot:
ST3_6:
 s_cbranch_execz STB3_0
 s_endpgm
DA_86:
 s_add_u32 m0, s64, 24576
 s_mov_b32 s96, 18432
 v_lshl_add_u64 v[254:255], s[96:97], 0, v[252:253]
 global_load_lds_dwordx4 v[254:255], off
 global_load_lds_dwordx4 v[254:255], off offset:1024
 s_branch DB_87
DA_88:
 s_add_u32 m0, s64, 32768
 s_mov_b32 s96, 20480
 v_lshl_add_u64 v[254:255], s[96:97], 0, v[252:253]
 global_load_lds_dwordx4 v[254:255], off
 global_load_lds_dwordx4 v[254:255], off offset:1024
 s_branch DB_89
DA_90:
 s_add_u32 m0, s64, 40960
 s_mov_b32 s96, 22528
 v_lshl_add_u64 v[254:255], s[96:97], 0, v[252:253]
 global_load_lds_dwordx4 v[254:255], off
 global_load_lds_dwordx4 v[254:255], off offset:1024
 s_branch DB_91
DA_92:
 s_add_u32 m0, s64, 49152
 s_mov_b32 s96, 24576
 v_lshl_add_u64 v[254:255], s[96:97], 0, v[252:253]
 global_load_lds_dwordx4 v[254:255], off
 global_load_lds_dwordx4 v[254:255], off offset:1024
 s_branch DB_93
DA_94:
 s_add_u32 m0, s64, 57344
 s_mov_b32 s96, 26624
 v_lshl_add_u64 v[254:255], s[96:97], 0, v[252:253]
 global_load_lds_dwordx4 v[254:255], off
 global_load_lds_dwordx4 v[254:255], off offset:1024
 s_branch DB_95
DA_96:
 s_add_u32 m0, s64, 65536
 s_mov_b32 s96, 28672
 v_lshl_add_u64 v[254:255], s[96:97], 0, v[252:253]
 global_load_lds_dwordx4 v[254:255], off
 global_load_lds_dwordx4 v[254:255], off offset:1024
 s_branch DB_97
BC_98:
 s_mov_b32 s99, 8
BC_98_l:
 s_buffer_load_dwordx8 s[20:27], s[16:19], s49 glc
 s_waitcnt lgkmcnt(0)
 s_sub_u32 s20, s20, s47
 s_sub_u32 s21, s21, s47
 s_sub_u32 s22, s22, s47
 s_sub_u32 s23, s23, s47
 s_sub_u32 s24, s24, s47
 s_sub_u32 s25, s25, s47
 s_sub_u32 s26, s26, s47
 s_sub_u32 s27, s27, s47
 s_max_u32 s20, s20, s21
 s_max_u32 s22, s22, s23
 s_max_u32 s24, s24, s25
 s_max_u32 s26, s26, s27
 s_max_u32 s20, s20, s22
 s_max_u32 s24, s24, s26
 s_max_u32 s20, s20, s24
 s_cmp_gt_u32 s20, 8
 s_cbranch_scc0 BK_99
 s_sub_u32 s99, s99, 1
 s_cbranch_scc0 BC_98_l
 s_mov_b32 s20, -1
 s_add_u32 s20, s20, s47
 s_sub_u32 s20, s20, s47
 s_sub_u32 s21, s21, s47
 s_sub_u32 s22, s22, s47
 s_sub_u32 s23, s23, s47
 s_sub_u32 s24, s24, s47
 s_sub_u32 s25, s25, s47
 s_sub_u32 s26, s26, s47
 s_sub_u32 s27, s27, s47
 s_max_u32 s20, s20, s21
 s_max_u32 s22, s22, s23
 s_max_u32 s24, s24, s25
 s_max_u32 s26, s26, s27
 s_max_u32 s20, s20, s22
 s_max_u32 s24, s24, s26
 s_max_u32 s20, s20, s24
 s_cmp_gt_u32 s20, 8
 s_cbranch_scc1 EC_8100
EK_8101:
 s_branch BK_99
DA_100:
 s_add_u32 m0, s64, 24576
 s_mov_b32 s96, 18432
 v_lshl_add_u64 v[254:255], s[96:97], 0, v[252:253]
 global_load_lds_dwordx4 v[254:255], off
 global_load_lds_dwordx4 v[254:255], off offset:1024
 s_branch DB_101
DA_102:
 s_add_u32 m0, s64, 32768
 s_mov_b32 s96, 20480
 v_lshl_add_u64 v[254:255], s[96:97], 0, v[252:253]
 global_load_lds_dwordx4 v[254:255], off
 global_load_lds_dwordx4 v[254:255], off offset:1024
 s_branch DB_103
DA_104:
 s_add_u32 m0, s64, 40960
 s_mov_b32 s96, 22528
 v_lshl_add_u64 v[254:255], s[96:97], 0, v[252:253]
 global_load_lds_dwordx4 v[254:255], off
 global_load_lds_dwordx4 v[254:255], off offset:1024
 s_branch DB_105
DA_106:
 s_add_u32 m0, s64, 49152
 s_mov_b32 s96, 24576
 v_lshl_add_u64 v[254:255], s[96:97], 0, v[252:253]
 global_load_lds_dwordx4 v[254:255], off
 global_load_lds_dwordx4 v[254:255], off offset:1024
 s_branch DB_107
DA_108:
 s_add_u32 m0, s64, 57344
 s_mov_b32 s96, 26624
 v_lshl_add_u64 v[254:255], s[96:97], 0, v[252:253]
 global_load_lds_dwordx4 v[254:255], off
 global_load_lds_dwordx4 v[254:255], off offset:1024
 s_branch DB_109
DA_110:
 s_add_u32 m0, s64, 65536
 s_mov_b32 s96, 28672
 v_lshl_add_u64 v[254:255], s[96:97], 0, v[252:253]
 global_load_lds_dwordx4 v[254:255], off
 global_load_lds_dwordx4 v[254:255], off offset:1024
 s_branch DB_111
BC_112:
 s_mov_b32 s99, 8
BC_112_l:
 s_buffer_load_dwordx8 s[20:27], s[16:19], s49 glc
 s_waitcnt lgkmcnt(0)
 s_sub_u32 s20, s20, s47
 s_sub_u32 s21, s21, s47
 s_sub_u32 s22, s22, s47
 s_sub_u32 s23, s23, s47
 s_sub_u32 s24, s24, s47
 s_sub_u32 s25, s25, s47
 s_sub_u32 s26, s26, s47
 s_sub_u32 s27, s27, s47
 s_max_u32 s20, s20, s21
 s_max_u32 s22, s22, s23
 s_max_u32 s24, s24, s25
 s_max_u32 s26, s26, s27
 s_max_u32 s20, s20, s22
 s_max_u32 s24, s24, s26
 s_max_u32 s20, s20, s24
 s_cmp_gt_u32 s20, 8
 s_cbranch_scc0 BK_113
 s_sub_u32 s99, s99, 1
 s_cbranch_scc0 BC_112_l
 s_mov_b32 s20, -1
 s_add_u32 s20, s20, s47
 s_sub_u32 s20, s20, s47
 s_sub_u32 s21, s21, s47
 s_sub_u32 s22, s22, s47
 s_sub_u32 s23, s23, s47
 s_sub_u32 s24, s24, s47
 s_sub_u32 s25, s25, s47
 s_sub_u32 s26, s26, s47
 s_sub_u32 s27, s27, s47
 s_max_u32 s20, s20, s21
 s_max_u32 s22, s22, s23
 s_max_u32 s24, s24, s25
 s_max_u32 s26, s26, s27
 s_max_u32 s20, s20, s22
 s_max_u32 s24, s24, s26
 s_max_u32 s20, s20, s24
 s_cmp_gt_u32 s20, 8
 s_cbranch_scc1 EC_8114
EK_8115:
 s_branch BK_113
L_nfw:
 s_nop 8
 v_cvt_pk_bf16_f32 v72, v72, v73
 v_cvt_pk_bf16_f32 v73, v74, v75
 v_cvt_pk_bf16_f32 v74, v76, v77
 v_cvt_pk_bf16_f32 v75, v78, v79
 s_add_u32 s3, s66, 98304
 buffer_store_dwordx4 v[72:75], v0, s[16:19], s3 offen offset:0 sc1
 v_cvt_pk_bf16_f32 v80, v80, v81
 v_cvt_pk_bf16_f32 v81, v82, v83
 v_cvt_pk_bf16_f32 v82, v84, v85
 v_cvt_pk_bf16_f32 v83, v86, v87
 s_add_u32 s3, s66, 98304
 buffer_store_dwordx4 v[80:83], v0, s[16:19], s3 offen offset:1024 sc1
 v_cvt_pk_bf16_f32 v88, v88, v89
 v_cvt_pk_bf16_f32 v89, v90, v91
 v_cvt_pk_bf16_f32 v90, v92, v93
 v_cvt_pk_bf16_f32 v91, v94, v95
 s_add_u32 s3, s66, 114688
 buffer_store_dwordx4 v[88:91], v0, s[16:19], s3 offen offset:0 sc1
 v_cvt_pk_bf16_f32 v96, v96, v97
 v_cvt_pk_bf16_f32 v97, v98, v99
 v_cvt_pk_bf16_f32 v98, v100, v101
 v_cvt_pk_bf16_f32 v99, v102, v103
 s_add_u32 s3, s66, 114688
 buffer_store_dwordx4 v[96:99], v0, s[16:19], s3 offen offset:1024 sc1
 s_bitcmp1_b32 s44, 4
 s_cbranch_scc1 L_w3
 v_add_u32 v249, 7, v248
 s_add_u32 s3, s67, 49152
 s_waitcnt vmcnt(0)
 s_mov_b64 exec, 1
 buffer_store_dword v249, off, s[16:19], s3 sc1
 s_mov_b64 exec, -1
 s_branch L_fin
L_w3:
 s_mov_b32 m0, 122880
 s_mov_b32 s96, 79872
 v_lshl_add_u64 v[254:255], s[96:97], 0, v[252:253]
 global_load_lds_dwordx4 v[254:255], off offset:0
 global_load_lds_dwordx4 v[254:255], off offset:1024
 global_load_lds_dwordx4 v[254:255], off offset:2048
 global_load_lds_dwordx4 v[254:255], off offset:3072
 s_waitcnt vmcnt(8)
 s_barrier
 s_mov_b32 m0, 126976
 s_mov_b32 s96, 83968
 v_lshl_add_u64 v[254:255], s[96:97], 0, v[252:253]
 global_load_lds_dwordx4 v[254:255], off offset:0
 global_load_lds_dwordx4 v[254:255], off offset:1024
 global_load_lds_dwordx4 v[254:255], off offset:2048
 global_load_lds_dwordx4 v[254:255], off offset:3072
 s_mov_b32 m0, 131072
 s_mov_b32 s96, 88064
 v_lshl_add_u64 v[254:255], s[96:97], 0, v[252:253]
 global_load_lds_dwordx4 v[254:255], off offset:0
 global_load_lds_dwordx4 v[254:255], off offset:1024
 global_load_lds_dwordx4 v[254:255], off offset:2048
 global_load_lds_dwordx4 v[254:255], off offset:3072
 s_mov_b32 m0, 135168
 s_mov_b32 s96, 92160
 v_lshl_add_u64 v[254:255], s[96:97], 0, v[252:253]
 global_load_lds_dwordx4 v[254:255], off offset:0
 global_load_lds_dwordx4 v[254:255], off offset:1024
 global_load_lds_dwordx4 v[254:255], off offset:2048
 global_load_lds_dwordx4 v[254:255], off offset:3072
 s_mov_b32 m0, 139264
 s_mov_b32 s96, 96256
 v_lshl_add_u64 v[254:255], s[96:97], 0, v[252:253]
 global_load_lds_dwordx4 v[254:255], off offset:0
 global_load_lds_dwordx4 v[254:255], off offset:1024
 global_load_lds_dwordx4 v[254:255], off offset:2048
 global_load_lds_dwordx4 v[254:255], off offset:3072
 s_mov_b32 m0, 143360
 s_mov_b32 s96, 100352
 v_lshl_add_u64 v[254:255], s[96:97], 0, v[252:253]
 global_load_lds_dwordx4 v[254:255], off offset:0
 global_load_lds_dwordx4 v[254:255], off offset:1024
 global_load_lds_dwordx4 v[254:255], off offset:2048
 global_load_lds_dwordx4 v[254:255], off offset:3072
 v_add_u32 v249, 7, v248
 s_add_u32 s3, s67, 49152
 s_waitcnt vmcnt(24)
 s_mov_b64 exec, 1
 buffer_store_dword v249, off, s[16:19], s3 sc1
 s_mov_b64 exec, -1
 s_waitcnt vmcnt(0)
 s_barrier
 s_branch L_fin
L_tailend:
L_odd:
ST2_2:
 s_cbranch_execz STB2_0
 s_bitcmp1_b32 s44, 1
 s_cbranch_scc1 L_dft
 .p2align 3
 v_dot2_f32_bf16 v224, v136, v220, v216
 v_dot2_f32_bf16 v225, v137, v220, v216
 v_dot2_f32_bf16 v226, v138, v220, v216
 v_dot2_f32_bf16 v227, v139, v220, v216
 v_dot2_f32_bf16 v228, v140, v220, v216
 v_dot2_f32_bf16 v229, v141, v220, v216
 v_dot2_f32_bf16 v230, v142, v220, v216
 v_dot2_f32_bf16 v231, v143, v220, v216
 v_dot2_f32_bf16 v232, v136, v221, v216
 v_dot2_f32_bf16 v233, v137, v221, v216
 v_dot2_f32_bf16 v234, v138, v221, v216
 v_dot2_f32_bf16 v235, v139, v221, v216
 v_dot2_f32_bf16 v236, v140, v221, v216
 v_dot2_f32_bf16 v237, v141, v221, v216
 v_dot2_f32_bf16 v238, v142, v221, v216
 v_dot2_f32_bf16 v239, v143, v221, v216
 v_cvt_pk_bf16_f32 v136, v224, v225
 v_cvt_pk_bf16_f32 v137, v226, v227
 v_cvt_pk_bf16_f32 v138, v228, v229
 v_cvt_pk_bf16_f32 v139, v230, v231
 v_cvt_pk_bf16_f32 v140, v232, v233
 v_cvt_pk_bf16_f32 v141, v234, v235
 v_cvt_pk_bf16_f32 v142, v236, v237
 v_cvt_pk_bf16_f32 v143, v238, v239
 v_dot2_f32_bf16 v224, v144, v220, v216
 v_dot2_f32_bf16 v225, v145, v220, v216
 v_dot2_f32_bf16 v226, v146, v220, v216
 v_dot2_f32_bf16 v227, v147, v220, v216
 v_dot2_f32_bf16 v228, v148, v220, v216
 v_dot2_f32_bf16 v229, v149, v220, v216
 v_dot2_f32_bf16 v230, v150, v220, v216
 v_dot2_f32_bf16 v231, v151, v220, v216
 v_dot2_f32_bf16 v232, v144, v221, v216
 v_dot2_f32_bf16 v233, v145, v221, v216
 v_dot2_f32_bf16 v234, v146, v221, v216
 v_dot2_f32_bf16 v235, v147, v221, v216
 v_dot2_f32_bf16 v236, v148, v221, v216
 v_dot2_f32_bf16 v237, v149, v221, v216
 v_dot2_f32_bf16 v238, v150, v221, v216
 v_dot2_f32_bf16 v239, v151, v221, v216
 v_cvt_pk_bf16_f32 v144, v224, v225
 v_cvt_pk_bf16_f32 v145, v226, v227
 v_cvt_pk_bf16_f32 v146, v228, v229
 v_cvt_pk_bf16_f32 v147, v230, v231
 v_cvt_pk_bf16_f32 v148, v232, v233
 v_cvt_pk_bf16_f32 v149, v234, v235
 v_cvt_pk_bf16_f32 v150, v236, v237
 v_cvt_pk_bf16_f32 v151, v238, v239
 s_lshr_b32 s96, s42, 1
 s_and_b32 s98, s42, 1
 s_mul_i32 s55, s96, 663552
 s_lshl_b32 s99, s98, 8
 s_add_u32 s55, s55, s99
 s_mul_i32 s99, s98, 294912
 s_add_u32 s56, s55, 73728
 s_add_u32 s56, s56, s99
 s_add_u32 s57, s55, 147456
 s_add_u32 s57, s57, s99
 s_add_u32 s58, s55, 221184
 s_add_u32 s58, s58, s99
 s_add_u32 s59, s55, 294912
 s_add_u32 s59, s59, s99
 s_add_u32 s60, s55, 368640
 s_sub_u32 s60, s60, s99
 s_add_u32 s61, s55, 442368
 s_sub_u32 s61, s61, s99
 s_add_u32 s62, s55, 516096
 s_sub_u32 s62, s62, s99
 s_add_u32 s63, s55, 589824
 s_sub_u32 s63, s63, s99
 s_mul_i32 s66, s43, 18
 s_lshl_b32 s98, s98, 2
 s_add_u32 s66, s66, s98
 s_lshl_b32 s66, s66, 3
 s_add_u32 s66, s66, s96
 s_lshl_b32 s66, s66, 11
 s_add_u32 s66, s66, 18874368
 s_and_b32 s98, s42, 1
 s_mul_i32 s32, s43, 288
 s_mul_i32 s99, s96, 36
 s_add_u32 s32, s32, s99
 s_lshl_b32 s32, s32, 10
 s_lshl_b32 s99, s98, 14
 s_sub_u32 s33, s32, s99
 s_xor_b32 s34, s67, 128
 s_bfe_u32 s98, s44, 0x30008
 s_sub_u32 s98, s98, 5
 s_lshl_b32 s98, s98, 6
 s_add_u32 s98, s98, s43
 s_bfe_u32 s99, s44, 0x30008
 s_sub_u32 s99, s99, 5
 s_bfe_u32 s96, s42, 0x10001
 s_mul_i32 s96, s96, 3
 s_add_u32 s99, s99, s96
 s_lshl_b32 s99, s99, 2
 s_add_u32 s99, s99, s40
 s_mul_i32 s99, s99, 13824
 s_lshr_b32 s96, s41, 3
 s_mul_i32 s96, s96, 663552
 s_add_u32 s99, s99, s96
 s_lshr_b32 s96, s42, 2
 s_mul_i32 s96, s96, 1327104
 s_add_u32 s99, s99, s96
 v_lshlrev_b32 v1, 7, v2
 s_bfm_b64 exec, 54, 0
 buffer_load_dword a255, v1, s[12:15], s99 offen
 s_mov_b64 exec, -1
 s_add_u32 s99, s99, 6912
 s_bfm_b64 exec, 54, 0
 buffer_load_dword a255, v1, s[12:15], s99 offen
 s_mov_b64 exec, -1
 s_add_u32 s99, s99, 6912
 s_mul_i32 s99, s98, 1920
 s_add_u32 s99, s99, 368640
 v_add_u32 v254, s99, v1
 v_min_u32 v254, 724988, v254
 v_mov_b32 v255, 0
 v_lshl_add_u64 v[254:255], s[100:101], 0, v[254:255]
 s_bfm_b64 exec, 15, 0
 global_load_dword a255, v[254:255], off
 s_mov_b64 exec, -1
 s_add_u32 m0, s64, 73600
 s_nop 0
 buffer_load_dwordx4 v4, s[8:11], s46 offen offset:128  lds
 buffer_load_dwordx4 v5, s[8:11], s46 offen offset:1152  lds
 s_add_u32 m0, s64, 81792
 s_nop 0
 buffer_load_dwordx4 v4, s[8:11], s47 offen offset:128  lds
 buffer_load_dwordx4 v5, s[8:11], s47 offen offset:1152  lds
 s_add_u32 m0, s64, 89984
 s_nop 0
 buffer_load_dwordx4 v4, s[8:11], s48 offen offset:128  lds
 buffer_load_dwordx4 v5, s[8:11], s48 offen offset:1152  lds
 s_add_u32 m0, s64, 98176
 s_nop 0
 buffer_load_dwordx4 v4, s[8:11], s49 offen offset:128  lds
 buffer_load_dwordx4 v5, s[8:11], s49 offen offset:1152  lds
 s_add_u32 m0, s64, 106368
 s_nop 0
 buffer_load_dwordx4 v4, s[8:11], s50 offen offset:128  lds
 buffer_load_dwordx4 v5, s[8:11], s50 offen offset:1152  lds
 s_add_u32 m0, s64, 114560
 s_nop 0
 buffer_load_dwordx4 v4, s[8:11], s51 offen offset:128  lds
 buffer_load_dwordx4 v5, s[8:11], s51 offen offset:1152  lds
 s_add_u32 m0, s64, 122752
 s_nop 0
 buffer_load_dwordx4 v4, s[8:11], s52 offen offset:128  lds
 buffer_load_dwordx4 v5, s[8:11], s52 offen offset:1152  lds
 s_add_u32 m0, s64, 130944
 s_nop 0
 buffer_load_dwordx4 v4, s[8:11], s53 offen offset:128  lds
 buffer_load_dwordx4 v5, s[8:11], s53 offen offset:1152  lds
 s_add_u32 m0, s64, 139136
 s_nop 0
 buffer_load_dwordx4 v4, s[8:11], s54 offen offset:128  lds
 buffer_load_dwordx4 v5, s[8:11], s54 offen offset:1152  lds
 s_add_u32 m0, s64, 0
 s_add_u32 s68, s46, 256
 buffer_load_dwordx4 v4, s[8:11], s68 offen  lds
 buffer_load_dwordx4 v5, s[8:11], s68 offen offset:1024  lds
 s_add_u32 m0, s64, 7936
 s_nop 0
 buffer_load_dwordx4 v4, s[8:11], s47 offen offset:256  lds
 buffer_load_dwordx4 v5, s[8:11], s47 offen offset:1280  lds
 s_add_u32 m0, s64, 16128
 s_nop 0
 buffer_load_dwordx4 v4, s[8:11], s48 offen offset:256  lds
 buffer_load_dwordx4 v5, s[8:11], s48 offen offset:1280  lds
 s_waitcnt vmcnt(18)
 s_barrier
 ds_read_b64_tr_b16 a[0:1], v242 offset:24576
 ds_read_b64_tr_b16 a[2:3], v242 offset:25088
 ds_read_b64_tr_b16 a[4:5], v243 offset:24576
 ds_read_b64_tr_b16 a[6:7], v243 offset:25088
 ds_read_b64_tr_b16 a[8:9], v242 offset:26624
 ds_read_b64_tr_b16 a[10:11], v242 offset:27136
 ds_read_b64_tr_b16 a[12:13], v243 offset:26624
 ds_read_b64_tr_b16 a[14:15], v243 offset:27136
 ds_read_b64_tr_b16 a[16:17], v242 offset:28672
 ds_read_b64_tr_b16 a[18:19], v242 offset:29184
 ds_read_b64_tr_b16 a[20:21], v243 offset:28672
 ds_read_b64_tr_b16 a[22:23], v243 offset:29184
 ds_read_b128 v[184:187], v246 offset:256
 ds_read_b128 v[188:191], v246 offset:288
 ds_read_b128 v[192:195], v246 offset:320
 ds_read_b128 v[196:199], v246 offset:352
 ds_read_b128 v[200:203], v246 offset:384
 ds_read_b128 v[204:207], v246 offset:416
 ds_read_b128 v[208:211], v246 offset:448
 ds_read_b128 v[212:215], v246 offset:480
 s_waitcnt lgkmcnt(0)
 v_mfma_f32_32x32x16_bf16 v[184:199], a[0:3], v[8:11], v[184:199]
 ds_read_b64_tr_b16 a[24:25], v242 offset:30720
 ds_read_b64_tr_b16 a[26:27], v242 offset:31232
 v_mfma_f32_32x32x16_bf16 v[200:215], a[4:7], v[8:11], v[200:215]
 ds_read_b64_tr_b16 a[28:29], v243 offset:30720
 s_add_u32 m0, s64, 24320
ST2_3:
 s_cbranch_execz STB2_0
 ds_read_b64_tr_b16 a[30:31], v243 offset:31232
 buffer_load_dwordx4 v4, s[8:11], s49 offen offset:256  lds
 v_mfma_f32_32x32x16_bf16 v[184:199], a[8:11], v[12:15], v[184:199]
 ds_read_b64_tr_b16 a[0:1], v242 offset:32768
 ds_read_b64_tr_b16 a[2:3], v242 offset:33280
NC_22:
 v_readfirstlane_b32 s45, v248
 s_nop 3
 s_cmp_eq_u32 s45, 0
 s_cbranch_scc1 NS_23
NK_24:
 v_mfma_f32_32x32x16_bf16 v[200:215], a[12:15], v[12:15], v[200:215]
 ds_read_b64_tr_b16 a[4:5], v243 offset:32768
 ds_read_b64_tr_b16 a[6:7], v243 offset:33280
 s_waitcnt lgkmcnt(4)
 v_mfma_f32_32x32x16_bf16 v[184:199], a[16:19], v[16:19], v[184:199]
 ds_read_b64_tr_b16 a[8:9], v242 offset:34816
 ds_read_b64_tr_b16 a[10:11], v242 offset:35328
 v_mfma_f32_32x32x16_bf16 v[200:215], a[20:23], v[16:19], v[200:215]
 ds_read_b64_tr_b16 a[12:13], v243 offset:34816
 ds_read_b64_tr_b16 a[14:15], v243 offset:35328
 buffer_load_dwordx4 v5, s[8:11], s49 offen offset:1280  lds
 v_mfma_f32_32x32x16_bf16 v[184:199], a[24:27], v[20:23], v[184:199]
 ds_read_b64_tr_b16 a[16:17], v242 offset:36864
 ds_read_b64_tr_b16 a[18:19], v242 offset:37376
 v_mfma_f32_32x32x16_bf16 v[200:215], a[28:31], v[20:23], v[200:215]
 ds_read_b64_tr_b16 a[20:21], v243 offset:36864
 ds_read_b64_tr_b16 a[22:23], v243 offset:37376
 s_waitcnt lgkmcnt(4)
 v_mfma_f32_32x32x16_bf16 v[184:199], a[0:3], v[24:27], v[184:199]
 ds_read_b64_tr_b16 a[24:25], v242 offset:38912
 ds_read_b64_tr_b16 a[26:27], v242 offset:39424
 v_mfma_f32_32x32x16_bf16 v[200:215], a[4:7], v[24:27], v[200:215]
 ds_read_b64_tr_b16 a[28:29], v243 offset:38912
 s_add_u32 m0, s64, 32512
 ds_read_b64_tr_b16 a[30:31], v243 offset:39424
 buffer_load_dwordx4 v4, s[8:11], s50 offen offset:256  lds
 v_mfma_f32_32x32x16_bf16 v[184:199], a[8:11], v[28:31], v[184:199]
 ds_read_b64_tr_b16 a[0:1], v242 offset:40960
 ds_read_b64_tr_b16 a[2:3], v242 offset:41472
 s_min_u32 s3, s40, 2
 s_lshl_b32 s3, s3, 12
 s_add_u32 s3, s3, 149504
 v_and_b32 v224, 31, v2
 v_lshl_add_u32 v224, v224, 6, s3
 v_mfma_f32_32x32x16_bf16 v[200:215], a[12:15], v[28:31], v[200:215]
 ds_read_b64_tr_b16 a[4:5], v243 offset:40960
 ds_read_b64_tr_b16 a[6:7], v243 offset:41472
 s_waitcnt lgkmcnt(4)
 v_mfma_f32_32x32x16_bf16 v[184:199], a[16:19], v[32:35], v[184:199]
 ds_read_b64_tr_b16 a[8:9], v242 offset:43008
 ds_read_b64_tr_b16 a[10:11], v242 offset:43520
 v_mfma_f32_32x32x16_bf16 v[200:215], a[20:23], v[32:35], v[200:215]
 ds_read_b64_tr_b16 a[12:13], v243 offset:43008
 ds_read_b64_tr_b16 a[14:15], v243 offset:43520
 buffer_load_dwordx4 v5, s[8:11], s50 offen offset:1280  lds
 v_mfma_f32_32x32x16_bf16 v[184:199], a[24:27], v[36:39], v[184:199]
 ds_read_b64_tr_b16 a[16:17], v242 offset:45056
 ds_read_b64_tr_b16 a[18:19], v242 offset:45568
 v_bfe_u32 v225, v2, 2, 2
 v_mfma_f32_32x32x16_bf16 v[200:215], a[28:31], v[36:39], v[200:215]
 ds_read_b64_tr_b16 a[20:21], v243 offset:45056
 ds_read_b64_tr_b16 a[22:23], v243 offset:45568
 v_lshl_add_u32 v224, v225, 4, v224
 s_waitcnt lgkmcnt(4)
 v_mfma_f32_32x32x16_bf16 v[184:199], a[0:3], v[40:43], v[184:199]
 ds_read_b64_tr_b16 a[24:25], v242 offset:47104
 ds_read_b64_tr_b16 a[26:27], v242 offset:47616
 v_lshrrev_b32 v225, 5, v2
 v_mfma_f32_32x32x16_bf16 v[200:215], a[4:7], v[40:43], v[200:215]
 ds_read_b64_tr_b16 a[28:29], v243 offset:47104
 s_add_u32 m0, s64, 40704
 ds_read_b64_tr_b16 a[30:31], v243 offset:47616
 buffer_load_dwordx4 v4, s[8:11], s51 offen offset:256  lds
 v_lshl_add_u32 v224, v225, 3, v224
 v_mfma_f32_32x32x16_bf16 v[184:199], a[8:11], v[44:47], v[184:199]
 s_waitcnt vmcnt(17)
 s_barrier
 ds_read_b64_tr_b16 a[0:1], v244 offset:0
 ds_read_b64_tr_b16 a[2:3], v244 offset:512
 ds_read_b64 a[232:233], v224 offset:0
 v_mfma_f32_32x32x16_bf16 v[200:215], a[12:15], v[44:47], v[200:215]
 ds_read_b64_tr_b16 a[4:5], v245 offset:0
 ds_read_b64_tr_b16 a[6:7], v245 offset:512
 ds_read_b64 a[240:241], v224 offset:2048
 s_waitcnt lgkmcnt(6)
 v_mfma_f32_32x32x16_bf16 v[184:199], a[16:19], v[48:51], v[184:199]
 ds_read_b64_tr_b16 a[8:9], v244 offset:2048
 ds_read_b64_tr_b16 a[10:11], v244 offset:2560
 v_xor_b32 v225, 16, v224
 v_mfma_f32_32x32x16_bf16 v[200:215], a[20:23], v[48:51], v[200:215]
 ds_read_b64_tr_b16 a[12:13], v245 offset:2048
 ds_read_b64_tr_b16 a[14:15], v245 offset:2560
 buffer_load_dwordx4 v5, s[8:11], s51 offen offset:1280  lds
 ds_read_b64 a[234:235], v225 offset:0
 v_mfma_f32_32x32x16_bf16 v[184:199], a[24:27], v[52:55], v[184:199]
 ds_read_b64_tr_b16 a[16:17], v244 offset:4096
 ds_read_b64_tr_b16 a[18:19], v244 offset:4608
 ds_read_b64 a[242:243], v225 offset:2048
 v_mfma_f32_32x32x16_bf16 v[200:215], a[28:31], v[52:55], v[200:215]
 ds_read_b64_tr_b16 a[20:21], v245 offset:4096
 ds_read_b64_tr_b16 a[22:23], v245 offset:4608
 v_xor_b32 v225, 32, v224
 s_waitcnt lgkmcnt(6)
 v_mfma_f32_32x32x16_bf16 v[184:199], a[0:3], v[56:59], v[184:199]
 ds_read_b64_tr_b16 a[24:25], v244 offset:6144
 ds_read_b64_tr_b16 a[26:27], v244 offset:6656
 v_mfma_f32_32x32x16_bf16 v[200:215], a[4:7], v[56:59], v[200:215]
 ds_read_b64_tr_b16 a[28:29], v245 offset:6144
 s_add_u32 m0, s64, 48896
 ds_read_b64_tr_b16 a[30:31], v245 offset:6656
 buffer_load_dwordx4 v4, s[8:11], s52 offen offset:256  lds
 ds_read_b64 a[236:237], v225 offset:0
 v_mfma_f32_32x32x16_bf16 v[184:199], a[8:11], v[60:63], v[184:199]
 ds_read_b64_tr_b16 a[0:1], v244 offset:8192
 ds_read_b64_tr_b16 a[2:3], v244 offset:8704
 ds_read_b64 a[244:245], v225 offset:2048
 v_mfma_f32_32x32x16_bf16 v[200:215], a[12:15], v[60:63], v[200:215]
 ds_read_b64_tr_b16 a[4:5], v245 offset:8192
 ds_read_b64_tr_b16 a[6:7], v245 offset:8704
 v_xor_b32 v225, 48, v224
 s_waitcnt lgkmcnt(6)
 v_mfma_f32_32x32x16_bf16 v[184:199], a[16:19], v[64:67], v[184:199]
 ds_read_b64_tr_b16 a[8:9], v244 offset:10240
 ds_read_b64_tr_b16 a[10:11], v244 offset:10752
 ds_read_b64 a[238:239], v225 offset:0
 v_mfma_f32_32x32x16_bf16 v[200:215], a[20:23], v[64:67], v[200:215]
 ds_read_b64_tr_b16 a[12:13], v245 offset:10240
 ds_read_b64_tr_b16 a[14:15], v245 offset:10752
 buffer_load_dwordx4 v5, s[8:11], s52 offen offset:1280  lds
 ds_read_b64 a[246:247], v225 offset:2048
 v_mfma_f32_32x32x16_bf16 v[184:199], a[24:27], v[68:71], v[184:199]
 ds_read_b64_tr_b16 a[16:17], v244 offset:12288
 ds_read_b64_tr_b16 a[18:19], v244 offset:12800
 v_mfma_f32_32x32x16_bf16 v[200:215], a[28:31], v[68:71], v[200:215]
 ds_read_b64_tr_b16 a[20:21], v245 offset:12288
 ds_read_b64_tr_b16 a[22:23], v245 offset:12800
 s_waitcnt lgkmcnt(5)
 v_mfma_f32_32x32x16_bf16 v[184:199], a[0:3], v[72:75], v[184:199]
 ds_read_b64_tr_b16 a[24:25], v244 offset:14336
 ds_read_b64_tr_b16 a[26:27], v244 offset:14848
 v_mfma_f32_32x32x16_bf16 v[200:215], a[4:7], v[72:75], v[200:215]
 ds_read_b64_tr_b16 a[28:29], v245 offset:14336
 s_add_u32 m0, s64, 57088
 ds_read_b64_tr_b16 a[30:31], v245 offset:14848
 buffer_load_dwordx4 v4, s[8:11], s53 offen offset:256  lds
 v_mfma_f32_32x32x16_bf16 v[184:199], a[8:11], v[76:79], v[184:199]
 ds_read_b64_tr_b16 a[0:1], v244 offset:16384
 ds_read_b64_tr_b16 a[2:3], v244 offset:16896
 v_mfma_f32_32x32x16_bf16 v[200:215], a[12:15], v[76:79], v[200:215]
 ds_read_b64_tr_b16 a[4:5], v245 offset:16384
 ds_read_b64_tr_b16 a[6:7], v245 offset:16896
 s_waitcnt lgkmcnt(4)
 v_mfma_f32_32x32x16_bf16 v[184:199], a[16:19], v[80:83], v[184:199]
 ds_read_b64_tr_b16 a[8:9], v244 offset:18432
 ds_read_b64_tr_b16 a[10:11], v244 offset:18944
 v_mfma_f32_32x32x16_bf16 v[200:215], a[20:23], v[80:83], v[200:215]
 ds_read_b64_tr_b16 a[12:13], v245 offset:18432
 ds_read_b64_tr_b16 a[14:15], v245 offset:18944
 buffer_load_dwordx4 v5, s[8:11], s53 offen offset:1280  lds
 v_mfma_f32_32x32x16_bf16 v[184:199], a[24:27], v[84:87], v[184:199]
 ds_read_b64_tr_b16 a[16:17], v244 offset:20480
 ds_read_b64_tr_b16 a[18:19], v244 offset:20992
 v_mfma_f32_32x32x16_bf16 v[200:215], a[28:31], v[84:87], v[200:215]
 ds_read_b64_tr_b16 a[20:21], v245 offset:20480
 ds_read_b64_tr_b16 a[22:23], v245 offset:20992
 s_waitcnt lgkmcnt(4)
 v_mfma_f32_32x32x16_bf16 v[184:199], a[0:3], v[88:91], v[184:199]
 ds_read_b64_tr_b16 a[24:25], v244 offset:22528
 ds_read_b64_tr_b16 a[26:27], v244 offset:23040
 v_mfma_f32_32x32x16_bf16 v[200:215], a[4:7], v[88:91], v[200:215]
 ds_read_b64_tr_b16 a[28:29], v245 offset:22528
 s_add_u32 m0, s64, 65280
 ds_read_b64_tr_b16 a[30:31], v245 offset:23040
 buffer_load_dwordx4 v4, s[8:11], s54 offen offset:256  lds
 ds_read_b128 v[152:155], v246 offset:512
 v_mfma_f32_32x32x16_bf16 v[184:199], a[8:11], v[92:95], v[184:199]
 s_waitcnt vmcnt(17)
 s_barrier
 ds_read_b64_tr_b16 a[0:1], v244 offset:24576
 ds_read_b64_tr_b16 a[2:3], v244 offset:25088
 v_mfma_f32_32x32x16_bf16 v[200:215], a[12:15], v[92:95], v[200:215]
 ds_read_b64_tr_b16 a[4:5], v245 offset:24576
 ds_read_b64_tr_b16 a[6:7], v245 offset:25088
 s_waitcnt lgkmcnt(5)
 v_mfma_f32_32x32x16_bf16 v[184:199], a[16:19], v[96:99], v[184:199]
 ds_read_b64_tr_b16 a[8:9], v244 offset:26624
 ds_read_b64_tr_b16 a[10:11], v244 offset:27136
 ds_read_b128 v[156:159], v246 offset:544
 v_mfma_f32_32x32x16_bf16 v[200:215], a[20:23], v[96:99], v[200:215]
 ds_read_b64_tr_b16 a[12:13], v245 offset:26624
 ds_read_b64_tr_b16 a[14:15], v245 offset:27136
 buffer_load_dwordx4 v5, s[8:11], s54 offen offset:1280  lds
 v_mfma_f32_32x32x16_bf16 v[184:199], a[24:27], v[100:103], v[184:199]
 ds_read_b64_tr_b16 a[16:17], v244 offset:28672
 ds_read_b64_tr_b16 a[18:19], v244 offset:29184
 v_mfma_f32_32x32x16_bf16 v[200:215], a[28:31], v[100:103], v[200:215]
 ds_read_b64_tr_b16 a[20:21], v245 offset:28672
 ds_read_b64_tr_b16 a[22:23], v245 offset:29184
 s_waitcnt lgkmcnt(4)
 v_mfma_f32_32x32x16_bf16 v[184:199], a[0:3], v[104:107], v[184:199]
 ds_read_b64_tr_b16 a[24:25], v244 offset:30720
 ds_read_b64_tr_b16 a[26:27], v244 offset:31232
 ds_read_b128 v[160:163], v246 offset:576
 v_mfma_f32_32x32x16_bf16 v[200:215], a[4:7], v[104:107], v[200:215]
 ds_read_b64_tr_b16 a[28:29], v245 offset:30720
 s_add_u32 m0, s64, 73344
 ds_read_b64_tr_b16 a[30:31], v245 offset:31232
 buffer_load_dwordx4 v4, s[8:11], s46 offen offset:384  lds
 v_mfma_f32_32x32x16_bf16 v[184:199], a[8:11], v[108:111], v[184:199]
 ds_read_b64_tr_b16 a[0:1], v244 offset:32768
 ds_read_b64_tr_b16 a[2:3], v244 offset:33280
 v_mfma_f32_32x32x16_bf16 v[200:215], a[12:15], v[108:111], v[200:215]
 ds_read_b64_tr_b16 a[4:5], v245 offset:32768
 ds_read_b64_tr_b16 a[6:7], v245 offset:33280
 ds_read_b128 v[164:167], v246 offset:608
 s_waitcnt lgkmcnt(5)
 v_mfma_f32_32x32x16_bf16 v[184:199], a[16:19], v[112:115], v[184:199]
 ds_read_b64_tr_b16 a[8:9], v244 offset:34816
 ds_read_b64_tr_b16 a[10:11], v244 offset:35328
 v_mfma_f32_32x32x16_bf16 v[200:215], a[20:23], v[112:115], v[200:215]
 ds_read_b64_tr_b16 a[12:13], v245 offset:34816
 ds_read_b64_tr_b16 a[14:15], v245 offset:35328
 buffer_load_dwordx4 v5, s[8:11], s46 offen offset:1408  lds
 v_mfma_f32_32x32x16_bf16 v[184:199], a[24:27], v[116:119], v[184:199]
 ds_read_b64_tr_b16 a[16:17], v244 offset:36864
 ds_read_b64_tr_b16 a[18:19], v244 offset:37376
 ds_read_b128 v[168:171], v246 offset:640
 v_mfma_f32_32x32x16_bf16 v[200:215], a[28:31], v[116:119], v[200:215]
 ds_read_b64_tr_b16 a[20:21], v245 offset:36864
 ds_read_b64_tr_b16 a[22:23], v245 offset:37376
 s_waitcnt lgkmcnt(5)
 v_mfma_f32_32x32x16_bf16 v[184:199], a[0:3], v[120:123], v[184:199]
 ds_read_b64_tr_b16 a[24:25], v244 offset:38912
 ds_read_b64_tr_b16 a[26:27], v244 offset:39424
 v_mfma_f32_32x32x16_bf16 v[200:215], a[4:7], v[120:123], v[200:215]
 ds_read_b64_tr_b16 a[28:29], v245 offset:38912
 s_add_u32 m0, s64, 81536
 ds_read_b64_tr_b16 a[30:31], v245 offset:39424
 buffer_load_dwordx4 v4, s[8:11], s47 offen offset:384  lds
 ds_read_b128 v[172:175], v246 offset:672
 v_mfma_f32_32x32x16_bf16 v[184:199], a[8:11], v[124:127], v[184:199]
 ds_read_b64_tr_b16 a[0:1], v244 offset:40960
 ds_read_b64_tr_b16 a[2:3], v244 offset:41472
 v_mfma_f32_32x32x16_bf16 v[200:215], a[12:15], v[124:127], v[200:215]
 ds_read_b64_tr_b16 a[4:5], v245 offset:40960
 ds_read_b64_tr_b16 a[6:7], v245 offset:41472
 s_waitcnt lgkmcnt(5)
 v_mfma_f32_32x32x16_bf16 v[184:199], a[16:19], v[128:131], v[184:199]
 ds_read_b64_tr_b16 a[8:9], v244 offset:43008
 ds_read_b64_tr_b16 a[10:11], v244 offset:43520
 v_mfma_f32_32x32x16_bf16 v[200:215], a[20:23], v[128:131], v[200:215]
 ds_read_b64_tr_b16 a[12:13], v245 offset:43008
 ds_read_b64_tr_b16 a[14:15], v245 offset:43520
 buffer_load_dwordx4 v5, s[8:11], s47 offen offset:1408  lds
 ds_read_b128 v[176:179], v246 offset:704
 v_mfma_f32_32x32x16_bf16 v[184:199], a[24:27], v[132:135], v[184:199]
 ds_read_b64_tr_b16 a[16:17], v244 offset:45056
 ds_read_b64_tr_b16 a[18:19], v244 offset:45568
 v_mfma_f32_32x32x16_bf16 v[200:215], a[28:31], v[132:135], v[200:215]
 ds_read_b64_tr_b16 a[20:21], v245 offset:45056
 ds_read_b64_tr_b16 a[22:23], v245 offset:45568
 s_waitcnt lgkmcnt(5)
 v_mfma_f32_32x32x16_bf16 v[184:199], a[0:3], v[136:139], v[184:199]
 ds_read_b64_tr_b16 a[24:25], v244 offset:47104
 ds_read_b64_tr_b16 a[26:27], v244 offset:47616
 ds_read_b128 v[180:183], v246 offset:736
 v_mfma_f32_32x32x16_bf16 v[200:215], a[4:7], v[136:139], v[200:215]
 ds_read_b64_tr_b16 a[28:29], v245 offset:47104
 s_add_u32 m0, s64, 89728
 ds_read_b64_tr_b16 a[30:31], v245 offset:47616
 buffer_load_dwordx4 v4, s[8:11], s48 offen offset:384  lds
 v_mfma_f32_32x32x16_bf16 v[184:199], a[8:11], v[140:143], v[184:199]
 s_waitcnt vmcnt(17)
 s_barrier
 ds_read_b64_tr_b16 a[0:1], v240 offset:0
 ds_read_b64_tr_b16 a[2:3], v240 offset:512
 v_mfma_f32_32x32x16_bf16 v[200:215], a[12:15], v[140:143], v[200:215]
 ds_read_b64_tr_b16 a[4:5], v241 offset:0
 ds_read_b64_tr_b16 a[6:7], v241 offset:512
 s_waitcnt lgkmcnt(4)
 v_mfma_f32_32x32x16_bf16 v[184:199], a[16:19], v[144:147], v[184:199]
 ds_read_b64_tr_b16 a[8:9], v240 offset:2048
 ds_read_b64_tr_b16 a[10:11], v240 offset:2560
 v_mfma_f32_32x32x16_bf16 v[200:215], a[20:23], v[144:147], v[200:215]
 ds_read_b64_tr_b16 a[12:13], v241 offset:2048
 ds_read_b64_tr_b16 a[14:15], v241 offset:2560
 buffer_load_dwordx4 v5, s[8:11], s48 offen offset:1408  lds
 v_mfma_f32_32x32x16_bf16 v[184:199], a[24:27], v[148:151], v[184:199]
 ds_read_b64_tr_b16 a[16:17], v240 offset:4096
 ds_read_b64_tr_b16 a[18:19], v240 offset:4608
 v_mfma_f32_32x32x16_bf16 v[200:215], a[28:31], v[148:151], v[200:215]
 ds_read_b64_tr_b16 a[20:21], v241 offset:4096
 ds_read_b64_tr_b16 a[22:23], v241 offset:4608
 s_branch L_s3
L_dft:
ST2_4:
 s_cbranch_execz STB2_1
 v_mov_b32 v250, v0
 v_add_u32 v251, 49152, v0
 s_barrier
 ds_read_b128 a[0:3], v250 offset:0
 ds_read_b128 a[4:7], v250 offset:1024
 ds_read_b128 a[8:11], v250 offset:2048
 ds_read_b128 a[12:15], v250 offset:3072
 ds_read_b128 a[16:19], v250 offset:4096
 ds_read_b128 a[20:23], v250 offset:5120
 .p2align 3
 v_dot2_f32_bf16 v224, v136, v220, v216
 v_dot2_f32_bf16 v225, v137, v220, v216
 v_dot2_f32_bf16 v226, v138, v220, v216
 v_dot2_f32_bf16 v227, v139, v220, v216
 v_dot2_f32_bf16 v228, v140, v220, v216
 v_dot2_f32_bf16 v229, v141, v220, v216
 v_dot2_f32_bf16 v230, v142, v220, v216
 v_dot2_f32_bf16 v231, v143, v220, v216
 v_dot2_f32_bf16 v232, v136, v221, v216
 v_dot2_f32_bf16 v233, v137, v221, v216
 v_dot2_f32_bf16 v234, v138, v221, v216
 v_dot2_f32_bf16 v235, v139, v221, v216
 v_dot2_f32_bf16 v236, v140, v221, v216
 v_dot2_f32_bf16 v237, v141, v221, v216
 v_dot2_f32_bf16 v238, v142, v221, v216
 v_dot2_f32_bf16 v239, v143, v221, v216
 v_cvt_pk_bf16_f32 v136, v224, v225
 v_cvt_pk_bf16_f32 v137, v226, v227
 v_cvt_pk_bf16_f32 v138, v228, v229
 v_cvt_pk_bf16_f32 v139, v230, v231
 v_cvt_pk_bf16_f32 v140, v232, v233
 v_cvt_pk_bf16_f32 v141, v234, v235
 v_cvt_pk_bf16_f32 v142, v236, v237
 v_cvt_pk_bf16_f32 v143, v238, v239
 v_dot2_f32_bf16 v224, v144, v220, v216
 v_dot2_f32_bf16 v225, v145, v220, v216
 v_dot2_f32_bf16 v226, v146, v220, v216
 v_dot2_f32_bf16 v227, v147, v220, v216
 v_dot2_f32_bf16 v228, v148, v220, v216
 v_dot2_f32_bf16 v229, v149, v220, v216
 v_dot2_f32_bf16 v230, v150, v220, v216
 v_dot2_f32_bf16 v231, v151, v220, v216
 v_dot2_f32_bf16 v232, v144, v221, v216
 v_dot2_f32_bf16 v233, v145, v221, v216
 v_dot2_f32_bf16 v234, v146, v221, v216
 v_dot2_f32_bf16 v235, v147, v221, v216
 v_dot2_f32_bf16 v236, v148, v221, v216
 v_dot2_f32_bf16 v237, v149, v221, v216
 v_dot2_f32_bf16 v238, v150, v221, v216
 v_dot2_f32_bf16 v239, v151, v221, v216
 v_cvt_pk_bf16_f32 v144, v224, v225
 v_cvt_pk_bf16_f32 v145, v226, v227
 v_cvt_pk_bf16_f32 v146, v228, v229
 v_cvt_pk_bf16_f32 v147, v230, v231
 v_cvt_pk_bf16_f32 v148, v232, v233
 v_cvt_pk_bf16_f32 v149, v234, v235
 v_cvt_pk_bf16_f32 v150, v236, v237
 v_cvt_pk_bf16_f32 v151, v238, v239
 s_waitcnt lgkmcnt(2)
 v_mfma_f32_32x32x16_bf16 v[152:167], v[8:11], a[0:3], 0
 ds_read_b128 a[24:27], v250 offset:6144
 v_mfma_f32_32x32x16_bf16 v[168:183], v[8:11], a[4:7], 0
 ds_read_b128 a[28:31], v250 offset:7168
 s_add_u32 m0, s64, 49152
 s_lshl_b32 s96, s61, 13
 s_add_u32 s96, s96, s66
 v_lshl_add_u64 v[254:255], s[96:97], 0, v[252:253]
 global_load_lds_dwordx4 v[254:255], off
 v_mfma_f32_32x32x16_bf16 a[200:215], v[12:15], a[8:11], 0
 ds_read_b128 a[0:3], v250 offset:8192
 v_mfma_f32_32x32x16_bf16 a[216:231], v[12:15], a[12:15], 0
 ds_read_b128 a[4:7], v250 offset:9216
 global_load_lds_dwordx4 v[254:255], off offset:1024
 s_waitcnt lgkmcnt(2)
 v_mfma_f32_32x32x16_bf16 v[152:167], v[16:19], a[16:19], v[152:167]
 ds_read_b128 a[8:11], v250 offset:10240
 v_mfma_f32_32x32x16_bf16 v[168:183], v[16:19], a[20:23], v[168:183]
 ds_read_b128 a[12:15], v250 offset:11264
 s_add_u32 m0, s64, 57344
 s_lshl_b32 s96, s62, 13
 s_add_u32 s96, s96, s66
 v_lshl_add_u64 v[254:255], s[96:97], 0, v[252:253]
 global_load_lds_dwordx4 v[254:255], off
 v_mfma_f32_32x32x16_bf16 a[200:215], v[20:23], a[24:27], a[200:215]
 ds_read_b128 a[16:19], v250 offset:12288
 v_mfma_f32_32x32x16_bf16 a[216:231], v[20:23], a[28:31], a[216:231]
 ds_read_b128 a[20:23], v250 offset:13312
 global_load_lds_dwordx4 v[254:255], off offset:1024
 s_waitcnt lgkmcnt(2)
 v_mfma_f32_32x32x16_bf16 v[152:167], v[24:27], a[0:3], v[152:167]
 ds_read_b128 a[24:27], v250 offset:14336
 v_mfma_f32_32x32x16_bf16 v[168:183], v[24:27], a[4:7], v[168:183]
 ds_read_b128 a[28:31], v250 offset:15360
 s_add_u32 m0, s64, 65536
 s_lshl_b32 s96, s63, 13
 s_add_u32 s96, s96, s66
 v_lshl_add_u64 v[254:255], s[96:97], 0, v[252:253]
 global_load_lds_dwordx4 v[254:255], off
 v_mfma_f32_32x32x16_bf16 a[200:215], v[28:31], a[8:11], a[200:215]
 ds_read_b128 a[0:3], v250 offset:16384
 s_min_u32 s3, s40, 2
 s_lshl_b32 s3, s3, 12
 s_add_u32 s3, s3, 149504
 v_and_b32 v224, 31, v2
 v_lshl_add_u32 v224, v224, 6, s3
 v_mfma_f32_32x32x16_bf16 a[216:231], v[28:31], a[12:15], a[216:231]
 ds_read_b128 a[4:7], v250 offset:17408
 global_load_lds_dwordx4 v[254:255], off offset:1024
 s_waitcnt lgkmcnt(2)
 v_mfma_f32_32x32x16_bf16 v[152:167], v[32:35], a[16:19], v[152:167]
 ds_read_b128 a[8:11], v250 offset:18432
 v_mfma_f32_32x32x16_bf16 v[168:183], v[32:35], a[20:23], v[168:183]
 s_add_u32 m0, s64, 73600
 ds_read_b128 a[12:15], v250 offset:19456
 buffer_load_dwordx4 v4, s[8:11], s46 offen offset:128  lds
 v_mfma_f32_32x32x16_bf16 a[200:215], v[36:39], a[24:27], a[200:215]
 ds_read_b128 a[16:19], v250 offset:20480
 v_bfe_u32 v225, v2, 2, 2
 v_mfma_f32_32x32x16_bf16 a[216:231], v[36:39], a[28:31], a[216:231]
 ds_read_b128 a[20:23], v250 offset:21504
 buffer_load_dwordx4 v5, s[8:11], s46 offen offset:1152  lds
 v_lshl_add_u32 v224, v225, 4, v224
 s_waitcnt lgkmcnt(2)
 v_mfma_f32_32x32x16_bf16 v[152:167], v[40:43], a[0:3], v[152:167]
 ds_read_b128 a[24:27], v250 offset:22528
 v_lshrrev_b32 v225, 5, v2
 v_mfma_f32_32x32x16_bf16 v[168:183], v[40:43], a[4:7], v[168:183]
 s_add_u32 m0, s64, 81792
 ds_read_b128 a[28:31], v250 offset:23552
 buffer_load_dwordx4 v4, s[8:11], s47 offen offset:128  lds
 v_lshl_add_u32 v224, v225, 3, v224
 v_mfma_f32_32x32x16_bf16 a[200:215], v[44:47], a[8:11], a[200:215]
 s_barrier
 ds_read_b128 a[0:3], v250 offset:24576
 ds_read_b64 a[232:233], v224 offset:0
 v_mfma_f32_32x32x16_bf16 a[216:231], v[44:47], a[12:15], a[216:231]
 ds_read_b128 a[4:7], v250 offset:25600
 buffer_load_dwordx4 v5, s[8:11], s47 offen offset:1152  lds
 ds_read_b64 a[240:241], v224 offset:2048
 s_waitcnt lgkmcnt(4)
 v_mfma_f32_32x32x16_bf16 v[152:167], v[48:51], a[16:19], v[152:167]
 ds_read_b128 a[8:11], v250 offset:26624
 v_xor_b32 v225, 16, v224
 v_mfma_f32_32x32x16_bf16 v[168:183], v[48:51], a[20:23], v[168:183]
 s_add_u32 m0, s64, 89984
 ds_read_b128 a[12:15], v250 offset:27648
 buffer_load_dwordx4 v4, s[8:11], s48 offen offset:128  lds
 ds_read_b64 a[234:235], v225 offset:0
 v_mfma_f32_32x32x16_bf16 a[200:215], v[52:55], a[24:27], a[200:215]
 ds_read_b128 a[16:19], v250 offset:28672
 ds_read_b64 a[242:243], v225 offset:2048
 v_mfma_f32_32x32x16_bf16 a[216:231], v[52:55], a[28:31], a[216:231]
 ds_read_b128 a[20:23], v250 offset:29696
 buffer_load_dwordx4 v5, s[8:11], s48 offen offset:1152  lds
 v_xor_b32 v225, 32, v224
 s_waitcnt lgkmcnt(4)
 v_mfma_f32_32x32x16_bf16 v[152:167], v[56:59], a[0:3], v[152:167]
 ds_read_b128 a[24:27], v250 offset:30720
 v_mfma_f32_32x32x16_bf16 v[168:183], v[56:59], a[4:7], v[168:183]
 s_add_u32 m0, s64, 98176
 ds_read_b128 a[28:31], v250 offset:31744
 buffer_load_dwordx4 v4, s[8:11], s49 offen offset:128  lds
 ds_read_b64 a[236:237], v225 offset:0
 v_mfma_f32_32x32x16_bf16 a[200:215], v[60:63], a[8:11], a[200:215]
 ds_read_b128 a[0:3], v250 offset:32768
 ds_read_b64 a[244:245], v225 offset:2048
 v_mfma_f32_32x32x16_bf16 a[216:231], v[60:63], a[12:15], a[216:231]
 ds_read_b128 a[4:7], v250 offset:33792
 buffer_load_dwordx4 v5, s[8:11], s49 offen offset:1152  lds
 v_xor_b32 v225, 48, v224
 s_waitcnt lgkmcnt(4)
 v_mfma_f32_32x32x16_bf16 v[152:167], v[64:67], a[16:19], v[152:167]
 ds_read_b128 a[8:11], v250 offset:34816
 ds_read_b64 a[238:239], v225 offset:0
 v_mfma_f32_32x32x16_bf16 v[168:183], v[64:67], a[20:23], v[168:183]
 s_add_u32 m0, s64, 106368
 ds_read_b128 a[12:15], v250 offset:35840
 buffer_load_dwordx4 v4, s[8:11], s50 offen offset:128  lds
 ds_read_b64 a[246:247], v225 offset:2048
 v_mfma_f32_32x32x16_bf16 a[200:215], v[68:71], a[24:27], a[200:215]
 ds_read_b128 a[16:19], v250 offset:36864
 s_lshr_b32 s96, s42, 1
 s_and_b32 s98, s42, 1
 s_nop 0
 v_mfma_f32_32x32x16_bf16 a[216:231], v[68:71], a[28:31], a[216:231]
 ds_read_b128 a[20:23], v250 offset:37888
 buffer_load_dwordx4 v5, s[8:11], s50 offen offset:1152  lds
 s_mul_i32 s55, s96, 663552
 s_lshl_b32 s99, s98, 8
 s_waitcnt lgkmcnt(3)
 v_mfma_f32_32x32x16_bf16 v[152:167], v[72:75], a[0:3], v[152:167]
 ds_read_b128 a[24:27], v250 offset:38912
 s_add_u32 s55, s55, s99
 s_mul_i32 s99, s98, 294912
 s_add_u32 s56, s55, 73728
 v_mfma_f32_32x32x16_bf16 v[168:183], v[72:75], a[4:7], v[168:183]
 s_add_u32 m0, s64, 114560
 ds_read_b128 a[28:31], v250 offset:39936
 buffer_load_dwordx4 v4, s[8:11], s51 offen offset:128  lds
 s_add_u32 s56, s56, s99
 s_add_u32 s57, s55, 147456
 v_mfma_f32_32x32x16_bf16 a[200:215], v[76:79], a[8:11], a[200:215]
 ds_read_b128 a[0:3], v250 offset:40960
 s_add_u32 s57, s57, s99
 s_add_u32 s58, s55, 221184
 v_mfma_f32_32x32x16_bf16 a[216:231], v[76:79], a[12:15], a[216:231]
 ds_read_b128 a[4:7], v250 offset:41984
 buffer_load_dwordx4 v5, s[8:11], s51 offen offset:1152  lds
 s_add_u32 s58, s58, s99
 s_add_u32 s59, s55, 294912
 s_waitcnt lgkmcnt(2)
 v_mfma_f32_32x32x16_bf16 v[152:167], v[80:83], a[16:19], v[152:167]
 ds_read_b128 a[8:11], v250 offset:43008
 s_add_u32 s59, s59, s99
 s_add_u32 s60, s55, 368640
 v_mfma_f32_32x32x16_bf16 v[168:183], v[80:83], a[20:23], v[168:183]
 s_add_u32 m0, s64, 122752
 ds_read_b128 a[12:15], v250 offset:44032
 buffer_load_dwordx4 v4, s[8:11], s52 offen offset:128  lds
 s_sub_u32 s60, s60, s99
 s_add_u32 s61, s55, 442368
 v_mfma_f32_32x32x16_bf16 a[200:215], v[84:87], a[24:27], a[200:215]
 ds_read_b128 a[16:19], v250 offset:45056
 s_sub_u32 s61, s61, s99
 s_add_u32 s62, s55, 516096
 s_sub_u32 s62, s62, s99
 v_mfma_f32_32x32x16_bf16 a[216:231], v[84:87], a[28:31], a[216:231]
 ds_read_b128 a[20:23], v250 offset:46080
 buffer_load_dwordx4 v5, s[8:11], s52 offen offset:1152  lds
 s_add_u32 s63, s55, 589824
 s_sub_u32 s63, s63, s99
 s_waitcnt lgkmcnt(2)
 v_mfma_f32_32x32x16_bf16 v[152:167], v[88:91], a[0:3], v[152:167]
 ds_read_b128 a[24:27], v250 offset:47104
 s_mul_i32 s66, s43, 18
 s_lshl_b32 s98, s98, 2
 v_mfma_f32_32x32x16_bf16 v[168:183], v[88:91], a[4:7], v[168:183]
 s_add_u32 m0, s64, 130944
 ds_read_b128 a[28:31], v250 offset:48128
 buffer_load_dwordx4 v4, s[8:11], s53 offen offset:128  lds
 s_add_u32 s66, s66, s98
 s_lshl_b32 s66, s66, 3
 v_mfma_f32_32x32x16_bf16 a[200:215], v[92:95], a[8:11], a[200:215]
 s_waitcnt vmcnt(15)
 s_barrier
 ds_read_b128 a[0:3], v251 offset:0
 s_add_u32 s66, s66, s96
 s_lshl_b32 s66, s66, 11
 v_mfma_f32_32x32x16_bf16 a[216:231], v[92:95], a[12:15], a[216:231]
 ds_read_b128 a[4:7], v251 offset:1024
 buffer_load_dwordx4 v5, s[8:11], s53 offen offset:1152  lds
 s_add_u32 s66, s66, 18874368
 s_and_b32 s98, s42, 1
 s_waitcnt lgkmcnt(2)
 v_mfma_f32_32x32x16_bf16 v[152:167], v[96:99], a[16:19], v[152:167]
 ds_read_b128 a[8:11], v251 offset:2048
 s_mul_i32 s32, s43, 288
 s_mul_i32 s99, s96, 36
 s_add_u32 s32, s32, s99
 v_mfma_f32_32x32x16_bf16 v[168:183], v[96:99], a[20:23], v[168:183]
 s_add_u32 m0, s64, 139136
 ds_read_b128 a[12:15], v251 offset:3072
ST2_5:
 s_cbranch_execz STB2_1
 buffer_load_dwordx4 v4, s[8:11], s54 offen offset:128  lds
 s_lshl_b32 s32, s32, 10
 s_lshl_b32 s99, s98, 14
 v_mfma_f32_32x32x16_bf16 a[200:215], v[100:103], a[24:27], a[200:215]
 ds_read_b128 a[16:19], v251 offset:4096
 s_sub_u32 s33, s32, s99
 s_xor_b32 s34, s67, 128
 v_mfma_f32_32x32x16_bf16 a[216:231], v[100:103], a[28:31], a[216:231]
 ds_read_b128 a[20:23], v251 offset:5120
 s_waitcnt lgkmcnt(2)
 v_mfma_f32_32x32x16_bf16 v[152:167], v[104:107], a[0:3], v[152:167]
 ds_read_b128 a[24:27], v251 offset:6144
 v_and_b32 v1, 31, v2
 v_lshlrev_b32 v1, 6, v1
 v_mfma_f32_32x32x16_bf16 v[168:183], v[104:107], a[4:7], v[168:183]
 ds_read_b128 a[28:31], v251 offset:7168
 buffer_load_dwordx4 v5, s[8:11], s54 offen offset:1152  lds
 v_lshrrev_b32 v3, 5, v2
 v_mfma_f32_32x32x16_bf16 a[200:215], v[108:111], a[8:11], a[200:215]
 ds_read_b128 a[0:3], v251 offset:8192
 v_lshlrev_b32 v3, 1, v3
 v_bfe_u32 v250, v2, 1, 2
 v_mfma_f32_32x32x16_bf16 a[216:231], v[108:111], a[12:15], a[216:231]
 ds_read_b128 a[4:7], v251 offset:9216
 v_xor_b32 v3, v3, v250
 v_lshl_add_u32 v1, v3, 4, v1
 s_waitcnt lgkmcnt(2)
 v_mfma_f32_32x32x16_bf16 v[152:167], v[112:115], a[16:19], v[152:167]
 ds_read_b128 a[8:11], v251 offset:10240
 s_add_u32 s98, s64, 149504
 v_mfma_f32_32x32x16_bf16 v[168:183], v[112:115], a[20:23], v[168:183]
 ds_read_b128 a[12:15], v251 offset:11264
 s_add_u32 m0, s64, 0
 s_add_u32 s68, s46, 256
 buffer_load_dwordx4 v4, s[8:11], s68 offen  lds
 v_add_u32 v1, s98, v1
 v_bfe_u32 v3, v2, 3, 2
 v_mfma_f32_32x32x16_bf16 a[200:215], v[116:119], a[24:27], a[200:215]
 ds_read_b128 a[16:19], v251 offset:12288
 v_lshlrev_b32 v3, 4, v3
 v_xor_b32 v3, v3, v0
 v_mfma_f32_32x32x16_bf16 a[216:231], v[116:119], a[28:31], a[216:231]
 ds_read_b128 a[20:23], v251 offset:13312
 v_add_u32 v3, s98, v3
 s_waitcnt lgkmcnt(2)
 v_mfma_f32_32x32x16_bf16 v[152:167], v[120:123], a[0:3], v[152:167]
 ds_read_b128 a[24:27], v251 offset:14336
 v_lshrrev_b32 v250, 2, v2
 v_mul_u32_u24 v250, 73728, v250
 ds_read_b128 v[184:187], v246 offset:256
 v_mfma_f32_32x32x16_bf16 v[168:183], v[120:123], a[4:7], v[168:183]
 ds_read_b128 a[28:31], v251 offset:15360
 buffer_load_dwordx4 v5, s[8:11], s68 offen offset:1024  lds
 v_and_b32 v254, 3, v2
 v_lshl_add_u32 v250, v254, 4, v250
 v_mfma_f32_32x32x16_bf16 a[200:215], v[124:127], a[8:11], a[200:215]
 ds_read_b128 a[0:3], v251 offset:16384
 s_bfe_u32 s96, s44, 0x30008
 ds_read_b128 v[188:191], v246 offset:288
 v_mfma_f32_32x32x16_bf16 a[216:231], v[124:127], a[12:15], a[216:231]
 ds_read_b128 a[4:7], v251 offset:17408
 s_lshl_b32 s98, s96, 6
 s_add_u32 s98, s98, s43
 s_waitcnt lgkmcnt(3)
 v_mfma_f32_32x32x16_bf16 v[152:167], v[128:131], a[16:19], v[152:167]
 ds_read_b128 a[8:11], v251 offset:18432
 s_lshl_b32 s35, s98, 3
 s_add_u32 s35, s35, 42602496
 ds_read_b128 v[192:195], v246 offset:320
 v_mfma_f32_32x32x16_bf16 v[168:183], v[128:131], a[20:23], v[168:183]
 s_add_u32 m0, s64, 7936
 ds_read_b128 a[12:15], v251 offset:19456
 buffer_load_dwordx4 v4, s[8:11], s47 offen offset:256  lds
 s_lshl_b32 s98, s98, 7
 v_mfma_f32_32x32x16_bf16 a[200:215], v[132:135], a[24:27], a[200:215]
 ds_read_b128 a[16:19], v251 offset:20480
 s_add_u32 s98, s98, 37748736
 s_sub_u32 s99, 8, s96
 ds_read_b128 v[196:199], v246 offset:352
 v_mfma_f32_32x32x16_bf16 a[216:231], v[132:135], a[28:31], a[216:231]
 ds_read_b128 a[20:23], v251 offset:21504
 s_lshl_b32 s99, s99, 6
 s_add_u32 s99, s99, s43
 ds_read_b128 v[200:203], v246 offset:384
 s_waitcnt lgkmcnt(4)
 v_mfma_f32_32x32x16_bf16 v[152:167], v[136:139], a[0:3], v[152:167]
 ds_read_b128 a[24:27], v251 offset:22528
 s_lshl_b32 s99, s99, 7
 v_mfma_f32_32x32x16_bf16 v[168:183], v[136:139], a[4:7], v[168:183]
 ds_read_b128 a[28:31], v251 offset:23552
 buffer_load_dwordx4 v5, s[8:11], s47 offen offset:1280  lds
 s_add_u32 s99, s99, 37748736
 s_cmp_eq_u32 s96, 4
 s_cselect_b32 s96, 5386240, 0
 s_add_u32 s99, s99, s96
 ds_read_b128 v[204:207], v246 offset:416
 v_mfma_f32_32x32x16_bf16 a[200:215], v[140:143], a[8:11], a[200:215]
 s_waitcnt vmcnt(16)
 s_barrier
 ds_read_b64_tr_b16 a[0:1], v242 offset:24576
 ds_read_b64_tr_b16 a[2:3], v242 offset:25088
 v_mfma_f32_32x32x16_bf16 a[216:231], v[140:143], a[12:15], a[216:231]
 ds_read_b64_tr_b16 a[4:5], v243 offset:24576
 ds_read_b64_tr_b16 a[6:7], v243 offset:25088
 ds_read_b128 v[208:211], v246 offset:448
 s_waitcnt lgkmcnt(6)
 v_mfma_f32_32x32x16_bf16 v[152:167], v[144:147], a[16:19], v[152:167]
 ds_read_b64_tr_b16 a[8:9], v242 offset:26624
 s_add_u32 m0, s64, 16128
 ds_read_b64_tr_b16 a[10:11], v242 offset:27136
 buffer_load_dwordx4 v4, s[8:11], s48 offen offset:256  lds
 v_mfma_f32_32x32x16_bf16 v[168:183], v[144:147], a[20:23], v[168:183]
 ds_read_b64_tr_b16 a[12:13], v243 offset:26624
 ds_read_b64_tr_b16 a[14:15], v243 offset:27136
 buffer_load_dwordx4 v5, s[8:11], s48 offen offset:1280  lds
 ds_read_b128 v[212:215], v246 offset:480
 v_mfma_f32_32x32x16_bf16 a[200:215], v[148:151], a[24:27], a[200:215]
 ds_read_b64_tr_b16 a[16:17], v242 offset:28672
 ds_read_b64_tr_b16 a[18:19], v242 offset:29184
 v_mfma_f32_32x32x16_bf16 a[216:231], v[148:151], a[28:31], a[216:231]
 ds_read_b64_tr_b16 a[20:21], v243 offset:28672
 ds_read_b64_tr_b16 a[22:23], v243 offset:29184
 s_waitcnt lgkmcnt(4)
 v_mfma_f32_32x32x16_bf16 v[184:199], a[0:3], v[8:11], v[184:199]
 ds_read_b64_tr_b16 a[24:25], v242 offset:30720
 ds_read_b64_tr_b16 a[26:27], v242 offset:31232
 v_mfma_f32_32x32x16_bf16 v[200:215], a[4:7], v[8:11], v[200:215]
 ds_read_b64_tr_b16 a[28:29], v243 offset:30720
 s_add_u32 m0, s64, 24320
 ds_read_b64_tr_b16 a[30:31], v243 offset:31232
 buffer_load_dwordx4 v4, s[8:11], s49 offen offset:256  lds
 v_mfma_f32_32x32x16_bf16 v[184:199], a[8:11], v[12:15], v[184:199]
 ds_read_b64_tr_b16 a[0:1], v242 offset:32768
 ds_read_b64_tr_b16 a[2:3], v242 offset:33280
NC_25:
 v_readfirstlane_b32 s45, v248
 s_nop 3
 s_cmp_eq_u32 s45, 0
 s_cbranch_scc1 NS_26
NK_27:
 v_mfma_f32_32x32x16_bf16 v[200:215], a[12:15], v[12:15], v[200:215]
 ds_read_b64_tr_b16 a[4:5], v243 offset:32768
 ds_read_b64_tr_b16 a[6:7], v243 offset:33280
 v_add_u32 v251, 1179648, v250
 v_accvgpr_read_b32 v220, a200
 v_accvgpr_read_b32 v221, a201
 v_add_f32 v216, v152, v220
 s_waitcnt lgkmcnt(4)
 v_mfma_f32_32x32x16_bf16 v[184:199], a[16:19], v[16:19], v[184:199]
 ds_read_b64_tr_b16 a[8:9], v242 offset:34816
 ds_read_b64_tr_b16 a[10:11], v242 offset:35328
 v_add_f32 v217, v153, v221
 v_sub_f32 v218, v152, v220
 v_sub_f32 v219, v153, v221
 v_cvt_pk_bf16_f32 v224, v216, v217
 v_cvt_pk_bf16_f32 v152, v218, v219
 v_mfma_f32_32x32x16_bf16 v[200:215], a[20:23], v[16:19], v[200:215]
 ds_read_b64_tr_b16 a[12:13], v243 offset:34816
 ds_read_b64_tr_b16 a[14:15], v243 offset:35328
 buffer_load_dwordx4 v5, s[8:11], s49 offen offset:1280  lds
 v_accvgpr_read_b32 v220, a202
 v_accvgpr_read_b32 v221, a203
 v_add_f32 v216, v154, v220
 v_add_f32 v217, v155, v221
 v_mfma_f32_32x32x16_bf16 v[184:199], a[24:27], v[20:23], v[184:199]
 ds_read_b64_tr_b16 a[16:17], v242 offset:36864
 ds_read_b64_tr_b16 a[18:19], v242 offset:37376
 v_sub_f32 v218, v154, v220
 v_sub_f32 v219, v155, v221
 v_cvt_pk_bf16_f32 v225, v216, v217
 v_cvt_pk_bf16_f32 v153, v218, v219
 v_mfma_f32_32x32x16_bf16 v[200:215], a[28:31], v[20:23], v[200:215]
 ds_read_b64_tr_b16 a[20:21], v243 offset:36864
 ds_read_b64_tr_b16 a[22:23], v243 offset:37376
 v_accvgpr_read_b32 v220, a204
 v_accvgpr_read_b32 v221, a205
 v_add_f32 v216, v156, v220
 v_add_f32 v217, v157, v221
 v_sub_f32 v218, v156, v220
 s_waitcnt lgkmcnt(4)
 v_mfma_f32_32x32x16_bf16 v[184:199], a[0:3], v[24:27], v[184:199]
 ds_read_b64_tr_b16 a[24:25], v242 offset:38912
 ds_read_b64_tr_b16 a[26:27], v242 offset:39424
 v_sub_f32 v219, v157, v221
 v_cvt_pk_bf16_f32 v226, v216, v217
 v_cvt_pk_bf16_f32 v154, v218, v219
 v_accvgpr_read_b32 v220, a206
 v_mfma_f32_32x32x16_bf16 v[200:215], a[4:7], v[24:27], v[200:215]
 ds_read_b64_tr_b16 a[28:29], v243 offset:38912
 s_add_u32 m0, s64, 32512
 ds_read_b64_tr_b16 a[30:31], v243 offset:39424
 buffer_load_dwordx4 v4, s[8:11], s50 offen offset:256  lds
 v_accvgpr_read_b32 v221, a207
 v_add_f32 v216, v158, v220
 v_add_f32 v217, v159, v221
 v_sub_f32 v218, v158, v220
 v_mfma_f32_32x32x16_bf16 v[184:199], a[8:11], v[28:31], v[184:199]
 ds_read_b64_tr_b16 a[0:1], v242 offset:40960
 ds_read_b64_tr_b16 a[2:3], v242 offset:41472
 v_sub_f32 v219, v159, v221
 v_cvt_pk_bf16_f32 v227, v216, v217
 v_cvt_pk_bf16_f32 v155, v218, v219
 v_accvgpr_read_b32 v220, a208
 v_mfma_f32_32x32x16_bf16 v[200:215], a[12:15], v[28:31], v[200:215]
 ds_read_b64_tr_b16 a[4:5], v243 offset:40960
 ds_read_b64_tr_b16 a[6:7], v243 offset:41472
 v_accvgpr_read_b32 v221, a209
 v_add_f32 v216, v160, v220
 v_add_f32 v217, v161, v221
 v_sub_f32 v218, v160, v220
 v_sub_f32 v219, v161, v221
 s_waitcnt lgkmcnt(4)
 v_mfma_f32_32x32x16_bf16 v[184:199], a[16:19], v[32:35], v[184:199]
 ds_read_b64_tr_b16 a[8:9], v242 offset:43008
 ds_read_b64_tr_b16 a[10:11], v242 offset:43520
 v_cvt_pk_bf16_f32 v228, v216, v217
 v_cvt_pk_bf16_f32 v156, v218, v219
 v_accvgpr_read_b32 v220, a210
 v_accvgpr_read_b32 v221, a211
 v_mfma_f32_32x32x16_bf16 v[200:215], a[20:23], v[32:35], v[200:215]
 ds_read_b64_tr_b16 a[12:13], v243 offset:43008
 ds_read_b64_tr_b16 a[14:15], v243 offset:43520
 buffer_load_dwordx4 v5, s[8:11], s50 offen offset:1280  lds
 v_add_f32 v216, v162, v220
 v_add_f32 v217, v163, v221
 v_sub_f32 v218, v162, v220
 v_sub_f32 v219, v163, v221
 v_mfma_f32_32x32x16_bf16 v[184:199], a[24:27], v[36:39], v[184:199]
 ds_read_b64_tr_b16 a[16:17], v242 offset:45056
 ds_read_b64_tr_b16 a[18:19], v242 offset:45568
 v_cvt_pk_bf16_f32 v229, v216, v217
 v_cvt_pk_bf16_f32 v157, v218, v219
 v_accvgpr_read_b32 v220, a212
 v_accvgpr_read_b32 v221, a213
 v_add_f32 v216, v164, v220
 v_mfma_f32_32x32x16_bf16 v[200:215], a[28:31], v[36:39], v[200:215]
 ds_read_b64_tr_b16 a[20:21], v243 offset:45056
 ds_read_b64_tr_b16 a[22:23], v243 offset:45568
 v_add_f32 v217, v165, v221
 v_sub_f32 v218, v164, v220
 v_sub_f32 v219, v165, v221
 v_cvt_pk_bf16_f32 v230, v216, v217
 s_waitcnt lgkmcnt(4)
 v_mfma_f32_32x32x16_bf16 v[184:199], a[0:3], v[40:43], v[184:199]
 ds_read_b64_tr_b16 a[24:25], v242 offset:47104
 ds_read_b64_tr_b16 a[26:27], v242 offset:47616
 v_cvt_pk_bf16_f32 v158, v218, v219
 v_accvgpr_read_b32 v220, a214
 v_accvgpr_read_b32 v221, a215
 v_add_f32 v216, v166, v220
 v_mfma_f32_32x32x16_bf16 v[200:215], a[4:7], v[40:43], v[200:215]
 ds_read_b64_tr_b16 a[28:29], v243 offset:47104
 s_add_u32 m0, s64, 40704
 ds_read_b64_tr_b16 a[30:31], v243 offset:47616
 buffer_load_dwordx4 v4, s[8:11], s51 offen offset:256  lds
 v_add_f32 v217, v167, v221
 v_sub_f32 v218, v166, v220
 v_sub_f32 v219, v167, v221
 v_cvt_pk_bf16_f32 v231, v216, v217
 v_cvt_pk_bf16_f32 v159, v218, v219
 v_mfma_f32_32x32x16_bf16 v[184:199], a[8:11], v[44:47], v[184:199]
 s_waitcnt vmcnt(17)
 s_barrier
 ds_read_b64_tr_b16 a[0:1], v244 offset:0
 ds_read_b64_tr_b16 a[2:3], v244 offset:512
 v_accvgpr_read_b32 v220, a216
 v_accvgpr_read_b32 v221, a217
 v_add_f32 v216, v168, v220
 v_add_f32 v217, v169, v221
 v_mfma_f32_32x32x16_bf16 v[200:215], a[12:15], v[44:47], v[200:215]
 ds_read_b64_tr_b16 a[4:5], v245 offset:0
 ds_read_b64_tr_b16 a[6:7], v245 offset:512
 v_sub_f32 v218, v220, v168
 v_sub_f32 v219, v221, v169
 v_cvt_pk_bf16_f32 v232, v216, v217
 v_cvt_pk_bf16_f32 v160, v218, v219
 s_waitcnt lgkmcnt(4)
 v_mfma_f32_32x32x16_bf16 v[184:199], a[16:19], v[48:51], v[184:199]
 ds_read_b64_tr_b16 a[8:9], v244 offset:2048
 ds_read_b64_tr_b16 a[10:11], v244 offset:2560
 v_accvgpr_read_b32 v220, a218
 v_accvgpr_read_b32 v221, a219
 v_add_f32 v216, v170, v220
 v_add_f32 v217, v171, v221
 v_mfma_f32_32x32x16_bf16 v[200:215], a[20:23], v[48:51], v[200:215]
 ds_read_b64_tr_b16 a[12:13], v245 offset:2048
 ds_read_b64_tr_b16 a[14:15], v245 offset:2560
 buffer_load_dwordx4 v5, s[8:11], s51 offen offset:1280  lds
 v_sub_f32 v218, v220, v170
 v_sub_f32 v219, v221, v171
 v_cvt_pk_bf16_f32 v233, v216, v217
 v_cvt_pk_bf16_f32 v161, v218, v219
 v_accvgpr_read_b32 v220, a220
 v_mfma_f32_32x32x16_bf16 v[184:199], a[24:27], v[52:55], v[184:199]
 ds_read_b64_tr_b16 a[16:17], v244 offset:4096
 ds_read_b64_tr_b16 a[18:19], v244 offset:4608
 v_accvgpr_read_b32 v221, a221
 v_add_f32 v216, v172, v220
 v_add_f32 v217, v173, v221
 v_sub_f32 v218, v220, v172
 v_mfma_f32_32x32x16_bf16 v[200:215], a[28:31], v[52:55], v[200:215]
 ds_read_b64_tr_b16 a[20:21], v245 offset:4096
 ds_read_b64_tr_b16 a[22:23], v245 offset:4608
 v_sub_f32 v219, v221, v173
 v_cvt_pk_bf16_f32 v234, v216, v217
 v_cvt_pk_bf16_f32 v162, v218, v219
 v_accvgpr_read_b32 v220, a222
 s_waitcnt lgkmcnt(4)
 v_mfma_f32_32x32x16_bf16 v[184:199], a[0:3], v[56:59], v[184:199]
 ds_read_b64_tr_b16 a[24:25], v244 offset:6144
 ds_read_b64_tr_b16 a[26:27], v244 offset:6656
 v_accvgpr_read_b32 v221, a223
 v_add_f32 v216, v174, v220
 v_add_f32 v217, v175, v221
 v_sub_f32 v218, v220, v174
 v_sub_f32 v219, v221, v175
 v_mfma_f32_32x32x16_bf16 v[200:215], a[4:7], v[56:59], v[200:215]
 ds_read_b64_tr_b16 a[28:29], v245 offset:6144
 s_add_u32 m0, s64, 48896
 ds_read_b64_tr_b16 a[30:31], v245 offset:6656
 buffer_load_dwordx4 v4, s[8:11], s52 offen offset:256  lds
 v_cvt_pk_bf16_f32 v235, v216, v217
 v_cvt_pk_bf16_f32 v163, v218, v219
 v_accvgpr_read_b32 v220, a224
 v_accvgpr_read_b32 v221, a225
 v_mfma_f32_32x32x16_bf16 v[184:199], a[8:11], v[60:63], v[184:199]
 ds_read_b64_tr_b16 a[0:1], v244 offset:8192
 ds_read_b64_tr_b16 a[2:3], v244 offset:8704
 v_add_f32 v216, v176, v220
 v_add_f32 v217, v177, v221
 v_sub_f32 v218, v220, v176
 v_sub_f32 v219, v221, v177
 v_mfma_f32_32x32x16_bf16 v[200:215], a[12:15], v[60:63], v[200:215]
 ds_read_b64_tr_b16 a[4:5], v245 offset:8192
 ds_read_b64_tr_b16 a[6:7], v245 offset:8704
 v_cvt_pk_bf16_f32 v236, v216, v217
 v_cvt_pk_bf16_f32 v164, v218, v219
 v_accvgpr_read_b32 v220, a226
 v_accvgpr_read_b32 v221, a227
 v_add_f32 v216, v178, v220
 s_waitcnt lgkmcnt(4)
 v_mfma_f32_32x32x16_bf16 v[184:199], a[16:19], v[64:67], v[184:199]
 ds_read_b64_tr_b16 a[8:9], v244 offset:10240
 ds_read_b64_tr_b16 a[10:11], v244 offset:10752
 v_add_f32 v217, v179, v221
 v_sub_f32 v218, v220, v178
 v_sub_f32 v219, v221, v179
 v_cvt_pk_bf16_f32 v237, v216, v217
 v_mfma_f32_32x32x16_bf16 v[200:215], a[20:23], v[64:67], v[200:215]
 ds_read_b64_tr_b16 a[12:13], v245 offset:10240
 ds_read_b64_tr_b16 a[14:15], v245 offset:10752
 buffer_load_dwordx4 v5, s[8:11], s52 offen offset:1280  lds
 v_cvt_pk_bf16_f32 v165, v218, v219
 v_accvgpr_read_b32 v220, a228
 v_accvgpr_read_b32 v221, a229
 v_add_f32 v216, v180, v220
 v_mfma_f32_32x32x16_bf16 v[184:199], a[24:27], v[68:71], v[184:199]
 ds_read_b64_tr_b16 a[16:17], v244 offset:12288
 ds_read_b64_tr_b16 a[18:19], v244 offset:12800
 v_add_f32 v217, v181, v221
 v_sub_f32 v218, v220, v180
 v_sub_f32 v219, v221, v181
 v_cvt_pk_bf16_f32 v238, v216, v217
 v_mfma_f32_32x32x16_bf16 v[200:215], a[28:31], v[68:71], v[200:215]
 ds_read_b64_tr_b16 a[20:21], v245 offset:12288
 ds_read_b64_tr_b16 a[22:23], v245 offset:12800
 v_cvt_pk_bf16_f32 v166, v218, v219
 v_accvgpr_read_b32 v220, a230
 v_accvgpr_read_b32 v221, a231
 v_add_f32 v216, v182, v220
 v_add_f32 v217, v183, v221
 s_waitcnt lgkmcnt(4)
 v_mfma_f32_32x32x16_bf16 v[184:199], a[0:3], v[72:75], v[184:199]
 ds_read_b64_tr_b16 a[24:25], v244 offset:14336
 ds_read_b64_tr_b16 a[26:27], v244 offset:14848
 v_sub_f32 v218, v220, v182
 v_sub_f32 v219, v221, v183
 v_cvt_pk_bf16_f32 v239, v216, v217
 v_cvt_pk_bf16_f32 v167, v218, v219
 v_mfma_f32_32x32x16_bf16 v[200:215], a[4:7], v[72:75], v[200:215]
 ds_read_b64_tr_b16 a[28:29], v245 offset:14336
 s_add_u32 m0, s64, 57088
 ds_read_b64_tr_b16 a[30:31], v245 offset:14848
 buffer_load_dwordx4 v4, s[8:11], s53 offen offset:256  lds
 s_nop 1
 v_mfma_f32_32x32x16_bf16 v[168:183], v[224:227], a[176:179], 0
 v_mfma_f32_32x32x16_bf16 v[168:183], v[228:231], a[180:183], v[168:183]
 v_mfma_f32_32x32x16_bf16 v[184:199], a[8:11], v[76:79], v[184:199]
 ds_read_b64_tr_b16 a[0:1], v244 offset:16384
 ds_read_b64_tr_b16 a[2:3], v244 offset:16896
 v_mfma_f32_32x32x16_bf16 v[168:183], v[232:235], a[184:187], v[168:183]
 v_mfma_f32_32x32x16_bf16 v[168:183], v[236:239], a[188:191], v[168:183]
 v_mfma_f32_32x32x16_bf16 v[200:215], a[12:15], v[76:79], v[200:215]
 ds_read_b64_tr_b16 a[4:5], v245 offset:16384
 ds_read_b64_tr_b16 a[6:7], v245 offset:16896
 s_waitcnt lgkmcnt(4)
 v_mfma_f32_32x32x16_bf16 v[184:199], a[16:19], v[80:83], v[184:199]
 ds_read_b64_tr_b16 a[8:9], v244 offset:18432
 ds_read_b64_tr_b16 a[10:11], v244 offset:18944
 v_mfma_f32_32x32x16_bf16 v[200:215], a[20:23], v[80:83], v[200:215]
 ds_read_b64_tr_b16 a[12:13], v245 offset:18432
 ds_read_b64_tr_b16 a[14:15], v245 offset:18944
 buffer_load_dwordx4 v5, s[8:11], s53 offen offset:1280  lds
 v_mfma_f32_32x32x16_bf16 v[184:199], a[24:27], v[84:87], v[184:199]
 ds_read_b64_tr_b16 a[16:17], v244 offset:20480
 ds_read_b64_tr_b16 a[18:19], v244 offset:20992
 v_cvt_pk_bf16_f32 v216, v168, v169
 v_cvt_pk_bf16_f32 v217, v170, v171
 v_cvt_pk_bf16_f32 v218, v172, v173
 v_cvt_pk_bf16_f32 v219, v174, v175
 v_mfma_f32_32x32x16_bf16 v[200:215], a[28:31], v[84:87], v[200:215]
 ds_read_b64_tr_b16 a[20:21], v245 offset:20480
 ds_read_b64_tr_b16 a[22:23], v245 offset:20992
 ds_write_b128 v1, v[216:219]
 v_cvt_pk_bf16_f32 v220, v176, v177
 v_cvt_pk_bf16_f32 v221, v178, v179
 v_cvt_pk_bf16_f32 v222, v180, v181
 v_cvt_pk_bf16_f32 v223, v182, v183
 s_waitcnt lgkmcnt(5)
 v_mfma_f32_32x32x16_bf16 v[184:199], a[0:3], v[88:91], v[184:199]
 ds_read_b64_tr_b16 a[24:25], v244 offset:22528
 ds_read_b64_tr_b16 a[26:27], v244 offset:23040
 v_xor_b32 v254, 16, v1
 ds_write_b128 v254, v[220:223]
 ds_read_b128 a[200:203], v3 offset:0
 ds_read_b128 a[204:207], v3 offset:1024
 v_mfma_f32_32x32x16_bf16 v[200:215], a[4:7], v[88:91], v[200:215]
 ds_read_b64_tr_b16 a[28:29], v245 offset:22528
 s_add_u32 m0, s64, 65280
 ds_read_b64_tr_b16 a[30:31], v245 offset:23040
 buffer_load_dwordx4 v4, s[8:11], s54 offen offset:256  lds
 s_nop 1
 v_mfma_f32_32x32x16_bf16 v[168:183], v[232:235], a[176:179], 0
 v_mfma_f32_32x32x16_bf16 v[168:183], v[236:239], a[180:183], v[168:183]
 v_mfma_f32_32x32x16_bf16 v[184:199], a[8:11], v[92:95], v[184:199]
 s_waitcnt vmcnt(17)
 s_barrier
 ds_read_b64_tr_b16 a[0:1], v244 offset:24576
 ds_read_b64_tr_b16 a[2:3], v244 offset:25088
 v_mfma_f32_32x32x16_bf16 v[168:183], v[224:227], a[192:195], v[168:183]
 v_mfma_f32_32x32x16_bf16 v[168:183], v[228:231], a[196:199], v[168:183]
 v_mfma_f32_32x32x16_bf16 v[200:215], a[12:15], v[92:95], v[200:215]
 ds_read_b64_tr_b16 a[4:5], v245 offset:24576
 ds_read_b64_tr_b16 a[6:7], v245 offset:25088
 s_waitcnt lgkmcnt(4)
 v_mfma_f32_32x32x16_bf16 v[184:199], a[16:19], v[96:99], v[184:199]
 ds_read_b64_tr_b16 a[8:9], v244 offset:26624
 ds_read_b64_tr_b16 a[10:11], v244 offset:27136
 v_mfma_f32_32x32x16_bf16 v[200:215], a[20:23], v[96:99], v[200:215]
 ds_read_b64_tr_b16 a[12:13], v245 offset:26624
 ds_read_b64_tr_b16 a[14:15], v245 offset:27136
 buffer_load_dwordx4 v5, s[8:11], s54 offen offset:1280  lds
 v_mfma_f32_32x32x16_bf16 v[184:199], a[24:27], v[100:103], v[184:199]
 ds_read_b64_tr_b16 a[16:17], v244 offset:28672
 ds_read_b64_tr_b16 a[18:19], v244 offset:29184
 v_cvt_pk_bf16_f32 v216, v168, v169
 v_cvt_pk_bf16_f32 v217, v170, v171
 v_cvt_pk_bf16_f32 v218, v172, v173
 v_cvt_pk_bf16_f32 v219, v174, v175
 buffer_store_dwordx4 a[200:203], v250, s[16:19], s98 offen offset:0 sc1
 v_mfma_f32_32x32x16_bf16 v[200:215], a[28:31], v[100:103], v[200:215]
 ds_read_b64_tr_b16 a[20:21], v245 offset:28672
 ds_read_b64_tr_b16 a[22:23], v245 offset:29184
 ds_write_b128 v1, v[216:219]
 v_cvt_pk_bf16_f32 v220, v176, v177
 v_cvt_pk_bf16_f32 v221, v178, v179
 v_cvt_pk_bf16_f32 v222, v180, v181
 v_cvt_pk_bf16_f32 v223, v182, v183
 s_waitcnt lgkmcnt(5)
 v_mfma_f32_32x32x16_bf16 v[184:199], a[0:3], v[104:107], v[184:199]
 ds_read_b64_tr_b16 a[24:25], v244 offset:30720
 ds_read_b64_tr_b16 a[26:27], v244 offset:31232
 v_xor_b32 v254, 16, v1
 ds_write_b128 v254, v[220:223]
 ds_read_b128 a[208:211], v3 offset:0
 ds_read_b128 a[212:215], v3 offset:1024
 v_mfma_f32_32x32x16_bf16 v[200:215], a[4:7], v[104:107], v[200:215]
 ds_read_b64_tr_b16 a[28:29], v245 offset:30720
 s_add_u32 m0, s64, 73344
 ds_read_b64_tr_b16 a[30:31], v245 offset:31232
 buffer_load_dwordx4 v4, s[8:11], s46 offen offset:384  lds
 s_nop 1
 v_mfma_f32_32x32x16_bf16 v[168:183], v[152:155], a[176:179], 0
 v_mfma_f32_32x32x16_bf16 v[168:183], v[156:159], a[180:183], v[168:183]
 v_mfma_f32_32x32x16_bf16 v[184:199], a[8:11], v[108:111], v[184:199]
 ds_read_b64_tr_b16 a[0:1], v244 offset:32768
 ds_read_b64_tr_b16 a[2:3], v244 offset:33280
 v_mfma_f32_32x32x16_bf16 v[168:183], v[160:163], a[184:187], v[168:183]
 v_mfma_f32_32x32x16_bf16 v[168:183], v[164:167], a[188:191], v[168:183]
 v_mfma_f32_32x32x16_bf16 v[200:215], a[12:15], v[108:111], v[200:215]
 ds_read_b64_tr_b16 a[4:5], v245 offset:32768
 ds_read_b64_tr_b16 a[6:7], v245 offset:33280
 s_waitcnt lgkmcnt(4)
 v_mfma_f32_32x32x16_bf16 v[184:199], a[16:19], v[112:115], v[184:199]
 ds_read_b64_tr_b16 a[8:9], v244 offset:34816
 ds_read_b64_tr_b16 a[10:11], v244 offset:35328
 v_mfma_f32_32x32x16_bf16 v[200:215], a[20:23], v[112:115], v[200:215]
 ds_read_b64_tr_b16 a[12:13], v245 offset:34816
 ds_read_b64_tr_b16 a[14:15], v245 offset:35328
 buffer_load_dwordx4 v5, s[8:11], s46 offen offset:1408  lds
 v_mfma_f32_32x32x16_bf16 v[184:199], a[24:27], v[116:119], v[184:199]
 ds_read_b64_tr_b16 a[16:17], v244 offset:36864
 ds_read_b64_tr_b16 a[18:19], v244 offset:37376
 v_cvt_pk_bf16_f32 v216, v183, v182
 v_cvt_pk_bf16_f32 v217, v181, v180
 v_cvt_pk_bf16_f32 v218, v179, v178
 v_cvt_pk_bf16_f32 v219, v177, v176
 v_xor_b32 v254, 32, v1
 v_mfma_f32_32x32x16_bf16 v[200:215], a[28:31], v[116:119], v[200:215]
 ds_read_b64_tr_b16 a[20:21], v245 offset:36864
 ds_read_b64_tr_b16 a[22:23], v245 offset:37376
 ds_write_b128 v254, v[216:219]
 v_cvt_pk_bf16_f32 v220, v175, v174
 v_cvt_pk_bf16_f32 v221, v173, v172
 v_cvt_pk_bf16_f32 v222, v171, v170
 buffer_store_dwordx4 a[204:207], v251, s[16:19], s98 offen offset:0 sc1
 s_waitcnt lgkmcnt(5)
 v_mfma_f32_32x32x16_bf16 v[184:199], a[0:3], v[120:123], v[184:199]
 ds_read_b64_tr_b16 a[24:25], v244 offset:38912
 ds_read_b64_tr_b16 a[26:27], v244 offset:39424
 v_cvt_pk_bf16_f32 v223, v169, v168
 v_xor_b32 v254, 48, v1
 ds_write_b128 v254, v[220:223]
 ds_read_b128 a[216:219], v3 offset:0
 ds_read_b128 a[220:223], v3 offset:1024
 v_mfma_f32_32x32x16_bf16 v[200:215], a[4:7], v[120:123], v[200:215]
 ds_read_b64_tr_b16 a[28:29], v245 offset:38912
 s_add_u32 m0, s64, 81536
 ds_read_b64_tr_b16 a[30:31], v245 offset:39424
 buffer_load_dwordx4 v4, s[8:11], s47 offen offset:384  lds
 s_nop 1
 v_mfma_f32_32x32x16_bf16 v[168:183], v[160:163], a[176:179], 0
 v_mfma_f32_32x32x16_bf16 v[168:183], v[164:167], a[180:183], v[168:183]
 v_mfma_f32_32x32x16_bf16 v[184:199], a[8:11], v[124:127], v[184:199]
 ds_read_b64_tr_b16 a[0:1], v244 offset:40960
 ds_read_b64_tr_b16 a[2:3], v244 offset:41472
 v_mfma_f32_32x32x16_bf16 v[168:183], v[152:155], a[192:195], v[168:183]
 v_mfma_f32_32x32x16_bf16 v[168:183], v[156:159], a[196:199], v[168:183]
 v_mfma_f32_32x32x16_bf16 v[200:215], a[12:15], v[124:127], v[200:215]
 ds_read_b64_tr_b16 a[4:5], v245 offset:40960
 ds_read_b64_tr_b16 a[6:7], v245 offset:41472
 s_waitcnt lgkmcnt(4)
 v_mfma_f32_32x32x16_bf16 v[184:199], a[16:19], v[128:131], v[184:199]
 ds_read_b64_tr_b16 a[8:9], v244 offset:43008
 ds_read_b64_tr_b16 a[10:11], v244 offset:43520
 v_mfma_f32_32x32x16_bf16 v[200:215], a[20:23], v[128:131], v[200:215]
 ds_read_b64_tr_b16 a[12:13], v245 offset:43008
 ds_read_b64_tr_b16 a[14:15], v245 offset:43520
 buffer_load_dwordx4 v5, s[8:11], s47 offen offset:1408  lds
 v_mfma_f32_32x32x16_bf16 v[184:199], a[24:27], v[132:135], v[184:199]
 ds_read_b64_tr_b16 a[16:17], v244 offset:45056
 ds_read_b64_tr_b16 a[18:19], v244 offset:45568
 v_cvt_pk_bf16_f32 v216, v183, v182
 v_cvt_pk_bf16_f32 v217, v181, v180
 v_cvt_pk_bf16_f32 v218, v179, v178
 v_cvt_pk_bf16_f32 v219, v177, v176
 v_xor_b32 v254, 32, v1
 v_mfma_f32_32x32x16_bf16 v[200:215], a[28:31], v[132:135], v[200:215]
 ds_read_b64_tr_b16 a[20:21], v245 offset:45056
 ds_read_b64_tr_b16 a[22:23], v245 offset:45568
 ds_write_b128 v254, v[216:219]
 v_cvt_pk_bf16_f32 v220, v175, v174
 v_cvt_pk_bf16_f32 v221, v173, v172
 v_cvt_pk_bf16_f32 v222, v171, v170
 s_waitcnt lgkmcnt(5)
 v_mfma_f32_32x32x16_bf16 v[184:199], a[0:3], v[136:139], v[184:199]
 ds_read_b64_tr_b16 a[24:25], v244 offset:47104
 ds_read_b64_tr_b16 a[26:27], v244 offset:47616
 v_cvt_pk_bf16_f32 v223, v169, v168
 v_xor_b32 v254, 48, v1
 ds_write_b128 v254, v[220:223]
 ds_read_b128 a[224:227], v3 offset:0
 ds_read_b128 a[228:231], v3 offset:1024
 v_mfma_f32_32x32x16_bf16 v[200:215], a[4:7], v[136:139], v[200:215]
 ds_read_b64_tr_b16 a[28:29], v245 offset:47104
 s_add_u32 m0, s64, 89728
 ds_read_b64_tr_b16 a[30:31], v245 offset:47616
 buffer_load_dwordx4 v4, s[8:11], s48 offen offset:384  lds
 buffer_store_dwordx4 a[208:211], v250, s[16:19], s98 offen offset:64 sc1
 ds_read_b128 v[152:155], v246 offset:512
ST2_6:
 s_cbranch_execz STB2_1
 ds_read_b128 v[156:159], v246 offset:544
 v_mfma_f32_32x32x16_bf16 v[184:199], a[8:11], v[140:143], v[184:199]
 s_waitcnt vmcnt(20)
 s_barrier
 ds_read_b64_tr_b16 a[0:1], v240 offset:0
 ds_read_b64_tr_b16 a[2:3], v240 offset:512
 ds_read_b128 v[160:163], v246 offset:576
 v_mfma_f32_32x32x16_bf16 v[200:215], a[12:15], v[140:143], v[200:215]
 ds_read_b64_tr_b16 a[4:5], v241 offset:0
 ds_read_b64_tr_b16 a[6:7], v241 offset:512
 ds_read_b128 v[164:167], v246 offset:608
 ds_read_b128 v[168:171], v246 offset:640
 s_waitcnt lgkmcnt(9)
 v_mfma_f32_32x32x16_bf16 v[184:199], a[16:19], v[144:147], v[184:199]
 ds_read_b64_tr_b16 a[8:9], v240 offset:2048
 ds_read_b64_tr_b16 a[10:11], v240 offset:2560
 ds_read_b128 v[172:175], v246 offset:672
 v_mfma_f32_32x32x16_bf16 v[200:215], a[20:23], v[144:147], v[200:215]
 ds_read_b64_tr_b16 a[12:13], v241 offset:2048
 ds_read_b64_tr_b16 a[14:15], v241 offset:2560
 buffer_load_dwordx4 v5, s[8:11], s48 offen offset:1408  lds
 ds_read_b128 v[176:179], v246 offset:704
 ds_read_b128 v[180:183], v246 offset:736
 v_mfma_f32_32x32x16_bf16 v[184:199], a[24:27], v[148:151], v[184:199]
 ds_read_b64_tr_b16 a[16:17], v240 offset:4096
 ds_read_b64_tr_b16 a[18:19], v240 offset:4608
 v_mfma_f32_32x32x16_bf16 v[200:215], a[28:31], v[148:151], v[200:215]
 ds_read_b64_tr_b16 a[20:21], v241 offset:4096
 ds_read_b64_tr_b16 a[22:23], v241 offset:4608
L_s3:
ST2_7:
 s_cbranch_execz STB2_1
 s_waitcnt lgkmcnt(4)
 v_mfma_f32_32x32x16_bf16 v[152:167], a[0:3], v[8:11], v[152:167]
 ds_read_b64_tr_b16 a[24:25], v240 offset:6144
 ds_read_b64_tr_b16 a[26:27], v240 offset:6656
 v_mfma_f32_32x32x16_bf16 v[168:183], a[4:7], v[8:11], v[168:183]
 ds_read_b64_tr_b16 a[28:29], v241 offset:6144
 s_add_u32 m0, s64, 97920
 ds_read_b64_tr_b16 a[30:31], v241 offset:6656
 buffer_load_dwordx4 v4, s[8:11], s49 offen offset:384  lds
 v_cvt_pk_f16_f32 v220, v184, v185
 v_cvt_pk_f16_f32 v221, v186, v187
 v_pk_fma_f16 v222, v220, v220, s70
 v_pk_fma_f16 v223, v221, v221, s70
 v_mfma_f32_32x32x16_bf16 v[152:167], a[8:11], v[12:15], v[152:167]
 ds_read_b64_tr_b16 a[0:1], v240 offset:8192
 ds_read_b64_tr_b16 a[2:3], v240 offset:8704
 v_pk_mul_f16 v220, v222, v220 neg_lo:[1,0] neg_hi:[1,0]
 v_pk_mul_f16 v221, v223, v221 neg_lo:[1,0] neg_hi:[1,0]
 v_exp_f16 v222, v220
 v_mfma_f32_32x32x16_bf16 v[168:183], a[12:15], v[12:15], v[168:183]
 ds_read_b64_tr_b16 a[4:5], v241 offset:8192
 ds_read_b64_tr_b16 a[6:7], v241 offset:8704
 v_exp_f16 v223, v221
 v_exp_f16_sdwa v222, v220 dst_sel:WORD_1 dst_unused:UNUSED_PRESERVE src0_sel:WORD_1
 s_waitcnt lgkmcnt(4)
 v_mfma_f32_32x32x16_bf16 v[152:167], a[16:19], v[16:19], v[152:167]
 ds_read_b64_tr_b16 a[8:9], v240 offset:10240
 ds_read_b64_tr_b16 a[10:11], v240 offset:10752
 v_exp_f16_sdwa v223, v221 dst_sel:WORD_1 dst_unused:UNUSED_PRESERVE src0_sel:WORD_1
 v_pk_fma_f16 v220, v222, v247, v247
 v_pk_fma_f16 v221, v223, v247, v247
 v_mfma_f32_32x32x16_bf16 v[168:183], a[20:23], v[16:19], v[168:183]
 ds_read_b64_tr_b16 a[12:13], v241 offset:10240
 ds_read_b64_tr_b16 a[14:15], v241 offset:10752
 buffer_load_dwordx4 v5, s[8:11], s49 offen offset:1408  lds
 v_rcp_f16 v216, v220
 v_rcp_f16 v218, v221
 s_bitcmp1_b32 s44, 1
 s_cbranch_scc0 ON_59
 buffer_store_dwordx4 a[212:215], v251, s[16:19], s98 offen offset:64 sc1
ON_59:
 v_mfma_f32_32x32x16_bf16 v[152:167], a[24:27], v[20:23], v[152:167]
 ds_read_b64_tr_b16 a[16:17], v240 offset:12288
 ds_read_b64_tr_b16 a[18:19], v240 offset:12800
 v_rcp_f16_sdwa v217, v220 dst_sel:WORD_0 dst_unused:UNUSED_PAD src0_sel:WORD_1
 v_rcp_f16_sdwa v219, v221 dst_sel:WORD_0 dst_unused:UNUSED_PAD src0_sel:WORD_1
 v_mfma_f32_32x32x16_bf16 v[168:183], a[28:31], v[20:23], v[168:183]
 ds_read_b64_tr_b16 a[20:21], v241 offset:12288
 ds_read_b64_tr_b16 a[22:23], v241 offset:12800
 v_fma_mix_f32 v216, v184, v216, 0 op_sel_hi:[0,1,0]
 v_fma_mix_f32 v218, v186, v218, 0 op_sel_hi:[0,1,0]
 v_fma_mix_f32 v217, v185, v217, 0 op_sel_hi:[0,1,0]
 v_fma_mix_f32 v219, v187, v219, 0 op_sel_hi:[0,1,0]
 s_waitcnt lgkmcnt(4)
 v_mfma_f32_32x32x16_bf16 v[152:167], a[0:3], v[24:27], v[152:167]
 ds_read_b64_tr_b16 a[24:25], v240 offset:14336
 ds_read_b64_tr_b16 a[26:27], v240 offset:14848
 ds_read_b128 v[184:187], v246 offset:768
 v_cvt_pk_bf16_f32 v224, v216, v217
 v_cvt_pk_bf16_f32 v225, v218, v219
 v_mfma_f32_32x32x16_bf16 v[168:183], a[4:7], v[24:27], v[168:183]
 ds_read_b64_tr_b16 a[28:29], v241 offset:14336
 s_add_u32 m0, s64, 106112
 ds_read_b64_tr_b16 a[30:31], v241 offset:14848
 buffer_load_dwordx4 v4, s[8:11], s50 offen offset:384  lds
 v_accvgpr_write_b32 a48, v224
 v_accvgpr_write_b32 a49, v225
 v_cvt_pk_f16_f32 v220, v188, v189
 v_cvt_pk_f16_f32 v221, v190, v191
 v_mfma_f32_32x32x16_bf16 v[152:167], a[8:11], v[28:31], v[152:167]
 ds_read_b64_tr_b16 a[0:1], v240 offset:16384
 ds_read_b64_tr_b16 a[2:3], v240 offset:16896
 v_pk_fma_f16 v222, v220, v220, s70
 v_pk_fma_f16 v223, v221, v221, s70
 v_pk_mul_f16 v220, v222, v220 neg_lo:[1,0] neg_hi:[1,0]
 v_pk_mul_f16 v221, v223, v221 neg_lo:[1,0] neg_hi:[1,0]
 v_mfma_f32_32x32x16_bf16 v[168:183], a[12:15], v[28:31], v[168:183]
 ds_read_b64_tr_b16 a[4:5], v241 offset:16384
 ds_read_b64_tr_b16 a[6:7], v241 offset:16896
 v_exp_f16 v222, v220
 v_exp_f16 v223, v221
 s_waitcnt lgkmcnt(4)
 v_mfma_f32_32x32x16_bf16 v[152:167], a[16:19], v[32:35], v[152:167]
 ds_read_b64_tr_b16 a[8:9], v240 offset:18432
 ds_read_b64_tr_b16 a[10:11], v240 offset:18944
 v_exp_f16_sdwa v222, v220 dst_sel:WORD_1 dst_unused:UNUSED_PRESERVE src0_sel:WORD_1
 v_exp_f16_sdwa v223, v221 dst_sel:WORD_1 dst_unused:UNUSED_PRESERVE src0_sel:WORD_1
 v_mfma_f32_32x32x16_bf16 v[168:183], a[20:23], v[32:35], v[168:183]
 ds_read_b64_tr_b16 a[12:13], v241 offset:18432
 ds_read_b64_tr_b16 a[14:15], v241 offset:18944
 buffer_load_dwordx4 v5, s[8:11], s50 offen offset:1408  lds
 v_pk_fma_f16 v220, v222, v247, v247
 v_pk_fma_f16 v221, v223, v247, v247
 v_rcp_f16 v216, v220
 s_bitcmp1_b32 s44, 1
 s_cbranch_scc0 ON_60
 buffer_store_dwordx4 a[216:219], v250, s[16:19], s99 offen offset:0 sc1
ON_60:
 v_mfma_f32_32x32x16_bf16 v[152:167], a[24:27], v[36:39], v[152:167]
 ds_read_b64_tr_b16 a[16:17], v240 offset:20480
 ds_read_b64_tr_b16 a[18:19], v240 offset:20992
 v_rcp_f16 v218, v221
 v_rcp_f16_sdwa v217, v220 dst_sel:WORD_0 dst_unused:UNUSED_PAD src0_sel:WORD_1
 v_mfma_f32_32x32x16_bf16 v[168:183], a[28:31], v[36:39], v[168:183]
 ds_read_b64_tr_b16 a[20:21], v241 offset:20480
 ds_read_b64_tr_b16 a[22:23], v241 offset:20992
 v_rcp_f16_sdwa v219, v221 dst_sel:WORD_0 dst_unused:UNUSED_PAD src0_sel:WORD_1
 v_fma_mix_f32 v216, v188, v216, 0 op_sel_hi:[0,1,0]
 s_waitcnt lgkmcnt(4)
 v_mfma_f32_32x32x16_bf16 v[152:167], a[0:3], v[40:43], v[152:167]
 ds_read_b64_tr_b16 a[24:25], v240 offset:22528
 ds_read_b64_tr_b16 a[26:27], v240 offset:23040
 v_fma_mix_f32 v218, v190, v218, 0 op_sel_hi:[0,1,0]
 v_fma_mix_f32 v217, v189, v217, 0 op_sel_hi:[0,1,0]
 v_fma_mix_f32 v219, v191, v219, 0 op_sel_hi:[0,1,0]
 ds_read_b128 v[188:191], v246 offset:800
 v_mfma_f32_32x32x16_bf16 v[168:183], a[4:7], v[40:43], v[168:183]
 ds_read_b64_tr_b16 a[28:29], v241 offset:22528
 s_add_u32 m0, s64, 114304
 ds_read_b64_tr_b16 a[30:31], v241 offset:23040
 buffer_load_dwordx4 v4, s[8:11], s51 offen offset:384  lds
 v_cvt_pk_bf16_f32 v226, v216, v217
 v_cvt_pk_bf16_f32 v227, v218, v219
 v_accvgpr_write_b32 a50, v226
 v_mfma_f32_32x32x16_bf16 v[152:167], a[8:11], v[44:47], v[152:167]
 s_waitcnt vmcnt(17)
 s_barrier
 ds_read_b64_tr_b16 a[0:1], v240 offset:24576
 ds_read_b64_tr_b16 a[2:3], v240 offset:25088
 v_accvgpr_write_b32 a51, v227
 s_add_u32 s69, s65, 4096
 buffer_store_dwordx4 v[224:227], v0, s[16:19], s69 offen offset:0 sc1
 v_cvt_pk_f16_f32 v220, v192, v193
 v_mfma_f32_32x32x16_bf16 v[168:183], a[12:15], v[44:47], v[168:183]
 ds_read_b64_tr_b16 a[4:5], v241 offset:24576
 ds_read_b64_tr_b16 a[6:7], v241 offset:25088
 v_cvt_pk_f16_f32 v221, v194, v195
 v_pk_fma_f16 v222, v220, v220, s70
 v_pk_fma_f16 v223, v221, v221, s70
 v_pk_mul_f16 v220, v222, v220 neg_lo:[1,0] neg_hi:[1,0]
 s_waitcnt lgkmcnt(4)
 v_mfma_f32_32x32x16_bf16 v[152:167], a[16:19], v[48:51], v[152:167]
 ds_read_b64_tr_b16 a[8:9], v240 offset:26624
 ds_read_b64_tr_b16 a[10:11], v240 offset:27136
 v_pk_mul_f16 v221, v223, v221 neg_lo:[1,0] neg_hi:[1,0]
 v_exp_f16 v222, v220
 v_exp_f16 v223, v221
 s_bitcmp1_b32 s44, 1
 s_cbranch_scc0 ON_61
 buffer_store_dwordx4 a[220:223], v251, s[16:19], s99 offen offset:0 sc1
ON_61:
 v_mfma_f32_32x32x16_bf16 v[168:183], a[20:23], v[48:51], v[168:183]
 ds_read_b64_tr_b16 a[12:13], v241 offset:26624
 ds_read_b64_tr_b16 a[14:15], v241 offset:27136
 buffer_load_dwordx4 v5, s[8:11], s51 offen offset:1408  lds
 v_exp_f16_sdwa v222, v220 dst_sel:WORD_1 dst_unused:UNUSED_PRESERVE src0_sel:WORD_1
 v_exp_f16_sdwa v223, v221 dst_sel:WORD_1 dst_unused:UNUSED_PRESERVE src0_sel:WORD_1
 v_mfma_f32_32x32x16_bf16 v[152:167], a[24:27], v[52:55], v[152:167]
 ds_read_b64_tr_b16 a[16:17], v240 offset:28672
 ds_read_b64_tr_b16 a[18:19], v240 offset:29184
 v_pk_fma_f16 v220, v222, v247, v247
 v_pk_fma_f16 v221, v223, v247, v247
 v_rcp_f16 v216, v220
 v_mfma_f32_32x32x16_bf16 v[168:183], a[28:31], v[52:55], v[168:183]
 ds_read_b64_tr_b16 a[20:21], v241 offset:28672
 ds_read_b64_tr_b16 a[22:23], v241 offset:29184
 v_rcp_f16 v218, v221
 v_rcp_f16_sdwa v217, v220 dst_sel:WORD_0 dst_unused:UNUSED_PAD src0_sel:WORD_1
 s_waitcnt lgkmcnt(4)
 v_mfma_f32_32x32x16_bf16 v[152:167], a[0:3], v[56:59], v[152:167]
 ds_read_b64_tr_b16 a[24:25], v240 offset:30720
 ds_read_b64_tr_b16 a[26:27], v240 offset:31232
 v_rcp_f16_sdwa v219, v221 dst_sel:WORD_0 dst_unused:UNUSED_PAD src0_sel:WORD_1
 v_fma_mix_f32 v216, v192, v216, 0 op_sel_hi:[0,1,0]
 v_mfma_f32_32x32x16_bf16 v[168:183], a[4:7], v[56:59], v[168:183]
 ds_read_b64_tr_b16 a[28:29], v241 offset:30720
 s_add_u32 m0, s64, 122496
 ds_read_b64_tr_b16 a[30:31], v241 offset:31232
 buffer_load_dwordx4 v4, s[8:11], s52 offen offset:384  lds
 v_fma_mix_f32 v218, v194, v218, 0 op_sel_hi:[0,1,0]
 v_fma_mix_f32 v217, v193, v217, 0 op_sel_hi:[0,1,0]
 v_fma_mix_f32 v219, v195, v219, 0 op_sel_hi:[0,1,0]
 v_mfma_f32_32x32x16_bf16 v[152:167], a[8:11], v[60:63], v[152:167]
 ds_read_b64_tr_b16 a[0:1], v240 offset:32768
 ds_read_b64_tr_b16 a[2:3], v240 offset:33280
 ds_read_b128 v[192:195], v246 offset:832
 v_cvt_pk_bf16_f32 v228, v216, v217
 v_cvt_pk_bf16_f32 v229, v218, v219
 v_accvgpr_write_b32 a52, v228
 v_mfma_f32_32x32x16_bf16 v[168:183], a[12:15], v[60:63], v[168:183]
 ds_read_b64_tr_b16 a[4:5], v241 offset:32768
 ds_read_b64_tr_b16 a[6:7], v241 offset:33280
 v_accvgpr_write_b32 a53, v229
 v_cvt_pk_f16_f32 v220, v196, v197
 v_cvt_pk_f16_f32 v221, v198, v199
 v_pk_fma_f16 v222, v220, v220, s70
 s_waitcnt lgkmcnt(5)
 v_mfma_f32_32x32x16_bf16 v[152:167], a[16:19], v[64:67], v[152:167]
 ds_read_b64_tr_b16 a[8:9], v240 offset:34816
 ds_read_b64_tr_b16 a[10:11], v240 offset:35328
 v_pk_fma_f16 v223, v221, v221, s70
 v_pk_mul_f16 v220, v222, v220 neg_lo:[1,0] neg_hi:[1,0]
 v_pk_mul_f16 v221, v223, v221 neg_lo:[1,0] neg_hi:[1,0]
 s_bitcmp1_b32 s44, 1
 s_cbranch_scc0 ON_62
 buffer_store_dwordx4 a[224:227], v250, s[16:19], s99 offen offset:64 sc1
ON_62:
 v_mfma_f32_32x32x16_bf16 v[168:183], a[20:23], v[64:67], v[168:183]
 ds_read_b64_tr_b16 a[12:13], v241 offset:34816
 ds_read_b64_tr_b16 a[14:15], v241 offset:35328
 buffer_load_dwordx4 v5, s[8:11], s52 offen offset:1408  lds
 v_exp_f16 v222, v220
 v_exp_f16 v223, v221
 v_mfma_f32_32x32x16_bf16 v[152:167], a[24:27], v[68:71], v[152:167]
 ds_read_b64_tr_b16 a[16:17], v240 offset:36864
 ds_read_b64_tr_b16 a[18:19], v240 offset:37376
 v_exp_f16_sdwa v222, v220 dst_sel:WORD_1 dst_unused:UNUSED_PRESERVE src0_sel:WORD_1
 v_exp_f16_sdwa v223, v221 dst_sel:WORD_1 dst_unused:UNUSED_PRESERVE src0_sel:WORD_1
 v_pk_fma_f16 v220, v222, v247, v247
 v_mfma_f32_32x32x16_bf16 v[168:183], a[28:31], v[68:71], v[168:183]
 ds_read_b64_tr_b16 a[20:21], v241 offset:36864
 ds_read_b64_tr_b16 a[22:23], v241 offset:37376
 v_pk_fma_f16 v221, v223, v247, v247
 v_rcp_f16 v216, v220
 s_waitcnt lgkmcnt(4)
 v_mfma_f32_32x32x16_bf16 v[152:167], a[0:3], v[72:75], v[152:167]
 ds_read_b64_tr_b16 a[24:25], v240 offset:38912
 ds_read_b64_tr_b16 a[26:27], v240 offset:39424
 v_rcp_f16 v218, v221
 v_rcp_f16_sdwa v217, v220 dst_sel:WORD_0 dst_unused:UNUSED_PAD src0_sel:WORD_1
 v_mfma_f32_32x32x16_bf16 v[168:183], a[4:7], v[72:75], v[168:183]
 ds_read_b64_tr_b16 a[28:29], v241 offset:38912
 s_add_u32 m0, s64, 130688
 ds_read_b64_tr_b16 a[30:31], v241 offset:39424
 buffer_load_dwordx4 v4, s[8:11], s53 offen offset:384  lds
 v_rcp_f16_sdwa v219, v221 dst_sel:WORD_0 dst_unused:UNUSED_PAD src0_sel:WORD_1
 v_fma_mix_f32 v216, v196, v216, 0 op_sel_hi:[0,1,0]
 v_fma_mix_f32 v218, v198, v218, 0 op_sel_hi:[0,1,0]
 v_fma_mix_f32 v217, v197, v217, 0 op_sel_hi:[0,1,0]
 v_mfma_f32_32x32x16_bf16 v[152:167], a[8:11], v[76:79], v[152:167]
 ds_read_b64_tr_b16 a[0:1], v240 offset:40960
 ds_read_b64_tr_b16 a[2:3], v240 offset:41472
 v_fma_mix_f32 v219, v199, v219, 0 op_sel_hi:[0,1,0]
 ds_read_b128 v[196:199], v246 offset:864
 v_cvt_pk_bf16_f32 v230, v216, v217
 v_mfma_f32_32x32x16_bf16 v[168:183], a[12:15], v[76:79], v[168:183]
 ds_read_b64_tr_b16 a[4:5], v241 offset:40960
 ds_read_b64_tr_b16 a[6:7], v241 offset:41472
 v_cvt_pk_bf16_f32 v231, v218, v219
 v_accvgpr_write_b32 a54, v230
 v_accvgpr_write_b32 a55, v231
 buffer_store_dwordx4 v[228:231], v0, s[16:19], s69 offen offset:1024 sc1
 s_waitcnt lgkmcnt(5)
 v_mfma_f32_32x32x16_bf16 v[152:167], a[16:19], v[80:83], v[152:167]
 ds_read_b64_tr_b16 a[8:9], v240 offset:43008
 ds_read_b64_tr_b16 a[10:11], v240 offset:43520
 v_cvt_pk_f16_f32 v220, v200, v201
 v_cvt_pk_f16_f32 v221, v202, v203
 v_pk_fma_f16 v222, v220, v220, s70
 s_bitcmp1_b32 s44, 1
 s_cbranch_scc0 ON_63
 buffer_store_dwordx4 a[228:231], v251, s[16:19], s99 offen offset:64 sc1
ON_63:
 v_mfma_f32_32x32x16_bf16 v[168:183], a[20:23], v[80:83], v[168:183]
 ds_read_b64_tr_b16 a[12:13], v241 offset:43008
 ds_read_b64_tr_b16 a[14:15], v241 offset:43520
 buffer_load_dwordx4 v5, s[8:11], s53 offen offset:1408  lds
 v_pk_fma_f16 v223, v221, v221, s70
 v_pk_mul_f16 v220, v222, v220 neg_lo:[1,0] neg_hi:[1,0]
 v_pk_mul_f16 v221, v223, v221 neg_lo:[1,0] neg_hi:[1,0]
 v_exp_f16 v222, v220
 v_mfma_f32_32x32x16_bf16 v[152:167], a[24:27], v[84:87], v[152:167]
 ds_read_b64_tr_b16 a[16:17], v240 offset:45056
 ds_read_b64_tr_b16 a[18:19], v240 offset:45568
 v_exp_f16 v223, v221
 v_exp_f16_sdwa v222, v220 dst_sel:WORD_1 dst_unused:UNUSED_PRESERVE src0_sel:WORD_1
 v_mfma_f32_32x32x16_bf16 v[168:183], a[28:31], v[84:87], v[168:183]
 ds_read_b64_tr_b16 a[20:21], v241 offset:45056
 ds_read_b64_tr_b16 a[22:23], v241 offset:45568
 v_exp_f16_sdwa v223, v221 dst_sel:WORD_1 dst_unused:UNUSED_PRESERVE src0_sel:WORD_1
 v_pk_fma_f16 v220, v222, v247, v247
 s_waitcnt lgkmcnt(4)
 v_mfma_f32_32x32x16_bf16 v[152:167], a[0:3], v[88:91], v[152:167]
 ds_read_b64_tr_b16 a[24:25], v240 offset:47104
 ds_read_b64_tr_b16 a[26:27], v240 offset:47616
 v_pk_fma_f16 v221, v223, v247, v247
 v_rcp_f16 v216, v220
 v_rcp_f16 v218, v221
 v_mfma_f32_32x32x16_bf16 v[168:183], a[4:7], v[88:91], v[168:183]
 ds_read_b64_tr_b16 a[28:29], v241 offset:47104
 s_add_u32 m0, s64, 138880
 ds_read_b64_tr_b16 a[30:31], v241 offset:47616
 buffer_load_dwordx4 v4, s[8:11], s54 offen offset:384  lds
 v_rcp_f16_sdwa v217, v220 dst_sel:WORD_0 dst_unused:UNUSED_PAD src0_sel:WORD_1
 v_rcp_f16_sdwa v219, v221 dst_sel:WORD_0 dst_unused:UNUSED_PAD src0_sel:WORD_1
 v_mfma_f32_32x32x16_bf16 v[152:167], a[8:11], v[92:95], v[152:167]
 s_waitcnt vmcnt(19)
 s_barrier
 ds_read_b64_tr_b16 a[0:1], v242 offset:0
 ds_read_b64_tr_b16 a[2:3], v242 offset:512
 v_fma_mix_f32 v216, v200, v216, 0 op_sel_hi:[0,1,0]
 v_fma_mix_f32 v218, v202, v218, 0 op_sel_hi:[0,1,0]
 v_fma_mix_f32 v217, v201, v217, 0 op_sel_hi:[0,1,0]
 v_mfma_f32_32x32x16_bf16 v[168:183], a[12:15], v[92:95], v[168:183]
 ds_read_b64_tr_b16 a[4:5], v243 offset:0
 ds_read_b64_tr_b16 a[6:7], v243 offset:512
 v_fma_mix_f32 v219, v203, v219, 0 op_sel_hi:[0,1,0]
 ds_read_b128 v[200:203], v246 offset:896
 v_cvt_pk_bf16_f32 v232, v216, v217
 s_waitcnt lgkmcnt(5)
 v_mfma_f32_32x32x16_bf16 v[152:167], a[16:19], v[96:99], v[152:167]
 ds_read_b64_tr_b16 a[8:9], v242 offset:2048
 ds_read_b64_tr_b16 a[10:11], v242 offset:2560
 v_cvt_pk_bf16_f32 v233, v218, v219
 v_accvgpr_write_b32 a56, v232
 v_accvgpr_write_b32 a57, v233
 v_cvt_pk_f16_f32 v220, v204, v205
 v_accvgpr_write_b32 a248, -1
 v_accvgpr_write_b32 a249, -1
 v_accvgpr_write_b32 a250, -1
 v_accvgpr_write_b32 a251, -1
 v_mfma_f32_32x32x16_bf16 v[168:183], a[20:23], v[96:99], v[168:183]
 ds_read_b64_tr_b16 a[12:13], v243 offset:2048
 ds_read_b64_tr_b16 a[14:15], v243 offset:2560
 buffer_load_dwordx4 v5, s[8:11], s54 offen offset:1408  lds
 v_cvt_pk_f16_f32 v221, v206, v207
 v_pk_fma_f16 v222, v220, v220, s70
 v_pk_fma_f16 v223, v221, v221, s70
 v_pk_mul_f16 v220, v222, v220 neg_lo:[1,0] neg_hi:[1,0]
 v_mfma_f32_32x32x16_bf16 v[152:167], a[24:27], v[100:103], v[152:167]
 ds_read_b64_tr_b16 a[16:17], v242 offset:4096
 ds_read_b64_tr_b16 a[18:19], v242 offset:4608
 v_pk_mul_f16 v221, v223, v221 neg_lo:[1,0] neg_hi:[1,0]
 v_exp_f16 v222, v220
 v_exp_f16 v223, v221
 v_mfma_f32_32x32x16_bf16 v[168:183], a[28:31], v[100:103], v[168:183]
 ds_read_b64_tr_b16 a[20:21], v243 offset:4096
 ds_read_b64_tr_b16 a[22:23], v243 offset:4608
 v_exp_f16_sdwa v222, v220 dst_sel:WORD_1 dst_unused:UNUSED_PRESERVE src0_sel:WORD_1
 s_waitcnt lgkmcnt(4)
 v_mfma_f32_32x32x16_bf16 v[152:167], a[0:3], v[104:107], v[152:167]
 ds_read_b64_tr_b16 a[24:25], v242 offset:6144
 ds_read_b64_tr_b16 a[26:27], v242 offset:6656
 v_exp_f16_sdwa v223, v221 dst_sel:WORD_1 dst_unused:UNUSED_PRESERVE src0_sel:WORD_1
 v_pk_fma_f16 v220, v222, v247, v247
 v_pk_fma_f16 v221, v223, v247, v247
 v_mfma_f32_32x32x16_bf16 v[168:183], a[4:7], v[104:107], v[168:183]
 ds_read_b64_tr_b16 a[28:29], v243 offset:6144
 ds_read_b64_tr_b16 a[30:31], v243 offset:6656
 s_add_u32 m0, s64, 0
 s_add_u32 s68, s46, 512
 buffer_load_dwordx4 v4, s[8:11], s68 offen  lds
 v_rcp_f16 v216, v220
 v_rcp_f16 v218, v221
 s_add_u32 s3, s33, 32768
 buffer_store_dwordx4 a[248:251], v0, s[16:19], s3 offen offset:0 sc1
 v_mfma_f32_32x32x16_bf16 v[152:167], a[8:11], v[108:111], v[152:167]
 ds_read_b64_tr_b16 a[0:1], v242 offset:8192
 ds_read_b64_tr_b16 a[2:3], v242 offset:8704
 v_rcp_f16_sdwa v217, v220 dst_sel:WORD_0 dst_unused:UNUSED_PAD src0_sel:WORD_1
 v_rcp_f16_sdwa v219, v221 dst_sel:WORD_0 dst_unused:UNUSED_PAD src0_sel:WORD_1
 v_fma_mix_f32 v216, v204, v216, 0 op_sel_hi:[0,1,0]
 v_mfma_f32_32x32x16_bf16 v[168:183], a[12:15], v[108:111], v[168:183]
 ds_read_b64_tr_b16 a[4:5], v243 offset:8192
 ds_read_b64_tr_b16 a[6:7], v243 offset:8704
 v_fma_mix_f32 v218, v206, v218, 0 op_sel_hi:[0,1,0]
 v_fma_mix_f32 v217, v205, v217, 0 op_sel_hi:[0,1,0]
 v_fma_mix_f32 v219, v207, v219, 0 op_sel_hi:[0,1,0]
 s_waitcnt lgkmcnt(4)
 v_mfma_f32_32x32x16_bf16 v[152:167], a[16:19], v[112:115], v[152:167]
 ds_read_b64_tr_b16 a[8:9], v242 offset:10240
 ds_read_b64_tr_b16 a[10:11], v242 offset:10752
 ds_read_b128 v[204:207], v246 offset:928
 v_cvt_pk_bf16_f32 v234, v216, v217
 v_cvt_pk_bf16_f32 v235, v218, v219
 v_accvgpr_write_b32 a58, v234
 s_buffer_load_dwordx2 s[0:1], s[16:19], s34 glc
 v_mfma_f32_32x32x16_bf16 v[168:183], a[20:23], v[112:115], v[168:183]
 ds_read_b64_tr_b16 a[12:13], v243 offset:10240
 ds_read_b64_tr_b16 a[14:15], v243 offset:10752
 buffer_load_dwordx4 v5, s[8:11], s68 offen offset:1024  lds
 v_accvgpr_write_b32 a59, v235
 buffer_store_dwordx4 v[232:235], v0, s[16:19], s69 offen offset:2048 sc1
 v_cvt_pk_f16_f32 v220, v208, v209
 v_cvt_pk_f16_f32 v221, v210, v211
 v_mfma_f32_32x32x16_bf16 v[152:167], a[24:27], v[116:119], v[152:167]
 ds_read_b64_tr_b16 a[16:17], v242 offset:12288
 ds_read_b64_tr_b16 a[18:19], v242 offset:12800
 v_pk_fma_f16 v222, v220, v220, s70
 v_pk_fma_f16 v223, v221, v221, s70
 v_pk_mul_f16 v220, v222, v220 neg_lo:[1,0] neg_hi:[1,0]
 v_pk_mul_f16 v221, v223, v221 neg_lo:[1,0] neg_hi:[1,0]
 v_mfma_f32_32x32x16_bf16 v[168:183], a[28:31], v[116:119], v[168:183]
 ds_read_b64_tr_b16 a[20:21], v243 offset:12288
 ds_read_b64_tr_b16 a[22:23], v243 offset:12800
 v_exp_f16 v222, v220
 v_exp_f16 v223, v221
 s_waitcnt lgkmcnt(9)
 v_mfma_f32_32x32x16_bf16 v[152:167], a[0:3], v[120:123], v[152:167]
 ds_read_b64_tr_b16 a[24:25], v242 offset:14336
 ds_read_b64_tr_b16 a[26:27], v242 offset:14848
 v_exp_f16_sdwa v222, v220 dst_sel:WORD_1 dst_unused:UNUSED_PRESERVE src0_sel:WORD_1
 v_exp_f16_sdwa v223, v221 dst_sel:WORD_1 dst_unused:UNUSED_PRESERVE src0_sel:WORD_1
 v_mfma_f32_32x32x16_bf16 v[168:183], a[4:7], v[120:123], v[168:183]
 ds_read_b64_tr_b16 a[28:29], v243 offset:14336
 s_add_u32 m0, s64, 7680
 ds_read_b64_tr_b16 a[30:31], v243 offset:14848
 buffer_load_dwordx4 v4, s[8:11], s47 offen offset:512  lds
 v_pk_fma_f16 v220, v222, v247, v247
 v_pk_fma_f16 v221, v223, v247, v247
 v_rcp_f16 v216, v220
 s_waitcnt lgkmcnt(8)
 v_mfma_f32_32x32x16_bf16 v[152:167], a[8:11], v[124:127], v[152:167]
 ds_read_b64_tr_b16 a[0:1], v242 offset:16384
 ds_read_b64_tr_b16 a[2:3], v242 offset:16896
 v_rcp_f16 v218, v221
 v_rcp_f16_sdwa v217, v220 dst_sel:WORD_0 dst_unused:UNUSED_PAD src0_sel:WORD_1
 v_mfma_f32_32x32x16_bf16 v[168:183], a[12:15], v[124:127], v[168:183]
 ds_read_b64_tr_b16 a[4:5], v243 offset:16384
 ds_read_b64_tr_b16 a[6:7], v243 offset:16896
 v_rcp_f16_sdwa v219, v221 dst_sel:WORD_0 dst_unused:UNUSED_PAD src0_sel:WORD_1
 v_fma_mix_f32 v216, v208, v216, 0 op_sel_hi:[0,1,0]
 s_waitcnt lgkmcnt(8)
 v_mfma_f32_32x32x16_bf16 v[152:167], a[16:19], v[128:131], v[152:167]
 ds_read_b64_tr_b16 a[8:9], v242 offset:18432
 ds_read_b64_tr_b16 a[10:11], v242 offset:18944
 v_fma_mix_f32 v218, v210, v218, 0 op_sel_hi:[0,1,0]
 v_fma_mix_f32 v217, v209, v217, 0 op_sel_hi:[0,1,0]
 v_fma_mix_f32 v219, v211, v219, 0 op_sel_hi:[0,1,0]
 ds_read_b128 v[208:211], v246 offset:960
 v_mfma_f32_32x32x16_bf16 v[168:183], a[20:23], v[128:131], v[168:183]
 ds_read_b64_tr_b16 a[12:13], v243 offset:18432
 ds_read_b64_tr_b16 a[14:15], v243 offset:18944
 buffer_load_dwordx4 v5, s[8:11], s47 offen offset:1536  lds
 v_cvt_pk_bf16_f32 v236, v216, v217
 v_cvt_pk_bf16_f32 v237, v218, v219
 v_accvgpr_write_b32 a60, v236
 s_add_u32 s3, s33, 32768
 buffer_store_dwordx4 a[248:251], v0, s[16:19], s3 offen offset:1024 sc1
 s_waitcnt lgkmcnt(9)
 v_mfma_f32_32x32x16_bf16 v[152:167], a[24:27], v[132:135], v[152:167]
 ds_read_b64_tr_b16 a[16:17], v242 offset:20480
 ds_read_b64_tr_b16 a[18:19], v242 offset:20992
 v_accvgpr_write_b32 a61, v237
 v_cvt_pk_f16_f32 v220, v212, v213
 v_cvt_pk_f16_f32 v221, v214, v215
 v_pk_fma_f16 v222, v220, v220, s70
 v_mfma_f32_32x32x16_bf16 v[168:183], a[28:31], v[132:135], v[168:183]
 ds_read_b64_tr_b16 a[20:21], v243 offset:20480
 ds_read_b64_tr_b16 a[22:23], v243 offset:20992
 v_pk_fma_f16 v223, v221, v221, s70
 v_pk_mul_f16 v220, v222, v220 neg_lo:[1,0] neg_hi:[1,0]
 v_pk_mul_f16 v221, v223, v221 neg_lo:[1,0] neg_hi:[1,0]
 v_exp_f16 v222, v220
 s_waitcnt lgkmcnt(9)
 v_mfma_f32_32x32x16_bf16 v[152:167], a[0:3], v[136:139], v[152:167]
 ds_read_b64_tr_b16 a[24:25], v242 offset:22528
 ds_read_b64_tr_b16 a[26:27], v242 offset:23040
 v_exp_f16 v223, v221
 v_exp_f16_sdwa v222, v220 dst_sel:WORD_1 dst_unused:UNUSED_PRESERVE src0_sel:WORD_1
 v_mfma_f32_32x32x16_bf16 v[168:183], a[4:7], v[136:139], v[168:183]
 ds_read_b64_tr_b16 a[28:29], v243 offset:22528
 s_add_u32 m0, s64, 15872
 ds_read_b64_tr_b16 a[30:31], v243 offset:23040
 buffer_load_dwordx4 v4, s[8:11], s48 offen offset:512  lds
 v_exp_f16_sdwa v223, v221 dst_sel:WORD_1 dst_unused:UNUSED_PRESERVE src0_sel:WORD_1
 v_pk_fma_f16 v220, v222, v247, v247
 s_waitcnt lgkmcnt(8)
 v_mfma_f32_32x32x16_bf16 v[152:167], a[8:11], v[140:143], v[152:167]
 s_waitcnt vmcnt(22)
 s_barrier
 ds_read_b64_tr_b16 a[0:1], v242 offset:24576
 ds_read_b64_tr_b16 a[2:3], v242 offset:25088
 v_pk_fma_f16 v221, v223, v247, v247
 v_rcp_f16 v216, v220
 v_rcp_f16 v218, v221
 v_mfma_f32_32x32x16_bf16 v[168:183], a[12:15], v[140:143], v[168:183]
 ds_read_b64_tr_b16 a[4:5], v243 offset:24576
 ds_read_b64_tr_b16 a[6:7], v243 offset:25088
 v_rcp_f16_sdwa v217, v220 dst_sel:WORD_0 dst_unused:UNUSED_PAD src0_sel:WORD_1
 v_rcp_f16_sdwa v219, v221 dst_sel:WORD_0 dst_unused:UNUSED_PAD src0_sel:WORD_1
 s_waitcnt lgkmcnt(8)
 v_mfma_f32_32x32x16_bf16 v[152:167], a[16:19], v[144:147], v[152:167]
 ds_read_b64_tr_b16 a[8:9], v242 offset:26624
 ds_read_b64_tr_b16 a[10:11], v242 offset:27136
 v_fma_mix_f32 v216, v212, v216, 0 op_sel_hi:[0,1,0]
 v_fma_mix_f32 v218, v214, v218, 0 op_sel_hi:[0,1,0]
 v_fma_mix_f32 v217, v213, v217, 0 op_sel_hi:[0,1,0]
 v_mfma_f32_32x32x16_bf16 v[168:183], a[20:23], v[144:147], v[168:183]
 ds_read_b64_tr_b16 a[12:13], v243 offset:26624
 ds_read_b64_tr_b16 a[14:15], v243 offset:27136
 buffer_load_dwordx4 v5, s[8:11], s48 offen offset:1536  lds
 v_fma_mix_f32 v219, v215, v219, 0 op_sel_hi:[0,1,0]
 ds_read_b128 v[212:215], v246 offset:992
 v_cvt_pk_bf16_f32 v238, v216, v217
 s_waitcnt lgkmcnt(9)
 v_mfma_f32_32x32x16_bf16 v[152:167], a[24:27], v[148:151], v[152:167]
 ds_read_b64_tr_b16 a[16:17], v242 offset:28672
 ds_read_b64_tr_b16 a[18:19], v242 offset:29184
 v_cvt_pk_bf16_f32 v239, v218, v219
 v_accvgpr_write_b32 a62, v238
 v_accvgpr_write_b32 a63, v239
 buffer_store_dwordx4 v[236:239], v0, s[16:19], s69 offen offset:3072 sc1
 v_mfma_f32_32x32x16_bf16 v[168:183], a[28:31], v[148:151], v[168:183]
 ds_read_b64_tr_b16 a[20:21], v243 offset:28672
 ds_read_b64_tr_b16 a[22:23], v243 offset:29184
 s_waitcnt lgkmcnt(4)
 v_mfma_f32_32x32x16_bf16 v[184:199], a[0:3], v[8:11], v[184:199]
 ds_read_b64_tr_b16 a[24:25], v242 offset:30720
 ds_read_b64_tr_b16 a[26:27], v242 offset:31232
 v_mfma_f32_32x32x16_bf16 v[200:215], a[4:7], v[8:11], v[200:215]
 ds_read_b64_tr_b16 a[28:29], v243 offset:30720
 s_add_u32 m0, s64, 24064
 ds_read_b64_tr_b16 a[30:31], v243 offset:31232
 buffer_load_dwordx4 v4, s[8:11], s49 offen offset:512  lds
 v_cvt_pk_f16_f32 v220, v152, v153
 v_cvt_pk_f16_f32 v221, v154, v155
 v_pk_fma_f16 v222, v220, v220, s70
 v_pk_fma_f16 v223, v221, v221, s70
 v_mfma_f32_32x32x16_bf16 v[184:199], a[8:11], v[12:15], v[184:199]
 ds_read_b64_tr_b16 a[0:1], v242 offset:32768
 ds_read_b64_tr_b16 a[2:3], v242 offset:33280
 v_pk_mul_f16 v220, v222, v220 neg_lo:[1,0] neg_hi:[1,0]
 v_pk_mul_f16 v221, v223, v221 neg_lo:[1,0] neg_hi:[1,0]
ST2_8:
 s_cbranch_execz ST2_12
 v_exp_f16 v222, v220
 s_bitcmp1_b32 s44, 1
 s_cbranch_scc0 ON_64
 v_mov_b32 v249, 1
 s_waitcnt vmcnt(14)
 s_mov_b64 exec, 1
 buffer_store_dwordx2 v[248:249], off, s[16:19], s35 sc1
 s_mov_b64 exec, -1
ON_64:
 v_mfma_f32_32x32x16_bf16 v[200:215], a[12:15], v[12:15], v[200:215]
 ds_read_b64_tr_b16 a[4:5], v243 offset:32768
 ds_read_b64_tr_b16 a[6:7], v243 offset:33280
 v_exp_f16 v223, v221
 v_exp_f16_sdwa v222, v220 dst_sel:WORD_1 dst_unused:UNUSED_PRESERVE src0_sel:WORD_1
 s_waitcnt lgkmcnt(8)
 v_mfma_f32_32x32x16_bf16 v[184:199], a[16:19], v[16:19], v[184:199]
 ds_read_b64_tr_b16 a[8:9], v242 offset:34816
 ds_read_b64_tr_b16 a[10:11], v242 offset:35328
 v_exp_f16_sdwa v223, v221 dst_sel:WORD_1 dst_unused:UNUSED_PRESERVE src0_sel:WORD_1
 v_pk_fma_f16 v220, v222, v247, v247
 v_pk_fma_f16 v221, v223, v247, v247
 s_add_u32 s3, s33, 34816
 buffer_store_dwordx4 a[248:251], v0, s[16:19], s3 offen offset:0 sc1
 v_mfma_f32_32x32x16_bf16 v[200:215], a[20:23], v[16:19], v[200:215]
 ds_read_b64_tr_b16 a[12:13], v243 offset:34816
 ds_read_b64_tr_b16 a[14:15], v243 offset:35328
 buffer_load_dwordx4 v5, s[8:11], s49 offen offset:1536  lds
 v_rcp_f16 v216, v220
 v_rcp_f16 v218, v221
 s_waitcnt lgkmcnt(8)
 v_mfma_f32_32x32x16_bf16 v[184:199], a[24:27], v[20:23], v[184:199]
 ds_read_b64_tr_b16 a[16:17], v242 offset:36864
 ds_read_b64_tr_b16 a[18:19], v242 offset:37376
 v_rcp_f16_sdwa v217, v220 dst_sel:WORD_0 dst_unused:UNUSED_PAD src0_sel:WORD_1
 v_rcp_f16_sdwa v219, v221 dst_sel:WORD_0 dst_unused:UNUSED_PAD src0_sel:WORD_1
 v_mfma_f32_32x32x16_bf16 v[200:215], a[28:31], v[20:23], v[200:215]
 ds_read_b64_tr_b16 a[20:21], v243 offset:36864
 ds_read_b64_tr_b16 a[22:23], v243 offset:37376
 v_fma_mix_f32 v216, v152, v216, 0 op_sel_hi:[0,1,0]
 v_fma_mix_f32 v218, v154, v218, 0 op_sel_hi:[0,1,0]
 v_fma_mix_f32 v217, v153, v217, 0 op_sel_hi:[0,1,0]
 v_fma_mix_f32 v219, v155, v219, 0 op_sel_hi:[0,1,0]
 s_waitcnt lgkmcnt(8)
 v_mfma_f32_32x32x16_bf16 v[184:199], a[0:3], v[24:27], v[184:199]
 ds_read_b64_tr_b16 a[24:25], v242 offset:38912
 ds_read_b64_tr_b16 a[26:27], v242 offset:39424
 ds_read_b128 v[152:155], v246 offset:1024
 v_cvt_pk_bf16_f32 v224, v216, v217
 v_cvt_pk_bf16_f32 v225, v218, v219
 s_waitcnt lgkmcnt(0)
 s_sub_u32 s1, s1, 1
 s_cmp_lt_u32 s1, 60
 s_cselect_b32 s0, s0, 0
 s_cmp_lg_u32 s0, s45
 s_cbranch_scc1 QC_65
QK_66:
 v_mfma_f32_32x32x16_bf16 v[200:215], a[4:7], v[24:27], v[200:215]
 ds_read_b64_tr_b16 a[28:29], v243 offset:38912
 s_add_u32 m0, s64, 32256
 ds_read_b64_tr_b16 a[30:31], v243 offset:39424
 buffer_load_dwordx4 v4, s[8:11], s50 offen offset:512  lds
 v_accvgpr_write_b32 a64, v224
 v_accvgpr_write_b32 a65, v225
 v_cvt_pk_f16_f32 v220, v156, v157
 v_cvt_pk_f16_f32 v221, v158, v159
 v_mfma_f32_32x32x16_bf16 v[184:199], a[8:11], v[28:31], v[184:199]
 ds_read_b64_tr_b16 a[0:1], v242 offset:40960
 ds_read_b64_tr_b16 a[2:3], v242 offset:41472
 v_pk_fma_f16 v222, v220, v220, s70
 v_pk_fma_f16 v223, v221, v221, s70
 v_pk_mul_f16 v220, v222, v220 neg_lo:[1,0] neg_hi:[1,0]
 v_pk_mul_f16 v221, v223, v221 neg_lo:[1,0] neg_hi:[1,0]
 s_add_u32 s3, s33, 34816
 buffer_store_dwordx4 a[248:251], v0, s[16:19], s3 offen offset:1024 sc1
 v_mfma_f32_32x32x16_bf16 v[200:215], a[12:15], v[28:31], v[200:215]
 ds_read_b64_tr_b16 a[4:5], v243 offset:40960
 ds_read_b64_tr_b16 a[6:7], v243 offset:41472
 v_exp_f16 v222, v220
 v_exp_f16 v223, v221
 s_waitcnt lgkmcnt(4)
 v_mfma_f32_32x32x16_bf16 v[184:199], a[16:19], v[32:35], v[184:199]
 ds_read_b64_tr_b16 a[8:9], v242 offset:43008
 ds_read_b64_tr_b16 a[10:11], v242 offset:43520
 v_exp_f16_sdwa v222, v220 dst_sel:WORD_1 dst_unused:UNUSED_PRESERVE src0_sel:WORD_1
 v_exp_f16_sdwa v223, v221 dst_sel:WORD_1 dst_unused:UNUSED_PRESERVE src0_sel:WORD_1
 v_mfma_f32_32x32x16_bf16 v[200:215], a[20:23], v[32:35], v[200:215]
 ds_read_b64_tr_b16 a[12:13], v243 offset:43008
 ds_read_b64_tr_b16 a[14:15], v243 offset:43520
 buffer_load_dwordx4 v5, s[8:11], s50 offen offset:1536  lds
 v_pk_fma_f16 v220, v222, v247, v247
 v_pk_fma_f16 v221, v223, v247, v247
 v_rcp_f16 v216, v220
 v_mfma_f32_32x32x16_bf16 v[184:199], a[24:27], v[36:39], v[184:199]
 ds_read_b64_tr_b16 a[16:17], v242 offset:45056
 ds_read_b64_tr_b16 a[18:19], v242 offset:45568
 v_rcp_f16 v218, v221
 v_rcp_f16_sdwa v217, v220 dst_sel:WORD_0 dst_unused:UNUSED_PAD src0_sel:WORD_1
 v_mfma_f32_32x32x16_bf16 v[200:215], a[28:31], v[36:39], v[200:215]
 ds_read_b64_tr_b16 a[20:21], v243 offset:45056
 ds_read_b64_tr_b16 a[22:23], v243 offset:45568
 v_rcp_f16_sdwa v219, v221 dst_sel:WORD_0 dst_unused:UNUSED_PAD src0_sel:WORD_1
 v_fma_mix_f32 v216, v156, v216, 0 op_sel_hi:[0,1,0]
 s_waitcnt lgkmcnt(4)
 v_mfma_f32_32x32x16_bf16 v[184:199], a[0:3], v[40:43], v[184:199]
 ds_read_b64_tr_b16 a[24:25], v242 offset:47104
 ds_read_b64_tr_b16 a[26:27], v242 offset:47616
 v_fma_mix_f32 v218, v158, v218, 0 op_sel_hi:[0,1,0]
 v_fma_mix_f32 v217, v157, v217, 0 op_sel_hi:[0,1,0]
 v_fma_mix_f32 v219, v159, v219, 0 op_sel_hi:[0,1,0]
 ds_read_b128 v[156:159], v246 offset:1056
 s_add_u32 s3, s32, 0
 buffer_load_dwordx4 a[32:35], v0, s[16:19], s3 offen offset:0 sc1
 v_mfma_f32_32x32x16_bf16 v[200:215], a[4:7], v[40:43], v[200:215]
 ds_read_b64_tr_b16 a[28:29], v243 offset:47104
 s_add_u32 m0, s64, 40448
 ds_read_b64_tr_b16 a[30:31], v243 offset:47616
 buffer_load_dwordx4 v4, s[8:11], s51 offen offset:512  lds
 v_cvt_pk_bf16_f32 v226, v216, v217
 v_cvt_pk_bf16_f32 v227, v218, v219
 v_accvgpr_write_b32 a66, v226
 v_mfma_f32_32x32x16_bf16 v[184:199], a[8:11], v[44:47], v[184:199]
 s_waitcnt vmcnt(25)
 s_barrier
 ds_read_b64_tr_b16 a[0:1], v244 offset:0
 ds_read_b64_tr_b16 a[2:3], v244 offset:512
 v_accvgpr_write_b32 a67, v227
 s_add_u32 s69, s65, 8192
 buffer_store_dwordx4 v[224:227], v0, s[16:19], s69 offen offset:0 sc1
 v_cvt_pk_f16_f32 v220, v160, v161
 v_mfma_f32_32x32x16_bf16 v[200:215], a[12:15], v[44:47], v[200:215]
 ds_read_b64_tr_b16 a[4:5], v245 offset:0
 ds_read_b64_tr_b16 a[6:7], v245 offset:512
 v_cvt_pk_f16_f32 v221, v162, v163
 v_pk_fma_f16 v222, v220, v220, s70
 v_pk_fma_f16 v223, v221, v221, s70
 v_pk_mul_f16 v220, v222, v220 neg_lo:[1,0] neg_hi:[1,0]
 s_waitcnt lgkmcnt(4)
 v_mfma_f32_32x32x16_bf16 v[184:199], a[16:19], v[48:51], v[184:199]
 ds_read_b64_tr_b16 a[8:9], v244 offset:2048
 ds_read_b64_tr_b16 a[10:11], v244 offset:2560
 v_pk_mul_f16 v221, v223, v221 neg_lo:[1,0] neg_hi:[1,0]
 v_exp_f16 v222, v220
 v_exp_f16 v223, v221
 v_mfma_f32_32x32x16_bf16 v[200:215], a[20:23], v[48:51], v[200:215]
 ds_read_b64_tr_b16 a[12:13], v245 offset:2048
 ds_read_b64_tr_b16 a[14:15], v245 offset:2560
 buffer_load_dwordx4 v5, s[8:11], s51 offen offset:1536  lds
 v_exp_f16_sdwa v222, v220 dst_sel:WORD_1 dst_unused:UNUSED_PRESERVE src0_sel:WORD_1
 v_exp_f16_sdwa v223, v221 dst_sel:WORD_1 dst_unused:UNUSED_PRESERVE src0_sel:WORD_1
 v_mfma_f32_32x32x16_bf16 v[184:199], a[24:27], v[52:55], v[184:199]
 ds_read_b64_tr_b16 a[16:17], v244 offset:4096
 ds_read_b64_tr_b16 a[18:19], v244 offset:4608
 v_pk_fma_f16 v220, v222, v247, v247
 v_pk_fma_f16 v221, v223, v247, v247
 v_rcp_f16 v216, v220
 v_mfma_f32_32x32x16_bf16 v[200:215], a[28:31], v[52:55], v[200:215]
 ds_read_b64_tr_b16 a[20:21], v245 offset:4096
 ds_read_b64_tr_b16 a[22:23], v245 offset:4608
 v_rcp_f16 v218, v221
 v_rcp_f16_sdwa v217, v220 dst_sel:WORD_0 dst_unused:UNUSED_PAD src0_sel:WORD_1
 s_waitcnt lgkmcnt(4)
 v_mfma_f32_32x32x16_bf16 v[184:199], a[0:3], v[56:59], v[184:199]
 ds_read_b64_tr_b16 a[24:25], v244 offset:6144
 ds_read_b64_tr_b16 a[26:27], v244 offset:6656
 v_rcp_f16_sdwa v219, v221 dst_sel:WORD_0 dst_unused:UNUSED_PAD src0_sel:WORD_1
 v_fma_mix_f32 v216, v160, v216, 0 op_sel_hi:[0,1,0]
 v_mfma_f32_32x32x16_bf16 v[200:215], a[4:7], v[56:59], v[200:215]
 ds_read_b64_tr_b16 a[28:29], v245 offset:6144
 s_add_u32 m0, s64, 48640
 ds_read_b64_tr_b16 a[30:31], v245 offset:6656
 buffer_load_dwordx4 v4, s[8:11], s52 offen offset:512  lds
 v_fma_mix_f32 v218, v162, v218, 0 op_sel_hi:[0,1,0]
 v_fma_mix_f32 v217, v161, v217, 0 op_sel_hi:[0,1,0]
 v_fma_mix_f32 v219, v163, v219, 0 op_sel_hi:[0,1,0]
 v_mfma_f32_32x32x16_bf16 v[184:199], a[8:11], v[60:63], v[184:199]
 ds_read_b64_tr_b16 a[0:1], v244 offset:8192
 ds_read_b64_tr_b16 a[2:3], v244 offset:8704
 ds_read_b128 v[160:163], v246 offset:1088
 v_cvt_pk_bf16_f32 v228, v216, v217
 v_cvt_pk_bf16_f32 v229, v218, v219
 v_accvgpr_write_b32 a68, v228
 v_mfma_f32_32x32x16_bf16 v[200:215], a[12:15], v[60:63], v[200:215]
 ds_read_b64_tr_b16 a[4:5], v245 offset:8192
 ds_read_b64_tr_b16 a[6:7], v245 offset:8704
 v_accvgpr_write_b32 a69, v229
 v_cvt_pk_f16_f32 v220, v164, v165
 v_cvt_pk_f16_f32 v221, v166, v167
 v_pk_fma_f16 v222, v220, v220, s70
 s_waitcnt lgkmcnt(5)
 v_mfma_f32_32x32x16_bf16 v[184:199], a[16:19], v[64:67], v[184:199]
 ds_read_b64_tr_b16 a[8:9], v244 offset:10240
 ds_read_b64_tr_b16 a[10:11], v244 offset:10752
 v_pk_fma_f16 v223, v221, v221, s70
 v_pk_mul_f16 v220, v222, v220 neg_lo:[1,0] neg_hi:[1,0]
 v_pk_mul_f16 v221, v223, v221 neg_lo:[1,0] neg_hi:[1,0]
 v_mfma_f32_32x32x16_bf16 v[200:215], a[20:23], v[64:67], v[200:215]
 ds_read_b64_tr_b16 a[12:13], v245 offset:10240
 ds_read_b64_tr_b16 a[14:15], v245 offset:10752
 buffer_load_dwordx4 v5, s[8:11], s52 offen offset:1536  lds
 v_exp_f16 v222, v220
 v_exp_f16 v223, v221
 v_mfma_f32_32x32x16_bf16 v[184:199], a[24:27], v[68:71], v[184:199]
 ds_read_b64_tr_b16 a[16:17], v244 offset:12288
 ds_read_b64_tr_b16 a[18:19], v244 offset:12800
 v_exp_f16_sdwa v222, v220 dst_sel:WORD_1 dst_unused:UNUSED_PRESERVE src0_sel:WORD_1
 v_exp_f16_sdwa v223, v221 dst_sel:WORD_1 dst_unused:UNUSED_PRESERVE src0_sel:WORD_1
 v_pk_fma_f16 v220, v222, v247, v247
 s_add_u32 s3, s32, 0
 buffer_load_dwordx4 a[36:39], v0, s[16:19], s3 offen offset:1024 sc1
 v_mfma_f32_32x32x16_bf16 v[200:215], a[28:31], v[68:71], v[200:215]
 ds_read_b64_tr_b16 a[20:21], v245 offset:12288
 ds_read_b64_tr_b16 a[22:23], v245 offset:12800
 v_pk_fma_f16 v221, v223, v247, v247
 v_rcp_f16 v216, v220
 s_waitcnt lgkmcnt(4)
 v_mfma_f32_32x32x16_bf16 v[184:199], a[0:3], v[72:75], v[184:199]
 ds_read_b64_tr_b16 a[24:25], v244 offset:14336
 ds_read_b64_tr_b16 a[26:27], v244 offset:14848
 v_rcp_f16 v218, v221
 v_rcp_f16_sdwa v217, v220 dst_sel:WORD_0 dst_unused:UNUSED_PAD src0_sel:WORD_1
 v_mfma_f32_32x32x16_bf16 v[200:215], a[4:7], v[72:75], v[200:215]
 ds_read_b64_tr_b16 a[28:29], v245 offset:14336
 s_add_u32 m0, s64, 56832
 ds_read_b64_tr_b16 a[30:31], v245 offset:14848
 buffer_load_dwordx4 v4, s[8:11], s53 offen offset:512  lds
 v_rcp_f16_sdwa v219, v221 dst_sel:WORD_0 dst_unused:UNUSED_PAD src0_sel:WORD_1
 v_fma_mix_f32 v216, v164, v216, 0 op_sel_hi:[0,1,0]
 v_fma_mix_f32 v218, v166, v218, 0 op_sel_hi:[0,1,0]
 v_fma_mix_f32 v217, v165, v217, 0 op_sel_hi:[0,1,0]
 v_mfma_f32_32x32x16_bf16 v[184:199], a[8:11], v[76:79], v[184:199]
 ds_read_b64_tr_b16 a[0:1], v244 offset:16384
 ds_read_b64_tr_b16 a[2:3], v244 offset:16896
 v_fma_mix_f32 v219, v167, v219, 0 op_sel_hi:[0,1,0]
 ds_read_b128 v[164:167], v246 offset:1120
 v_cvt_pk_bf16_f32 v230, v216, v217
 v_mfma_f32_32x32x16_bf16 v[200:215], a[12:15], v[76:79], v[200:215]
 ds_read_b64_tr_b16 a[4:5], v245 offset:16384
 ds_read_b64_tr_b16 a[6:7], v245 offset:16896
 v_cvt_pk_bf16_f32 v231, v218, v219
 v_accvgpr_write_b32 a70, v230
 v_accvgpr_write_b32 a71, v231
 buffer_store_dwordx4 v[228:231], v0, s[16:19], s69 offen offset:1024 sc1
 s_waitcnt lgkmcnt(5)
 v_mfma_f32_32x32x16_bf16 v[184:199], a[16:19], v[80:83], v[184:199]
 ds_read_b64_tr_b16 a[8:9], v244 offset:18432
 ds_read_b64_tr_b16 a[10:11], v244 offset:18944
 v_cvt_pk_f16_f32 v220, v168, v169
 v_cvt_pk_f16_f32 v221, v170, v171
 v_pk_fma_f16 v222, v220, v220, s70
 v_mfma_f32_32x32x16_bf16 v[200:215], a[20:23], v[80:83], v[200:215]
 ds_read_b64_tr_b16 a[12:13], v245 offset:18432
 ds_read_b64_tr_b16 a[14:15], v245 offset:18944
 buffer_load_dwordx4 v5, s[8:11], s53 offen offset:1536  lds
 v_pk_fma_f16 v223, v221, v221, s70
 v_pk_mul_f16 v220, v222, v220 neg_lo:[1,0] neg_hi:[1,0]
 v_pk_mul_f16 v221, v223, v221 neg_lo:[1,0] neg_hi:[1,0]
 v_exp_f16 v222, v220
 v_mfma_f32_32x32x16_bf16 v[184:199], a[24:27], v[84:87], v[184:199]
 ds_read_b64_tr_b16 a[16:17], v244 offset:20480
 ds_read_b64_tr_b16 a[18:19], v244 offset:20992
 v_exp_f16 v223, v221
 v_exp_f16_sdwa v222, v220 dst_sel:WORD_1 dst_unused:UNUSED_PRESERVE src0_sel:WORD_1
 v_mfma_f32_32x32x16_bf16 v[200:215], a[28:31], v[84:87], v[200:215]
 ds_read_b64_tr_b16 a[20:21], v245 offset:20480
 ds_read_b64_tr_b16 a[22:23], v245 offset:20992
 v_exp_f16_sdwa v223, v221 dst_sel:WORD_1 dst_unused:UNUSED_PRESERVE src0_sel:WORD_1
 v_pk_fma_f16 v220, v222, v247, v247
 s_waitcnt lgkmcnt(4)
 v_mfma_f32_32x32x16_bf16 v[184:199], a[0:3], v[88:91], v[184:199]
 ds_read_b64_tr_b16 a[24:25], v244 offset:22528
 ds_read_b64_tr_b16 a[26:27], v244 offset:23040
 v_pk_fma_f16 v221, v223, v247, v247
 v_rcp_f16 v216, v220
 v_rcp_f16 v218, v221
 v_mfma_f32_32x32x16_bf16 v[200:215], a[4:7], v[88:91], v[200:215]
 ds_read_b64_tr_b16 a[28:29], v245 offset:22528
 s_add_u32 m0, s64, 65024
 ds_read_b64_tr_b16 a[30:31], v245 offset:23040
 buffer_load_dwordx4 v4, s[8:11], s54 offen offset:512  lds
 v_rcp_f16_sdwa v217, v220 dst_sel:WORD_0 dst_unused:UNUSED_PAD src0_sel:WORD_1
 v_rcp_f16_sdwa v219, v221 dst_sel:WORD_0 dst_unused:UNUSED_PAD src0_sel:WORD_1
 v_mfma_f32_32x32x16_bf16 v[184:199], a[8:11], v[92:95], v[184:199]
 s_waitcnt vmcnt(27)
 s_barrier
 ds_read_b64_tr_b16 a[0:1], v244 offset:24576
 ds_read_b64_tr_b16 a[2:3], v244 offset:25088
 v_fma_mix_f32 v216, v168, v216, 0 op_sel_hi:[0,1,0]
 v_fma_mix_f32 v218, v170, v218, 0 op_sel_hi:[0,1,0]
 v_fma_mix_f32 v217, v169, v217, 0 op_sel_hi:[0,1,0]
 v_mfma_f32_32x32x16_bf16 v[200:215], a[12:15], v[92:95], v[200:215]
 ds_read_b64_tr_b16 a[4:5], v245 offset:24576
 ds_read_b64_tr_b16 a[6:7], v245 offset:25088
 v_fma_mix_f32 v219, v171, v219, 0 op_sel_hi:[0,1,0]
 ds_read_b128 v[168:171], v246 offset:1152
 v_cvt_pk_bf16_f32 v232, v216, v217
 s_add_u32 s3, s32, 0
 buffer_load_dwordx4 a[40:43], v0, s[16:19], s3 offen offset:2048 sc1
 s_waitcnt lgkmcnt(5)
 v_mfma_f32_32x32x16_bf16 v[184:199], a[16:19], v[96:99], v[184:199]
 ds_read_b64_tr_b16 a[8:9], v244 offset:26624
 ds_read_b64_tr_b16 a[10:11], v244 offset:27136
 v_cvt_pk_bf16_f32 v233, v218, v219
 v_accvgpr_write_b32 a72, v232
 v_accvgpr_write_b32 a73, v233
 v_cvt_pk_f16_f32 v220, v172, v173
 v_mov_b32 v249, 2
 s_waitcnt vmcnt(13)
 s_mov_b64 exec, 1
 buffer_store_dwordx2 v[248:249], off, s[16:19], s67 sc1
 s_mov_b64 exec, -1
 v_mfma_f32_32x32x16_bf16 v[200:215], a[20:23], v[96:99], v[200:215]
 ds_read_b64_tr_b16 a[12:13], v245 offset:26624
 ds_read_b64_tr_b16 a[14:15], v245 offset:27136
 buffer_load_dwordx4 v5, s[8:11], s54 offen offset:1536  lds
 v_cvt_pk_f16_f32 v221, v174, v175
 v_pk_fma_f16 v222, v220, v220, s70
 v_pk_fma_f16 v223, v221, v221, s70
 v_pk_mul_f16 v220, v222, v220 neg_lo:[1,0] neg_hi:[1,0]
 v_mfma_f32_32x32x16_bf16 v[184:199], a[24:27], v[100:103], v[184:199]
 ds_read_b64_tr_b16 a[16:17], v244 offset:28672
 ds_read_b64_tr_b16 a[18:19], v244 offset:29184
 v_pk_mul_f16 v221, v223, v221 neg_lo:[1,0] neg_hi:[1,0]
 v_exp_f16 v222, v220
 v_exp_f16 v223, v221
 v_mfma_f32_32x32x16_bf16 v[200:215], a[28:31], v[100:103], v[200:215]
 ds_read_b64_tr_b16 a[20:21], v245 offset:28672
 ds_read_b64_tr_b16 a[22:23], v245 offset:29184
 v_exp_f16_sdwa v222, v220 dst_sel:WORD_1 dst_unused:UNUSED_PRESERVE src0_sel:WORD_1
 s_waitcnt lgkmcnt(4)
 v_mfma_f32_32x32x16_bf16 v[184:199], a[0:3], v[104:107], v[184:199]
 ds_read_b64_tr_b16 a[24:25], v244 offset:30720
 ds_read_b64_tr_b16 a[26:27], v244 offset:31232
 v_exp_f16_sdwa v223, v221 dst_sel:WORD_1 dst_unused:UNUSED_PRESERVE src0_sel:WORD_1
 v_pk_fma_f16 v220, v222, v247, v247
 v_pk_fma_f16 v221, v223, v247, v247
 v_mfma_f32_32x32x16_bf16 v[200:215], a[4:7], v[104:107], v[200:215]
 ds_read_b64_tr_b16 a[28:29], v245 offset:30720
 s_add_u32 m0, s64, 73216
 ds_read_b64_tr_b16 a[30:31], v245 offset:31232
 buffer_load_dwordx4 v6, s[12:15], s56 offen offset:512  lds
 v_rcp_f16 v216, v220
 v_rcp_f16 v218, v221
 v_mfma_f32_32x32x16_bf16 v[184:199], a[8:11], v[108:111], v[184:199]
 ds_read_b64_tr_b16 a[0:1], v244 offset:32768
 ds_read_b64_tr_b16 a[2:3], v244 offset:33280
 v_rcp_f16_sdwa v217, v220 dst_sel:WORD_0 dst_unused:UNUSED_PAD src0_sel:WORD_1
 v_rcp_f16_sdwa v219, v221 dst_sel:WORD_0 dst_unused:UNUSED_PAD src0_sel:WORD_1
 v_fma_mix_f32 v216, v172, v216, 0 op_sel_hi:[0,1,0]
 v_mfma_f32_32x32x16_bf16 v[200:215], a[12:15], v[108:111], v[200:215]
 ds_read_b64_tr_b16 a[4:5], v245 offset:32768
 ds_read_b64_tr_b16 a[6:7], v245 offset:33280
 v_fma_mix_f32 v218, v174, v218, 0 op_sel_hi:[0,1,0]
 v_fma_mix_f32 v217, v173, v217, 0 op_sel_hi:[0,1,0]
 v_fma_mix_f32 v219, v175, v219, 0 op_sel_hi:[0,1,0]
 s_waitcnt lgkmcnt(4)
 v_mfma_f32_32x32x16_bf16 v[184:199], a[16:19], v[112:115], v[184:199]
 ds_read_b64_tr_b16 a[8:9], v244 offset:34816
 ds_read_b64_tr_b16 a[10:11], v244 offset:35328
 ds_read_b128 v[172:175], v246 offset:1184
 v_cvt_pk_bf16_f32 v234, v216, v217
 v_cvt_pk_bf16_f32 v235, v218, v219
 v_accvgpr_write_b32 a74, v234
 s_buffer_load_dwordx2 s[0:1], s[16:19], s34 glc
 v_mfma_f32_32x32x16_bf16 v[200:215], a[20:23], v[112:115], v[200:215]
 ds_read_b64_tr_b16 a[12:13], v245 offset:34816
 ds_read_b64_tr_b16 a[14:15], v245 offset:35328
 buffer_load_dwordx4 v7, s[12:15], s56 offen offset:1536  lds
 v_accvgpr_write_b32 a75, v235
 buffer_store_dwordx4 v[232:235], v0, s[16:19], s69 offen offset:2048 sc1
 v_cvt_pk_f16_f32 v220, v176, v177
 v_cvt_pk_f16_f32 v221, v178, v179
 v_mfma_f32_32x32x16_bf16 v[184:199], a[24:27], v[116:119], v[184:199]
 ds_read_b64_tr_b16 a[16:17], v244 offset:36864
 ds_read_b64_tr_b16 a[18:19], v244 offset:37376
 v_pk_fma_f16 v222, v220, v220, s70
 v_pk_fma_f16 v223, v221, v221, s70
 v_pk_mul_f16 v220, v222, v220 neg_lo:[1,0] neg_hi:[1,0]
 v_pk_mul_f16 v221, v223, v221 neg_lo:[1,0] neg_hi:[1,0]
 v_mfma_f32_32x32x16_bf16 v[200:215], a[28:31], v[116:119], v[200:215]
 ds_read_b64_tr_b16 a[20:21], v245 offset:36864
 ds_read_b64_tr_b16 a[22:23], v245 offset:37376
 v_exp_f16 v222, v220
 v_exp_f16 v223, v221
 s_waitcnt lgkmcnt(9)
 v_mfma_f32_32x32x16_bf16 v[184:199], a[0:3], v[120:123], v[184:199]
 ds_read_b64_tr_b16 a[24:25], v244 offset:38912
 ds_read_b64_tr_b16 a[26:27], v244 offset:39424
 v_exp_f16_sdwa v222, v220 dst_sel:WORD_1 dst_unused:UNUSED_PRESERVE src0_sel:WORD_1
 v_exp_f16_sdwa v223, v221 dst_sel:WORD_1 dst_unused:UNUSED_PRESERVE src0_sel:WORD_1
 v_mfma_f32_32x32x16_bf16 v[200:215], a[4:7], v[120:123], v[200:215]
 ds_read_b64_tr_b16 a[28:29], v245 offset:38912
 s_add_u32 m0, s64, 81152
 ds_read_b64_tr_b16 a[30:31], v245 offset:39424
 buffer_load_dwordx4 v6, s[12:15], s56 offen offset:768  lds
 v_pk_fma_f16 v220, v222, v247, v247
 v_pk_fma_f16 v221, v223, v247, v247
 v_rcp_f16 v216, v220
 s_add_u32 s3, s32, 0
 buffer_load_dwordx4 a[44:47], v0, s[16:19], s3 offen offset:3072 sc1
 s_waitcnt lgkmcnt(8)
 v_mfma_f32_32x32x16_bf16 v[184:199], a[8:11], v[124:127], v[184:199]
 ds_read_b64_tr_b16 a[0:1], v244 offset:40960
 ds_read_b64_tr_b16 a[2:3], v244 offset:41472
 v_rcp_f16 v218, v221
 v_rcp_f16_sdwa v217, v220 dst_sel:WORD_0 dst_unused:UNUSED_PAD src0_sel:WORD_1
 v_mfma_f32_32x32x16_bf16 v[200:215], a[12:15], v[124:127], v[200:215]
 ds_read_b64_tr_b16 a[4:5], v245 offset:40960
 ds_read_b64_tr_b16 a[6:7], v245 offset:41472
 v_rcp_f16_sdwa v219, v221 dst_sel:WORD_0 dst_unused:UNUSED_PAD src0_sel:WORD_1
 v_fma_mix_f32 v216, v176, v216, 0 op_sel_hi:[0,1,0]
 s_waitcnt lgkmcnt(8)
 v_mfma_f32_32x32x16_bf16 v[184:199], a[16:19], v[128:131], v[184:199]
 ds_read_b64_tr_b16 a[8:9], v244 offset:43008
 ds_read_b64_tr_b16 a[10:11], v244 offset:43520
 v_fma_mix_f32 v218, v178, v218, 0 op_sel_hi:[0,1,0]
 v_fma_mix_f32 v217, v177, v217, 0 op_sel_hi:[0,1,0]
 v_fma_mix_f32 v219, v179, v219, 0 op_sel_hi:[0,1,0]
 ds_read_b128 v[176:179], v246 offset:1216
 v_mfma_f32_32x32x16_bf16 v[200:215], a[20:23], v[128:131], v[200:215]
 ds_read_b64_tr_b16 a[12:13], v245 offset:43008
 ds_read_b64_tr_b16 a[14:15], v245 offset:43520
 buffer_load_dwordx4 v7, s[12:15], s56 offen offset:1792  lds
 v_cvt_pk_bf16_f32 v236, v216, v217
 v_cvt_pk_bf16_f32 v237, v218, v219
 v_accvgpr_write_b32 a76, v236
 s_waitcnt lgkmcnt(9)
 v_mfma_f32_32x32x16_bf16 v[184:199], a[24:27], v[132:135], v[184:199]
 ds_read_b64_tr_b16 a[16:17], v244 offset:45056
 ds_read_b64_tr_b16 a[18:19], v244 offset:45568
 v_accvgpr_write_b32 a77, v237
 v_cvt_pk_f16_f32 v220, v180, v181
 v_cvt_pk_f16_f32 v221, v182, v183
 v_pk_fma_f16 v222, v220, v220, s70
 v_mfma_f32_32x32x16_bf16 v[200:215], a[28:31], v[132:135], v[200:215]
 ds_read_b64_tr_b16 a[20:21], v245 offset:45056
 ds_read_b64_tr_b16 a[22:23], v245 offset:45568
 v_pk_fma_f16 v223, v221, v221, s70
 v_pk_mul_f16 v220, v222, v220 neg_lo:[1,0] neg_hi:[1,0]
 v_pk_mul_f16 v221, v223, v221 neg_lo:[1,0] neg_hi:[1,0]
 v_exp_f16 v222, v220
 s_waitcnt lgkmcnt(9)
 v_mfma_f32_32x32x16_bf16 v[184:199], a[0:3], v[136:139], v[184:199]
 ds_read_b64_tr_b16 a[24:25], v244 offset:47104
 ds_read_b64_tr_b16 a[26:27], v244 offset:47616
 v_exp_f16 v223, v221
 v_exp_f16_sdwa v222, v220 dst_sel:WORD_1 dst_unused:UNUSED_PRESERVE src0_sel:WORD_1
 v_mfma_f32_32x32x16_bf16 v[200:215], a[4:7], v[136:139], v[200:215]
 ds_read_b64_tr_b16 a[28:29], v245 offset:47104
 s_add_u32 m0, s64, 89600
 ds_read_b64_tr_b16 a[30:31], v245 offset:47616
 buffer_load_dwordx4 v6, s[12:15], s57 offen offset:512  lds
 v_exp_f16_sdwa v223, v221 dst_sel:WORD_1 dst_unused:UNUSED_PRESERVE src0_sel:WORD_1
 v_pk_fma_f16 v220, v222, v247, v247
 s_waitcnt lgkmcnt(8)
 v_mfma_f32_32x32x16_bf16 v[184:199], a[8:11], v[140:143], v[184:199]
 s_barrier
 ds_read_b64_tr_b16 a[0:1], v240 offset:0
 ds_read_b64_tr_b16 a[2:3], v240 offset:512
 v_pk_fma_f16 v221, v223, v247, v247
 v_rcp_f16 v216, v220
 v_rcp_f16 v218, v221
 v_mfma_f32_32x32x16_bf16 v[200:215], a[12:15], v[140:143], v[200:215]
 ds_read_b64_tr_b16 a[4:5], v241 offset:0
 ds_read_b64_tr_b16 a[6:7], v241 offset:512
 v_rcp_f16_sdwa v217, v220 dst_sel:WORD_0 dst_unused:UNUSED_PAD src0_sel:WORD_1
 v_rcp_f16_sdwa v219, v221 dst_sel:WORD_0 dst_unused:UNUSED_PAD src0_sel:WORD_1
 s_waitcnt lgkmcnt(8)
 v_mfma_f32_32x32x16_bf16 v[184:199], a[16:19], v[144:147], v[184:199]
 ds_read_b64_tr_b16 a[8:9], v240 offset:2048
 ds_read_b64_tr_b16 a[10:11], v240 offset:2560
 v_fma_mix_f32 v216, v180, v216, 0 op_sel_hi:[0,1,0]
 v_fma_mix_f32 v218, v182, v218, 0 op_sel_hi:[0,1,0]
 v_fma_mix_f32 v217, v181, v217, 0 op_sel_hi:[0,1,0]
 v_mfma_f32_32x32x16_bf16 v[200:215], a[20:23], v[144:147], v[200:215]
 ds_read_b64_tr_b16 a[12:13], v241 offset:2048
 ds_read_b64_tr_b16 a[14:15], v241 offset:2560
 buffer_load_dwordx4 v7, s[12:15], s57 offen offset:1536  lds
 v_fma_mix_f32 v219, v183, v219, 0 op_sel_hi:[0,1,0]
 ds_read_b128 v[180:183], v246 offset:1248
 v_cvt_pk_bf16_f32 v238, v216, v217
 s_waitcnt lgkmcnt(9)
 v_mfma_f32_32x32x16_bf16 v[184:199], a[24:27], v[148:151], v[184:199]
 ds_read_b64_tr_b16 a[16:17], v240 offset:4096
 ds_read_b64_tr_b16 a[18:19], v240 offset:4608
 v_cvt_pk_bf16_f32 v239, v218, v219
 v_accvgpr_write_b32 a78, v238
 v_accvgpr_write_b32 a79, v239
 buffer_store_dwordx4 v[236:239], v0, s[16:19], s69 offen offset:3072 sc1
 v_mfma_f32_32x32x16_bf16 v[200:215], a[28:31], v[148:151], v[200:215]
 ds_read_b64_tr_b16 a[20:21], v241 offset:4096
 ds_read_b64_tr_b16 a[22:23], v241 offset:4608
 s_waitcnt lgkmcnt(4)
 v_mfma_f32_32x32x16_bf16 v[152:167], a[0:3], v[8:11], v[152:167]
 ds_read_b64_tr_b16 a[24:25], v240 offset:6144
 ds_read_b64_tr_b16 a[26:27], v240 offset:6656
 v_mfma_f32_32x32x16_bf16 v[168:183], a[4:7], v[8:11], v[168:183]
 ds_read_b64_tr_b16 a[28:29], v241 offset:6144
 s_add_u32 m0, s64, 97536
 ds_read_b64_tr_b16 a[30:31], v241 offset:6656
 buffer_load_dwordx4 v6, s[12:15], s57 offen offset:768  lds
 v_cvt_pk_f16_f32 v220, v184, v185
 v_cvt_pk_f16_f32 v221, v186, v187
 v_pk_fma_f16 v222, v220, v220, s70
 v_pk_fma_f16 v223, v221, v221, s70
 v_mfma_f32_32x32x16_bf16 v[152:167], a[8:11], v[12:15], v[152:167]
 ds_read_b64_tr_b16 a[0:1], v240 offset:8192
 ds_read_b64_tr_b16 a[2:3], v240 offset:8704
 v_pk_mul_f16 v220, v222, v220 neg_lo:[1,0] neg_hi:[1,0]
 v_pk_mul_f16 v221, v223, v221 neg_lo:[1,0] neg_hi:[1,0]
 v_exp_f16 v222, v220
 v_mfma_f32_32x32x16_bf16 v[168:183], a[12:15], v[12:15], v[168:183]
 ds_read_b64_tr_b16 a[4:5], v241 offset:8192
 ds_read_b64_tr_b16 a[6:7], v241 offset:8704
 v_exp_f16 v223, v221
 v_exp_f16_sdwa v222, v220 dst_sel:WORD_1 dst_unused:UNUSED_PRESERVE src0_sel:WORD_1
 s_waitcnt lgkmcnt(8)
 v_mfma_f32_32x32x16_bf16 v[152:167], a[16:19], v[16:19], v[152:167]
 ds_read_b64_tr_b16 a[8:9], v240 offset:10240
 ds_read_b64_tr_b16 a[10:11], v240 offset:10752
 v_exp_f16_sdwa v223, v221 dst_sel:WORD_1 dst_unused:UNUSED_PRESERVE src0_sel:WORD_1
 v_pk_fma_f16 v220, v222, v247, v247
 v_mfma_f32_32x32x16_bf16 v[168:183], a[20:23], v[16:19], v[168:183]
 ds_read_b64_tr_b16 a[12:13], v241 offset:10240
 ds_read_b64_tr_b16 a[14:15], v241 offset:10752
 buffer_load_dwordx4 v7, s[12:15], s57 offen offset:1792  lds
 v_pk_fma_f16 v221, v223, v247, v247
 v_rcp_f16 v216, v220
 s_waitcnt lgkmcnt(8)
 v_mfma_f32_32x32x16_bf16 v[152:167], a[24:27], v[20:23], v[152:167]
 ds_read_b64_tr_b16 a[16:17], v240 offset:12288
 ds_read_b64_tr_b16 a[18:19], v240 offset:12800
 v_rcp_f16 v218, v221
 v_rcp_f16_sdwa v217, v220 dst_sel:WORD_0 dst_unused:UNUSED_PAD src0_sel:WORD_1
 v_mfma_f32_32x32x16_bf16 v[168:183], a[28:31], v[20:23], v[168:183]
 ds_read_b64_tr_b16 a[20:21], v241 offset:12288
 ds_read_b64_tr_b16 a[22:23], v241 offset:12800
 v_rcp_f16_sdwa v219, v221 dst_sel:WORD_0 dst_unused:UNUSED_PAD src0_sel:WORD_1
 v_fma_mix_f32 v216, v184, v216, 0 op_sel_hi:[0,1,0]
 v_fma_mix_f32 v218, v186, v218, 0 op_sel_hi:[0,1,0]
 s_waitcnt lgkmcnt(8)
 v_mfma_f32_32x32x16_bf16 v[152:167], a[0:3], v[24:27], v[152:167]
 ds_read_b64_tr_b16 a[24:25], v240 offset:14336
 ds_read_b64_tr_b16 a[26:27], v240 offset:14848
 v_fma_mix_f32 v217, v185, v217, 0 op_sel_hi:[0,1,0]
 v_fma_mix_f32 v219, v187, v219, 0 op_sel_hi:[0,1,0]
 v_cvt_pk_bf16_f32 v224, v216, v217
 v_cvt_pk_bf16_f32 v225, v218, v219
 s_waitcnt lgkmcnt(0)
 s_sub_u32 s1, s1, 2
 s_cmp_lt_u32 s1, 60
 s_cselect_b32 s0, s0, 0
 s_cmp_lg_u32 s0, s45
 s_cbranch_scc1 QC_67
QK_68:
 v_mfma_f32_32x32x16_bf16 v[168:183], a[4:7], v[24:27], v[168:183]
 ds_read_b64_tr_b16 a[28:29], v241 offset:14336
 s_add_u32 m0, s64, 105984
 ds_read_b64_tr_b16 a[30:31], v241 offset:14848
 buffer_load_dwordx4 v6, s[12:15], s58 offen offset:512  lds
 v_accvgpr_write_b32 a80, v224
 v_accvgpr_write_b32 a81, v225
ST2_9:
 s_cbranch_execz STB2_2
 v_cvt_pk_f16_f32 v220, v188, v189
 v_cvt_pk_f16_f32 v221, v190, v191
 v_mfma_f32_32x32x16_bf16 v[152:167], a[8:11], v[28:31], v[152:167]
 ds_read_b64_tr_b16 a[0:1], v240 offset:16384
 ds_read_b64_tr_b16 a[2:3], v240 offset:16896
 v_pk_fma_f16 v222, v220, v220, s70
 v_pk_fma_f16 v223, v221, v221, s70
 v_pk_mul_f16 v220, v222, v220 neg_lo:[1,0] neg_hi:[1,0]
 v_mfma_f32_32x32x16_bf16 v[168:183], a[12:15], v[28:31], v[168:183]
 ds_read_b64_tr_b16 a[4:5], v241 offset:16384
 ds_read_b64_tr_b16 a[6:7], v241 offset:16896
 v_pk_mul_f16 v221, v223, v221 neg_lo:[1,0] neg_hi:[1,0]
 v_exp_f16 v222, v220
 v_exp_f16 v223, v221
 s_waitcnt lgkmcnt(4)
 v_mfma_f32_32x32x16_bf16 v[152:167], a[16:19], v[32:35], v[152:167]
 ds_read_b64_tr_b16 a[8:9], v240 offset:18432
 ds_read_b64_tr_b16 a[10:11], v240 offset:18944
 v_exp_f16_sdwa v222, v220 dst_sel:WORD_1 dst_unused:UNUSED_PRESERVE src0_sel:WORD_1
 v_mfma_f32_32x32x16_bf16 v[168:183], a[20:23], v[32:35], v[168:183]
 ds_read_b64_tr_b16 a[12:13], v241 offset:18432
 ds_read_b64_tr_b16 a[14:15], v241 offset:18944
 buffer_load_dwordx4 v7, s[12:15], s58 offen offset:1536  lds
 v_exp_f16_sdwa v223, v221 dst_sel:WORD_1 dst_unused:UNUSED_PRESERVE src0_sel:WORD_1
 v_pk_fma_f16 v220, v222, v247, v247
 v_pk_fma_f16 v221, v223, v247, v247
 v_mfma_f32_32x32x16_bf16 v[152:167], a[24:27], v[36:39], v[152:167]
 ds_read_b64_tr_b16 a[16:17], v240 offset:20480
 ds_read_b64_tr_b16 a[18:19], v240 offset:20992
 v_rcp_f16 v216, v220
 v_rcp_f16 v218, v221
 v_mfma_f32_32x32x16_bf16 v[168:183], a[28:31], v[36:39], v[168:183]
 ds_read_b64_tr_b16 a[20:21], v241 offset:20480
 ds_read_b64_tr_b16 a[22:23], v241 offset:20992
 v_rcp_f16_sdwa v217, v220 dst_sel:WORD_0 dst_unused:UNUSED_PAD src0_sel:WORD_1
 v_rcp_f16_sdwa v219, v221 dst_sel:WORD_0 dst_unused:UNUSED_PAD src0_sel:WORD_1
 s_waitcnt lgkmcnt(4)
 v_mfma_f32_32x32x16_bf16 v[152:167], a[0:3], v[40:43], v[152:167]
 ds_read_b64_tr_b16 a[24:25], v240 offset:22528
 ds_read_b64_tr_b16 a[26:27], v240 offset:23040
 v_fma_mix_f32 v216, v188, v216, 0 op_sel_hi:[0,1,0]
 v_fma_mix_f32 v218, v190, v218, 0 op_sel_hi:[0,1,0]
 v_fma_mix_f32 v217, v189, v217, 0 op_sel_hi:[0,1,0]
 v_fma_mix_f32 v219, v191, v219, 0 op_sel_hi:[0,1,0]
 s_add_u32 s3, s33, 20480
 buffer_load_dwordx4 a[112:115], v0, s[16:19], s3 offen offset:0 sc1
 v_mfma_f32_32x32x16_bf16 v[168:183], a[4:7], v[40:43], v[168:183]
 ds_read_b64_tr_b16 a[28:29], v241 offset:22528
 s_add_u32 m0, s64, 113920
 ds_read_b64_tr_b16 a[30:31], v241 offset:23040
 buffer_load_dwordx4 v6, s[12:15], s58 offen offset:768  lds
 v_cvt_pk_bf16_f32 v226, v216, v217
 v_cvt_pk_bf16_f32 v227, v218, v219
 v_accvgpr_write_b32 a82, v226
 v_mfma_f32_32x32x16_bf16 v[152:167], a[8:11], v[44:47], v[152:167]
 s_waitcnt vmcnt(25)
 s_barrier
 ds_read_b64_tr_b16 a[0:1], v240 offset:24576
 ds_read_b64_tr_b16 a[2:3], v240 offset:25088
 v_accvgpr_write_b32 a83, v227
 s_add_u32 s69, s65, 12288
 buffer_store_dwordx4 v[224:227], v0, s[16:19], s69 offen offset:0 sc1
 v_cvt_pk_f16_f32 v220, v192, v193
 v_mfma_f32_32x32x16_bf16 v[168:183], a[12:15], v[44:47], v[168:183]
 ds_read_b64_tr_b16 a[4:5], v241 offset:24576
 ds_read_b64_tr_b16 a[6:7], v241 offset:25088
 v_cvt_pk_f16_f32 v221, v194, v195
 v_pk_fma_f16 v222, v220, v220, s70
 v_pk_fma_f16 v223, v221, v221, s70
 v_pk_mul_f16 v220, v222, v220 neg_lo:[1,0] neg_hi:[1,0]
 s_waitcnt lgkmcnt(4)
 v_mfma_f32_32x32x16_bf16 v[152:167], a[16:19], v[48:51], v[152:167]
 ds_read_b64_tr_b16 a[8:9], v240 offset:26624
 ds_read_b64_tr_b16 a[10:11], v240 offset:27136
 v_pk_mul_f16 v221, v223, v221 neg_lo:[1,0] neg_hi:[1,0]
 v_exp_f16 v222, v220
 v_mfma_f32_32x32x16_bf16 v[168:183], a[20:23], v[48:51], v[168:183]
 ds_read_b64_tr_b16 a[12:13], v241 offset:26624
 ds_read_b64_tr_b16 a[14:15], v241 offset:27136
 buffer_load_dwordx4 v7, s[12:15], s58 offen offset:1792  lds
 v_exp_f16 v223, v221
 v_exp_f16_sdwa v222, v220 dst_sel:WORD_1 dst_unused:UNUSED_PRESERVE src0_sel:WORD_1
 v_mfma_f32_32x32x16_bf16 v[152:167], a[24:27], v[52:55], v[152:167]
 ds_read_b64_tr_b16 a[16:17], v240 offset:28672
 ds_read_b64_tr_b16 a[18:19], v240 offset:29184
 v_exp_f16_sdwa v223, v221 dst_sel:WORD_1 dst_unused:UNUSED_PRESERVE src0_sel:WORD_1
 v_pk_fma_f16 v220, v222, v247, v247
 v_pk_fma_f16 v221, v223, v247, v247
 v_mfma_f32_32x32x16_bf16 v[168:183], a[28:31], v[52:55], v[168:183]
 ds_read_b64_tr_b16 a[20:21], v241 offset:28672
 ds_read_b64_tr_b16 a[22:23], v241 offset:29184
 v_rcp_f16 v216, v220
 v_rcp_f16 v218, v221
 s_waitcnt lgkmcnt(4)
 v_mfma_f32_32x32x16_bf16 v[152:167], a[0:3], v[56:59], v[152:167]
 ds_read_b64_tr_b16 a[24:25], v240 offset:30720
 ds_read_b64_tr_b16 a[26:27], v240 offset:31232
 v_rcp_f16_sdwa v217, v220 dst_sel:WORD_0 dst_unused:UNUSED_PAD src0_sel:WORD_1
 v_rcp_f16_sdwa v219, v221 dst_sel:WORD_0 dst_unused:UNUSED_PAD src0_sel:WORD_1
 v_mov_b32 v249, 3
 s_waitcnt vmcnt(8)
 s_mov_b64 exec, 1
 buffer_store_dwordx2 v[248:249], off, s[16:19], s67 sc1
 s_mov_b64 exec, -1
 v_mfma_f32_32x32x16_bf16 v[168:183], a[4:7], v[56:59], v[168:183]
 ds_read_b64_tr_b16 a[28:29], v241 offset:30720
 s_add_u32 m0, s64, 122368
 ds_read_b64_tr_b16 a[30:31], v241 offset:31232
 buffer_load_dwordx4 v6, s[12:15], s59 offen offset:512  lds
 v_fma_mix_f32 v216, v192, v216, 0 op_sel_hi:[0,1,0]
 v_fma_mix_f32 v218, v194, v218, 0 op_sel_hi:[0,1,0]
 v_fma_mix_f32 v217, v193, v217, 0 op_sel_hi:[0,1,0]
 v_mfma_f32_32x32x16_bf16 v[152:167], a[8:11], v[60:63], v[152:167]
 ds_read_b64_tr_b16 a[0:1], v240 offset:32768
 ds_read_b64_tr_b16 a[2:3], v240 offset:33280
 v_fma_mix_f32 v219, v195, v219, 0 op_sel_hi:[0,1,0]
 v_cvt_pk_bf16_f32 v228, v216, v217
 v_cvt_pk_bf16_f32 v229, v218, v219
 v_accvgpr_write_b32 a84, v228
 v_mfma_f32_32x32x16_bf16 v[168:183], a[12:15], v[60:63], v[168:183]
 ds_read_b64_tr_b16 a[4:5], v241 offset:32768
 ds_read_b64_tr_b16 a[6:7], v241 offset:33280
 v_accvgpr_write_b32 a85, v229
 v_cvt_pk_f16_f32 v220, v196, v197
 v_cvt_pk_f16_f32 v221, v198, v199
 v_pk_fma_f16 v222, v220, v220, s70
 s_waitcnt lgkmcnt(4)
 v_mfma_f32_32x32x16_bf16 v[152:167], a[16:19], v[64:67], v[152:167]
 ds_read_b64_tr_b16 a[8:9], v240 offset:34816
 ds_read_b64_tr_b16 a[10:11], v240 offset:35328
 v_pk_fma_f16 v223, v221, v221, s70
 v_pk_mul_f16 v220, v222, v220 neg_lo:[1,0] neg_hi:[1,0]
 v_pk_mul_f16 v221, v223, v221 neg_lo:[1,0] neg_hi:[1,0]
 v_mfma_f32_32x32x16_bf16 v[168:183], a[20:23], v[64:67], v[168:183]
 ds_read_b64_tr_b16 a[12:13], v241 offset:34816
 ds_read_b64_tr_b16 a[14:15], v241 offset:35328
 buffer_load_dwordx4 v7, s[12:15], s59 offen offset:1536  lds
 v_exp_f16 v222, v220
 v_exp_f16 v223, v221
 v_mfma_f32_32x32x16_bf16 v[152:167], a[24:27], v[68:71], v[152:167]
 ds_read_b64_tr_b16 a[16:17], v240 offset:36864
 ds_read_b64_tr_b16 a[18:19], v240 offset:37376
 v_exp_f16_sdwa v222, v220 dst_sel:WORD_1 dst_unused:UNUSED_PRESERVE src0_sel:WORD_1
 v_exp_f16_sdwa v223, v221 dst_sel:WORD_1 dst_unused:UNUSED_PRESERVE src0_sel:WORD_1
 s_add_u32 s3, s33, 20480
 buffer_load_dwordx4 a[116:119], v0, s[16:19], s3 offen offset:1024 sc1
 v_mfma_f32_32x32x16_bf16 v[168:183], a[28:31], v[68:71], v[168:183]
 ds_read_b64_tr_b16 a[20:21], v241 offset:36864
 ds_read_b64_tr_b16 a[22:23], v241 offset:37376
 v_pk_fma_f16 v220, v222, v247, v247
 v_pk_fma_f16 v221, v223, v247, v247
 v_rcp_f16 v216, v220
 s_waitcnt lgkmcnt(4)
 v_mfma_f32_32x32x16_bf16 v[152:167], a[0:3], v[72:75], v[152:167]
 ds_read_b64_tr_b16 a[24:25], v240 offset:38912
 ds_read_b64_tr_b16 a[26:27], v240 offset:39424
 v_rcp_f16 v218, v221
 v_rcp_f16_sdwa v217, v220 dst_sel:WORD_0 dst_unused:UNUSED_PAD src0_sel:WORD_1
 v_mfma_f32_32x32x16_bf16 v[168:183], a[4:7], v[72:75], v[168:183]
 ds_read_b64_tr_b16 a[28:29], v241 offset:38912
 s_add_u32 m0, s64, 130304
 ds_read_b64_tr_b16 a[30:31], v241 offset:39424
 buffer_load_dwordx4 v6, s[12:15], s59 offen offset:768  lds
 v_rcp_f16_sdwa v219, v221 dst_sel:WORD_0 dst_unused:UNUSED_PAD src0_sel:WORD_1
 v_fma_mix_f32 v216, v196, v216, 0 op_sel_hi:[0,1,0]
 v_mfma_f32_32x32x16_bf16 v[152:167], a[8:11], v[76:79], v[152:167]
 ds_read_b64_tr_b16 a[0:1], v240 offset:40960
 ds_read_b64_tr_b16 a[2:3], v240 offset:41472
 v_fma_mix_f32 v218, v198, v218, 0 op_sel_hi:[0,1,0]
 v_fma_mix_f32 v217, v197, v217, 0 op_sel_hi:[0,1,0]
 v_fma_mix_f32 v219, v199, v219, 0 op_sel_hi:[0,1,0]
 v_cvt_pk_bf16_f32 v230, v216, v217
 v_mfma_f32_32x32x16_bf16 v[168:183], a[12:15], v[76:79], v[168:183]
 ds_read_b64_tr_b16 a[4:5], v241 offset:40960
 ds_read_b64_tr_b16 a[6:7], v241 offset:41472
 v_cvt_pk_bf16_f32 v231, v218, v219
 v_accvgpr_write_b32 a86, v230
 v_accvgpr_write_b32 a87, v231
 buffer_store_dwordx4 v[228:231], v0, s[16:19], s69 offen offset:1024 sc1
 s_waitcnt lgkmcnt(4)
 v_mfma_f32_32x32x16_bf16 v[152:167], a[16:19], v[80:83], v[152:167]
 ds_read_b64_tr_b16 a[8:9], v240 offset:43008
 ds_read_b64_tr_b16 a[10:11], v240 offset:43520
 v_cvt_pk_f16_f32 v220, v200, v201
 v_cvt_pk_f16_f32 v221, v202, v203
 v_pk_fma_f16 v222, v220, v220, s70
 v_mfma_f32_32x32x16_bf16 v[168:183], a[20:23], v[80:83], v[168:183]
 ds_read_b64_tr_b16 a[12:13], v241 offset:43008
 ds_read_b64_tr_b16 a[14:15], v241 offset:43520
 buffer_load_dwordx4 v7, s[12:15], s59 offen offset:1792  lds
 v_pk_fma_f16 v223, v221, v221, s70
 v_pk_mul_f16 v220, v222, v220 neg_lo:[1,0] neg_hi:[1,0]
 v_pk_mul_f16 v221, v223, v221 neg_lo:[1,0] neg_hi:[1,0]
 v_mfma_f32_32x32x16_bf16 v[152:167], a[24:27], v[84:87], v[152:167]
 ds_read_b64_tr_b16 a[16:17], v240 offset:45056
 ds_read_b64_tr_b16 a[18:19], v240 offset:45568
 v_exp_f16 v222, v220
 v_exp_f16 v223, v221
 v_mfma_f32_32x32x16_bf16 v[168:183], a[28:31], v[84:87], v[168:183]
 ds_read_b64_tr_b16 a[20:21], v241 offset:45056
 ds_read_b64_tr_b16 a[22:23], v241 offset:45568
 v_exp_f16_sdwa v222, v220 dst_sel:WORD_1 dst_unused:UNUSED_PRESERVE src0_sel:WORD_1
 v_exp_f16_sdwa v223, v221 dst_sel:WORD_1 dst_unused:UNUSED_PRESERVE src0_sel:WORD_1
 s_waitcnt lgkmcnt(4)
 v_mfma_f32_32x32x16_bf16 v[152:167], a[0:3], v[88:91], v[152:167]
 ds_read_b64_tr_b16 a[24:25], v240 offset:47104
 ds_read_b64_tr_b16 a[26:27], v240 offset:47616
 v_pk_fma_f16 v220, v222, v247, v247
 v_pk_fma_f16 v221, v223, v247, v247
 v_rcp_f16 v216, v220
 v_mfma_f32_32x32x16_bf16 v[168:183], a[4:7], v[88:91], v[168:183]
 ds_read_b64_tr_b16 a[28:29], v241 offset:47104
 s_add_u32 m0, s64, 138752
 ds_read_b64_tr_b16 a[30:31], v241 offset:47616
 buffer_load_dwordx4 v6, s[12:15], s55 offen offset:512  lds
 v_rcp_f16 v218, v221
 v_rcp_f16_sdwa v217, v220 dst_sel:WORD_0 dst_unused:UNUSED_PAD src0_sel:WORD_1
 v_mfma_f32_32x32x16_bf16 v[152:167], a[8:11], v[92:95], v[152:167]
 s_barrier
 ds_read_b64_tr_b16 a[0:1], v242 offset:0
 ds_read_b64_tr_b16 a[2:3], v242 offset:512
 v_rcp_f16_sdwa v219, v221 dst_sel:WORD_0 dst_unused:UNUSED_PAD src0_sel:WORD_1
 v_fma_mix_f32 v216, v200, v216, 0 op_sel_hi:[0,1,0]
 v_fma_mix_f32 v218, v202, v218, 0 op_sel_hi:[0,1,0]
 v_mfma_f32_32x32x16_bf16 v[168:183], a[12:15], v[92:95], v[168:183]
 ds_read_b64_tr_b16 a[4:5], v243 offset:0
 ds_read_b64_tr_b16 a[6:7], v243 offset:512
 v_fma_mix_f32 v217, v201, v217, 0 op_sel_hi:[0,1,0]
 v_fma_mix_f32 v219, v203, v219, 0 op_sel_hi:[0,1,0]
 v_cvt_pk_bf16_f32 v232, v216, v217
 s_add_u32 s3, s33, 20480
 buffer_load_dwordx4 a[120:123], v0, s[16:19], s3 offen offset:2048 sc1
 s_waitcnt lgkmcnt(4)
 v_mfma_f32_32x32x16_bf16 v[152:167], a[16:19], v[96:99], v[152:167]
 ds_read_b64_tr_b16 a[8:9], v242 offset:2048
 ds_read_b64_tr_b16 a[10:11], v242 offset:2560
 v_cvt_pk_bf16_f32 v233, v218, v219
 v_accvgpr_write_b32 a88, v232
 v_accvgpr_write_b32 a89, v233
 v_cvt_pk_f16_f32 v220, v204, v205
 v_mfma_f32_32x32x16_bf16 v[168:183], a[20:23], v[96:99], v[168:183]
 ds_read_b64_tr_b16 a[12:13], v243 offset:2048
 ds_read_b64_tr_b16 a[14:15], v243 offset:2560
 buffer_load_dwordx4 v7, s[12:15], s55 offen offset:1536  lds
 v_cvt_pk_f16_f32 v221, v206, v207
 v_pk_fma_f16 v222, v220, v220, s70
 v_pk_fma_f16 v223, v221, v221, s70
 v_pk_mul_f16 v220, v222, v220 neg_lo:[1,0] neg_hi:[1,0]
 v_mfma_f32_32x32x16_bf16 v[152:167], a[24:27], v[100:103], v[152:167]
 ds_read_b64_tr_b16 a[16:17], v242 offset:4096
 ds_read_b64_tr_b16 a[18:19], v242 offset:4608
 v_pk_mul_f16 v221, v223, v221 neg_lo:[1,0] neg_hi:[1,0]
 v_exp_f16 v222, v220
 v_mfma_f32_32x32x16_bf16 v[168:183], a[28:31], v[100:103], v[168:183]
 ds_read_b64_tr_b16 a[20:21], v243 offset:4096
 ds_read_b64_tr_b16 a[22:23], v243 offset:4608
 v_exp_f16 v223, v221
 v_exp_f16_sdwa v222, v220 dst_sel:WORD_1 dst_unused:UNUSED_PRESERVE src0_sel:WORD_1
 s_waitcnt lgkmcnt(4)
 v_mfma_f32_32x32x16_bf16 v[152:167], a[0:3], v[104:107], v[152:167]
 ds_read_b64_tr_b16 a[24:25], v242 offset:6144
 ds_read_b64_tr_b16 a[26:27], v242 offset:6656
 v_exp_f16_sdwa v223, v221 dst_sel:WORD_1 dst_unused:UNUSED_PRESERVE src0_sel:WORD_1
 v_pk_fma_f16 v220, v222, v247, v247
 v_pk_fma_f16 v221, v223, v247, v247
 v_mfma_f32_32x32x16_bf16 v[168:183], a[4:7], v[104:107], v[168:183]
 ds_read_b64_tr_b16 a[28:29], v243 offset:6144
 ds_read_b64_tr_b16 a[30:31], v243 offset:6656
 s_add_u32 m0, s64, 0
 s_add_u32 s68, s55, 768
 buffer_load_dwordx4 v6, s[12:15], s68 offen  lds
 v_rcp_f16 v216, v220
 v_rcp_f16 v218, v221
 v_mfma_f32_32x32x16_bf16 v[152:167], a[8:11], v[108:111], v[152:167]
 ds_read_b64_tr_b16 a[0:1], v242 offset:8192
 ds_read_b64_tr_b16 a[2:3], v242 offset:8704
 v_rcp_f16_sdwa v217, v220 dst_sel:WORD_0 dst_unused:UNUSED_PAD src0_sel:WORD_1
 v_rcp_f16_sdwa v219, v221 dst_sel:WORD_0 dst_unused:UNUSED_PAD src0_sel:WORD_1
 v_mfma_f32_32x32x16_bf16 v[168:183], a[12:15], v[108:111], v[168:183]
 ds_read_b64_tr_b16 a[4:5], v243 offset:8192
 ds_read_b64_tr_b16 a[6:7], v243 offset:8704
 v_fma_mix_f32 v216, v204, v216, 0 op_sel_hi:[0,1,0]
 v_fma_mix_f32 v218, v206, v218, 0 op_sel_hi:[0,1,0]
 v_fma_mix_f32 v217, v205, v217, 0 op_sel_hi:[0,1,0]
 s_waitcnt lgkmcnt(4)
 v_mfma_f32_32x32x16_bf16 v[152:167], a[16:19], v[112:115], v[152:167]
 ds_read_b64_tr_b16 a[8:9], v242 offset:10240
 ds_read_b64_tr_b16 a[10:11], v242 offset:10752
 v_fma_mix_f32 v219, v207, v219, 0 op_sel_hi:[0,1,0]
 v_cvt_pk_bf16_f32 v234, v216, v217
 v_cvt_pk_bf16_f32 v235, v218, v219
 v_accvgpr_write_b32 a90, v234
 s_buffer_load_dwordx2 s[0:1], s[16:19], s34 glc
 v_mfma_f32_32x32x16_bf16 v[168:183], a[20:23], v[112:115], v[168:183]
 ds_read_b64_tr_b16 a[12:13], v243 offset:10240
 ds_read_b64_tr_b16 a[14:15], v243 offset:10752
 buffer_load_dwordx4 v7, s[12:15], s68 offen offset:1024  lds
 v_accvgpr_write_b32 a91, v235
 buffer_store_dwordx4 v[232:235], v0, s[16:19], s69 offen offset:2048 sc1
 v_cvt_pk_f16_f32 v220, v208, v209
 v_cvt_pk_f16_f32 v221, v210, v211
 v_mfma_f32_32x32x16_bf16 v[152:167], a[24:27], v[116:119], v[152:167]
 ds_read_b64_tr_b16 a[16:17], v242 offset:12288
 ds_read_b64_tr_b16 a[18:19], v242 offset:12800
 v_pk_fma_f16 v222, v220, v220, s70
 v_pk_fma_f16 v223, v221, v221, s70
 v_pk_mul_f16 v220, v222, v220 neg_lo:[1,0] neg_hi:[1,0]
 v_mfma_f32_32x32x16_bf16 v[168:183], a[28:31], v[116:119], v[168:183]
 ds_read_b64_tr_b16 a[20:21], v243 offset:12288
 ds_read_b64_tr_b16 a[22:23], v243 offset:12800
 v_pk_mul_f16 v221, v223, v221 neg_lo:[1,0] neg_hi:[1,0]
 v_exp_f16 v222, v220
 v_exp_f16 v223, v221
 s_waitcnt lgkmcnt(8)
 v_mfma_f32_32x32x16_bf16 v[152:167], a[0:3], v[120:123], v[152:167]
 ds_read_b64_tr_b16 a[24:25], v242 offset:14336
 ds_read_b64_tr_b16 a[26:27], v242 offset:14848
 v_exp_f16_sdwa v222, v220 dst_sel:WORD_1 dst_unused:UNUSED_PRESERVE src0_sel:WORD_1
 v_mfma_f32_32x32x16_bf16 v[168:183], a[4:7], v[120:123], v[168:183]
 ds_read_b64_tr_b16 a[28:29], v243 offset:14336
 s_add_u32 m0, s64, 7680
 ds_read_b64_tr_b16 a[30:31], v243 offset:14848
 buffer_load_dwordx4 v6, s[12:15], s60 offen offset:512  lds
 v_exp_f16_sdwa v223, v221 dst_sel:WORD_1 dst_unused:UNUSED_PRESERVE src0_sel:WORD_1
 v_pk_fma_f16 v220, v222, v247, v247
 v_pk_fma_f16 v221, v223, v247, v247
 s_add_u32 s3, s33, 20480
 buffer_load_dwordx4 a[124:127], v0, s[16:19], s3 offen offset:3072 sc1
 s_waitcnt lgkmcnt(8)
 v_mfma_f32_32x32x16_bf16 v[152:167], a[8:11], v[124:127], v[152:167]
 ds_read_b64_tr_b16 a[0:1], v242 offset:16384
 ds_read_b64_tr_b16 a[2:3], v242 offset:16896
 v_rcp_f16 v216, v220
 v_rcp_f16 v218, v221
 v_mfma_f32_32x32x16_bf16 v[168:183], a[12:15], v[124:127], v[168:183]
 ds_read_b64_tr_b16 a[4:5], v243 offset:16384
 ds_read_b64_tr_b16 a[6:7], v243 offset:16896
 v_rcp_f16_sdwa v217, v220 dst_sel:WORD_0 dst_unused:UNUSED_PAD src0_sel:WORD_1
 v_rcp_f16_sdwa v219, v221 dst_sel:WORD_0 dst_unused:UNUSED_PAD src0_sel:WORD_1
 s_waitcnt lgkmcnt(8)
 v_mfma_f32_32x32x16_bf16 v[152:167], a[16:19], v[128:131], v[152:167]
 ds_read_b64_tr_b16 a[8:9], v242 offset:18432
 ds_read_b64_tr_b16 a[10:11], v242 offset:18944
 v_fma_mix_f32 v216, v208, v216, 0 op_sel_hi:[0,1,0]
 v_fma_mix_f32 v218, v210, v218, 0 op_sel_hi:[0,1,0]
 v_fma_mix_f32 v217, v209, v217, 0 op_sel_hi:[0,1,0]
 v_fma_mix_f32 v219, v211, v219, 0 op_sel_hi:[0,1,0]
 v_mfma_f32_32x32x16_bf16 v[168:183], a[20:23], v[128:131], v[168:183]
 ds_read_b64_tr_b16 a[12:13], v243 offset:18432
 ds_read_b64_tr_b16 a[14:15], v243 offset:18944
 buffer_load_dwordx4 v7, s[12:15], s60 offen offset:1536  lds
 v_cvt_pk_bf16_f32 v236, v216, v217
 v_cvt_pk_bf16_f32 v237, v218, v219
 v_accvgpr_write_b32 a92, v236
 s_waitcnt lgkmcnt(8)
 v_mfma_f32_32x32x16_bf16 v[152:167], a[24:27], v[132:135], v[152:167]
 ds_read_b64_tr_b16 a[16:17], v242 offset:20480
 ds_read_b64_tr_b16 a[18:19], v242 offset:20992
 v_accvgpr_write_b32 a93, v237
 v_cvt_pk_f16_f32 v220, v212, v213
 v_cvt_pk_f16_f32 v221, v214, v215
 v_pk_fma_f16 v222, v220, v220, s70
 v_mfma_f32_32x32x16_bf16 v[168:183], a[28:31], v[132:135], v[168:183]
 ds_read_b64_tr_b16 a[20:21], v243 offset:20480
 ds_read_b64_tr_b16 a[22:23], v243 offset:20992
 v_pk_fma_f16 v223, v221, v221, s70
 v_pk_mul_f16 v220, v222, v220 neg_lo:[1,0] neg_hi:[1,0]
 v_pk_mul_f16 v221, v223, v221 neg_lo:[1,0] neg_hi:[1,0]
 s_waitcnt lgkmcnt(8)
 v_mfma_f32_32x32x16_bf16 v[152:167], a[0:3], v[136:139], v[152:167]
 ds_read_b64_tr_b16 a[24:25], v242 offset:22528
 ds_read_b64_tr_b16 a[26:27], v242 offset:23040
 v_exp_f16 v222, v220
 v_exp_f16 v223, v221
 v_mfma_f32_32x32x16_bf16 v[168:183], a[4:7], v[136:139], v[168:183]
 ds_read_b64_tr_b16 a[28:29], v243 offset:22528
 s_add_u32 m0, s64, 15616
 ds_read_b64_tr_b16 a[30:31], v243 offset:23040
 buffer_load_dwordx4 v6, s[12:15], s60 offen offset:768  lds
 v_exp_f16_sdwa v222, v220 dst_sel:WORD_1 dst_unused:UNUSED_PRESERVE src0_sel:WORD_1
 v_exp_f16_sdwa v223, v221 dst_sel:WORD_1 dst_unused:UNUSED_PRESERVE src0_sel:WORD_1
 s_waitcnt lgkmcnt(8)
 v_mfma_f32_32x32x16_bf16 v[152:167], a[8:11], v[140:143], v[152:167]
 s_barrier
 ds_read_b64_tr_b16 a[0:1], v242 offset:24576
 ds_read_b64_tr_b16 a[2:3], v242 offset:25088
 v_pk_fma_f16 v220, v222, v247, v247
 v_pk_fma_f16 v221, v223, v247, v247
 v_rcp_f16 v216, v220
 v_mfma_f32_32x32x16_bf16 v[168:183], a[12:15], v[140:143], v[168:183]
 ds_read_b64_tr_b16 a[4:5], v243 offset:24576
 ds_read_b64_tr_b16 a[6:7], v243 offset:25088
 v_rcp_f16 v218, v221
 v_rcp_f16_sdwa v217, v220 dst_sel:WORD_0 dst_unused:UNUSED_PAD src0_sel:WORD_1
 s_waitcnt lgkmcnt(8)
 v_mfma_f32_32x32x16_bf16 v[152:167], a[16:19], v[144:147], v[152:167]
 ds_read_b64_tr_b16 a[8:9], v242 offset:26624
 ds_read_b64_tr_b16 a[10:11], v242 offset:27136
 v_rcp_f16_sdwa v219, v221 dst_sel:WORD_0 dst_unused:UNUSED_PAD src0_sel:WORD_1
 v_fma_mix_f32 v216, v212, v216, 0 op_sel_hi:[0,1,0]
 v_fma_mix_f32 v218, v214, v218, 0 op_sel_hi:[0,1,0]
 v_mfma_f32_32x32x16_bf16 v[168:183], a[20:23], v[144:147], v[168:183]
 ds_read_b64_tr_b16 a[12:13], v243 offset:26624
 ds_read_b64_tr_b16 a[14:15], v243 offset:27136
 buffer_load_dwordx4 v7, s[12:15], s60 offen offset:1792  lds
 v_fma_mix_f32 v217, v213, v217, 0 op_sel_hi:[0,1,0]
 v_fma_mix_f32 v219, v215, v219, 0 op_sel_hi:[0,1,0]
 v_cvt_pk_bf16_f32 v238, v216, v217
 s_waitcnt lgkmcnt(8)
 v_mfma_f32_32x32x16_bf16 v[152:167], a[24:27], v[148:151], v[152:167]
 ds_read_b64_tr_b16 a[16:17], v242 offset:28672
 ds_read_b64_tr_b16 a[18:19], v242 offset:29184
 v_cvt_pk_bf16_f32 v239, v218, v219
 v_accvgpr_write_b32 a94, v238
 v_accvgpr_write_b32 a95, v239
 buffer_store_dwordx4 v[236:239], v0, s[16:19], s69 offen offset:3072 sc1
 v_mfma_f32_32x32x16_bf16 v[168:183], a[28:31], v[148:151], v[168:183]
 ds_read_b64_tr_b16 a[20:21], v243 offset:28672
 ds_read_b64_tr_b16 a[22:23], v243 offset:29184
 s_waitcnt lgkmcnt(8)
 v_mfma_f32_32x32x16_bf16 v[8:23], a[0:3], a[48:51], 0
 ds_read_b64_tr_b16 a[24:25], v242 offset:30720
 ds_read_b64_tr_b16 a[26:27], v242 offset:31232
 v_mfma_f32_32x32x16_bf16 v[24:39], a[4:7], a[48:51], 0
 ds_read_b64_tr_b16 a[28:29], v243 offset:30720
 s_add_u32 m0, s64, 24064
 ds_read_b64_tr_b16 a[30:31], v243 offset:31232
 buffer_load_dwordx4 v6, s[12:15], s61 offen offset:512  lds
 s_waitcnt lgkmcnt(8)
 v_mfma_f32_32x32x16_bf16 v[8:23], a[8:11], a[52:55], v[8:23]
 ds_read_b64_tr_b16 a[0:1], v242 offset:32768
 ds_read_b64_tr_b16 a[2:3], v242 offset:33280
 v_mfma_f32_32x32x16_bf16 v[24:39], a[12:15], a[52:55], v[24:39]
 ds_read_b64_tr_b16 a[4:5], v243 offset:32768
 ds_read_b64_tr_b16 a[6:7], v243 offset:33280
 v_cvt_pk_f16_f32 v220, v152, v153
 v_cvt_pk_f16_f32 v221, v154, v155
 v_pk_fma_f16 v222, v220, v220, s70
 v_pk_fma_f16 v223, v221, v221, s70
 v_pk_mul_f16 v220, v222, v220 neg_lo:[1,0] neg_hi:[1,0]
 v_pk_mul_f16 v221, v223, v221 neg_lo:[1,0] neg_hi:[1,0]
 s_waitcnt lgkmcnt(8)
 v_mfma_f32_32x32x16_bf16 v[8:23], a[16:19], a[56:59], v[8:23]
 ds_read_b64_tr_b16 a[8:9], v242 offset:34816
 ds_read_b64_tr_b16 a[10:11], v242 offset:35328
 v_exp_f16 v222, v220
 v_exp_f16 v223, v221
 v_exp_f16_sdwa v222, v220 dst_sel:WORD_1 dst_unused:UNUSED_PRESERVE src0_sel:WORD_1
 v_mfma_f32_32x32x16_bf16 v[24:39], a[20:23], a[56:59], v[24:39]
 ds_read_b64_tr_b16 a[12:13], v243 offset:34816
 ds_read_b64_tr_b16 a[14:15], v243 offset:35328
 buffer_load_dwordx4 v7, s[12:15], s61 offen offset:1536  lds
 v_exp_f16_sdwa v223, v221 dst_sel:WORD_1 dst_unused:UNUSED_PRESERVE src0_sel:WORD_1
 v_pk_fma_f16 v220, v222, v247, v247
 v_pk_fma_f16 v221, v223, v247, v247
 v_rcp_f16 v216, v220
 s_waitcnt lgkmcnt(8)
 v_mfma_f32_32x32x16_bf16 v[8:23], a[24:27], a[60:63], v[8:23]
 ds_read_b64_tr_b16 a[16:17], v242 offset:36864
 ds_read_b64_tr_b16 a[18:19], v242 offset:37376
 v_rcp_f16 v218, v221
 v_rcp_f16_sdwa v217, v220 dst_sel:WORD_0 dst_unused:UNUSED_PAD src0_sel:WORD_1
 v_rcp_f16_sdwa v219, v221 dst_sel:WORD_0 dst_unused:UNUSED_PAD src0_sel:WORD_1
 v_mfma_f32_32x32x16_bf16 v[24:39], a[28:31], a[60:63], v[24:39]
 ds_read_b64_tr_b16 a[20:21], v243 offset:36864
 ds_read_b64_tr_b16 a[22:23], v243 offset:37376
 v_fma_mix_f32 v216, v152, v216, 0 op_sel_hi:[0,1,0]
 v_fma_mix_f32 v218, v154, v218, 0 op_sel_hi:[0,1,0]
 v_fma_mix_f32 v217, v153, v217, 0 op_sel_hi:[0,1,0]
 v_fma_mix_f32 v219, v155, v219, 0 op_sel_hi:[0,1,0]
 v_cvt_pk_bf16_f32 v224, v216, v217
 v_cvt_pk_bf16_f32 v225, v218, v219
 s_waitcnt lgkmcnt(8)
 v_mfma_f32_32x32x16_bf16 v[40:55], a[0:3], a[48:51], 0
 ds_read_b64_tr_b16 a[24:25], v242 offset:38912
 ds_read_b64_tr_b16 a[26:27], v242 offset:39424
 v_accvgpr_write_b32 a96, v224
 v_accvgpr_write_b32 a97, v225
 v_cvt_pk_f16_f32 v220, v156, v157
 v_cvt_pk_f16_f32 v221, v158, v159
 v_pk_fma_f16 v222, v220, v220, s70
 v_pk_fma_f16 v223, v221, v221, s70
 s_waitcnt lgkmcnt(0)
 s_sub_u32 s1, s1, 3
 s_cmp_lt_u32 s1, 60
 s_cselect_b32 s0, s0, 0
 s_cmp_lg_u32 s0, s45
 s_cbranch_scc1 QC_69
QK_70:
 v_mfma_f32_32x32x16_bf16 v[56:71], a[4:7], a[48:51], 0
 ds_read_b64_tr_b16 a[28:29], v243 offset:38912
 s_add_u32 m0, s64, 32000
 ds_read_b64_tr_b16 a[30:31], v243 offset:39424
 buffer_load_dwordx4 v6, s[12:15], s61 offen offset:768  lds
 v_pk_mul_f16 v220, v222, v220 neg_lo:[1,0] neg_hi:[1,0]
 v_pk_mul_f16 v221, v223, v221 neg_lo:[1,0] neg_hi:[1,0]
 v_exp_f16 v222, v220
 v_exp_f16 v223, v221
 v_mfma_f32_32x32x16_bf16 v[40:55], a[8:11], a[52:55], v[40:55]
 ds_read_b64_tr_b16 a[0:1], v242 offset:40960
 ds_read_b64_tr_b16 a[2:3], v242 offset:41472
 v_exp_f16_sdwa v222, v220 dst_sel:WORD_1 dst_unused:UNUSED_PRESERVE src0_sel:WORD_1
 v_exp_f16_sdwa v223, v221 dst_sel:WORD_1 dst_unused:UNUSED_PRESERVE src0_sel:WORD_1
 v_pk_fma_f16 v220, v222, v247, v247
 v_mfma_f32_32x32x16_bf16 v[56:71], a[12:15], a[52:55], v[56:71]
 ds_read_b64_tr_b16 a[4:5], v243 offset:40960
 ds_read_b64_tr_b16 a[6:7], v243 offset:41472
 v_pk_fma_f16 v221, v223, v247, v247
 v_rcp_f16 v216, v220
 v_rcp_f16 v218, v221
 v_rcp_f16_sdwa v217, v220 dst_sel:WORD_0 dst_unused:UNUSED_PAD src0_sel:WORD_1
 s_waitcnt lgkmcnt(4)
 v_mfma_f32_32x32x16_bf16 v[40:55], a[16:19], a[56:59], v[40:55]
 ds_read_b64_tr_b16 a[8:9], v242 offset:43008
 ds_read_b64_tr_b16 a[10:11], v242 offset:43520
 v_rcp_f16_sdwa v219, v221 dst_sel:WORD_0 dst_unused:UNUSED_PAD src0_sel:WORD_1
 v_fma_mix_f32 v216, v156, v216, 0 op_sel_hi:[0,1,0]
 v_fma_mix_f32 v218, v158, v218, 0 op_sel_hi:[0,1,0]
 v_fma_mix_f32 v217, v157, v217, 0 op_sel_hi:[0,1,0]
 v_mfma_f32_32x32x16_bf16 v[56:71], a[20:23], a[56:59], v[56:71]
 ds_read_b64_tr_b16 a[12:13], v243 offset:43008
 ds_read_b64_tr_b16 a[14:15], v243 offset:43520
 buffer_load_dwordx4 v7, s[12:15], s61 offen offset:1792  lds
 v_fma_mix_f32 v219, v159, v219, 0 op_sel_hi:[0,1,0]
 v_cvt_pk_bf16_f32 v226, v216, v217
 v_cvt_pk_bf16_f32 v227, v218, v219
 v_accvgpr_write_b32 a98, v226
 v_accvgpr_write_b32 a99, v227
 s_add_u32 s69, s65, 16384
 v_mfma_f32_32x32x16_bf16 v[40:55], a[24:27], a[60:63], v[40:55]
 ds_read_b64_tr_b16 a[16:17], v242 offset:45056
 ds_read_b64_tr_b16 a[18:19], v242 offset:45568
 buffer_store_dwordx4 v[224:227], v0, s[16:19], s69 offen offset:0 sc1
 v_cvt_pk_f16_f32 v220, v160, v161
 v_cvt_pk_f16_f32 v221, v162, v163
 v_pk_fma_f16 v222, v220, v220, s70
 v_pk_fma_f16 v223, v221, v221, s70
 v_pk_mul_f16 v220, v222, v220 neg_lo:[1,0] neg_hi:[1,0]
 s_add_u32 s3, s33, 24576
 buffer_load_dwordx4 a[128:131], v0, s[16:19], s3 offen offset:0 sc1
 v_mfma_f32_32x32x16_bf16 v[56:71], a[28:31], a[60:63], v[56:71]
 ds_read_b64_tr_b16 a[20:21], v243 offset:45056
 ds_read_b64_tr_b16 a[22:23], v243 offset:45568
 v_pk_mul_f16 v221, v223, v221 neg_lo:[1,0] neg_hi:[1,0]
 v_exp_f16 v222, v220
 v_exp_f16 v223, v221
 v_exp_f16_sdwa v222, v220 dst_sel:WORD_1 dst_unused:UNUSED_PRESERVE src0_sel:WORD_1
 s_waitcnt lgkmcnt(4)
 v_mfma_f32_32x32x16_bf16 v[8:23], a[0:3], a[64:67], v[8:23]
 ds_read_b64_tr_b16 a[24:25], v242 offset:47104
 ds_read_b64_tr_b16 a[26:27], v242 offset:47616
 v_exp_f16_sdwa v223, v221 dst_sel:WORD_1 dst_unused:UNUSED_PRESERVE src0_sel:WORD_1
ST2_10:
 s_cbranch_execz STB2_2
 v_pk_fma_f16 v220, v222, v247, v247
 v_pk_fma_f16 v221, v223, v247, v247
 v_rcp_f16 v216, v220
 v_mfma_f32_32x32x16_bf16 v[24:39], a[4:7], a[64:67], v[24:39]
 ds_read_b64_tr_b16 a[28:29], v243 offset:47104
 s_add_u32 m0, s64, 40448
 ds_read_b64_tr_b16 a[30:31], v243 offset:47616
 buffer_load_dwordx4 v6, s[12:15], s62 offen offset:512  lds
 v_rcp_f16 v218, v221
 v_rcp_f16_sdwa v217, v220 dst_sel:WORD_0 dst_unused:UNUSED_PAD src0_sel:WORD_1
 v_mfma_f32_32x32x16_bf16 v[8:23], a[8:11], a[68:71], v[8:23]
 s_waitcnt vmcnt(26)
 s_barrier
 ds_read_b64_tr_b16 a[0:1], v244 offset:0
 ds_read_b64_tr_b16 a[2:3], v244 offset:512
 v_rcp_f16_sdwa v219, v221 dst_sel:WORD_0 dst_unused:UNUSED_PAD src0_sel:WORD_1
 v_fma_mix_f32 v216, v160, v216, 0 op_sel_hi:[0,1,0]
 v_fma_mix_f32 v218, v162, v218, 0 op_sel_hi:[0,1,0]
 v_fma_mix_f32 v217, v161, v217, 0 op_sel_hi:[0,1,0]
 v_fma_mix_f32 v219, v163, v219, 0 op_sel_hi:[0,1,0]
 v_cvt_pk_bf16_f32 v228, v216, v217
 v_mfma_f32_32x32x16_bf16 v[24:39], a[12:15], a[68:71], v[24:39]
 ds_read_b64_tr_b16 a[4:5], v245 offset:0
 ds_read_b64_tr_b16 a[6:7], v245 offset:512
 v_cvt_pk_bf16_f32 v229, v218, v219
 v_accvgpr_write_b32 a100, v228
 v_accvgpr_write_b32 a101, v229
 v_cvt_pk_f16_f32 v220, v164, v165
 v_cvt_pk_f16_f32 v221, v166, v167
 v_pk_fma_f16 v222, v220, v220, s70
 s_waitcnt lgkmcnt(4)
 v_mfma_f32_32x32x16_bf16 v[8:23], a[16:19], a[72:75], v[8:23]
 ds_read_b64_tr_b16 a[8:9], v244 offset:2048
 ds_read_b64_tr_b16 a[10:11], v244 offset:2560
 v_pk_fma_f16 v223, v221, v221, s70
 v_pk_mul_f16 v220, v222, v220 neg_lo:[1,0] neg_hi:[1,0]
 v_pk_mul_f16 v221, v223, v221 neg_lo:[1,0] neg_hi:[1,0]
 v_exp_f16 v222, v220
 v_mfma_f32_32x32x16_bf16 v[24:39], a[20:23], a[72:75], v[24:39]
 ds_read_b64_tr_b16 a[12:13], v245 offset:2048
 ds_read_b64_tr_b16 a[14:15], v245 offset:2560
 buffer_load_dwordx4 v7, s[12:15], s62 offen offset:1536  lds
 v_exp_f16 v223, v221
 v_exp_f16_sdwa v222, v220 dst_sel:WORD_1 dst_unused:UNUSED_PRESERVE src0_sel:WORD_1
 v_exp_f16_sdwa v223, v221 dst_sel:WORD_1 dst_unused:UNUSED_PRESERVE src0_sel:WORD_1
 v_pk_fma_f16 v220, v222, v247, v247
 v_mfma_f32_32x32x16_bf16 v[8:23], a[24:27], a[76:79], v[8:23]
 ds_read_b64_tr_b16 a[16:17], v244 offset:4096
 ds_read_b64_tr_b16 a[18:19], v244 offset:4608
 v_pk_fma_f16 v221, v223, v247, v247
 v_rcp_f16 v216, v220
 v_rcp_f16 v218, v221
 v_mfma_f32_32x32x16_bf16 v[24:39], a[28:31], a[76:79], v[24:39]
 ds_read_b64_tr_b16 a[20:21], v245 offset:4096
 ds_read_b64_tr_b16 a[22:23], v245 offset:4608
 v_rcp_f16_sdwa v217, v220 dst_sel:WORD_0 dst_unused:UNUSED_PAD src0_sel:WORD_1
 v_rcp_f16_sdwa v219, v221 dst_sel:WORD_0 dst_unused:UNUSED_PAD src0_sel:WORD_1
 v_fma_mix_f32 v216, v164, v216, 0 op_sel_hi:[0,1,0]
 v_fma_mix_f32 v218, v166, v218, 0 op_sel_hi:[0,1,0]
 v_fma_mix_f32 v217, v165, v217, 0 op_sel_hi:[0,1,0]
 s_add_u32 s3, s33, 24576
 buffer_load_dwordx4 a[132:135], v0, s[16:19], s3 offen offset:1024 sc1
 s_waitcnt lgkmcnt(4)
 v_mfma_f32_32x32x16_bf16 v[40:55], a[0:3], a[64:67], v[40:55]
 ds_read_b64_tr_b16 a[24:25], v244 offset:6144
 ds_read_b64_tr_b16 a[26:27], v244 offset:6656
 v_fma_mix_f32 v219, v167, v219, 0 op_sel_hi:[0,1,0]
 v_cvt_pk_bf16_f32 v230, v216, v217
 v_cvt_pk_bf16_f32 v231, v218, v219
 v_accvgpr_write_b32 a102, v230
 v_accvgpr_write_b32 a103, v231
 buffer_store_dwordx4 v[228:231], v0, s[16:19], s69 offen offset:1024 sc1
 v_mfma_f32_32x32x16_bf16 v[56:71], a[4:7], a[64:67], v[56:71]
 ds_read_b64_tr_b16 a[28:29], v245 offset:6144
 s_add_u32 m0, s64, 48384
 ds_read_b64_tr_b16 a[30:31], v245 offset:6656
 buffer_load_dwordx4 v6, s[12:15], s62 offen offset:768  lds
 v_cvt_pk_f16_f32 v220, v168, v169
 v_cvt_pk_f16_f32 v221, v170, v171
 v_pk_fma_f16 v222, v220, v220, s70
 v_pk_fma_f16 v223, v221, v221, s70
 v_pk_mul_f16 v220, v222, v220 neg_lo:[1,0] neg_hi:[1,0]
 v_mfma_f32_32x32x16_bf16 v[40:55], a[8:11], a[68:71], v[40:55]
 ds_read_b64_tr_b16 a[0:1], v244 offset:8192
 ds_read_b64_tr_b16 a[2:3], v244 offset:8704
 v_pk_mul_f16 v221, v223, v221 neg_lo:[1,0] neg_hi:[1,0]
 v_exp_f16 v222, v220
 v_exp_f16 v223, v221
 v_exp_f16_sdwa v222, v220 dst_sel:WORD_1 dst_unused:UNUSED_PRESERVE src0_sel:WORD_1
 v_mov_b32 v249, 4
 s_waitcnt vmcnt(11)
 s_mov_b64 exec, 1
 buffer_store_dwordx2 v[248:249], off, s[16:19], s67 sc1
 s_mov_b64 exec, -1
 v_mfma_f32_32x32x16_bf16 v[56:71], a[12:15], a[68:71], v[56:71]
 ds_read_b64_tr_b16 a[4:5], v245 offset:8192
 ds_read_b64_tr_b16 a[6:7], v245 offset:8704
 v_exp_f16_sdwa v223, v221 dst_sel:WORD_1 dst_unused:UNUSED_PRESERVE src0_sel:WORD_1
 v_pk_fma_f16 v220, v222, v247, v247
 v_pk_fma_f16 v221, v223, v247, v247
 v_rcp_f16 v216, v220
 s_waitcnt lgkmcnt(4)
 v_mfma_f32_32x32x16_bf16 v[40:55], a[16:19], a[72:75], v[40:55]
 ds_read_b64_tr_b16 a[8:9], v244 offset:10240
 ds_read_b64_tr_b16 a[10:11], v244 offset:10752
 v_rcp_f16 v218, v221
 v_rcp_f16_sdwa v217, v220 dst_sel:WORD_0 dst_unused:UNUSED_PAD src0_sel:WORD_1
 v_rcp_f16_sdwa v219, v221 dst_sel:WORD_0 dst_unused:UNUSED_PAD src0_sel:WORD_1
 v_mfma_f32_32x32x16_bf16 v[56:71], a[20:23], a[72:75], v[56:71]
 ds_read_b64_tr_b16 a[12:13], v245 offset:10240
 ds_read_b64_tr_b16 a[14:15], v245 offset:10752
 buffer_load_dwordx4 v7, s[12:15], s62 offen offset:1792  lds
 v_fma_mix_f32 v216, v168, v216, 0 op_sel_hi:[0,1,0]
 v_fma_mix_f32 v218, v170, v218, 0 op_sel_hi:[0,1,0]
 v_fma_mix_f32 v217, v169, v217, 0 op_sel_hi:[0,1,0]
 v_fma_mix_f32 v219, v171, v219, 0 op_sel_hi:[0,1,0]
 v_cvt_pk_bf16_f32 v232, v216, v217
 v_mfma_f32_32x32x16_bf16 v[40:55], a[24:27], a[76:79], v[40:55]
 ds_read_b64_tr_b16 a[16:17], v244 offset:12288
 ds_read_b64_tr_b16 a[18:19], v244 offset:12800
 v_cvt_pk_bf16_f32 v233, v218, v219
 v_accvgpr_write_b32 a104, v232
 v_accvgpr_write_b32 a105, v233
 v_cvt_pk_f16_f32 v220, v172, v173
 v_cvt_pk_f16_f32 v221, v174, v175
 v_pk_fma_f16 v222, v220, v220, s70
 v_mfma_f32_32x32x16_bf16 v[56:71], a[28:31], a[76:79], v[56:71]
 ds_read_b64_tr_b16 a[20:21], v245 offset:12288
 ds_read_b64_tr_b16 a[22:23], v245 offset:12800
 v_pk_fma_f16 v223, v221, v221, s70
 v_pk_mul_f16 v220, v222, v220 neg_lo:[1,0] neg_hi:[1,0]
 v_pk_mul_f16 v221, v223, v221 neg_lo:[1,0] neg_hi:[1,0]
 v_exp_f16 v222, v220
 v_exp_f16 v223, v221
 s_waitcnt lgkmcnt(4)
 v_mfma_f32_32x32x16_bf16 v[8:23], a[0:3], a[80:83], v[8:23]
 ds_read_b64_tr_b16 a[24:25], v244 offset:14336
 ds_read_b64_tr_b16 a[26:27], v244 offset:14848
 v_exp_f16_sdwa v222, v220 dst_sel:WORD_1 dst_unused:UNUSED_PRESERVE src0_sel:WORD_1
 v_exp_f16_sdwa v223, v221 dst_sel:WORD_1 dst_unused:UNUSED_PRESERVE src0_sel:WORD_1
 v_pk_fma_f16 v220, v222, v247, v247
 s_add_u32 s3, s33, 24576
 buffer_load_dwordx4 a[136:139], v0, s[16:19], s3 offen offset:2048 sc1
 v_mfma_f32_32x32x16_bf16 v[24:39], a[4:7], a[80:83], v[24:39]
 ds_read_b64_tr_b16 a[28:29], v245 offset:14336
 s_add_u32 m0, s64, 56832
 ds_read_b64_tr_b16 a[30:31], v245 offset:14848
 buffer_load_dwordx4 v6, s[12:15], s63 offen offset:512  lds
 v_pk_fma_f16 v221, v223, v247, v247
 v_rcp_f16 v216, v220
 v_rcp_f16 v218, v221
 v_mfma_f32_32x32x16_bf16 v[8:23], a[8:11], a[84:87], v[8:23]
 ds_read_b64_tr_b16 a[0:1], v244 offset:16384
 ds_read_b64_tr_b16 a[2:3], v244 offset:16896
 v_rcp_f16_sdwa v217, v220 dst_sel:WORD_0 dst_unused:UNUSED_PAD src0_sel:WORD_1
 v_rcp_f16_sdwa v219, v221 dst_sel:WORD_0 dst_unused:UNUSED_PAD src0_sel:WORD_1
 v_fma_mix_f32 v216, v172, v216, 0 op_sel_hi:[0,1,0]
 v_fma_mix_f32 v218, v174, v218, 0 op_sel_hi:[0,1,0]
 v_fma_mix_f32 v217, v173, v217, 0 op_sel_hi:[0,1,0]
 v_mfma_f32_32x32x16_bf16 v[24:39], a[12:15], a[84:87], v[24:39]
 ds_read_b64_tr_b16 a[4:5], v245 offset:16384
 ds_read_b64_tr_b16 a[6:7], v245 offset:16896
 v_fma_mix_f32 v219, v175, v219, 0 op_sel_hi:[0,1,0]
 v_cvt_pk_bf16_f32 v234, v216, v217
 v_cvt_pk_bf16_f32 v235, v218, v219
 v_accvgpr_write_b32 a106, v234
 v_accvgpr_write_b32 a107, v235
 buffer_store_dwordx4 v[232:235], v0, s[16:19], s69 offen offset:2048 sc1
 s_waitcnt lgkmcnt(4)
 v_mfma_f32_32x32x16_bf16 v[8:23], a[16:19], a[88:91], v[8:23]
 ds_read_b64_tr_b16 a[8:9], v244 offset:18432
 ds_read_b64_tr_b16 a[10:11], v244 offset:18944
 v_cvt_pk_f16_f32 v220, v176, v177
 v_cvt_pk_f16_f32 v221, v178, v179
 v_pk_fma_f16 v222, v220, v220, s70
 v_pk_fma_f16 v223, v221, v221, s70
 v_pk_mul_f16 v220, v222, v220 neg_lo:[1,0] neg_hi:[1,0]
 v_pk_mul_f16 v221, v223, v221 neg_lo:[1,0] neg_hi:[1,0]
 v_mfma_f32_32x32x16_bf16 v[24:39], a[20:23], a[88:91], v[24:39]
 ds_read_b64_tr_b16 a[12:13], v245 offset:18432
 ds_read_b64_tr_b16 a[14:15], v245 offset:18944
 buffer_load_dwordx4 v7, s[12:15], s63 offen offset:1536  lds
 v_exp_f16 v222, v220
 v_exp_f16 v223, v221
 v_exp_f16_sdwa v222, v220 dst_sel:WORD_1 dst_unused:UNUSED_PRESERVE src0_sel:WORD_1
 v_mfma_f32_32x32x16_bf16 v[8:23], a[24:27], a[92:95], v[8:23]
 ds_read_b64_tr_b16 a[16:17], v244 offset:20480
 ds_read_b64_tr_b16 a[18:19], v244 offset:20992
 v_exp_f16_sdwa v223, v221 dst_sel:WORD_1 dst_unused:UNUSED_PRESERVE src0_sel:WORD_1
 v_pk_fma_f16 v220, v222, v247, v247
 v_pk_fma_f16 v221, v223, v247, v247
 v_rcp_f16 v216, v220
 v_mfma_f32_32x32x16_bf16 v[24:39], a[28:31], a[92:95], v[24:39]
 ds_read_b64_tr_b16 a[20:21], v245 offset:20480
 ds_read_b64_tr_b16 a[22:23], v245 offset:20992
 v_rcp_f16 v218, v221
 v_rcp_f16_sdwa v217, v220 dst_sel:WORD_0 dst_unused:UNUSED_PAD src0_sel:WORD_1
 v_rcp_f16_sdwa v219, v221 dst_sel:WORD_0 dst_unused:UNUSED_PAD src0_sel:WORD_1
 s_waitcnt lgkmcnt(4)
 v_mfma_f32_32x32x16_bf16 v[40:55], a[0:3], a[80:83], v[40:55]
 ds_read_b64_tr_b16 a[24:25], v244 offset:22528
 ds_read_b64_tr_b16 a[26:27], v244 offset:23040
 v_fma_mix_f32 v216, v176, v216, 0 op_sel_hi:[0,1,0]
 v_fma_mix_f32 v218, v178, v218, 0 op_sel_hi:[0,1,0]
 v_fma_mix_f32 v217, v177, v217, 0 op_sel_hi:[0,1,0]
 v_fma_mix_f32 v219, v179, v219, 0 op_sel_hi:[0,1,0]
 v_cvt_pk_bf16_f32 v236, v216, v217
 v_mfma_f32_32x32x16_bf16 v[56:71], a[4:7], a[80:83], v[56:71]
 ds_read_b64_tr_b16 a[28:29], v245 offset:22528
 s_add_u32 m0, s64, 64768
 ds_read_b64_tr_b16 a[30:31], v245 offset:23040
 buffer_load_dwordx4 v6, s[12:15], s63 offen offset:768  lds
 v_cvt_pk_bf16_f32 v237, v218, v219
 v_accvgpr_write_b32 a108, v236
 v_accvgpr_write_b32 a109, v237
 v_cvt_pk_f16_f32 v220, v180, v181
 v_cvt_pk_f16_f32 v221, v182, v183
 v_pk_fma_f16 v222, v220, v220, s70
 s_add_u32 s3, s33, 24576
 buffer_load_dwordx4 a[140:143], v0, s[16:19], s3 offen offset:3072 sc1
 v_mfma_f32_32x32x16_bf16 v[40:55], a[8:11], a[84:87], v[40:55]
 s_barrier
 ds_read_b64_tr_b16 a[0:1], v244 offset:24576
 ds_read_b64_tr_b16 a[2:3], v244 offset:25088
 v_pk_fma_f16 v223, v221, v221, s70
 v_pk_mul_f16 v220, v222, v220 neg_lo:[1,0] neg_hi:[1,0]
 v_pk_mul_f16 v221, v223, v221 neg_lo:[1,0] neg_hi:[1,0]
 v_exp_f16 v222, v220
 v_exp_f16 v223, v221
 v_mfma_f32_32x32x16_bf16 v[56:71], a[12:15], a[84:87], v[56:71]
 ds_read_b64_tr_b16 a[4:5], v245 offset:24576
 ds_read_b64_tr_b16 a[6:7], v245 offset:25088
 v_exp_f16_sdwa v222, v220 dst_sel:WORD_1 dst_unused:UNUSED_PRESERVE src0_sel:WORD_1
 v_exp_f16_sdwa v223, v221 dst_sel:WORD_1 dst_unused:UNUSED_PRESERVE src0_sel:WORD_1
 v_pk_fma_f16 v220, v222, v247, v247
 s_waitcnt lgkmcnt(4)
 v_mfma_f32_32x32x16_bf16 v[40:55], a[16:19], a[88:91], v[40:55]
 ds_read_b64_tr_b16 a[8:9], v244 offset:26624
 ds_read_b64_tr_b16 a[10:11], v244 offset:27136
 v_pk_fma_f16 v221, v223, v247, v247
 v_rcp_f16 v216, v220
 v_rcp_f16 v218, v221
 v_rcp_f16_sdwa v217, v220 dst_sel:WORD_0 dst_unused:UNUSED_PAD src0_sel:WORD_1
 v_mfma_f32_32x32x16_bf16 v[56:71], a[20:23], a[88:91], v[56:71]
 ds_read_b64_tr_b16 a[12:13], v245 offset:26624
 ds_read_b64_tr_b16 a[14:15], v245 offset:27136
 buffer_load_dwordx4 v7, s[12:15], s63 offen offset:1792  lds
 v_rcp_f16_sdwa v219, v221 dst_sel:WORD_0 dst_unused:UNUSED_PAD src0_sel:WORD_1
 v_fma_mix_f32 v216, v180, v216, 0 op_sel_hi:[0,1,0]
 v_fma_mix_f32 v218, v182, v218, 0 op_sel_hi:[0,1,0]
 v_fma_mix_f32 v217, v181, v217, 0 op_sel_hi:[0,1,0]
 v_mfma_f32_32x32x16_bf16 v[40:55], a[24:27], a[92:95], v[40:55]
 ds_read_b64_tr_b16 a[16:17], v244 offset:28672
 ds_read_b64_tr_b16 a[18:19], v244 offset:29184
 v_fma_mix_f32 v219, v183, v219, 0 op_sel_hi:[0,1,0]
 v_cvt_pk_bf16_f32 v238, v216, v217
 v_cvt_pk_bf16_f32 v239, v218, v219
 v_accvgpr_write_b32 a110, v238
 v_accvgpr_write_b32 a111, v239
 buffer_store_dwordx4 v[236:239], v0, s[16:19], s69 offen offset:3072 sc1
 s_buffer_load_dwordx2 s[0:1], s[16:19], s34 glc
 v_mfma_f32_32x32x16_bf16 v[56:71], a[28:31], a[92:95], v[56:71]
 ds_read_b64_tr_b16 a[20:21], v245 offset:28672
 ds_read_b64_tr_b16 a[22:23], v245 offset:29184
 s_waitcnt lgkmcnt(8)
 v_mfma_f32_32x32x16_bf16 v[8:23], a[0:3], a[96:99], v[8:23]
 ds_read_b64_tr_b16 a[24:25], v244 offset:30720
 ds_read_b64_tr_b16 a[26:27], v244 offset:31232
 v_mfma_f32_32x32x16_bf16 v[24:39], a[4:7], a[96:99], v[24:39]
 ds_read_b64_tr_b16 a[28:29], v245 offset:30720
 s_add_u32 m0, s64, 73088
 ds_read_b64_tr_b16 a[30:31], v245 offset:31232
 buffer_load_dwordx4 v6, s[12:15], s56 offen offset:640  lds
 s_waitcnt lgkmcnt(8)
 v_mfma_f32_32x32x16_bf16 v[8:23], a[8:11], a[100:103], v[8:23]
 ds_read_b64_tr_b16 a[0:1], v244 offset:32768
 ds_read_b64_tr_b16 a[2:3], v244 offset:33280
 s_lshl_b32 s52, s41, 2
 s_lshr_b32 s38, s42, 2
 v_mfma_f32_32x32x16_bf16 v[24:39], a[12:15], a[100:103], v[24:39]
 ds_read_b64_tr_b16 a[4:5], v245 offset:32768
 ds_read_b64_tr_b16 a[6:7], v245 offset:33280
 s_add_u32 s52, s52, s38
 v_and_b32 v216, 31, v2
 v_lshrrev_b32 v217, 5, v2
 s_waitcnt lgkmcnt(8)
 v_mfma_f32_32x32x16_bf16 v[8:23], a[16:19], a[104:107], v[8:23]
 ds_read_b64_tr_b16 a[8:9], v244 offset:34816
 ds_read_b64_tr_b16 a[10:11], v244 offset:35328
 v_lshlrev_b32 v207, 2, v217
 v_sub_u32 v207, v216, v207
 v_mfma_f32_32x32x16_bf16 v[24:39], a[20:23], a[104:107], v[24:39]
 ds_read_b64_tr_b16 a[12:13], v245 offset:34816
 ds_read_b64_tr_b16 a[14:15], v245 offset:35328
 buffer_load_dwordx4 v7, s[12:15], s56 offen offset:1664  lds
 v_lshlrev_b32 v216, 6, v216
 v_add_u32 v216, s52, v216
 s_waitcnt lgkmcnt(8)
 v_mfma_f32_32x32x16_bf16 v[8:23], a[24:27], a[108:111], v[8:23]
 ds_read_b64_tr_b16 a[16:17], v244 offset:36864
 ds_read_b64_tr_b16 a[18:19], v244 offset:37376
 s_lshr_b32 s38, s40, 1
 s_and_b32 s39, s40, 1
 v_mfma_f32_32x32x16_bf16 v[24:39], a[28:31], a[108:111], v[24:39]
 ds_read_b64_tr_b16 a[20:21], v245 offset:36864
 ds_read_b64_tr_b16 a[22:23], v245 offset:37376
 s_lshl_b32 s8, s38, 4
 s_lshl_b32 s9, s39, 2
 s_add_u32 s8, s8, s9
 s_waitcnt lgkmcnt(8)
 v_mfma_f32_32x32x16_bf16 v[40:55], a[0:3], a[96:99], v[40:55]
 ds_read_b64_tr_b16 a[24:25], v244 offset:38912
 ds_read_b64_tr_b16 a[26:27], v244 offset:39424
 v_lshl_add_u32 v217, v217, 3, s8
 v_mul_u32_u24 v217, v217, v216
 v_mfma_f32_32x32x16_bf16 v[56:71], a[4:7], a[96:99], v[56:71]
 ds_read_b64_tr_b16 a[28:29], v245 offset:38912
 s_add_u32 m0, s64, 81280
 ds_read_b64_tr_b16 a[30:31], v245 offset:39424
 buffer_load_dwordx4 v6, s[12:15], s57 offen offset:640  lds
 s_add_u32 s8, s8, s9
 v_subrev_u32 v207, s8, v207
 s_waitcnt lgkmcnt(8)
 v_mfma_f32_32x32x16_bf16 v[40:55], a[8:11], a[100:103], v[40:55]
 ds_read_b64_tr_b16 a[0:1], v244 offset:40960
 ds_read_b64_tr_b16 a[2:3], v244 offset:41472
 s_lshl_b32 s38, s38, 10
 s_lshl_b32 s39, s39, 3
 v_mfma_f32_32x32x16_bf16 v[56:71], a[12:15], a[100:103], v[56:71]
 ds_read_b64_tr_b16 a[4:5], v245 offset:40960
 ds_read_b64_tr_b16 a[6:7], v245 offset:41472
 s_add_u32 s38, s38, s39
 s_add_u32 s38, s38, 149504
 v_add_u32 v206, s38, v0
 s_waitcnt lgkmcnt(8)
 v_mfma_f32_32x32x16_bf16 v[40:55], a[16:19], a[104:107], v[40:55]
 ds_read_b64_tr_b16 a[8:9], v244 offset:43008
 ds_read_b64_tr_b16 a[10:11], v244 offset:43520
 v_mad_u32_u24 v208, v216, 0, v217
 v_mad_u32_u24 v209, v216, 1, v217
 v_mfma_f32_32x32x16_bf16 v[56:71], a[20:23], a[104:107], v[56:71]
 ds_read_b64_tr_b16 a[12:13], v245 offset:43008
 ds_read_b64_tr_b16 a[14:15], v245 offset:43520
 buffer_load_dwordx4 v7, s[12:15], s57 offen offset:1664  lds
 v_mad_u32_u24 v210, v216, 2, v217
 v_mad_u32_u24 v211, v216, 3, v217
 s_waitcnt lgkmcnt(8)
 v_mfma_f32_32x32x16_bf16 v[40:55], a[24:27], a[108:111], v[40:55]
 ds_read_b64_tr_b16 a[16:17], v244 offset:45056
 ds_read_b64_tr_b16 a[18:19], v244 offset:45568
 v_and_b32 v208, 0x7ff, v208
 v_and_b32 v209, 0x7ff, v209
 v_mfma_f32_32x32x16_bf16 v[56:71], a[28:31], a[108:111], v[56:71]
 ds_read_b64_tr_b16 a[20:21], v245 offset:45056
 ds_read_b64_tr_b16 a[22:23], v245 offset:45568
 v_and_b32 v210, 0x7ff, v210
 v_and_b32 v211, 0x7ff, v211
 v_cvt_f32_u32 v208, v208
 s_waitcnt lgkmcnt(8)
 v_mfma_f32_32x32x16_bf16 v[8:23], a[0:3], a[32:35], v[8:23]
 ds_read_b64_tr_b16 a[24:25], v244 offset:47104
 ds_read_b64_tr_b16 a[26:27], v244 offset:47616
 v_cvt_f32_u32 v209, v209
 v_cvt_f32_u32 v210, v210
 v_mfma_f32_32x32x16_bf16 v[24:39], a[4:7], a[32:35], v[24:39]
 ds_read_b64_tr_b16 a[28:29], v245 offset:47104
 s_add_u32 m0, s64, 89472
 ds_read_b64_tr_b16 a[30:31], v245 offset:47616
 buffer_load_dwordx4 v6, s[12:15], s58 offen offset:640  lds
 v_cvt_f32_u32 v211, v211
 v_mul_f32 v208, 0x3a000000, v208
 s_waitcnt lgkmcnt(8)
 v_mfma_f32_32x32x16_bf16 v[8:23], a[8:11], a[36:39], v[8:23]
 s_barrier
 ds_read_b64_tr_b16 a[0:1], v240 offset:0
 ds_read_b64_tr_b16 a[2:3], v240 offset:512
 v_mul_f32 v209, 0x3a000000, v209
 v_mul_f32 v210, 0x3a000000, v210
 v_mfma_f32_32x32x16_bf16 v[24:39], a[12:15], a[36:39], v[24:39]
 ds_read_b64_tr_b16 a[4:5], v241 offset:0
 ds_read_b64_tr_b16 a[6:7], v241 offset:512
 v_mul_f32 v211, 0x3a000000, v211
 v_cos_f32 v212, v208
 v_cos_f32 v213, v209
 s_waitcnt lgkmcnt(8)
 v_mfma_f32_32x32x16_bf16 v[8:23], a[16:19], a[40:43], v[8:23]
 ds_read_b64_tr_b16 a[8:9], v240 offset:2048
 ds_read_b64_tr_b16 a[10:11], v240 offset:2560
 v_cos_f32 v214, v210
 v_cos_f32 v215, v211
 s_waitcnt lgkmcnt(0)
 s_sub_u32 s1, s1, 4
 s_cmp_lt_u32 s1, 60
 s_cselect_b32 s0, s0, 0
 s_cmp_lg_u32 s0, s45
 s_cbranch_scc1 QC_71
QK_72:
 v_mfma_f32_32x32x16_bf16 v[24:39], a[20:23], a[40:43], v[24:39]
 ds_read_b64_tr_b16 a[12:13], v241 offset:2048
 ds_read_b64_tr_b16 a[14:15], v241 offset:2560
 buffer_load_dwordx4 v7, s[12:15], s58 offen offset:1664  lds
 v_sin_f32 v208, v208
 v_sin_f32 v209, v209
 v_mfma_f32_32x32x16_bf16 v[8:23], a[24:27], a[44:47], v[8:23]
 ds_read_b64_tr_b16 a[16:17], v240 offset:4096
 ds_read_b64_tr_b16 a[18:19], v240 offset:4608
 v_sin_f32 v210, v210
 v_sin_f32 v211, v211
 v_mfma_f32_32x32x16_bf16 v[24:39], a[28:31], a[44:47], v[24:39]
 ds_read_b64_tr_b16 a[20:21], v241 offset:4096
 ds_read_b64_tr_b16 a[22:23], v241 offset:4608
 s_add_u32 s3, s33, 28672
 buffer_load_dwordx4 a[144:147], v0, s[16:19], s3 offen offset:0 sc1
 v_mul_f32 v212, 0x3672b9d6, v212
 v_mul_f32 v213, 0x3672b9d6, v213
 v_mul_f32 v214, 0x3672b9d6, v214
 s_waitcnt lgkmcnt(4)
 v_mfma_f32_32x32x16_bf16 v[40:55], a[0:3], a[32:35], v[40:55]
 ds_read_b64_tr_b16 a[24:25], v240 offset:6144
 ds_read_b64_tr_b16 a[26:27], v240 offset:6656
 v_mul_f32 v215, 0x3672b9d6, v215
 v_mul_f32 v208, 0x3672b9d6, v208
 v_mfma_f32_32x32x16_bf16 v[56:71], a[4:7], a[32:35], v[56:71]
 ds_read_b64_tr_b16 a[28:29], v241 offset:6144
 s_add_u32 m0, s64, 97664
 ds_read_b64_tr_b16 a[30:31], v241 offset:6656
 buffer_load_dwordx4 v6, s[12:15], s59 offen offset:640  lds
 v_mul_f32 v209, 0x3672b9d6, v209
 v_mul_f32 v210, 0x3672b9d6, v210
 v_mfma_f32_32x32x16_bf16 v[40:55], a[8:11], a[36:39], v[40:55]
 ds_read_b64_tr_b16 a[0:1], v240 offset:8192
 ds_read_b64_tr_b16 a[2:3], v240 offset:8704
 v_mul_f32 v211, 0x3672b9d6, v211
 v_cvt_pk_bf16_f32 v216, v212, v213
 v_cvt_pk_bf16_f32 v217, v214, v215
 v_mfma_f32_32x32x16_bf16 v[56:71], a[12:15], a[36:39], v[56:71]
 ds_read_b64_tr_b16 a[4:5], v241 offset:8192
 ds_read_b64_tr_b16 a[6:7], v241 offset:8704
 s_add_u32 s3, s33, 28672
 buffer_load_dwordx4 a[148:151], v0, s[16:19], s3 offen offset:1024 sc1
 v_cvt_pk_bf16_f32 v218, v208, v209
 v_cvt_pk_bf16_f32 v219, v210, v211
 s_waitcnt lgkmcnt(4)
 v_mfma_f32_32x32x16_bf16 v[40:55], a[16:19], a[40:43], v[40:55]
 ds_read_b64_tr_b16 a[8:9], v240 offset:10240
 ds_read_b64_tr_b16 a[10:11], v240 offset:10752
 v_xor_b32 v220, 0x80008000, v218
 v_xor_b32 v221, 0x80008000, v219
 v_mov_b32 v249, 5
 s_waitcnt vmcnt(9)
 s_mov_b64 exec, 1
 buffer_store_dwordx2 v[248:249], off, s[16:19], s67 sc1
 s_mov_b64 exec, -1
 v_mfma_f32_32x32x16_bf16 v[56:71], a[20:23], a[40:43], v[56:71]
 ds_read_b64_tr_b16 a[12:13], v241 offset:10240
 ds_read_b64_tr_b16 a[14:15], v241 offset:10752
 buffer_load_dwordx4 v7, s[12:15], s59 offen offset:1664  lds
 v_and_b32 v208, 1, v207
 v_lshlrev_b32 v208, 4, v208
 v_mfma_f32_32x32x16_bf16 v[40:55], a[24:27], a[44:47], v[40:55]
 ds_read_b64_tr_b16 a[16:17], v240 offset:12288
 ds_read_b64_tr_b16 a[18:19], v240 offset:12800
 v_mov_b32 v209, 0x3f80
 v_lshlrev_b32 v208, v208, v209
 v_and_b32 v207, -2, v207
 v_mfma_f32_32x32x16_bf16 v[56:71], a[28:31], a[44:47], v[56:71]
 ds_read_b64_tr_b16 a[20:21], v241 offset:12288
 ds_read_b64_tr_b16 a[22:23], v241 offset:12800
 s_add_u32 s3, s33, 28672
 buffer_load_dwordx4 a[152:155], v0, s[16:19], s3 offen offset:2048 sc1
 v_cmp_eq_u32 vcc, 0, v207
 s_nop 1
 v_cndmask_b32 v222, 0, v208, vcc
 s_waitcnt lgkmcnt(4)
 v_mfma_f32_32x32x16_bf16 v[8:23], a[0:3], a[112:115], v[8:23]
 ds_read_b64_tr_b16 a[24:25], v240 offset:14336
 ds_read_b64_tr_b16 a[26:27], v240 offset:14848
 v_mfma_f32_32x32x16_bf16 v[24:39], a[4:7], a[112:115], v[24:39]
 ds_read_b64_tr_b16 a[28:29], v241 offset:14336
 s_add_u32 m0, s64, 105856
 ds_read_b64_tr_b16 a[30:31], v241 offset:14848
 buffer_load_dwordx4 v6, s[12:15], s55 offen offset:640  lds
 v_cmp_eq_u32 vcc, 2, v207
 s_nop 1
 v_cndmask_b32 v223, 0, v208, vcc
 v_mfma_f32_32x32x16_bf16 v[8:23], a[8:11], a[116:119], v[8:23]
 ds_read_b64_tr_b16 a[0:1], v240 offset:16384
 ds_read_b64_tr_b16 a[2:3], v240 offset:16896
 v_mfma_f32_32x32x16_bf16 v[24:39], a[12:15], a[116:119], v[24:39]
 ds_read_b64_tr_b16 a[4:5], v241 offset:16384
 ds_read_b64_tr_b16 a[6:7], v241 offset:16896
 s_add_u32 s3, s33, 28672
 buffer_load_dwordx4 a[156:159], v0, s[16:19], s3 offen offset:3072 sc1
 ds_write_b64 v206, v[216:217] offset:0
 s_waitcnt lgkmcnt(5)
 v_mfma_f32_32x32x16_bf16 v[8:23], a[16:19], a[120:123], v[8:23]
 ds_read_b64_tr_b16 a[8:9], v240 offset:18432
 ds_read_b64_tr_b16 a[10:11], v240 offset:18944
 v_mfma_f32_32x32x16_bf16 v[24:39], a[20:23], a[120:123], v[24:39]
 ds_read_b64_tr_b16 a[12:13], v241 offset:18432
 ds_read_b64_tr_b16 a[14:15], v241 offset:18944
 buffer_load_dwordx4 v7, s[12:15], s55 offen offset:1664  lds
 v_mfma_f32_32x32x16_bf16 v[8:23], a[24:27], a[124:127], v[8:23]
 ds_read_b64_tr_b16 a[16:17], v240 offset:20480
 ds_read_b64_tr_b16 a[18:19], v240 offset:20992
 v_mfma_f32_32x32x16_bf16 v[24:39], a[28:31], a[124:127], v[24:39]
 ds_read_b64_tr_b16 a[20:21], v241 offset:20480
 ds_read_b64_tr_b16 a[22:23], v241 offset:20992
 ds_write_b64 v206, v[218:219] offset:2048
 s_waitcnt lgkmcnt(5)
 v_mfma_f32_32x32x16_bf16 v[40:55], a[0:3], a[112:115], v[40:55]
 ds_read_b64_tr_b16 a[24:25], v240 offset:22528
 ds_read_b64_tr_b16 a[26:27], v240 offset:23040
 v_mfma_f32_32x32x16_bf16 v[56:71], a[4:7], a[112:115], v[56:71]
 ds_read_b64_tr_b16 a[28:29], v241 offset:22528
 s_add_u32 m0, s64, 114048
 ds_read_b64_tr_b16 a[30:31], v241 offset:23040
 buffer_load_dwordx4 v6, s[12:15], s60 offen offset:640  lds
 v_mfma_f32_32x32x16_bf16 v[40:55], a[8:11], a[116:119], v[40:55]
 s_barrier
 ds_read_b64_tr_b16 a[0:1], v240 offset:24576
 ds_read_b64_tr_b16 a[2:3], v240 offset:25088
 ds_write_b64 v206, v[220:221] offset:4096
 v_mfma_f32_32x32x16_bf16 v[56:71], a[12:15], a[116:119], v[56:71]
 ds_read_b64_tr_b16 a[4:5], v241 offset:24576
 ds_read_b64_tr_b16 a[6:7], v241 offset:25088
 s_waitcnt lgkmcnt(5)
 v_mfma_f32_32x32x16_bf16 v[40:55], a[16:19], a[120:123], v[40:55]
 ds_read_b64_tr_b16 a[8:9], v240 offset:26624
 ds_read_b64_tr_b16 a[10:11], v240 offset:27136
 v_mfma_f32_32x32x16_bf16 v[56:71], a[20:23], a[120:123], v[56:71]
 ds_read_b64_tr_b16 a[12:13], v241 offset:26624
 ds_read_b64_tr_b16 a[14:15], v241 offset:27136
 buffer_load_dwordx4 v7, s[12:15], s60 offen offset:1664  lds
 s_add_u32 s3, s33, 32768
 buffer_load_dwordx4 a[160:163], v0, s[16:19], s3 offen offset:0 sc1
 v_mfma_f32_32x32x16_bf16 v[40:55], a[24:27], a[124:127], v[40:55]
 ds_read_b64_tr_b16 a[16:17], v240 offset:28672
 ds_read_b64_tr_b16 a[18:19], v240 offset:29184
 ds_write_b64 v206, v[222:223] offset:6144
 v_mfma_f32_32x32x16_bf16 v[56:71], a[28:31], a[124:127], v[56:71]
 ds_read_b64_tr_b16 a[20:21], v241 offset:28672
 ds_read_b64_tr_b16 a[22:23], v241 offset:29184
 s_waitcnt lgkmcnt(5)
 v_mfma_f32_32x32x16_bf16 v[8:23], a[0:3], a[128:131], v[8:23]
 ds_read_b64_tr_b16 a[24:25], v240 offset:30720
 ds_read_b64_tr_b16 a[26:27], v240 offset:31232
 v_mfma_f32_32x32x16_bf16 v[24:39], a[4:7], a[128:131], v[24:39]
 ds_read_b64_tr_b16 a[28:29], v241 offset:30720
 s_add_u32 m0, s64, 122240
 ds_read_b64_tr_b16 a[30:31], v241 offset:31232
 buffer_load_dwordx4 v6, s[12:15], s61 offen offset:640  lds
 s_add_u32 s3, s33, 32768
 buffer_load_dwordx4 a[164:167], v0, s[16:19], s3 offen offset:1024 sc1
 s_lshl_b32 s67, s43, 1
 s_and_b32 s39, s42, 1
 v_mfma_f32_32x32x16_bf16 v[8:23], a[8:11], a[132:135], v[8:23]
 ds_read_b64_tr_b16 a[0:1], v240 offset:32768
 ds_read_b64_tr_b16 a[2:3], v240 offset:33280
 s_add_u32 s67, s67, s39
 v_mfma_f32_32x32x16_bf16 v[24:39], a[12:15], a[132:135], v[24:39]
 ds_read_b64_tr_b16 a[4:5], v241 offset:32768
 ds_read_b64_tr_b16 a[6:7], v241 offset:33280
 s_mul_i32 s67, s67, 128
 s_lshr_b32 s39, s42, 1
 s_waitcnt lgkmcnt(4)
 v_mfma_f32_32x32x16_bf16 v[8:23], a[16:19], a[136:139], v[8:23]
 ds_read_b64_tr_b16 a[8:9], v240 offset:34816
 ds_read_b64_tr_b16 a[10:11], v240 offset:35328
 s_add_u32 s3, s33, 32768
ST2_11:
 s_cbranch_execz STB2_2
 buffer_load_dwordx4 a[168:171], v0, s[16:19], s3 offen offset:2048 sc1
 s_mul_i32 s39, s39, 4
 s_add_u32 s67, s67, s39
 v_mfma_f32_32x32x16_bf16 v[24:39], a[20:23], a[136:139], v[24:39]
 ds_read_b64_tr_b16 a[12:13], v241 offset:34816
 ds_read_b64_tr_b16 a[14:15], v241 offset:35328
 buffer_load_dwordx4 v7, s[12:15], s61 offen offset:1664  lds
 s_add_u32 s67, s67, 42610688
 s_lshl_b32 s52, s41, 2
 v_mfma_f32_32x32x16_bf16 v[8:23], a[24:27], a[140:143], v[8:23]
 ds_read_b64_tr_b16 a[16:17], v240 offset:36864
 ds_read_b64_tr_b16 a[18:19], v240 offset:37376
 s_lshr_b32 s38, s42, 2
 v_mfma_f32_32x32x16_bf16 v[24:39], a[28:31], a[140:143], v[24:39]
 ds_read_b64_tr_b16 a[20:21], v241 offset:36864
 ds_read_b64_tr_b16 a[22:23], v241 offset:37376
 s_add_u32 s52, s52, s38
 s_and_b32 s65, s42, 3
 s_waitcnt lgkmcnt(4)
 v_mfma_f32_32x32x16_bf16 v[40:55], a[0:3], a[128:131], v[40:55]
 ds_read_b64_tr_b16 a[24:25], v240 offset:38912
 ds_read_b64_tr_b16 a[26:27], v240 offset:39424
 s_add_u32 s3, s33, 32768
 buffer_load_dwordx4 a[172:175], v0, s[16:19], s3 offen offset:3072 sc1
 s_min_u32 s65, s65, 2
 s_mul_i32 s38, s40, 3
 v_mfma_f32_32x32x16_bf16 v[56:71], a[4:7], a[128:131], v[56:71]
 ds_read_b64_tr_b16 a[28:29], v241 offset:38912
 s_add_u32 m0, s64, 130432
 ds_read_b64_tr_b16 a[30:31], v241 offset:39424
 buffer_load_dwordx4 v6, s[12:15], s62 offen offset:640  lds
 s_add_u32 s65, s65, s38
 s_min_u32 s65, s65, 8
 v_mfma_f32_32x32x16_bf16 v[40:55], a[8:11], a[132:135], v[40:55]
 ds_read_b64_tr_b16 a[0:1], v240 offset:40960
 ds_read_b64_tr_b16 a[2:3], v240 offset:41472
 s_mul_i32 s39, s65, 3
 v_mfma_f32_32x32x16_bf16 v[56:71], a[12:15], a[132:135], v[56:71]
 ds_read_b64_tr_b16 a[4:5], v241 offset:40960
 ds_read_b64_tr_b16 a[6:7], v241 offset:41472
 s_lshr_b32 s46, 0x6ff69fe, s39
 s_and_b32 s46, s46, 7
 s_waitcnt lgkmcnt(4)
 v_mfma_f32_32x32x16_bf16 v[40:55], a[16:19], a[136:139], v[40:55]
 ds_read_b64_tr_b16 a[8:9], v240 offset:43008
 ds_read_b64_tr_b16 a[10:11], v240 offset:43520
 s_lshr_b32 s47, 0x496cb64, s39
 s_and_b32 s47, s47, 7
 v_mfma_f32_32x32x16_bf16 v[56:71], a[20:23], a[136:139], v[56:71]
 ds_read_b64_tr_b16 a[12:13], v241 offset:43008
 ds_read_b64_tr_b16 a[14:15], v241 offset:43520
 buffer_load_dwordx4 v7, s[12:15], s62 offen offset:1664  lds
 s_lshr_b32 s38, 0x2912122, s39
 s_and_b32 s38, s38, 7
 v_mfma_f32_32x32x16_bf16 v[40:55], a[24:27], a[140:143], v[40:55]
 ds_read_b64_tr_b16 a[16:17], v240 offset:45056
 ds_read_b64_tr_b16 a[18:19], v240 offset:45568
 s_lshl_b32 s53, 1, s38
 v_mfma_f32_32x32x16_bf16 v[56:71], a[28:31], a[140:143], v[56:71]
 ds_read_b64_tr_b16 a[20:21], v241 offset:45056
 ds_read_b64_tr_b16 a[22:23], v241 offset:45568
 s_lshr_b32 s38, 0x1249249, s39
 s_and_b32 s38, s38, 7
 s_waitcnt vmcnt(11)
 s_waitcnt lgkmcnt(4)
 v_mfma_f32_32x32x16_bf16 v[8:23], a[0:3], a[144:147], v[8:23]
 ds_read_b64_tr_b16 a[24:25], v240 offset:47104
 ds_read_b64_tr_b16 a[26:27], v240 offset:47616
 s_bitset1_b32 s53, s38
 v_mfma_f32_32x32x16_bf16 v[24:39], a[4:7], a[144:147], v[24:39]
 ds_read_b64_tr_b16 a[28:29], v241 offset:47104
 s_add_u32 m0, s64, 138624
 ds_read_b64_tr_b16 a[30:31], v241 offset:47616
 buffer_load_dwordx4 v6, s[12:15], s63 offen offset:640  lds
 s_bitcmp1_b32 s44, 5
 s_cselect_b32 s53, s53, 0
 s_mul_i32 s39, s52, 256
 v_mfma_f32_32x32x16_bf16 v[8:23], a[8:11], a[148:151], v[8:23]
 s_barrier
 ds_read_b64_tr_b16 a[0:1], v242 offset:0
 ds_read_b64_tr_b16 a[2:3], v242 offset:512
 s_add_u32 s39, s39, 42610816
 v_mfma_f32_32x32x16_bf16 v[24:39], a[12:15], a[148:151], v[24:39]
 ds_read_b64_tr_b16 a[4:5], v243 offset:0
 ds_read_b64_tr_b16 a[6:7], v243 offset:512
 s_cmp_eq_u32 s65, 8
 s_cselect_b32 s38, 0, 128
 s_waitcnt lgkmcnt(4)
 v_mfma_f32_32x32x16_bf16 v[8:23], a[16:19], a[152:155], v[8:23]
 ds_read_b64_tr_b16 a[8:9], v242 offset:2048
 ds_read_b64_tr_b16 a[10:11], v242 offset:2560
 s_sub_u32 s38, s39, s38
 s_mul_i32 s50, s52, 18
 v_mfma_f32_32x32x16_bf16 v[24:39], a[20:23], a[152:155], v[24:39]
 ds_read_b64_tr_b16 a[12:13], v243 offset:2048
 ds_read_b64_tr_b16 a[14:15], v243 offset:2560
 buffer_load_dwordx4 v7, s[12:15], s63 offen offset:1664  lds
 s_add_u32 s50, s50, s65
 s_lshl_b32 s50, s50, 14
 v_mfma_f32_32x32x16_bf16 v[8:23], a[24:27], a[156:159], v[8:23]
 ds_read_b64_tr_b16 a[16:17], v242 offset:4096
 ds_read_b64_tr_b16 a[18:19], v242 offset:4608
 s_add_u32 s50, s50, 18874368
 v_mfma_f32_32x32x16_bf16 v[24:39], a[28:31], a[156:159], v[24:39]
 ds_read_b64_tr_b16 a[20:21], v243 offset:4096
 ds_read_b64_tr_b16 a[22:23], v243 offset:4608
 s_lshl_b32 s4, s65, 6
 s_waitcnt lgkmcnt(4)
 v_mfma_f32_32x32x16_bf16 v[40:55], a[0:3], a[144:147], v[40:55]
 ds_read_b64_tr_b16 a[24:25], v242 offset:6144
 ds_read_b64_tr_b16 a[26:27], v242 offset:6656
 v_mfma_f32_32x32x16_bf16 v[56:71], a[4:7], a[144:147], v[56:71]
 ds_read_b64_tr_b16 a[28:29], v243 offset:6144
 ds_read_b64_tr_b16 a[30:31], v243 offset:6656
 s_add_u32 m0, s64, 0
 s_add_u32 s68, s56, 256
 buffer_load_dwordx4 v6, s[12:15], s68 offen  lds
 s_bitcmp1_b32 0xf, s65
 s_cselect_b32 s48, s39, s38
 s_cselect_b32 s49, s38, s39
 s_cselect_b32 s36, -1.0, 1.0
 s_cselect_b32 s37, 1.0, -1.0
 s_cselect_b32 s38, 147456, 0
 s_cselect_b32 s39, 576, 0
 v_mfma_f32_32x32x16_bf16 v[40:55], a[8:11], a[148:151], v[40:55]
 ds_read_b64_tr_b16 a[0:1], v242 offset:8192
 ds_read_b64_tr_b16 a[2:3], v242 offset:8704
 v_mfma_f32_32x32x16_bf16 v[56:71], a[12:15], a[148:151], v[56:71]
 ds_read_b64_tr_b16 a[4:5], v243 offset:8192
 ds_read_b64_tr_b16 a[6:7], v243 offset:8704
 s_add_u32 s51, s50, 147456
 s_waitcnt lgkmcnt(4)
 v_mfma_f32_32x32x16_bf16 v[40:55], a[16:19], a[152:155], v[40:55]
 ds_read_b64_tr_b16 a[8:9], v242 offset:10240
 ds_read_b64_tr_b16 a[10:11], v242 offset:10752
 s_sub_u32 s51, s51, s38
 s_add_u32 s50, s50, s38
 v_mfma_f32_32x32x16_bf16 v[56:71], a[20:23], a[152:155], v[56:71]
 ds_read_b64_tr_b16 a[12:13], v243 offset:10240
 ds_read_b64_tr_b16 a[14:15], v243 offset:10752
 buffer_load_dwordx4 v7, s[12:15], s68 offen offset:1024  lds
 s_add_u32 s5, s4, 576
 s_sub_u32 s5, s5, s39
 v_mfma_f32_32x32x16_bf16 v[40:55], a[24:27], a[156:159], v[40:55]
 ds_read_b64_tr_b16 a[16:17], v242 offset:12288
 ds_read_b64_tr_b16 a[18:19], v242 offset:12800
 s_add_u32 s4, s4, s39
 s_waitcnt vmcnt(6)
SC_73:
 v_accvgpr_read_b32 v216, a163
 v_accvgpr_read_b32 v217, a167
 v_accvgpr_read_b32 v218, a171
 v_accvgpr_read_b32 v219, a175
 v_max_u32 v216, v216, v217
 v_max3_u32 v216, v216, v218, v219
 v_cmp_eq_u32 vcc, -1, v216
 s_nop 1
 s_cmp_lg_u64 vcc, 0
 s_cbranch_scc1 SS_74
SK_75:
 v_mfma_f32_32x32x16_bf16 v[56:71], a[28:31], a[156:159], v[56:71]
 ds_read_b64_tr_b16 a[20:21], v243 offset:12288
 ds_read_b64_tr_b16 a[22:23], v243 offset:12800
 s_add_u32 s6, s4, 1179648
 s_add_u32 s7, s5, 1179648
 s_waitcnt lgkmcnt(4)
 v_mfma_f32_32x32x16_bf16 v[8:23], a[0:3], a[160:163], v[8:23]
 ds_read_b64_tr_b16 a[24:25], v242 offset:14336
 ds_read_b64_tr_b16 a[26:27], v242 offset:14848
 s_sub_u32 s38, s46, 4
 s_mul_i32 s38, s38, 16384
 v_mfma_f32_32x32x16_bf16 v[24:39], a[4:7], a[160:163], v[24:39]
 ds_read_b64_tr_b16 a[28:29], v243 offset:14336
 s_add_u32 m0, s64, 7936
 ds_read_b64_tr_b16 a[30:31], v243 offset:14848
 buffer_load_dwordx4 v6, s[12:15], s57 offen offset:256  lds
 s_add_u32 s48, s48, s38
 s_sub_u32 s38, s47, 4
 v_mfma_f32_32x32x16_bf16 v[8:23], a[8:11], a[164:167], v[8:23]
 ds_read_b64_tr_b16 a[0:1], v242 offset:16384
 ds_read_b64_tr_b16 a[2:3], v242 offset:16896
 s_mul_i32 s38, s38, 16384
 v_mfma_f32_32x32x16_bf16 v[24:39], a[12:15], a[164:167], v[24:39]
 ds_read_b64_tr_b16 a[4:5], v243 offset:16384
 ds_read_b64_tr_b16 a[6:7], v243 offset:16896
 s_add_u32 s49, s49, s38
 s_add_u32 s46, s46, s45
 s_waitcnt lgkmcnt(4)
 v_mfma_f32_32x32x16_bf16 v[8:23], a[16:19], a[168:171], v[8:23]
 ds_read_b64_tr_b16 a[8:9], v242 offset:18432
 ds_read_b64_tr_b16 a[10:11], v242 offset:18944
 s_add_u32 s47, s47, s45
 v_and_b32 v4, 7, v2
 s_getpc_b64 s[100:101]
CT_76:
 s_lshr_b32 s3, s2, 3
 s_lshl_b32 s3, s3, 2
 s_add_u32 s3, s3, s40
 s_lshl_b32 s3, s3, 8
 v_lshlrev_b32 v254, 7, v2
 v_add_u32 v254, s3, v254
 v_min_u32 v254, L_tailend-L_s9-4, v254
 s_sub_u32 s100, s100, CT_76-L_main
 s_subb_u32 s101, s101, 0
 v_add_u32 v254, L_s9-L_main, v254
 v_mov_b32 v255, 0
 v_lshl_add_u64 v[254:255], s[100:101], 0, v[254:255]
 s_mov_b64 exec, 3
 global_load_dword a252, v[254:255], off
 s_mov_b64 exec, -1
 v_mfma_f32_32x32x16_bf16 v[24:39], a[20:23], a[168:171], v[24:39]
 ds_read_b64_tr_b16 a[12:13], v243 offset:18432
 ds_read_b64_tr_b16 a[14:15], v243 offset:18944
 buffer_load_dwordx4 v7, s[12:15], s57 offen offset:1280  lds
 v_lshlrev_b32 v4, 2, v4
 v_lshrrev_b32 v5, 2, v2
 v_mfma_f32_32x32x16_bf16 v[8:23], a[24:27], a[172:175], v[8:23]
 ds_read_b64_tr_b16 a[16:17], v242 offset:20480
 ds_read_b64_tr_b16 a[18:19], v242 offset:20992
 s_mov_b32 s38, 73728
 v_mfma_f32_32x32x16_bf16 v[24:39], a[28:31], a[172:175], v[24:39]
 ds_read_b64_tr_b16 a[20:21], v243 offset:20480
 ds_read_b64_tr_b16 a[22:23], v243 offset:20992
 v_mul_lo_u32 v5, v5, s38
 v_and_b32 v206, 3, v2
 s_waitcnt lgkmcnt(4)
 v_mfma_f32_32x32x16_bf16 v[40:55], a[0:3], a[160:163], v[40:55]
 ds_read_b64_tr_b16 a[24:25], v242 offset:22528
 ds_read_b64_tr_b16 a[26:27], v242 offset:23040
 v_lshl_add_u32 v5, v206, 4, v5
 s_mul_i32 s38, s52, 1152
 v_mfma_f32_32x32x16_bf16 v[56:71], a[4:7], a[160:163], v[56:71]
 ds_read_b64_tr_b16 a[28:29], v243 offset:22528
 s_add_u32 m0, s64, 16128
 ds_read_b64_tr_b16 a[30:31], v243 offset:23040
 buffer_load_dwordx4 v6, s[12:15], s58 offen offset:256  lds
 v_add_u32 v5, s38, v5
 s_mul_i32 s54, s52, 36864
 v_mfma_f32_32x32x16_bf16 v[40:55], a[8:11], a[164:167], v[40:55]
 s_barrier
 ds_read_b64_tr_b16 a[0:1], v242 offset:24576
 ds_read_b64_tr_b16 a[2:3], v242 offset:25088
 s_mul_i32 s38, s40, 12288
 v_mfma_f32_32x32x16_bf16 v[56:71], a[12:15], a[164:167], v[56:71]
 ds_read_b64_tr_b16 a[4:5], v243 offset:24576
 ds_read_b64_tr_b16 a[6:7], v243 offset:25088
 s_add_u32 s54, s54, s38
 s_add_u32 s54, s54, 40108032
 s_waitcnt lgkmcnt(4)
 v_mfma_f32_32x32x16_bf16 v[40:55], a[16:19], a[168:171], v[40:55]
 ds_read_b64_tr_b16 a[8:9], v242 offset:26624
 ds_read_b64_tr_b16 a[10:11], v242 offset:27136
 s_and_b32 s98, s42, 3
 s_min_u32 s98, s98, 2
 v_mfma_f32_32x32x16_bf16 v[56:71], a[20:23], a[168:171], v[56:71]
 ds_read_b64_tr_b16 a[12:13], v243 offset:26624
 ds_read_b64_tr_b16 a[14:15], v243 offset:27136
 buffer_load_dwordx4 v7, s[12:15], s58 offen offset:1280  lds
 s_mul_i32 s96, s98, 110592
 v_mfma_f32_32x32x16_bf16 v[40:55], a[24:27], a[172:175], v[40:55]
 ds_read_b64_tr_b16 a[16:17], v242 offset:28672
 ds_read_b64_tr_b16 a[18:19], v242 offset:29184
 s_add_u32 s96, s96, 368640
 v_lshl_add_u64 v[252:253], s[96:97], 0, v[252:253]
 v_mfma_f32_32x32x16_bf16 v[56:71], a[28:31], a[172:175], v[56:71]
 ds_read_b64_tr_b16 a[20:21], v243 offset:28672
 ds_read_b64_tr_b16 a[22:23], v243 offset:29184
 s_waitcnt lgkmcnt(4)
 v_mfma_f32_32x32x16_bf16 v[72:87], a[0:3], a[48:51], 0
 ds_read_b64_tr_b16 a[24:25], v242 offset:30720
 ds_read_b64_tr_b16 a[26:27], v242 offset:31232
 v_mfma_f32_32x32x16_bf16 v[88:103], a[4:7], a[48:51], 0
 ds_read_b64_tr_b16 a[28:29], v243 offset:30720
 s_add_u32 m0, s64, 24320
 ds_read_b64_tr_b16 a[30:31], v243 offset:31232
 buffer_load_dwordx4 v6, s[12:15], s59 offen offset:256  lds
 v_mfma_f32_32x32x16_bf16 v[72:87], a[8:11], a[52:55], v[72:87]
 ds_read_b64_tr_b16 a[0:1], v242 offset:32768
 ds_read_b64_tr_b16 a[2:3], v242 offset:33280
 v_mfma_f32_32x32x16_bf16 v[88:103], a[12:15], a[52:55], v[88:103]
 ds_read_b64_tr_b16 a[4:5], v243 offset:32768
 ds_read_b64_tr_b16 a[6:7], v243 offset:33280
 s_add_u32 s69, s66, 131072
 s_waitcnt lgkmcnt(4)
 v_mfma_f32_32x32x16_bf16 v[72:87], a[16:19], a[56:59], v[72:87]
 ds_read_b64_tr_b16 a[8:9], v242 offset:34816
 ds_read_b64_tr_b16 a[10:11], v242 offset:35328
 v_cvt_pk_bf16_f32 v224, v8, v9
 v_mfma_f32_32x32x16_bf16 v[88:103], a[20:23], a[56:59], v[88:103]
 ds_read_b64_tr_b16 a[12:13], v243 offset:34816
 ds_read_b64_tr_b16 a[14:15], v243 offset:35328
 buffer_load_dwordx4 v7, s[12:15], s59 offen offset:1280  lds
 v_mfma_f32_32x32x16_bf16 v[72:87], a[24:27], a[60:63], v[72:87]
 ds_read_b64_tr_b16 a[16:17], v242 offset:36864
 ds_read_b64_tr_b16 a[18:19], v242 offset:37376
 v_cvt_pk_bf16_f32 v225, v10, v11
 v_mfma_f32_32x32x16_bf16 v[88:103], a[28:31], a[60:63], v[88:103]
 ds_read_b64_tr_b16 a[20:21], v243 offset:36864
 ds_read_b64_tr_b16 a[22:23], v243 offset:37376
 v_cvt_pk_bf16_f32 v226, v12, v13
 s_waitcnt lgkmcnt(4)
 v_mfma_f32_32x32x16_bf16 v[72:87], a[0:3], a[64:67], v[72:87]
 ds_read_b64_tr_b16 a[24:25], v242 offset:38912
 ds_read_b64_tr_b16 a[26:27], v242 offset:39424
 v_cvt_pk_bf16_f32 v227, v14, v15
 v_mfma_f32_32x32x16_bf16 v[88:103], a[4:7], a[64:67], v[88:103]
 ds_read_b64_tr_b16 a[28:29], v243 offset:38912
 s_add_u32 m0, s64, 32512
 ds_read_b64_tr_b16 a[30:31], v243 offset:39424
 buffer_load_dwordx4 v6, s[12:15], s55 offen offset:256  lds
 v_mfma_f32_32x32x16_bf16 v[72:87], a[8:11], a[68:71], v[72:87]
 ds_read_b64_tr_b16 a[0:1], v242 offset:40960
 ds_read_b64_tr_b16 a[2:3], v242 offset:41472
 buffer_store_dwordx4 v[224:227], v0, s[16:19], s69 offen offset:0 sc1
 v_mfma_f32_32x32x16_bf16 v[88:103], a[12:15], a[68:71], v[88:103]
 ds_read_b64_tr_b16 a[4:5], v243 offset:40960
 ds_read_b64_tr_b16 a[6:7], v243 offset:41472
 v_cvt_pk_bf16_f32 v228, v16, v17
 s_waitcnt lgkmcnt(4)
 v_mfma_f32_32x32x16_bf16 v[72:87], a[16:19], a[72:75], v[72:87]
 ds_read_b64_tr_b16 a[8:9], v242 offset:43008
 ds_read_b64_tr_b16 a[10:11], v242 offset:43520
 v_cvt_pk_bf16_f32 v229, v18, v19
 v_mfma_f32_32x32x16_bf16 v[88:103], a[20:23], a[72:75], v[88:103]
 ds_read_b64_tr_b16 a[12:13], v243 offset:43008
 ds_read_b64_tr_b16 a[14:15], v243 offset:43520
 buffer_load_dwordx4 v7, s[12:15], s55 offen offset:1280  lds
 v_mfma_f32_32x32x16_bf16 v[72:87], a[24:27], a[76:79], v[72:87]
 ds_read_b64_tr_b16 a[16:17], v242 offset:45056
 ds_read_b64_tr_b16 a[18:19], v242 offset:45568
 v_cvt_pk_bf16_f32 v230, v20, v21
 v_mfma_f32_32x32x16_bf16 v[88:103], a[28:31], a[76:79], v[88:103]
 ds_read_b64_tr_b16 a[20:21], v243 offset:45056
 ds_read_b64_tr_b16 a[22:23], v243 offset:45568
 v_cvt_pk_bf16_f32 v231, v22, v23
 s_waitcnt lgkmcnt(4)
 v_mfma_f32_32x32x16_bf16 v[72:87], a[0:3], a[80:83], v[72:87]
 ds_read_b64_tr_b16 a[24:25], v242 offset:47104
 ds_read_b64_tr_b16 a[26:27], v242 offset:47616
 buffer_store_dwordx4 v[228:231], v0, s[16:19], s69 offen offset:1024 sc1
 v_mfma_f32_32x32x16_bf16 v[88:103], a[4:7], a[80:83], v[88:103]
 ds_read_b64_tr_b16 a[28:29], v243 offset:47104
 s_add_u32 m0, s64, 40704
 ds_read_b64_tr_b16 a[30:31], v243 offset:47616
 buffer_load_dwordx4 v6, s[12:15], s60 offen offset:256  lds
 s_add_u32 s69, s66, 147456
 v_mfma_f32_32x32x16_bf16 v[72:87], a[8:11], a[84:87], v[72:87]
 s_barrier
 ds_read_b64_tr_b16 a[0:1], v244 offset:0
 ds_read_b64_tr_b16 a[2:3], v244 offset:512
 v_mfma_f32_32x32x16_bf16 v[88:103], a[12:15], a[84:87], v[88:103]
 ds_read_b64_tr_b16 a[4:5], v245 offset:0
 ds_read_b64_tr_b16 a[6:7], v245 offset:512
 v_cvt_pk_bf16_f32 v232, v24, v25
 s_waitcnt lgkmcnt(4)
 v_mfma_f32_32x32x16_bf16 v[72:87], a[16:19], a[88:91], v[72:87]
 ds_read_b64_tr_b16 a[8:9], v244 offset:2048
 ds_read_b64_tr_b16 a[10:11], v244 offset:2560
 v_cvt_pk_bf16_f32 v233, v26, v27
 v_mfma_f32_32x32x16_bf16 v[88:103], a[20:23], a[88:91], v[88:103]
 ds_read_b64_tr_b16 a[12:13], v245 offset:2048
 ds_read_b64_tr_b16 a[14:15], v245 offset:2560
 buffer_load_dwordx4 v7, s[12:15], s60 offen offset:1280  lds
 v_cvt_pk_bf16_f32 v234, v28, v29
 v_mfma_f32_32x32x16_bf16 v[72:87], a[24:27], a[92:95], v[72:87]
 ds_read_b64_tr_b16 a[16:17], v244 offset:4096
 ds_read_b64_tr_b16 a[18:19], v244 offset:4608
 v_mfma_f32_32x32x16_bf16 v[88:103], a[28:31], a[92:95], v[88:103]
 ds_read_b64_tr_b16 a[20:21], v245 offset:4096
 ds_read_b64_tr_b16 a[22:23], v245 offset:4608
 v_cvt_pk_bf16_f32 v235, v30, v31
 s_waitcnt lgkmcnt(4)
 v_mfma_f32_32x32x16_bf16 v[72:87], a[0:3], a[96:99], v[72:87]
 ds_read_b64_tr_b16 a[24:25], v244 offset:6144
 ds_read_b64_tr_b16 a[26:27], v244 offset:6656
 buffer_store_dwordx4 v[232:235], v0, s[16:19], s69 offen offset:0 sc1
 v_mfma_f32_32x32x16_bf16 v[88:103], a[4:7], a[96:99], v[88:103]
 ds_read_b64_tr_b16 a[28:29], v245 offset:6144
 s_add_u32 m0, s64, 48896
 ds_read_b64_tr_b16 a[30:31], v245 offset:6656
 buffer_load_dwordx4 v6, s[12:15], s61 offen offset:256  lds
 v_cvt_pk_bf16_f32 v236, v32, v33
 v_mfma_f32_32x32x16_bf16 v[72:87], a[8:11], a[100:103], v[72:87]
 ds_read_b64_tr_b16 a[0:1], v244 offset:8192
 ds_read_b64_tr_b16 a[2:3], v244 offset:8704
 v_cvt_pk_bf16_f32 v237, v34, v35
 v_mfma_f32_32x32x16_bf16 v[88:103], a[12:15], a[100:103], v[88:103]
 ds_read_b64_tr_b16 a[4:5], v245 offset:8192
 ds_read_b64_tr_b16 a[6:7], v245 offset:8704
 s_waitcnt lgkmcnt(4)
 v_mfma_f32_32x32x16_bf16 v[72:87], a[16:19], a[104:107], v[72:87]
 ds_read_b64_tr_b16 a[8:9], v244 offset:10240
 ds_read_b64_tr_b16 a[10:11], v244 offset:10752
 v_cvt_pk_bf16_f32 v238, v36, v37
 v_mfma_f32_32x32x16_bf16 v[88:103], a[20:23], a[104:107], v[88:103]
 ds_read_b64_tr_b16 a[12:13], v245 offset:10240
 ds_read_b64_tr_b16 a[14:15], v245 offset:10752
 buffer_load_dwordx4 v7, s[12:15], s61 offen offset:1280  lds
 v_cvt_pk_bf16_f32 v239, v38, v39
 v_mfma_f32_32x32x16_bf16 v[72:87], a[24:27], a[108:111], v[72:87]
 ds_read_b64_tr_b16 a[16:17], v244 offset:12288
 ds_read_b64_tr_b16 a[18:19], v244 offset:12800
 buffer_store_dwordx4 v[236:239], v0, s[16:19], s69 offen offset:1024 sc1
 v_mfma_f32_32x32x16_bf16 v[88:103], a[28:31], a[108:111], v[88:103]
 ds_read_b64_tr_b16 a[20:21], v245 offset:12288
 ds_read_b64_tr_b16 a[22:23], v245 offset:12800
 s_waitcnt lgkmcnt(4)
 v_mfma_f32_32x32x16_bf16 v[72:87], a[0:3], a[32:35], v[72:87]
 ds_read_b64_tr_b16 a[24:25], v244 offset:14336
 ds_read_b64_tr_b16 a[26:27], v244 offset:14848
 s_add_u32 s69, s66, 196608
 v_mfma_f32_32x32x16_bf16 v[88:103], a[4:7], a[32:35], v[88:103]
 ds_read_b64_tr_b16 a[28:29], v245 offset:14336
 s_add_u32 m0, s64, 57088
 ds_read_b64_tr_b16 a[30:31], v245 offset:14848
 buffer_load_dwordx4 v6, s[12:15], s62 offen offset:256  lds
 v_cvt_pk_bf16_f32 v224, v40, v41
 v_mfma_f32_32x32x16_bf16 v[72:87], a[8:11], a[36:39], v[72:87]
 ds_read_b64_tr_b16 a[0:1], v244 offset:16384
 ds_read_b64_tr_b16 a[2:3], v244 offset:16896
 v_cvt_pk_bf16_f32 v225, v42, v43
 v_mfma_f32_32x32x16_bf16 v[88:103], a[12:15], a[36:39], v[88:103]
 ds_read_b64_tr_b16 a[4:5], v245 offset:16384
 ds_read_b64_tr_b16 a[6:7], v245 offset:16896
 s_waitcnt lgkmcnt(4)
 v_mfma_f32_32x32x16_bf16 v[72:87], a[16:19], a[40:43], v[72:87]
 ds_read_b64_tr_b16 a[8:9], v244 offset:18432
 ds_read_b64_tr_b16 a[10:11], v244 offset:18944
 v_cvt_pk_bf16_f32 v226, v44, v45
 v_mfma_f32_32x32x16_bf16 v[88:103], a[20:23], a[40:43], v[88:103]
 ds_read_b64_tr_b16 a[12:13], v245 offset:18432
 ds_read_b64_tr_b16 a[14:15], v245 offset:18944
 buffer_load_dwordx4 v7, s[12:15], s62 offen offset:1280  lds
 v_cvt_pk_bf16_f32 v227, v46, v47
 v_mfma_f32_32x32x16_bf16 v[72:87], a[24:27], a[44:47], v[72:87]
 ds_read_b64_tr_b16 a[16:17], v244 offset:20480
 ds_read_b64_tr_b16 a[18:19], v244 offset:20992
 buffer_store_dwordx4 v[224:227], v0, s[16:19], s69 offen offset:0 sc1
 v_mfma_f32_32x32x16_bf16 v[88:103], a[28:31], a[44:47], v[88:103]
 ds_read_b64_tr_b16 a[20:21], v245 offset:20480
 ds_read_b64_tr_b16 a[22:23], v245 offset:20992
 v_cvt_pk_bf16_f32 v228, v48, v49
 s_waitcnt lgkmcnt(4)
 v_mfma_f32_32x32x16_bf16 v[72:87], a[0:3], a[112:115], v[72:87]
 ds_read_b64_tr_b16 a[24:25], v244 offset:22528
 ds_read_b64_tr_b16 a[26:27], v244 offset:23040
 v_mfma_f32_32x32x16_bf16 v[88:103], a[4:7], a[112:115], v[88:103]
 ds_read_b64_tr_b16 a[28:29], v245 offset:22528
 s_add_u32 m0, s64, 65280
 ds_read_b64_tr_b16 a[30:31], v245 offset:23040
 buffer_load_dwordx4 v6, s[12:15], s63 offen offset:256  lds
 v_cvt_pk_bf16_f32 v229, v50, v51
 v_mfma_f32_32x32x16_bf16 v[72:87], a[8:11], a[116:119], v[72:87]
 s_waitcnt vmcnt(23)
 s_barrier
 ds_read_b64_tr_b16 a[0:1], v244 offset:24576
 ds_read_b64_tr_b16 a[2:3], v244 offset:25088
 v_cvt_pk_bf16_f32 v230, v52, v53
 v_mfma_f32_32x32x16_bf16 v[88:103], a[12:15], a[116:119], v[88:103]
 ds_read_b64_tr_b16 a[4:5], v245 offset:24576
 ds_read_b64_tr_b16 a[6:7], v245 offset:25088
 v_cvt_pk_bf16_f32 v231, v54, v55
 s_waitcnt lgkmcnt(4)
 v_mfma_f32_32x32x16_bf16 v[72:87], a[16:19], a[120:123], v[72:87]
 ds_read_b64_tr_b16 a[8:9], v244 offset:26624
 ds_read_b64_tr_b16 a[10:11], v244 offset:27136
 v_mfma_f32_32x32x16_bf16 v[88:103], a[20:23], a[120:123], v[88:103]
 ds_read_b64_tr_b16 a[12:13], v245 offset:26624
 ds_read_b64_tr_b16 a[14:15], v245 offset:27136
 buffer_load_dwordx4 v7, s[12:15], s63 offen offset:1280  lds
 buffer_store_dwordx4 v[228:231], v0, s[16:19], s69 offen offset:1024 sc1
 v_mfma_f32_32x32x16_bf16 v[72:87], a[24:27], a[124:127], v[72:87]
 ds_read_b64_tr_b16 a[16:17], v244 offset:28672
 ds_read_b64_tr_b16 a[18:19], v244 offset:29184
 s_add_u32 s69, s66, 212992
 v_mfma_f32_32x32x16_bf16 v[88:103], a[28:31], a[124:127], v[88:103]
 ds_read_b64_tr_b16 a[20:21], v245 offset:28672
 ds_read_b64_tr_b16 a[22:23], v245 offset:29184
 v_cvt_pk_bf16_f32 v232, v56, v57
 s_waitcnt lgkmcnt(4)
 v_mfma_f32_32x32x16_bf16 v[72:87], a[0:3], a[128:131], v[72:87]
 ds_read_b64_tr_b16 a[24:25], v244 offset:30720
 ds_read_b64_tr_b16 a[26:27], v244 offset:31232
 v_cvt_pk_bf16_f32 v233, v58, v59
 v_mfma_f32_32x32x16_bf16 v[88:103], a[4:7], a[128:131], v[88:103]
 ds_read_b64_tr_b16 a[28:29], v245 offset:30720
 s_add_u32 m0, s64, 73344
 ds_read_b64_tr_b16 a[30:31], v245 offset:31232
 buffer_load_dwordx4 v6, s[12:15], s56 offen offset:384  lds
 v_mfma_f32_32x32x16_bf16 v[72:87], a[8:11], a[132:135], v[72:87]
 ds_read_b64_tr_b16 a[0:1], v244 offset:32768
 ds_read_b64_tr_b16 a[2:3], v244 offset:33280
 v_cvt_pk_bf16_f32 v234, v60, v61
 v_mfma_f32_32x32x16_bf16 v[88:103], a[12:15], a[132:135], v[88:103]
 ds_read_b64_tr_b16 a[4:5], v245 offset:32768
 ds_read_b64_tr_b16 a[6:7], v245 offset:33280
 v_cvt_pk_bf16_f32 v235, v62, v63
 s_waitcnt lgkmcnt(4)
 v_mfma_f32_32x32x16_bf16 v[72:87], a[16:19], a[136:139], v[72:87]
 ds_read_b64_tr_b16 a[8:9], v244 offset:34816
 ds_read_b64_tr_b16 a[10:11], v244 offset:35328
 buffer_store_dwordx4 v[232:235], v0, s[16:19], s69 offen offset:0 sc1
 v_mfma_f32_32x32x16_bf16 v[88:103], a[20:23], a[136:139], v[88:103]
 ds_read_b64_tr_b16 a[12:13], v245 offset:34816
 ds_read_b64_tr_b16 a[14:15], v245 offset:35328
 buffer_load_dwordx4 v7, s[12:15], s56 offen offset:1408  lds
 v_mfma_f32_32x32x16_bf16 v[72:87], a[24:27], a[140:143], v[72:87]
 ds_read_b64_tr_b16 a[16:17], v244 offset:36864
 ds_read_b64_tr_b16 a[18:19], v244 offset:37376
 v_cvt_pk_bf16_f32 v236, v64, v65
 v_mfma_f32_32x32x16_bf16 v[88:103], a[28:31], a[140:143], v[88:103]
 ds_read_b64_tr_b16 a[20:21], v245 offset:36864
 ds_read_b64_tr_b16 a[22:23], v245 offset:37376
 v_cvt_pk_bf16_f32 v237, v66, v67
 s_waitcnt lgkmcnt(4)
 v_mfma_f32_32x32x16_bf16 v[72:87], a[0:3], a[144:147], v[72:87]
 ds_read_b64_tr_b16 a[24:25], v244 offset:38912
 ds_read_b64_tr_b16 a[26:27], v244 offset:39424
 v_cvt_pk_bf16_f32 v238, v68, v69
 v_mfma_f32_32x32x16_bf16 v[88:103], a[4:7], a[144:147], v[88:103]
 ds_read_b64_tr_b16 a[28:29], v245 offset:38912
 s_add_u32 m0, s64, 81536
 ds_read_b64_tr_b16 a[30:31], v245 offset:39424
 buffer_load_dwordx4 v6, s[12:15], s57 offen offset:384  lds
 v_mfma_f32_32x32x16_bf16 v[72:87], a[8:11], a[148:151], v[72:87]
 ds_read_b64_tr_b16 a[0:1], v244 offset:40960
 ds_read_b64_tr_b16 a[2:3], v244 offset:41472
 v_cvt_pk_bf16_f32 v239, v70, v71
 v_mfma_f32_32x32x16_bf16 v[88:103], a[12:15], a[148:151], v[88:103]
 ds_read_b64_tr_b16 a[4:5], v245 offset:40960
 ds_read_b64_tr_b16 a[6:7], v245 offset:41472
 buffer_store_dwordx4 v[236:239], v0, s[16:19], s69 offen offset:1024 sc1
 s_waitcnt lgkmcnt(4)
 v_mfma_f32_32x32x16_bf16 v[72:87], a[16:19], a[152:155], v[72:87]
 ds_read_b64_tr_b16 a[8:9], v244 offset:43008
 ds_read_b64_tr_b16 a[10:11], v244 offset:43520
 s_add_u32 s10, s66, 163840
 v_mfma_f32_32x32x16_bf16 v[88:103], a[20:23], a[152:155], v[88:103]
 ds_read_b64_tr_b16 a[12:13], v245 offset:43008
 ds_read_b64_tr_b16 a[14:15], v245 offset:43520
 buffer_load_dwordx4 v7, s[12:15], s57 offen offset:1408  lds
 v_mfma_f32_32x32x16_bf16 v[72:87], a[24:27], a[156:159], v[72:87]
 ds_read_b64_tr_b16 a[16:17], v244 offset:45056
 ds_read_b64_tr_b16 a[18:19], v244 offset:45568
 v_mfma_f32_32x32x16_bf16 v[88:103], a[28:31], a[156:159], v[88:103]
 ds_read_b64_tr_b16 a[20:21], v245 offset:45056
 ds_read_b64_tr_b16 a[22:23], v245 offset:45568
 s_waitcnt lgkmcnt(4)
 v_mfma_f32_32x32x16_bf16 v[72:87], a[0:3], a[160:163], v[72:87]
 ds_read_b64_tr_b16 a[24:25], v244 offset:47104
 ds_read_b64_tr_b16 a[26:27], v244 offset:47616
 v_mfma_f32_32x32x16_bf16 v[88:103], a[4:7], a[160:163], v[88:103]
 ds_read_b64_tr_b16 a[28:29], v245 offset:47104
 s_add_u32 m0, s64, 89728
 ds_read_b64_tr_b16 a[30:31], v245 offset:47616
 buffer_load_dwordx4 v6, s[12:15], s58 offen offset:384  lds
 v_mfma_f32_32x32x16_bf16 v[72:87], a[8:11], a[164:167], v[72:87]
 s_waitcnt vmcnt(25)
 s_barrier
 ds_read_b64_tr_b16 a[0:1], v240 offset:0
 ds_read_b64_tr_b16 a[2:3], v240 offset:512
 v_mfma_f32_32x32x16_bf16 v[88:103], a[12:15], a[164:167], v[88:103]
 ds_read_b64_tr_b16 a[4:5], v241 offset:0
 ds_read_b64_tr_b16 a[6:7], v241 offset:512
 s_waitcnt lgkmcnt(4)
ST2_12:
 s_cbranch_execz STB2_2
 v_mfma_f32_32x32x16_bf16 v[72:87], a[16:19], a[168:171], v[72:87]
 ds_read_b64_tr_b16 a[8:9], v240 offset:2048
 ds_read_b64_tr_b16 a[10:11], v240 offset:2560
 v_mfma_f32_32x32x16_bf16 v[88:103], a[20:23], a[168:171], v[88:103]
 ds_read_b64_tr_b16 a[12:13], v241 offset:2048
 ds_read_b64_tr_b16 a[14:15], v241 offset:2560
 buffer_load_dwordx4 v7, s[12:15], s58 offen offset:1408  lds
 v_mfma_f32_32x32x16_bf16 v[72:87], a[24:27], a[172:175], v[72:87]
 ds_read_b64_tr_b16 a[16:17], v240 offset:4096
 ds_read_b64_tr_b16 a[18:19], v240 offset:4608
 v_mfma_f32_32x32x16_bf16 v[88:103], a[28:31], a[172:175], v[88:103]
 ds_read_b64_tr_b16 a[20:21], v241 offset:4096
 ds_read_b64_tr_b16 a[22:23], v241 offset:4608
 s_branch L_s9
NS_20:
 s_sub_u32 s71, s71, 1
 s_cbranch_scc1 NS_20_x
 s_sleep 8
 buffer_load_dword v248, off, s[36:39], 0 sc1
 s_waitcnt vmcnt(0)
 s_branch NC_19
NS_20_x:
 s_mov_b32 s71, 0
 s_branch NK_21
NS_23:
 s_sub_u32 s71, s71, 1
 s_cbranch_scc1 NS_23_x
 s_sleep 8
 buffer_load_dword v248, off, s[36:39], 0 sc1
 s_waitcnt vmcnt(0)
 s_branch NC_22
NS_23_x:
 s_mov_b32 s71, 0
 s_branch NK_24
NS_26:
 s_sub_u32 s71, s71, 1
 s_cbranch_scc1 NS_26_x
 s_sleep 8
 buffer_load_dword v248, off, s[36:39], 0 sc1
 s_waitcnt vmcnt(0)
 s_branch NC_25
NS_26_x:
 s_mov_b32 s71, 0
 s_branch NK_27
PS_39:
 s_sub_u32 s71, s71, 1
 s_cbranch_scc1 PS_39_x
 s_sleep 8
 buffer_load_dwordx2 v[4:5], v1, s[16:19], 0 offen sc1
 s_waitcnt vmcnt(0)
 s_branch PC_38
PS_39_x:
 s_mov_b32 s71, 0
 s_branch PK_40
QC_41:
 buffer_load_dwordx2 v[250:251], off, s[16:19], s34 sc1
 s_waitcnt vmcnt(0)
 v_subrev_u32 v251, 2, v251
 v_cmp_ne_u32 vcc, s45, v250
 v_cmp_lt_u32 s[100:101], 60, v251
 s_nop 1
 s_or_b64 vcc, vcc, s[100:101]
 s_cbranch_scc0 QK_42
 s_sub_u32 s71, s71, 1
 s_cbranch_scc1 QC_41_x
 s_sleep 8
 s_branch QC_41
QC_41_x:
 s_mov_b32 s71, 0
 s_branch QK_42
QC_44:
 buffer_load_dwordx2 v[250:251], off, s[16:19], s34 sc1
 s_waitcnt vmcnt(0)
 v_subrev_u32 v251, 3, v251
 v_cmp_ne_u32 vcc, s45, v250
 v_cmp_lt_u32 s[100:101], 60, v251
 s_nop 1
 s_or_b64 vcc, vcc, s[100:101]
 s_cbranch_scc0 QK_45
 s_sub_u32 s71, s71, 1
 s_cbranch_scc1 QC_44_x
 s_sleep 8
 s_branch QC_44
QC_44_x:
 s_mov_b32 s71, 0
 s_branch QK_45
QC_49:
 buffer_load_dwordx2 v[250:251], off, s[16:19], s34 sc1
 s_waitcnt vmcnt(0)
 v_subrev_u32 v251, 3, v251
 v_cmp_ne_u32 vcc, s45, v250
 v_cmp_lt_u32 s[100:101], 60, v251
 s_nop 1
 s_or_b64 vcc, vcc, s[100:101]
 s_cbranch_scc0 QK_50
 s_sub_u32 s71, s71, 1
 s_cbranch_scc1 QC_49_x
 s_sleep 8
 s_branch QC_49
QC_49_x:
 s_mov_b32 s71, 0
 s_branch QK_50
QC_51:
 buffer_load_dwordx2 v[250:251], off, s[16:19], s34 sc1
 s_waitcnt vmcnt(0)
 v_subrev_u32 v251, 4, v251
 v_cmp_ne_u32 vcc, s45, v250
 v_cmp_lt_u32 s[100:101], 60, v251
 s_nop 1
 s_or_b64 vcc, vcc, s[100:101]
 s_cbranch_scc0 QK_52
 s_sub_u32 s71, s71, 1
 s_cbranch_scc1 QC_51_x
 s_sleep 8
 s_branch QC_51
QC_51_x:
 s_mov_b32 s71, 0
 s_branch QK_52
QC_53:
 buffer_load_dwordx2 v[250:251], off, s[16:19], s34 sc1
 s_waitcnt vmcnt(0)
 v_subrev_u32 v251, 4, v251
 v_cmp_ne_u32 vcc, s45, v250
 v_cmp_lt_u32 s[100:101], 60, v251
 s_nop 1
 s_or_b64 vcc, vcc, s[100:101]
 s_cbranch_scc0 QK_54
 s_sub_u32 s71, s71, 1
 s_cbranch_scc1 QC_53_x
 s_sleep 8
 s_branch QC_53
QC_53_x:
 s_mov_b32 s71, 0
 s_branch QK_54
QC_55:
 buffer_load_dwordx2 v[250:251], off, s[16:19], s34 sc1
 s_waitcnt vmcnt(0)
 v_subrev_u32 v251, 5, v251
 v_cmp_ne_u32 vcc, s45, v250
 v_cmp_lt_u32 s[100:101], 60, v251
 s_nop 1
 s_or_b64 vcc, vcc, s[100:101]
 s_cbranch_scc0 QK_56
 s_sub_u32 s71, s71, 1
 s_cbranch_scc1 QC_55_x
 s_sleep 8
 s_branch QC_55
QC_55_x:
 s_mov_b32 s71, 0
 s_branch QK_56
QC_65:
 buffer_load_dwordx2 v[250:251], off, s[16:19], s34 sc1
 s_waitcnt vmcnt(0)
 v_subrev_u32 v251, 1, v251
 v_cmp_ne_u32 vcc, s45, v250
 v_cmp_lt_u32 s[100:101], 60, v251
 s_nop 1
 s_or_b64 vcc, vcc, s[100:101]
 s_cbranch_scc0 QK_66
 s_sub_u32 s71, s71, 1
 s_cbranch_scc1 QC_65_x
 s_sleep 8
 s_branch QC_65
QC_65_x:
 s_mov_b32 s71, 0
 s_branch QK_66
QC_67:
 buffer_load_dwordx2 v[250:251], off, s[16:19], s34 sc1
 s_waitcnt vmcnt(0)
 v_subrev_u32 v251, 2, v251
 v_cmp_ne_u32 vcc, s45, v250
 v_cmp_lt_u32 s[100:101], 60, v251
 s_nop 1
 s_or_b64 vcc, vcc, s[100:101]
 s_cbranch_scc0 QK_68
 s_sub_u32 s71, s71, 1
 s_cbranch_scc1 QC_67_x
 s_sleep 8
 s_branch QC_67
QC_67_x:
 s_mov_b32 s71, 0
 s_branch QK_68
QC_69:
 buffer_load_dwordx2 v[250:251], off, s[16:19], s34 sc1
 s_waitcnt vmcnt(0)
 v_subrev_u32 v251, 3, v251
 v_cmp_ne_u32 vcc, s45, v250
 v_cmp_lt_u32 s[100:101], 60, v251
 s_nop 1
 s_or_b64 vcc, vcc, s[100:101]
 s_cbranch_scc0 QK_70
 s_sub_u32 s71, s71, 1
 s_cbranch_scc1 QC_69_x
 s_sleep 8
 s_branch QC_69
QC_69_x:
 s_mov_b32 s71, 0
 s_branch QK_70
QC_71:
 buffer_load_dwordx2 v[250:251], off, s[16:19], s34 sc1
 s_waitcnt vmcnt(0)
 v_subrev_u32 v251, 4, v251
 v_cmp_ne_u32 vcc, s45, v250
 v_cmp_lt_u32 s[100:101], 60, v251
 s_nop 1
 s_or_b64 vcc, vcc, s[100:101]
 s_cbranch_scc0 QK_72
 s_sub_u32 s71, s71, 1
 s_cbranch_scc1 QC_71_x
 s_sleep 8
 s_branch QC_71
QC_71_x:
 s_mov_b32 s71, 0
 s_branch QK_72
SS_74:
 s_sub_u32 s71, s71, 1
 s_cbranch_scc1 SS_74_x
 s_sleep 2
 s_add_u32 s3, s33, 32768
 v_and_b32 v217, 3, v2
 v_lshlrev_b32 v217, 10, v217
 buffer_load_dword v216, v217, s[16:19], s3 offen offset:1020 sc1
 s_waitcnt vmcnt(0)
 v_cmp_eq_u32 vcc, -1, v216
 s_nop 1
 s_cmp_lg_u64 vcc, 0
 s_cbranch_scc1 SS_74
 s_add_u32 s3, s33, 32768
 buffer_load_dwordx4 a[160:163], v0, s[16:19], s3 offen offset:0 sc1
 s_add_u32 s3, s33, 32768
 buffer_load_dwordx4 a[164:167], v0, s[16:19], s3 offen offset:1024 sc1
 s_add_u32 s3, s33, 32768
 buffer_load_dwordx4 a[168:171], v0, s[16:19], s3 offen offset:2048 sc1
 s_add_u32 s3, s33, 32768
 buffer_load_dwordx4 a[172:175], v0, s[16:19], s3 offen offset:3072 sc1
 s_waitcnt vmcnt(0)
 s_branch SC_73
SS_74_x:
 s_mov_b32 s71, 0
 s_branch SK_75
PS_79:
 s_sub_u32 s71, s71, 1
 s_cbranch_scc1 PS_79_x
 s_sleep 8
 buffer_load_dwordx2 v[200:201], v204, s[16:19], 0 offen sc1
 s_waitcnt vmcnt(0)
 s_branch PC_78
PS_79_x:
 s_mov_b32 s71, 0
 s_branch PK_80
PS_82:
 s_sub_u32 s71, s71, 1
 s_cbranch_scc1 PS_82_x
 s_sleep 8
 buffer_load_dwordx2 v[202:203], v205, s[16:19], 0 offen sc1
 s_waitcnt vmcnt(0)
 s_branch PC_81
PS_82_x:
 s_mov_b32 s71, 0
 s_branch PK_83
EC_8100:
 buffer_load_dword v250, v4, s[16:19], s49 offen sc1
 s_waitcnt vmcnt(0)
 v_subrev_u32 v250, s47, v250
 v_cmp_lt_u32 vcc, 8, v250
 s_nop 1
 s_cmp_lg_u64 vcc, 0
 s_cbranch_scc0 EK_8101
 s_sub_u32 s71, s71, 1
 s_cbranch_scc1 EC_8100_x
 s_sleep 8
 s_branch EC_8100
EC_8100_x:
 s_mov_b32 s71, 0
 s_branch EK_8101
EC_8114:
 buffer_load_dword v250, v4, s[16:19], s49 offen sc1
 s_waitcnt vmcnt(0)
 v_subrev_u32 v250, s47, v250
 v_cmp_lt_u32 vcc, 8, v250
 s_nop 1
 s_cmp_lg_u64 vcc, 0
 s_cbranch_scc0 EK_8115
 s_sub_u32 s71, s71, 1
 s_cbranch_scc1 EC_8114_x
 s_sleep 8
 s_branch EC_8114
EC_8114_x:
 s_mov_b32 s71, 0
 s_branch EK_8115
EC_135:
 buffer_load_dword v250, v4, s[16:19], s48 offen sc1
 s_waitcnt vmcnt(0)
 v_subrev_u32 v250, s46, v250
 v_cmp_lt_u32 vcc, 8, v250
 s_nop 1
 s_cmp_lg_u64 vcc, 0
 s_cbranch_scc0 EK_136
 s_sub_u32 s71, s71, 1
 s_cbranch_scc1 EC_135_x
 s_sleep 2
 s_branch EC_135
EC_135_x:
 s_mov_b32 s71, 0
 s_branch EK_136
L_codeend:
.section .rodata,"a"
.p2align 6
.amdhsa_kernel recurrent_scan__spectral_gfnet__dense_activation_gelu__prompt_kernel
  .amdhsa_next_free_vgpr 512
  .amdhsa_next_free_sgpr 102
  .amdhsa_accum_offset 256
  .amdhsa_group_segment_fixed_size 0
  .amdhsa_kernarg_size 88
  .amdhsa_user_sgpr_count 2
  .amdhsa_user_sgpr_kernarg_segment_ptr 1
  .amdhsa_system_sgpr_workgroup_id_x 1
  .amdhsa_float_denorm_mode_32 3
.end_amdhsa_kernel
.set .Lc0, 16256
.set .Lc1, 16256
.set .Lc2, 16256
.set .Lc3, 16256
.set .Lc4, 16256
.set .Lc5, 16256
.set .Lc6, 16255
.set .Lc7, 16255
.set .Lc8, 16255
.set .Lc9, 16255
.set .Lc10, 16254
.set .Lc11, 16254
.set .Lc12, 16254
.set .Lc13, 16253
.set .Lc14, 16253
.set .Lc15, 16253
.set .Lc16, 16252
.set .Lc17, 16252
.set .Lc18, 16251
.set .Lc19, 16251
.set .Lc20, 16250
.set .Lc21, 16249
.set .Lc22, 16249
.set .Lc23, 16248
.set .Lc24, 16247
.set .Lc25, 16247
.set .Lc26, 16246
.set .Lc27, 16245
.set .Lc28, 16244
.set .Lc29, 16243
.set .Lc30, 16242
.set .Lc31, 16242
.set .Lc32, 16241
.set .Lc33, 16240
.set .Lc34, 16239
.set .Lc35, 16238
.set .Lc36, 16237
.set .Lc37, 16235
.set .Lc38, 16234
.set .Lc39, 16233
.set .Lc40, 16232
.set .Lc41, 16231
.set .Lc42, 16230
.set .Lc43, 16228
.set .Lc44, 16227
.set .Lc45, 16226
.set .Lc46, 16224
.set .Lc47, 16223
.set .Lc48, 16222
.set .Lc49, 16220
.set .Lc50, 16219
.set .Lc51, 16217
.set .Lc52, 16216
.set .Lc53, 16214
.set .Lc54, 16213
.set .Lc55, 16211
.set .Lc56, 16210
.set .Lc57, 16208
.set .Lc58, 16206
.set .Lc59, 16205
.set .Lc60, 16203
.set .Lc61, 16201
.set .Lc62, 16200
.set .Lc63, 16198
.set .Lc64, 16196
.set .Lc65, 16194
.set .Lc66, 16192
.set .Lc67, 16191
.set .Lc68, 16189
.set .Lc69, 16187
.set .Lc70, 16185
.set .Lc71, 16183
.set .Lc72, 16181
.set .Lc73, 16179
.set .Lc74, 16177
.set .Lc75, 16175
.set .Lc76, 16173
.set .Lc77, 16171
.set .Lc78, 16169
.set .Lc79, 16167
.set .Lc80, 16165
.set .Lc81, 16162
.set .Lc82, 16160
.set .Lc83, 16158
.set .Lc84, 16156
.set .Lc85, 16154
.set .Lc86, 16151
.set .Lc87, 16149
.set .Lc88, 16147
.set .Lc89, 16145
.set .Lc90, 16142
.set .Lc91, 16140
.set .Lc92, 16138
.set .Lc93, 16135
.set .Lc94, 16133
.set .Lc95, 16130
.set .Lc96, 16128
.set .Lc97, 16123
.set .Lc98, 16118
.set .Lc99, 16113
.set .Lc100, 16108
.set .Lc101, 16103
.set .Lc102, 16098
.set .Lc103, 16093
.set .Lc104, 16088
.set .Lc105, 16083
.set .Lc106, 16078
.set .Lc107, 16073
.set .Lc108, 16068
.set .Lc109, 16063
.set .Lc110, 16058
.set .Lc111, 16052
.set .Lc112, 16047
.set .Lc113, 16042
.set .Lc114, 16037
.set .Lc115, 16031
.set .Lc116, 16026
.set .Lc117, 16021
.set .Lc118, 16015
.set .Lc119, 16010
.set .Lc120, 16005
.set .Lc121, 15998
.set .Lc122, 15987
.set .Lc123, 15977
.set .Lc124, 15966
.set .Lc125, 15955
.set .Lc126, 15944
.set .Lc127, 15933
.set .Lc128, 15922
.set .Lc129, 15911
.set .Lc130, 15900
.set .Lc131, 15889
.set .Lc132, 15878
.set .Lc133, 15861
.set .Lc134, 15839
.set .Lc135, 15817
.set .Lc136, 15794
.set .Lc137, 15772
.set .Lc138, 15750
.set .Lc139, 15711
.set .Lc140, 15667
.set .Lc141, 15622
.set .Lc142, 15539
.set .Lc143, 15411
.set .Lc144, 0
.set .Lc145, 48179
.set .Lc146, 48307
.set .Lc147, 48390
.set .Lc148, 48435
.set .Lc149, 48479
.set .Lc150, 48518
.set .Lc151, 48540
.set .Lc152, 48562
.set .Lc153, 48585
.set .Lc154, 48607
.set .Lc155, 48629
.set .Lc156, 48646
.set .Lc157, 48657
.set .Lc158, 48668
.set .Lc159, 48679
.set .Lc160, 48690
.set .Lc161, 48701
.set .Lc162, 48712
.set .Lc163, 48723
.set .Lc164, 48734
.set .Lc165, 48745
.set .Lc166, 48755
.set .Lc167, 48766
.set .Lc168, 48773
.set .Lc169, 48778
.set .Lc170, 48783
.set .Lc171, 48789
.set .Lc172, 48794
.set .Lc173, 48799
.set .Lc174, 48805
.set .Lc175, 48810
.set .Lc176, 48815
.set .Lc177, 48820
.set .Lc178, 48826
.set .Lc179, 48831
.set .Lc180, 48836
.set .Lc181, 48841
.set .Lc182, 48846
.set .Lc183, 48851
.set .Lc184, 48856
.set .Lc185, 48861
.set .Lc186, 48866
.set .Lc187, 48871
.set .Lc188, 48876
.set .Lc189, 48881
.set .Lc190, 48886
.set .Lc191, 48891
.set .Lc192, 48896
.set .Lc193, 48898
.set .Lc194, 48901
.set .Lc195, 48903
.set .Lc196, 48906
.set .Lc197, 48908
.set .Lc198, 48910
.set .Lc199, 48913
.set .Lc200, 48915
.set .Lc201, 48917
.set .Lc202, 48919
.set .Lc203, 48922
.set .Lc204, 48924
.set .Lc205, 48926
.set .Lc206, 48928
.set .Lc207, 48930
.set .Lc208, 48933
.set .Lc209, 48935
.set .Lc210, 48937
.set .Lc211, 48939
.set .Lc212, 48941
.set .Lc213, 48943
.set .Lc214, 48945
.set .Lc215, 48947
.set .Lc216, 48949
.set .Lc217, 48951
.set .Lc218, 48953
.set .Lc219, 48955
.set .Lc220, 48957
.set .Lc221, 48959
.set .Lc222, 48960
.set .Lc223, 48962
.set .Lc224, 48964
.set .Lc225, 48966
.set .Lc226, 48968
.set .Lc227, 48969
.set .Lc228, 48971
.set .Lc229, 48973
.set .Lc230, 48974
.set .Lc231, 48976
.set .Lc232, 48978
.set .Lc233, 48979
.set .Lc234, 48981
.set .Lc235, 48982
.set .Lc236, 48984
.set .Lc237, 48985
.set .Lc238, 48987
.set .Lc239, 48988
.set .Lc240, 48990
.set .Lc241, 48991
.set .Lc242, 48992
.set .Lc243, 48994
.set .Lc244, 48995
.set .Lc245, 48996
.set .Lc246, 48998
.set .Lc247, 48999
.set .Lc248, 49000
.set .Lc249, 49001
.set .Lc250, 49002
.set .Lc251, 49003
.set .Lc252, 49005
.set .Lc253, 49006
.set .Lc254, 49007
.set .Lc255, 49008
.set .Lc256, 49009
.set .Lc257, 49010
.set .Lc258, 49010
.set .Lc259, 49011
.set .Lc260, 49012
.set .Lc261, 49013
.set .Lc262, 49014
.set .Lc263, 49015
.set .Lc264, 49015
.set .Lc265, 49016
.set .Lc266, 49017
.set .Lc267, 49017
.set .Lc268, 49018
.set .Lc269, 49019
.set .Lc270, 49019
.set .Lc271, 49020
.set .Lc272, 49020
.set .Lc273, 49021
.set .Lc274, 49021
.set .Lc275, 49021
.set .Lc276, 49022
.set .Lc277, 49022
.set .Lc278, 49022
.set .Lc279, 49023
.set .Lc280, 49023
.set .Lc281, 49023
.set .Lc282, 49023
.set .Lc283, 49024
.set .Lc284, 49024
.set .Lc285, 49024
.set .Lc286, 49024
.set .Lc287, 49024
.set .Lc288, 49024
.set .Lc289, 49024
.set .Lc290, 49024
.set .Lc291, 49024
.set .Lc292, 49024
.set .Lc293, 49024
.set .Lc294, 49023
.set .Lc295, 49023
.set .Lc296, 49023
.set .Lc297, 49023
.set .Lc298, 49022
.set .Lc299, 49022
.set .Lc300, 49022
.set .Lc301, 49021
.set .Lc302, 49021
.set .Lc303, 49021
.set .Lc304, 49020
.set .Lc305, 49020
.set .Lc306, 49019
.set .Lc307, 49019
.set .Lc308, 49018
.set .Lc309, 49017
.set .Lc310, 49017
.set .Lc311, 49016
.set .Lc312, 49015
.set .Lc313, 49015
.set .Lc314, 49014
.set .Lc315, 49013
.set .Lc316, 49012
.set .Lc317, 49011
.set .Lc318, 49010
.set .Lc319, 49010
.set .Lc320, 49009
.set .Lc321, 49008
.set .Lc322, 49007
.set .Lc323, 49006
.set .Lc324, 49005
.set .Lc325, 49003
.set .Lc326, 49002
.set .Lc327, 49001
.set .Lc328, 49000
.set .Lc329, 48999
.set .Lc330, 48998
.set .Lc331, 48996
.set .Lc332, 48995
.set .Lc333, 48994
.set .Lc334, 48992
.set .Lc335, 48991
.set .Lc336, 48990
.set .Lc337, 48988
.set .Lc338, 48987
.set .Lc339, 48985
.set .Lc340, 48984
.set .Lc341, 48982
.set .Lc342, 48981
.set .Lc343, 48979
.set .Lc344, 48978
.set .Lc345, 48976
.set .Lc346, 48974
.set .Lc347, 48973
.set .Lc348, 48971
.set .Lc349, 48969
.set .Lc350, 48968
.set .Lc351, 48966
.set .Lc352, 48964
.set .Lc353, 48962
.set .Lc354, 48960
.set .Lc355, 48959
.set .Lc356, 48957
.set .Lc357, 48955
.set .Lc358, 48953
.set .Lc359, 48951
.set .Lc360, 48949
.set .Lc361, 48947
.set .Lc362, 48945
.set .Lc363, 48943
.set .Lc364, 48941
.set .Lc365, 48939
.set .Lc366, 48937
.set .Lc367, 48935
.set .Lc368, 48933
.set .Lc369, 48930
.set .Lc370, 48928
.set .Lc371, 48926
.set .Lc372, 48924
.set .Lc373, 48922
.set .Lc374, 48919
.set .Lc375, 48917
.set .Lc376, 48915
.set .Lc377, 48913
.set .Lc378, 48910
.set .Lc379, 48908
.set .Lc380, 48906
.set .Lc381, 48903
.set .Lc382, 48901
.set .Lc383, 48898
.set .Lc384, 48896
.set .Lc385, 48891
.set .Lc386, 48886
.set .Lc387, 48881
.set .Lc388, 48876
.set .Lc389, 48871
.set .Lc390, 48866
.set .Lc391, 48861
.set .Lc392, 48856
.set .Lc393, 48851
.set .Lc394, 48846
.set .Lc395, 48841
.set .Lc396, 48836
.set .Lc397, 48831
.set .Lc398, 48826
.set .Lc399, 48820
.set .Lc400, 48815
.set .Lc401, 48810
.set .Lc402, 48805
.set .Lc403, 48799
.set .Lc404, 48794
.set .Lc405, 48789
.set .Lc406, 48783
.set .Lc407, 48778
.set .Lc408, 48773
.set .Lc409, 48766
.set .Lc410, 48755
.set .Lc411, 48745
.set .Lc412, 48734
.set .Lc413, 48723
.set .Lc414, 48712
.set .Lc415, 48701
.set .Lc416, 48690
.set .Lc417, 48679
.set .Lc418, 48668
.set .Lc419, 48657
.set .Lc420, 48646
.set .Lc421, 48629
.set .Lc422, 48607
.set .Lc423, 48585
.set .Lc424, 48562
.set .Lc425, 48540
.set .Lc426, 48518
.set .Lc427, 48479
.set .Lc428, 48435
.set .Lc429, 48390
.set .Lc430, 48307
.set .Lc431, 48179
.set .Lc432, 0
.set .Lc433, 15411
.set .Lc434, 15539
.set .Lc435, 15622
.set .Lc436, 15667
.set .Lc437, 15711
.set .Lc438, 15750
.set .Lc439, 15772
.set .Lc440, 15794
.set .Lc441, 15817
.set .Lc442, 15839
.set .Lc443, 15861
.set .Lc444, 15878
.set .Lc445, 15889
.set .Lc446, 15900
.set .Lc447, 15911
.set .Lc448, 15922
.set .Lc449, 15933
.set .Lc450, 15944
.set .Lc451, 15955
.set .Lc452, 15966
.set .Lc453, 15977
.set .Lc454, 15987
.set .Lc455, 15998
.set .Lc456, 16005
.set .Lc457, 16010
.set .Lc458, 16015
.set .Lc459, 16021
.set .Lc460, 16026
.set .Lc461, 16031
.set .Lc462, 16037
.set .Lc463, 16042
.set .Lc464, 16047
.set .Lc465, 16052
.set .Lc466, 16058
.set .Lc467, 16063
.set .Lc468, 16068
.set .Lc469, 16073
.set .Lc470, 16078
.set .Lc471, 16083
.set .Lc472, 16088
.set .Lc473, 16093
.set .Lc474, 16098
.set .Lc475, 16103
.set .Lc476, 16108
.set .Lc477, 16113
.set .Lc478, 16118
.set .Lc479, 16123
.set .Lc480, 16128
.set .Lc481, 16130
.set .Lc482, 16133
.set .Lc483, 16135
.set .Lc484, 16138
.set .Lc485, 16140
.set .Lc486, 16142
.set .Lc487, 16145
.set .Lc488, 16147
.set .Lc489, 16149
.set .Lc490, 16151
.set .Lc491, 16154
.set .Lc492, 16156
.set .Lc493, 16158
.set .Lc494, 16160
.set .Lc495, 16162
.set .Lc496, 16165
.set .Lc497, 16167
.set .Lc498, 16169
.set .Lc499, 16171
.set .Lc500, 16173
.set .Lc501, 16175
.set .Lc502, 16177
.set .Lc503, 16179
.set .Lc504, 16181
.set .Lc505, 16183
.set .Lc506, 16185
.set .Lc507, 16187
.set .Lc508, 16189
.set .Lc509, 16191
.set .Lc510, 16192
.set .Lc511, 16194
.set .Lc512, 16196
.set .Lc513, 16198
.set .Lc514, 16200
.set .Lc515, 16201
.set .Lc516, 16203
.set .Lc517, 16205
.set .Lc518, 16206
.set .Lc519, 16208
.set .Lc520, 16210
.set .Lc521, 16211
.set .Lc522, 16213
.set .Lc523, 16214
.set .Lc524, 16216
.set .Lc525, 16217
.set .Lc526, 16219
.set .Lc527, 16220
.set .Lc528, 16222
.set .Lc529, 16223
.set .Lc530, 16224
.set .Lc531, 16226
.set .Lc532, 16227
.set .Lc533, 16228
.set .Lc534, 16230
.set .Lc535, 16231
.set .Lc536, 16232
.set .Lc537, 16233
.set .Lc538, 16234
.set .Lc539, 16235
.set .Lc540, 16237
.set .Lc541, 16238
.set .Lc542, 16239
.set .Lc543, 16240
.set .Lc544, 16241
.set .Lc545, 16242
.set .Lc546, 16242
.set .Lc547, 16243
.set .Lc548, 16244
.set .Lc549, 16245
.set .Lc550, 16246
.set .Lc551, 16247
.set .Lc552, 16247
.set .Lc553, 16248
.set .Lc554, 16249
.set .Lc555, 16249
.set .Lc556, 16250
.set .Lc557, 16251
.set .Lc558, 16251
.set .Lc559, 16252
.set .Lc560, 16252
.set .Lc561, 16253
.set .Lc562, 16253
.set .Lc563, 16253
.set .Lc564, 16254
.set .Lc565, 16254
.set .Lc566, 16254
.set .Lc567, 16255
.set .Lc568, 16255
.set .Lc569, 16255
.set .Lc570, 16255
.set .Lc571, 16256
.set .Lc572, 16256
.set .Lc573, 16256
.set .Lc574, 16256
.set .Lc575, 16256
.altmacro
.macro put8 q0,q1,q2,q3,q4,q5,q6,q7
.short .Lc\q0,.Lc\q1,.Lc\q2,.Lc\q3,.Lc\q4,.Lc\q5,.Lc\q6,.Lc\q7
.endm
.p2align 12
.type tabF,@object
tabF:
.set .Lj, 0
.rept 5
 .set .Lks, 0
 .rept 36
  .set .Lph, 0
  .rept 2
   .set .Ll, 0
   .rept 64
    .set .Lk, 32*.Lj + 1 + 16*((.Ll>>2)&1) + 4*((.Ll>>3)&3) + (.Ll&3)
    .set .Lp, (32*(.Lks>>1) + (.Lks&1) + 8*(.Ll >> 5))*.Lk + .Lph
    .if .Lk == 160
     .set .Lz, (0x3f00 + 0x8000*(.Lks&1)) * (1 - .Lph/144)
     .short .Lz,.Lz,.Lz,.Lz,.Lz,.Lz,.Lz,.Lz
    .else
     put8 %((.Lp)%576),%((.Lp+2*.Lk)%576),%((.Lp+4*.Lk)%576),%((.Lp+6*.Lk)%576),%((.Lp+16*.Lk)%576),%((.Lp+18*.Lk)%576),%((.Lp+20*.Lk)%576),%((.Lp+22*.Lk)%576)
    .endif
    .set .Ll, .Ll+1
   .endr
   .set .Lph, .Lph+144
  .endr
  .set .Lks, .Lks+1
 .endr
 .set .Lj, .Lj+1
.endr
.size tabF, .-tabF
.type tabG,@object
tabG:
.set .Ltr, 0
.rept 3
.set .Lj, 0
.rept 9
 .set .Lcc, 0
 .rept 3
  .set .Lt, 0
  .rept 2
   .set .Lph, 0
   .rept 2
    .set .Ll, 0
    .rept 64
     .set .Ln, 32*.Ltr + 96*.Lcc + (.Ll&31)
     .set .Lk, 32*.Lj + 16*(.Ll>>5) + .Lt + 1 - (.Lj/5)
     .set .Lp, .Ln*.Lk + .Lph
     .set .Lz, .Lp+14*.Ln
     .if .Lk == 146
      .set .Lz, .Ln*288 + .Lph
     .endif
     put8 %((.Lp)%576),%((.Lp+2*.Ln)%576),%((.Lp+8*.Ln)%576),%((.Lp+10*.Ln)%576),%((.Lp+4*.Ln)%576),%((.Lp+6*.Ln)%576),%((.Lp+12*.Ln)%576),%((.Lz)%576)
     .set .Ll, .Ll+1
    .endr
    .set .Lph, .Lph+144
   .endr
   .set .Lt, .Lt+1
  .endr
  .set .Lcc, .Lcc+1
 .endr
 .set .Lj, .Lj+1
.endr
.set .Ltr, .Ltr+1
.endr
.size tabG, .-tabG
.type tab64,@object
tab64:
.irp ph,0,432,144
 .set .Lcc, 0
 .rept 2
  .set .Lks, 0
  .rept 4
   .set .Ll, 0
   .rept 64
    .set .Ln, 9*(32*.Lcc + (.Ll&31))
    .set .Lp, .Ln*(16*.Lks + 4*(.Ll>>5)) + \ph
    put8 %((.Lp)%576),%((.Lp+.Ln)%576),%((.Lp+2*.Ln)%576),%((.Lp+3*.Ln)%576),%((.Lp+8*.Ln)%576),%((.Lp+9*.Ln)%576),%((.Lp+10*.Ln)%576),%((.Lp+11*.Ln)%576)
    .set .Ll, .Ll+1
   .endr
   .set .Lks, .Lks+1
  .endr
  .set .Lcc, .Lcc+1
 .endr
.endr
.size tab64, .-tab64
.noaltmacro
```
